```python
import torch

def _softmax(x, axis=-1):
    return torch.softmax(x, dim=axis)
def _gelu(x):
    return torch.nn.functional.gelu(x, approximate="tanh")
def _silu(x):
    return torch.nn.functional.silu(x)
def _sigmoid(x):
    return torch.sigmoid(x)
def _layernorm(x, axis=-1, eps=1e-5):
    m = x.mean(dim=axis, keepdim=True)
    v = x.var(dim=axis, keepdim=True, unbiased=False)
    return (x - m) / torch.sqrt(v + eps)
def _scatter_add(tgt, idx, src, axis=0):
    return tgt.clone().index_add_(axis, idx, src)
def _segment_sum(src, seg, n):
    out = torch.zeros((n,) + src.shape[1:], dtype=src.dtype)
    return out.index_add_(0, seg, src)
def _pad(x, pw):
    flat = tuple(v for pair in reversed(pw) for v in pair)
    return torch.nn.functional.pad(x, flat)

kernel_name = 'recurrent_scan__mha_block_cached__mixer_s_mlp__prompt'

def setup_inputs():

    _w = (lambda a: (lambda t: t.to(torch.bfloat16) if t.is_floating_point() else t)(torch.as_tensor(a)))
    def _A_setup():
        B, Sq, D = 1, 2048, 576
        H, Sk, Dh = 32, 2048, 128
        return {
            "x": _w((lambda *s: torch.randn(*s, dtype=torch.bfloat16) * 0.05)(B, Sq, D)),
            "k_cache": _w((lambda *s: torch.randn(*s, dtype=torch.bfloat16) * 0.8)(B, H, Sk, Dh)),
            "v_cache": _w((lambda *s: torch.randn(*s, dtype=torch.bfloat16) * 0.8)(B, H, Sk, Dh)),
            "wq": _w((lambda *s: torch.randn(*s, dtype=torch.bfloat16) * 0.8)(D, H * Dh) * (D ** -0.5)),
            "wo": _w((lambda *s: torch.randn(*s, dtype=torch.bfloat16) * 0.8)(H * Dh, D) * ((H * Dh) ** -0.5)),
        }
    _A_in = _A_setup()

    def _B_setup():
        B, S, D, F = 1, 2048, 576, 4608
        return {
            "x":  _w((lambda *s: torch.randn(*s, dtype=torch.bfloat16) * 0.05)(B, S, D)),
            "w1": _w((lambda *s: torch.randn(*s, dtype=torch.bfloat16) * 3.2)(D, D) * (D ** -0.5)),
            "w2": _w((lambda *s: torch.randn(*s, dtype=torch.bfloat16) * 3.2)(D, D) * (D ** -0.5)),
            "w3": _w((lambda *s: torch.randn(*s, dtype=torch.bfloat16) * 3.2)(D, F) * (D ** -0.5)),
            "w4": _w((lambda *s: torch.randn(*s, dtype=torch.bfloat16) * 3.2)(F, D) * (F ** -0.5)),
        }
    _B_in = _B_setup()

    return {
        "A_x": _A_in["x"],
        "A_k_cache": _A_in["k_cache"],
        "A_v_cache": _A_in["v_cache"],
        "A_wq": _A_in["wq"],
        "A_wo": _A_in["wo"],
        "B_x": _B_in["x"],
        "B_w1": _B_in["w1"],
        "B_w2": _B_in["w2"],
        "B_w3": _B_in["w3"],
        "B_w4": _B_in["w4"],
    }

def reference(A_x, A_k_cache, A_v_cache, A_wq, A_wo, B_x, B_w1, B_w2, B_w3, B_w4):
    def _A_ref(x, k_cache, v_cache, wq, wo):
        B, Sq, D = x.shape
        H, Dh = 32, 128
        q = (lambda x, *d: x.permute(*d))((x @ wq).reshape(B, Sq, H, Dh), 0, 2, 1, 3)
        scores = torch.einsum("bhqd,bhkd->bhqk", q, k_cache) * (Dh ** -0.5)
        p = _softmax(scores, axis=-1)
        o = torch.einsum("bhqk,bhkd->bhqd", p, v_cache)
        return (lambda x, *d: x.permute(*d))(o, 0, 2, 1, 3).reshape(B, Sq, H * Dh) @ wo

    def _B_ref(x, w1, w2, w3, w4):
        B, S, D = x.shape
        h = _gelu(_layernorm(x, axis=-1) @ w1)
        c = D // 4
        g0 = _pad(h[:, :, 0*c:1*c], ((0, 0), (1, 0), (0, 0)))[:, :S, :]
        g1 = _pad(h[:, :, 1*c:2*c], ((0, 0), (0, 1), (0, 0)))[:, 1:, :]
        g2 = _pad(h[:, :, 2*c:3*c], ((0, 0), (2, 0), (0, 0)))[:, :S, :]
        g3 = _pad(h[:, :, 3*c:   ], ((0, 0), (0, 2), (0, 0)))[:, 2:, :]
        hs = torch.concatenate([g0, g1, g2, g3], axis=-1) @ w2
        x1 = x + hs
        h2 = _gelu(_layernorm(x1, axis=-1) @ w3) @ w4
        return x1 + h2

    x = A_x
    xn = _layernorm(x, axis=-1)
    s = _A_ref(xn, A_k_cache, A_v_cache, A_wq, A_wo)
    g = _silu(_B_ref(xn, B_w1, B_w2, B_w3, B_w4))
    return x + s * g
```

```asm
; @launch grid=(256,1,1) block=(256,1,1) lds=163840
.amdgcn_target "amdgcn-amd-amdhsa--gfx950"
.text
.globl recurrent_scan__mha_block_cached__mixer_s_mlp__prompt_kernel
.p2align 8
.type recurrent_scan__mha_block_cached__mixer_s_mlp__prompt_kernel,@function
recurrent_scan__mha_block_cached__mixer_s_mlp__prompt_kernel:
s_cmp_ge_u32 s2, 256
s_cbranch_scc1 L_exit
s_load_dwordx16 s[64:79], s[0:1], 0
s_load_dwordx8 s[80:87], s[0:1], 64
s_load_dwordx2 s[88:89], s[0:1], 96
s_getpc_b64 s[12:13]
L_pc0:
s_sub_u32 s12, s12, L_pc0-recurrent_scan__mha_block_cached__mixer_s_mlp__prompt_kernel
s_subb_u32 s13, s13, 0
s_mov_b32 s14, L_code_end-recurrent_scan__mha_block_cached__mixer_s_mlp__prompt_kernel
s_mov_b32 s15, 0x00020000
s_lshr_b32 s34, s2, 3
s_lshl_b32 s33, s34, 12
v_lshlrev_b32 v2, 4, v0
buffer_load_dwordx4 v[252:255], v2, s[12:15], s33 offen
v_lshrrev_b32 v1, 6, v0
v_and_b32 v0, 63, v0
s_and_b32 s33, s2, 7
v_readfirstlane_b32 s24, v1
s_lshl_b32 s48, s33, 3
s_lshr_b32 s35, s34, 2
s_add_u32 s48, s48, s35
v_lshrrev_b32 v12, 3, v0
v_mul_u32_u24 v14, 1152, v12
v_and_b32 v13, 7, v0
v_lshl_add_u32 v48, v13, 4, v14
s_lshl_b32 s26, s48, 2
s_add_u32 s26, s26, s24
s_mul_i32 s26, s26, 9216
s_mov_b32 s10, 0x240000
s_mov_b32 s11, 0x00020000
s_waitcnt lgkmcnt(0)
s_mov_b32 s8, s64
s_mov_b32 s9, s65
buffer_load_dwordx4 v[208:211], v48, s[8:11], s26 offen offset:0
buffer_load_dwordx4 v[212:215], v48, s[8:11], s26 offen offset:128
buffer_load_dwordx4 v[216:219], v48, s[8:11], s26 offen offset:256
buffer_load_dwordx4 v[220:223], v48, s[8:11], s26 offen offset:384
buffer_load_dwordx4 v[224:227], v48, s[8:11], s26 offen offset:512
buffer_load_dwordx4 v[228:231], v48, s[8:11], s26 offen offset:640
buffer_load_dwordx4 v[232:235], v48, s[8:11], s26 offen offset:768
buffer_load_dwordx4 v[236:239], v48, s[8:11], s26 offen offset:896
buffer_load_dwordx4 v[240:243], v48, s[8:11], s26 offen offset:1024
s_lshl_b32 s0, s34, 2
s_add_u32 s0, s0, s24
s_mul_i32 s35, s0, 5184
s_mov_b32 s16, s76
s_mov_b32 s17, s77
s_mov_b32 s18, 0xa2000
s_mov_b32 s19, 0x00020000
v_lshlrev_b32 v21, 7, v0
buffer_load_dword v10, v21, s[16:19], s35 offen
s_lshl_b32 s31, s33, 2
s_lshr_b32 s35, s34, 3
s_add_u32 s31, s31, s35
s_and_b32 s32, s34, 7
s_and_b32 s49, s34, 3
s_and_b32 s50, s33, 1
s_lshl_b32 s50, s50, 2
s_add_u32 s50, s50, s35
s_lshr_b32 s51, s33, 1
s_lshl_b32 s51, s51, 3
s_add_u32 s51, s51, s32
s_lshr_b32 s52, s33, 2
s_lshl_b32 s52, s52, 3
s_lshr_b32 s35, s34, 2
s_add_u32 s52, s52, s35
s_and_b32 s54, s33, 3
s_mul_i32 s30, s24, 9216
s_lshl_b32 s55, s24, 12
s_mul_i32 s33, s49, 288
s_cmp_ge_u32 s24, 2
s_cselect_b32 s34, 5, 0
s_mul_i32 s60, s49, 9
s_add_u32 s60, s60, s34
s_and_b32 s61, s24, 1
s_mul_i32 s53, s61, 9
s_add_u32 s53, s53, s34
s_lshl_b32 s53, s53, 10
s_lshl_b32 s62, s48, 1
s_add_u32 s62, s62, s61
s_add_u32 s4, s76, s33
s_addc_u32 s5, s77, 0
s_mov_b32 s6, 0x0
s_mov_b32 s7, 0x00020000
s_sub_u32 s6, 663552, s33
s_mov_b32 s90, 238609295
s_mov_b32 s91, 1152
v_add_u32 v12, 0, v0
v_mul_hi_u32 v13, v12, s90
v_mul_u32_u24 v14, 18, v13
v_sub_u32 v14, v12, v14
v_mul_lo_u32 v13, v13, s91
v_lshl_add_u32 v1, v14, 4, v13
v_add_u32 v12, 64, v0
v_mul_hi_u32 v13, v12, s90
v_mul_u32_u24 v14, 18, v13
v_sub_u32 v14, v12, v14
v_mul_lo_u32 v13, v13, s91
v_lshl_add_u32 v2, v14, 4, v13
v_subrev_u32 v2, 1024, v2
v_add_u32 v12, 128, v0
v_mul_hi_u32 v13, v12, s90
v_mul_u32_u24 v14, 18, v13
v_sub_u32 v14, v12, v14
v_mul_lo_u32 v13, v13, s91
v_lshl_add_u32 v3, v14, 4, v13
v_subrev_u32 v3, 2048, v3
v_add_u32 v12, 192, v0
v_mul_hi_u32 v13, v12, s90
v_mul_u32_u24 v14, 18, v13
v_sub_u32 v14, v12, v14
v_mul_lo_u32 v13, v13, s91
v_lshl_add_u32 v4, v14, 4, v13
v_subrev_u32 v4, 3072, v4
v_add_u32 v12, 256, v0
v_mul_hi_u32 v13, v12, s90
v_mul_u32_u24 v14, 18, v13
v_sub_u32 v14, v12, v14
v_mul_lo_u32 v13, v13, s91
v_lshl_add_u32 v5, v14, 4, v13
v_add_u32 v12, 320, v0
v_mul_hi_u32 v13, v12, s90
v_mul_u32_u24 v14, 18, v13
v_sub_u32 v14, v12, v14
v_mul_lo_u32 v13, v13, s91
v_lshl_add_u32 v6, v14, 4, v13
v_subrev_u32 v6, 1024, v6
v_add_u32 v12, 384, v0
v_mul_hi_u32 v13, v12, s90
v_mul_u32_u24 v14, 18, v13
v_sub_u32 v14, v12, v14
v_mul_lo_u32 v13, v13, s91
v_lshl_add_u32 v7, v14, 4, v13
v_subrev_u32 v7, 2048, v7
v_add_u32 v12, 448, v0
v_mul_hi_u32 v13, v12, s90
v_mul_u32_u24 v14, 18, v13
v_sub_u32 v14, v12, v14
v_mul_lo_u32 v13, v13, s91
v_lshl_add_u32 v8, v14, 4, v13
v_subrev_u32 v8, 3072, v8
v_add_u32 v12, 512, v0
v_mul_hi_u32 v13, v12, s90
v_mul_u32_u24 v14, 18, v13
v_sub_u32 v14, v12, v14
v_mul_lo_u32 v13, v13, s91
v_lshl_add_u32 v9, v14, 4, v13
v_lshlrev_b32 v11, 4, v0
s_mul_i32 s25, s24, 36864
s_add_u32 m0, s30, 0
s_add_u32 s3, s25, 0
buffer_load_dwordx4 v1, s[4:7], s3 offen offset:0 lds
s_add_u32 m0, s30, 0
s_add_u32 s3, s25, 0
buffer_load_dwordx4 v2, s[4:7], s3 offen offset:1024 lds
s_add_u32 m0, s30, 0
s_add_u32 s3, s25, 0
buffer_load_dwordx4 v3, s[4:7], s3 offen offset:2048 lds
s_add_u32 m0, s30, 0
s_add_u32 s3, s25, 0
buffer_load_dwordx4 v4, s[4:7], s3 offen offset:3072 lds
s_add_u32 m0, s30, 4096
s_add_u32 s3, s25, 0
buffer_load_dwordx4 v5, s[4:7], s3 offen offset:0 lds
s_add_u32 m0, s30, 4096
s_add_u32 s3, s25, 0
buffer_load_dwordx4 v6, s[4:7], s3 offen offset:1024 lds
s_add_u32 m0, s30, 4096
s_add_u32 s3, s25, 0
buffer_load_dwordx4 v7, s[4:7], s3 offen offset:2048 lds
s_add_u32 m0, s30, 4096
s_add_u32 s3, s25, 0
buffer_load_dwordx4 v8, s[4:7], s3 offen offset:3072 lds
s_add_u32 m0, s30, 8192
s_add_u32 s3, s25, 0
buffer_load_dwordx4 v9, s[4:7], s3 offen offset:0 lds
s_add_u32 m0, s30, 36864
s_add_u32 s3, s25, 147456
buffer_load_dwordx4 v1, s[4:7], s3 offen offset:0 lds
s_add_u32 m0, s30, 36864
s_add_u32 s3, s25, 147456
buffer_load_dwordx4 v2, s[4:7], s3 offen offset:1024 lds
s_add_u32 m0, s30, 36864
s_add_u32 s3, s25, 147456
buffer_load_dwordx4 v3, s[4:7], s3 offen offset:2048 lds
s_add_u32 m0, s30, 36864
s_add_u32 s3, s25, 147456
buffer_load_dwordx4 v4, s[4:7], s3 offen offset:3072 lds
s_add_u32 m0, s30, 40960
s_add_u32 s3, s25, 147456
buffer_load_dwordx4 v5, s[4:7], s3 offen offset:0 lds
s_add_u32 m0, s30, 40960
s_add_u32 s3, s25, 147456
buffer_load_dwordx4 v6, s[4:7], s3 offen offset:1024 lds
s_add_u32 m0, s30, 40960
s_add_u32 s3, s25, 147456
buffer_load_dwordx4 v7, s[4:7], s3 offen offset:2048 lds
s_add_u32 m0, s30, 40960
s_add_u32 s3, s25, 147456
buffer_load_dwordx4 v8, s[4:7], s3 offen offset:3072 lds
s_add_u32 m0, s30, 45056
s_add_u32 s3, s25, 147456
buffer_load_dwordx4 v9, s[4:7], s3 offen offset:0 lds
s_mov_b32 s56, s86
s_mov_b32 s57, s87
s_mov_b32 s58, 0x100
s_mov_b32 s59, 0x00020000
s_add_u32 s12, s88, 0x7800000
s_addc_u32 s13, s89, 0
s_mov_b32 s14, 0x10000
s_mov_b32 s15, 0x00020000
v_lshrrev_b32 v12, 4, v0
v_bfe_u32 v13, v0, 2, 2
v_lshl_add_u32 v12, v12, 3, v13
v_mul_u32_u24 v12, 288, v12
v_and_b32 v13, 3, v0
v_lshl_add_u32 v49, v13, 3, v12
v_lshlrev_b32 v62, 2, v0
v_add_u32 v49, s30, v49
v_add_u32 v50, 64512, v49
s_lshl_b32 s33, s52, 2
s_add_u32 s33, s33, s49
s_lshl_b32 s33, s33, 8
s_or_b32 s34, s24, s54
s_cmp_eq_u32 s34, 0
s_cselect_b32 s33, s33, 0x7fff0000
v_mov_b32 v12, 0
buffer_store_dword v12, v62, s[12:15], s33 offen sc1
v_and_b32 v12, 15, v0
v_mul_u32_u24 v12, 1152, v12
v_lshrrev_b32 v13, 4, v0
v_lshl_add_u32 v63, v13, 3, v12
s_lshl_b32 s33, s24, 3
v_lshrrev_b32 v12, 3, v0
v_add_u32 v12, s33, v12
v_bfe_u32 v13, v12, 1, 3
v_and_b32 v14, 7, v0
v_xor_b32 v13, v13, v14
v_mul_u32_u24 v15, 1152, v12
v_lshl_add_u32 v24, v13, 4, v15
v_add_u32 v24, 110592, v24
v_and_b32 v12, 15, v12
v_and_b32 v13, 3, v0
v_lshl_add_u32 v12, v13, 4, v12
v_lshlrev_b32 v12, 4, v12
s_lshr_b32 s33, s24, 1
s_mul_i32 s33, s33, 5120
s_add_u32 s33, s33, 147456
v_add_u32 v26, s33, v12
v_and_b32 v12, 15, v0
v_lshrrev_b32 v13, 4, v0
s_lshl_b32 s33, s61, 2
v_add_u32 v13, s33, v13
v_lshrrev_b32 v14, 1, v12
v_xor_b32 v13, v13, v14
v_mul_u32_u24 v12, 1152, v12
v_lshl_add_u32 v25, v13, 4, v12
s_lshr_b32 s33, s24, 1
s_lshl_b32 s33, s33, 7
s_add_u32 s33, s33, 110592
v_add_u32 v25, s33, v25
v_lshrrev_b32 v12, 4, v0
v_and_b32 v13, 15, v0
v_xor_b32 v14, v13, v12
v_lshlrev_b32 v14, 4, v14
v_lshl_add_u32 v32, v12, 8, v14
v_xor_b32 v33, 64, v32
v_xor_b32 v34, 0x80, v32
v_xor_b32 v35, 0xc0, v32
v_lshlrev_b32 v14, 1, v12
v_xor_b32 v14, v13, v14
v_lshlrev_b32 v14, 4, v14
v_lshl_add_u32 v36, v12, 8, v14
v_xor_b32 v37, 0x80, v36
v_lshl_add_u32 v38, v12, 13, v14
v_xor_b32 v39, 0x80, v38
v_bfe_u32 v13, v0, 2, 2
v_lshl_add_u32 v14, v12, 3, v13
v_and_b32 v12, 1, v12
v_lshl_add_u32 v12, v12, 2, v13
v_lshlrev_b32 v12, 1, v12
v_and_b32 v13, 3, v0
v_xor_b32 v12, v12, v13
v_lshlrev_b32 v12, 4, v12
v_lshl_add_u32 v40, v14, 8, v12
s_lshl_b32 s33, s32, 4
s_lshl_b32 s34, s24, 2
s_add_u32 s46, s33, s34
s_mul_i32 s27, s46, 18432
s_add_u32 s28, s27, 18432
s_add_u32 s29, s27, 36864
s_add_u32 s45, s27, 55296
s_lshl_b32 s34, s31, 8
s_lshl_b32 s44, s24, 17
s_add_u32 s12, s70, s34
s_addc_u32 s13, s71, 0
s_mov_b32 s14, 0x0
s_mov_b32 s15, 0x00020000
s_sub_u32 s14, 0x480000, s34
s_add_u32 s20, s88, 0x240000
s_addc_u32 s21, s89, 0
s_mov_b32 s22, 0x240000
s_mov_b32 s23, 0x00020000
v_xor_b32 v41, 64, v40
v_xor_b32 v42, 128, v40
v_xor_b32 v43, 192, v40
v_add_u32 v44, 0x10000, v40
v_add_u32 v45, 0x10000, v41
v_add_u32 v46, 0x10000, v42
v_add_u32 v47, 0x10000, v43
s_and_b32 s33, s31, 3
s_lshl_b32 s33, s33, 1
s_add_u32 s33, s33, s32
s_mov_b32 s74, 0
s_mov_b32 s75, 0
s_mov_b32 s1, 0
s_mov_b32 s33, 0
s_add_u32 s34, s33, 0
s_sub_u32 s35, s34, 9
s_cmp_ge_u32 s34, 9
s_cselect_b32 s34, s35, s34
s_sub_u32 s35, s34, 9
s_cmp_ge_u32 s34, 9
s_cselect_b32 s34, s35, s34
s_lshl_b32 s34, s34, 3
s_or_b32 s74, s74, s34
s_add_u32 s34, s33, 1
s_sub_u32 s35, s34, 9
s_cmp_ge_u32 s34, 9
s_cselect_b32 s34, s35, s34
s_sub_u32 s35, s34, 9
s_cmp_ge_u32 s34, 9
s_cselect_b32 s34, s35, s34
s_lshl_b32 s34, s34, 11
s_or_b32 s74, s74, s34
s_add_u32 s34, s33, 2
s_sub_u32 s35, s34, 9
s_cmp_ge_u32 s34, 9
s_cselect_b32 s34, s35, s34
s_sub_u32 s35, s34, 9
s_cmp_ge_u32 s34, 9
s_cselect_b32 s34, s35, s34
s_lshl_b32 s34, s34, 19
s_or_b32 s74, s74, s34
s_add_u32 s34, s33, 3
s_sub_u32 s35, s34, 9
s_cmp_ge_u32 s34, 9
s_cselect_b32 s34, s35, s34
s_sub_u32 s35, s34, 9
s_cmp_ge_u32 s34, 9
s_cselect_b32 s34, s35, s34
s_lshl_b32 s34, s34, 27
s_or_b32 s74, s74, s34
s_add_u32 s34, s33, 4
s_sub_u32 s35, s34, 9
s_cmp_ge_u32 s34, 9
s_cselect_b32 s34, s35, s34
s_sub_u32 s35, s34, 9
s_cmp_ge_u32 s34, 9
s_cselect_b32 s34, s35, s34
s_lshl_b32 s34, s34, 3
s_or_b32 s75, s75, s34
s_add_u32 s34, s33, 5
s_sub_u32 s35, s34, 9
s_cmp_ge_u32 s34, 9
s_cselect_b32 s34, s35, s34
s_sub_u32 s35, s34, 9
s_cmp_ge_u32 s34, 9
s_cselect_b32 s34, s35, s34
s_lshl_b32 s34, s34, 11
s_or_b32 s75, s75, s34
s_add_u32 s34, s33, 6
s_sub_u32 s35, s34, 9
s_cmp_ge_u32 s34, 9
s_cselect_b32 s34, s35, s34
s_sub_u32 s35, s34, 9
s_cmp_ge_u32 s34, 9
s_cselect_b32 s34, s35, s34
s_lshl_b32 s34, s34, 19
s_or_b32 s75, s75, s34
s_add_u32 s34, s33, 7
s_sub_u32 s35, s34, 9
s_cmp_ge_u32 s34, 9
s_cselect_b32 s34, s35, s34
s_sub_u32 s35, s34, 9
s_cmp_ge_u32 s34, 9
s_cselect_b32 s34, s35, s34
s_lshl_b32 s34, s34, 27
s_or_b32 s75, s75, s34
s_add_u32 s34, s33, 8
s_sub_u32 s35, s34, 9
s_cmp_ge_u32 s34, 9
s_cselect_b32 s34, s35, s34
s_sub_u32 s35, s34, 9
s_cmp_ge_u32 s34, 9
s_cselect_b32 s34, s35, s34
s_lshl_b32 s34, s34, 3
s_or_b32 s1, s1, s34
s_waitcnt vmcnt(20)
v_lshlrev_b32 v128, 16, v208
s_add_u32 m0, s30, 73728
s_add_u32 s3, s25, 294912
buffer_load_dwordx4 v1, s[4:7], s3 offen offset:0 lds
v_and_b32 v129, 0xffff0000, v208
v_lshlrev_b32 v130, 16, v209
v_and_b32 v131, 0xffff0000, v209
v_lshlrev_b32 v132, 16, v210
v_and_b32 v133, 0xffff0000, v210
v_lshlrev_b32 v134, 16, v211
v_and_b32 v135, 0xffff0000, v211
v_lshlrev_b32 v136, 16, v212
v_and_b32 v137, 0xffff0000, v212
v_lshlrev_b32 v138, 16, v213
v_and_b32 v139, 0xffff0000, v213
v_lshlrev_b32 v140, 16, v214
v_and_b32 v141, 0xffff0000, v214
v_lshlrev_b32 v142, 16, v215
v_and_b32 v143, 0xffff0000, v215
v_lshlrev_b32 v144, 16, v216
v_and_b32 v145, 0xffff0000, v216
v_lshlrev_b32 v146, 16, v217
s_add_u32 m0, s30, 73728
s_add_u32 s3, s25, 294912
buffer_load_dwordx4 v2, s[4:7], s3 offen offset:1024 lds
v_and_b32 v147, 0xffff0000, v217
v_lshlrev_b32 v148, 16, v218
v_and_b32 v149, 0xffff0000, v218
v_lshlrev_b32 v150, 16, v219
v_and_b32 v151, 0xffff0000, v219
v_lshlrev_b32 v152, 16, v220
v_and_b32 v153, 0xffff0000, v220
v_lshlrev_b32 v154, 16, v221
v_and_b32 v155, 0xffff0000, v221
v_lshlrev_b32 v156, 16, v222
v_and_b32 v157, 0xffff0000, v222
v_lshlrev_b32 v158, 16, v223
v_and_b32 v159, 0xffff0000, v223
v_lshlrev_b32 v160, 16, v224
v_and_b32 v161, 0xffff0000, v224
v_lshlrev_b32 v162, 16, v225
v_and_b32 v163, 0xffff0000, v225
v_lshlrev_b32 v164, 16, v226
s_add_u32 m0, s30, 73728
s_add_u32 s3, s25, 294912
buffer_load_dwordx4 v3, s[4:7], s3 offen offset:2048 lds
v_and_b32 v165, 0xffff0000, v226
v_lshlrev_b32 v166, 16, v227
v_and_b32 v167, 0xffff0000, v227
v_lshlrev_b32 v168, 16, v228
v_and_b32 v169, 0xffff0000, v228
v_lshlrev_b32 v170, 16, v229
v_and_b32 v171, 0xffff0000, v229
v_lshlrev_b32 v172, 16, v230
v_and_b32 v173, 0xffff0000, v230
v_lshlrev_b32 v174, 16, v231
v_and_b32 v175, 0xffff0000, v231
v_lshlrev_b32 v176, 16, v232
v_and_b32 v177, 0xffff0000, v232
v_lshlrev_b32 v178, 16, v233
v_and_b32 v179, 0xffff0000, v233
v_lshlrev_b32 v180, 16, v234
v_and_b32 v181, 0xffff0000, v234
v_lshlrev_b32 v182, 16, v235
s_add_u32 m0, s30, 73728
s_add_u32 s3, s25, 294912
buffer_load_dwordx4 v4, s[4:7], s3 offen offset:3072 lds
v_and_b32 v183, 0xffff0000, v235
v_lshlrev_b32 v184, 16, v236
v_and_b32 v185, 0xffff0000, v236
v_lshlrev_b32 v186, 16, v237
v_and_b32 v187, 0xffff0000, v237
v_lshlrev_b32 v188, 16, v238
v_and_b32 v189, 0xffff0000, v238
v_lshlrev_b32 v190, 16, v239
v_and_b32 v191, 0xffff0000, v239
v_lshlrev_b32 v192, 16, v240
v_and_b32 v193, 0xffff0000, v240
v_lshlrev_b32 v194, 16, v241
v_and_b32 v195, 0xffff0000, v241
v_lshlrev_b32 v196, 16, v242
v_and_b32 v197, 0xffff0000, v242
v_lshlrev_b32 v198, 16, v243
v_and_b32 v199, 0xffff0000, v243
v_pk_add_f32 v[16:17], v[128:129], v[130:131]
s_add_u32 m0, s30, 77824
s_add_u32 s3, s25, 294912
buffer_load_dwordx4 v5, s[4:7], s3 offen offset:0 lds
v_pk_add_f32 v[18:19], v[132:133], v[134:135]
v_pk_add_f32 v[16:17], v[16:17], v[136:137]
v_pk_add_f32 v[18:19], v[18:19], v[138:139]
v_pk_add_f32 v[16:17], v[16:17], v[140:141]
v_pk_add_f32 v[18:19], v[18:19], v[142:143]
v_pk_add_f32 v[16:17], v[16:17], v[144:145]
v_pk_add_f32 v[18:19], v[18:19], v[146:147]
v_pk_add_f32 v[16:17], v[16:17], v[148:149]
v_pk_add_f32 v[18:19], v[18:19], v[150:151]
v_pk_add_f32 v[16:17], v[16:17], v[152:153]
v_pk_add_f32 v[18:19], v[18:19], v[154:155]
v_pk_add_f32 v[16:17], v[16:17], v[156:157]
s_add_u32 m0, s30, 77824
s_add_u32 s3, s25, 294912
buffer_load_dwordx4 v6, s[4:7], s3 offen offset:1024 lds
v_pk_add_f32 v[18:19], v[18:19], v[158:159]
v_pk_add_f32 v[16:17], v[16:17], v[160:161]
v_pk_add_f32 v[18:19], v[18:19], v[162:163]
v_pk_add_f32 v[16:17], v[16:17], v[164:165]
v_pk_add_f32 v[18:19], v[18:19], v[166:167]
v_pk_add_f32 v[16:17], v[16:17], v[168:169]
v_pk_add_f32 v[18:19], v[18:19], v[170:171]
v_pk_add_f32 v[16:17], v[16:17], v[172:173]
v_pk_add_f32 v[18:19], v[18:19], v[174:175]
v_pk_add_f32 v[16:17], v[16:17], v[176:177]
v_pk_add_f32 v[18:19], v[18:19], v[178:179]
v_pk_add_f32 v[16:17], v[16:17], v[180:181]
s_add_u32 m0, s30, 77824
s_add_u32 s3, s25, 294912
buffer_load_dwordx4 v7, s[4:7], s3 offen offset:2048 lds
v_pk_add_f32 v[18:19], v[18:19], v[182:183]
v_pk_add_f32 v[16:17], v[16:17], v[184:185]
v_pk_add_f32 v[18:19], v[18:19], v[186:187]
v_pk_add_f32 v[16:17], v[16:17], v[188:189]
v_pk_add_f32 v[18:19], v[18:19], v[190:191]
v_pk_add_f32 v[16:17], v[16:17], v[192:193]
v_pk_add_f32 v[18:19], v[18:19], v[194:195]
v_pk_add_f32 v[16:17], v[16:17], v[196:197]
v_pk_add_f32 v[18:19], v[18:19], v[198:199]
v_pk_add_f32 v[16:17], v[16:17], v[18:19]
v_add_f32 v16, v16, v17
s_nop 1
v_add_f32_dpp v16, v16, v16 quad_perm:[1,0,3,2] row_mask:0xf bank_mask:0xf
s_add_u32 m0, s30, 77824
s_add_u32 s3, s25, 294912
buffer_load_dwordx4 v8, s[4:7], s3 offen offset:3072 lds
s_nop 1
v_add_f32_dpp v16, v16, v16 quad_perm:[2,3,0,1] row_mask:0xf bank_mask:0xf
s_nop 1
v_add_f32_dpp v16, v16, v16 row_half_mirror row_mask:0xf bank_mask:0xf
s_mov_b32 s47, 0xbae38e39
v_mul_f32 v16, s47, v16
v_pk_add_f32 v[128:129], v[128:129], v[16:17] op_sel_hi:[1,0]
v_pk_add_f32 v[130:131], v[130:131], v[16:17] op_sel_hi:[1,0]
v_pk_add_f32 v[132:133], v[132:133], v[16:17] op_sel_hi:[1,0]
v_pk_add_f32 v[134:135], v[134:135], v[16:17] op_sel_hi:[1,0]
v_pk_add_f32 v[136:137], v[136:137], v[16:17] op_sel_hi:[1,0]
v_pk_add_f32 v[138:139], v[138:139], v[16:17] op_sel_hi:[1,0]
v_pk_add_f32 v[140:141], v[140:141], v[16:17] op_sel_hi:[1,0]
s_add_u32 m0, s30, 81920
s_add_u32 s3, s25, 294912
buffer_load_dwordx4 v9, s[4:7], s3 offen offset:0 lds
v_pk_add_f32 v[142:143], v[142:143], v[16:17] op_sel_hi:[1,0]
v_pk_add_f32 v[144:145], v[144:145], v[16:17] op_sel_hi:[1,0]
v_pk_add_f32 v[146:147], v[146:147], v[16:17] op_sel_hi:[1,0]
v_pk_add_f32 v[148:149], v[148:149], v[16:17] op_sel_hi:[1,0]
v_pk_add_f32 v[150:151], v[150:151], v[16:17] op_sel_hi:[1,0]
v_pk_add_f32 v[152:153], v[152:153], v[16:17] op_sel_hi:[1,0]
v_pk_add_f32 v[154:155], v[154:155], v[16:17] op_sel_hi:[1,0]
v_pk_add_f32 v[156:157], v[156:157], v[16:17] op_sel_hi:[1,0]
v_pk_add_f32 v[158:159], v[158:159], v[16:17] op_sel_hi:[1,0]
v_pk_add_f32 v[160:161], v[160:161], v[16:17] op_sel_hi:[1,0]
v_pk_add_f32 v[162:163], v[162:163], v[16:17] op_sel_hi:[1,0]
v_pk_add_f32 v[164:165], v[164:165], v[16:17] op_sel_hi:[1,0]
v_pk_add_f32 v[166:167], v[166:167], v[16:17] op_sel_hi:[1,0]
v_pk_add_f32 v[168:169], v[168:169], v[16:17] op_sel_hi:[1,0]
v_pk_add_f32 v[170:171], v[170:171], v[16:17] op_sel_hi:[1,0]
v_pk_add_f32 v[172:173], v[172:173], v[16:17] op_sel_hi:[1,0]
v_pk_add_f32 v[174:175], v[174:175], v[16:17] op_sel_hi:[1,0]
v_pk_add_f32 v[176:177], v[176:177], v[16:17] op_sel_hi:[1,0]
v_pk_add_f32 v[178:179], v[178:179], v[16:17] op_sel_hi:[1,0]
v_pk_add_f32 v[180:181], v[180:181], v[16:17] op_sel_hi:[1,0]
v_pk_add_f32 v[182:183], v[182:183], v[16:17] op_sel_hi:[1,0]
v_pk_add_f32 v[184:185], v[184:185], v[16:17] op_sel_hi:[1,0]
v_pk_add_f32 v[186:187], v[186:187], v[16:17] op_sel_hi:[1,0]
v_pk_add_f32 v[188:189], v[188:189], v[16:17] op_sel_hi:[1,0]
v_pk_add_f32 v[190:191], v[190:191], v[16:17] op_sel_hi:[1,0]
v_pk_add_f32 v[192:193], v[192:193], v[16:17] op_sel_hi:[1,0]
v_pk_add_f32 v[194:195], v[194:195], v[16:17] op_sel_hi:[1,0]
v_pk_add_f32 v[196:197], v[196:197], v[16:17] op_sel_hi:[1,0]
v_pk_add_f32 v[198:199], v[198:199], v[16:17] op_sel_hi:[1,0]
v_pk_mul_f32 v[16:17], v[128:129], v[128:129]
v_pk_mul_f32 v[18:19], v[130:131], v[130:131]
v_pk_fma_f32 v[16:17], v[132:133], v[132:133], v[16:17]
v_pk_fma_f32 v[18:19], v[134:135], v[134:135], v[18:19]
v_pk_fma_f32 v[16:17], v[136:137], v[136:137], v[16:17]
v_pk_fma_f32 v[18:19], v[138:139], v[138:139], v[18:19]
v_pk_fma_f32 v[16:17], v[140:141], v[140:141], v[16:17]
v_pk_fma_f32 v[18:19], v[142:143], v[142:143], v[18:19]
v_pk_fma_f32 v[16:17], v[144:145], v[144:145], v[16:17]
v_pk_fma_f32 v[18:19], v[146:147], v[146:147], v[18:19]
v_pk_fma_f32 v[16:17], v[148:149], v[148:149], v[16:17]
v_pk_fma_f32 v[18:19], v[150:151], v[150:151], v[18:19]
v_pk_fma_f32 v[16:17], v[152:153], v[152:153], v[16:17]
v_pk_fma_f32 v[18:19], v[154:155], v[154:155], v[18:19]
v_pk_fma_f32 v[16:17], v[156:157], v[156:157], v[16:17]
v_pk_fma_f32 v[18:19], v[158:159], v[158:159], v[18:19]
v_pk_fma_f32 v[16:17], v[160:161], v[160:161], v[16:17]
v_pk_fma_f32 v[18:19], v[162:163], v[162:163], v[18:19]
v_pk_fma_f32 v[16:17], v[164:165], v[164:165], v[16:17]
v_pk_fma_f32 v[18:19], v[166:167], v[166:167], v[18:19]
v_pk_fma_f32 v[16:17], v[168:169], v[168:169], v[16:17]
v_pk_fma_f32 v[18:19], v[170:171], v[170:171], v[18:19]
v_pk_fma_f32 v[16:17], v[172:173], v[172:173], v[16:17]
v_pk_fma_f32 v[18:19], v[174:175], v[174:175], v[18:19]
v_pk_fma_f32 v[16:17], v[176:177], v[176:177], v[16:17]
v_pk_fma_f32 v[18:19], v[178:179], v[178:179], v[18:19]
v_pk_fma_f32 v[16:17], v[180:181], v[180:181], v[16:17]
v_pk_fma_f32 v[18:19], v[182:183], v[182:183], v[18:19]
v_pk_fma_f32 v[16:17], v[184:185], v[184:185], v[16:17]
v_pk_fma_f32 v[18:19], v[186:187], v[186:187], v[18:19]
v_pk_fma_f32 v[16:17], v[188:189], v[188:189], v[16:17]
v_pk_fma_f32 v[18:19], v[190:191], v[190:191], v[18:19]
v_pk_fma_f32 v[16:17], v[192:193], v[192:193], v[16:17]
v_pk_fma_f32 v[18:19], v[194:195], v[194:195], v[18:19]
v_pk_fma_f32 v[16:17], v[196:197], v[196:197], v[16:17]
v_pk_fma_f32 v[18:19], v[198:199], v[198:199], v[18:19]
v_pk_add_f32 v[16:17], v[16:17], v[18:19]
v_add_f32 v16, v16, v17
s_nop 1
v_add_f32_dpp v16, v16, v16 quad_perm:[1,0,3,2] row_mask:0xf bank_mask:0xf
s_nop 1
v_add_f32_dpp v16, v16, v16 quad_perm:[2,3,0,1] row_mask:0xf bank_mask:0xf
s_nop 1
v_add_f32_dpp v16, v16, v16 row_half_mirror row_mask:0xf bank_mask:0xf
s_mov_b32 s34, 0x3727c5ac
s_mov_b32 s47, 0x3ae38e39
s_mov_b32 s33, 0x3e0293ee
v_mul_f32 v16, s47, v16
v_add_f32 v18, s34, v16
v_fma_f32 v19, v18, s34, v16
v_rsq_f32 v18, v18
v_rsq_f32 v16, v19
s_nop 0
v_mul_f32 v18, s33, v18
s_mov_b32 s34, 0x0f0f0f0f
s_bitcmp1_b32 s49, 0
s_cselect_b32 s34, 0xf0f0f0f0, s34
s_mov_b32 s35, s34
s_bitcmp1_b32 s49, 1
s_cbranch_scc1 L_xq_odd
v_pk_mul_f32 v[64:65], v[128:129], v[18:19] op_sel_hi:[1,0]
v_pk_mul_f32 v[66:67], v[130:131], v[18:19] op_sel_hi:[1,0]
v_pk_mul_f32 v[68:69], v[132:133], v[18:19] op_sel_hi:[1,0]
v_pk_mul_f32 v[70:71], v[134:135], v[18:19] op_sel_hi:[1,0]
v_cvt_pk_bf16_f32 v208, v64, v65
v_cvt_pk_bf16_f32 v209, v66, v67
v_cvt_pk_bf16_f32 v210, v68, v69
v_cvt_pk_bf16_f32 v211, v70, v71
v_pk_mul_f32 v[64:65], v[144:145], v[18:19] op_sel_hi:[1,0]
v_pk_mul_f32 v[66:67], v[146:147], v[18:19] op_sel_hi:[1,0]
v_pk_mul_f32 v[68:69], v[148:149], v[18:19] op_sel_hi:[1,0]
v_pk_mul_f32 v[70:71], v[150:151], v[18:19] op_sel_hi:[1,0]
v_cvt_pk_bf16_f32 v212, v64, v65
v_cvt_pk_bf16_f32 v213, v66, v67
v_cvt_pk_bf16_f32 v214, v68, v69
v_cvt_pk_bf16_f32 v215, v70, v71
v_pk_mul_f32 v[64:65], v[160:161], v[18:19] op_sel_hi:[1,0]
v_pk_mul_f32 v[66:67], v[162:163], v[18:19] op_sel_hi:[1,0]
v_pk_mul_f32 v[68:69], v[164:165], v[18:19] op_sel_hi:[1,0]
v_pk_mul_f32 v[70:71], v[166:167], v[18:19] op_sel_hi:[1,0]
v_cvt_pk_bf16_f32 v216, v64, v65
v_cvt_pk_bf16_f32 v217, v66, v67
v_cvt_pk_bf16_f32 v218, v68, v69
v_cvt_pk_bf16_f32 v219, v70, v71
v_pk_mul_f32 v[64:65], v[176:177], v[18:19] op_sel_hi:[1,0]
v_pk_mul_f32 v[66:67], v[178:179], v[18:19] op_sel_hi:[1,0]
v_pk_mul_f32 v[68:69], v[180:181], v[18:19] op_sel_hi:[1,0]
v_pk_mul_f32 v[70:71], v[182:183], v[18:19] op_sel_hi:[1,0]
v_cvt_pk_bf16_f32 v220, v64, v65
v_cvt_pk_bf16_f32 v221, v66, v67
v_cvt_pk_bf16_f32 v222, v68, v69
v_cvt_pk_bf16_f32 v223, v70, v71
v_pk_mul_f32 v[64:65], v[192:193], v[18:19] op_sel_hi:[1,0]
v_pk_mul_f32 v[66:67], v[194:195], v[18:19] op_sel_hi:[1,0]
v_pk_mul_f32 v[68:69], v[196:197], v[18:19] op_sel_hi:[1,0]
v_pk_mul_f32 v[70:71], v[198:199], v[18:19] op_sel_hi:[1,0]
v_cvt_pk_bf16_f32 v224, v64, v65
v_cvt_pk_bf16_f32 v225, v66, v67
v_cvt_pk_bf16_f32 v226, v68, v69
v_cvt_pk_bf16_f32 v227, v70, v71
s_mov_b64 exec, s[34:35]
ds_write_b128 v26, v[208:211] offset:0
ds_write_b128 v26, v[212:215] offset:1024
ds_write_b128 v26, v[216:219] offset:2048
ds_write_b128 v26, v[220:223] offset:3072
ds_write_b128 v26, v[224:227] offset:4096
s_mov_b64 exec, -1
s_branch L_xq_done
L_xq_odd:
v_pk_mul_f32 v[64:65], v[136:137], v[18:19] op_sel_hi:[1,0]
v_pk_mul_f32 v[66:67], v[138:139], v[18:19] op_sel_hi:[1,0]
v_pk_mul_f32 v[68:69], v[140:141], v[18:19] op_sel_hi:[1,0]
v_pk_mul_f32 v[70:71], v[142:143], v[18:19] op_sel_hi:[1,0]
v_cvt_pk_bf16_f32 v208, v64, v65
v_cvt_pk_bf16_f32 v209, v66, v67
v_cvt_pk_bf16_f32 v210, v68, v69
v_cvt_pk_bf16_f32 v211, v70, v71
v_pk_mul_f32 v[64:65], v[152:153], v[18:19] op_sel_hi:[1,0]
v_pk_mul_f32 v[66:67], v[154:155], v[18:19] op_sel_hi:[1,0]
v_pk_mul_f32 v[68:69], v[156:157], v[18:19] op_sel_hi:[1,0]
v_pk_mul_f32 v[70:71], v[158:159], v[18:19] op_sel_hi:[1,0]
v_cvt_pk_bf16_f32 v212, v64, v65
v_cvt_pk_bf16_f32 v213, v66, v67
v_cvt_pk_bf16_f32 v214, v68, v69
v_cvt_pk_bf16_f32 v215, v70, v71
v_pk_mul_f32 v[64:65], v[168:169], v[18:19] op_sel_hi:[1,0]
v_pk_mul_f32 v[66:67], v[170:171], v[18:19] op_sel_hi:[1,0]
v_pk_mul_f32 v[68:69], v[172:173], v[18:19] op_sel_hi:[1,0]
v_pk_mul_f32 v[70:71], v[174:175], v[18:19] op_sel_hi:[1,0]
v_cvt_pk_bf16_f32 v216, v64, v65
v_cvt_pk_bf16_f32 v217, v66, v67
v_cvt_pk_bf16_f32 v218, v68, v69
v_cvt_pk_bf16_f32 v219, v70, v71
v_pk_mul_f32 v[64:65], v[184:185], v[18:19] op_sel_hi:[1,0]
v_pk_mul_f32 v[66:67], v[186:187], v[18:19] op_sel_hi:[1,0]
v_pk_mul_f32 v[68:69], v[188:189], v[18:19] op_sel_hi:[1,0]
v_pk_mul_f32 v[70:71], v[190:191], v[18:19] op_sel_hi:[1,0]
v_cvt_pk_bf16_f32 v220, v64, v65
v_cvt_pk_bf16_f32 v221, v66, v67
v_cvt_pk_bf16_f32 v222, v68, v69
v_cvt_pk_bf16_f32 v223, v70, v71
s_mov_b64 exec, s[34:35]
ds_write_b128 v26, v[208:211] offset:0
ds_write_b128 v26, v[212:215] offset:1024
ds_write_b128 v26, v[216:219] offset:2048
ds_write_b128 v26, v[220:223] offset:3072
s_mov_b64 exec, -1
L_xq_done:
v_pk_mul_f32 v[128:129], v[128:129], v[16:17] op_sel_hi:[1,0]
v_pk_mul_f32 v[130:131], v[130:131], v[16:17] op_sel_hi:[1,0]
v_pk_mul_f32 v[132:133], v[132:133], v[16:17] op_sel_hi:[1,0]
v_pk_mul_f32 v[134:135], v[134:135], v[16:17] op_sel_hi:[1,0]
v_cvt_pk_bf16_f32 v128, v128, v129
v_cvt_pk_bf16_f32 v129, v130, v131
v_cvt_pk_bf16_f32 v130, v132, v133
v_cvt_pk_bf16_f32 v131, v134, v135
ds_write_b128 v24, v[128:131] offset:0
v_pk_mul_f32 v[136:137], v[136:137], v[16:17] op_sel_hi:[1,0]
v_pk_mul_f32 v[138:139], v[138:139], v[16:17] op_sel_hi:[1,0]
v_pk_mul_f32 v[140:141], v[140:141], v[16:17] op_sel_hi:[1,0]
v_pk_mul_f32 v[142:143], v[142:143], v[16:17] op_sel_hi:[1,0]
v_cvt_pk_bf16_f32 v136, v136, v137
v_cvt_pk_bf16_f32 v137, v138, v139
v_cvt_pk_bf16_f32 v138, v140, v141
v_cvt_pk_bf16_f32 v139, v142, v143
ds_write_b128 v24, v[136:139] offset:128
v_pk_mul_f32 v[144:145], v[144:145], v[16:17] op_sel_hi:[1,0]
v_pk_mul_f32 v[146:147], v[146:147], v[16:17] op_sel_hi:[1,0]
v_pk_mul_f32 v[148:149], v[148:149], v[16:17] op_sel_hi:[1,0]
v_pk_mul_f32 v[150:151], v[150:151], v[16:17] op_sel_hi:[1,0]
v_cvt_pk_bf16_f32 v144, v144, v145
v_cvt_pk_bf16_f32 v145, v146, v147
v_cvt_pk_bf16_f32 v146, v148, v149
v_cvt_pk_bf16_f32 v147, v150, v151
ds_write_b128 v24, v[144:147] offset:256
v_pk_mul_f32 v[152:153], v[152:153], v[16:17] op_sel_hi:[1,0]
v_pk_mul_f32 v[154:155], v[154:155], v[16:17] op_sel_hi:[1,0]
v_pk_mul_f32 v[156:157], v[156:157], v[16:17] op_sel_hi:[1,0]
v_pk_mul_f32 v[158:159], v[158:159], v[16:17] op_sel_hi:[1,0]
v_cvt_pk_bf16_f32 v152, v152, v153
v_cvt_pk_bf16_f32 v153, v154, v155
v_cvt_pk_bf16_f32 v154, v156, v157
v_cvt_pk_bf16_f32 v155, v158, v159
ds_write_b128 v24, v[152:155] offset:384
v_pk_mul_f32 v[160:161], v[160:161], v[16:17] op_sel_hi:[1,0]
v_pk_mul_f32 v[162:163], v[162:163], v[16:17] op_sel_hi:[1,0]
v_pk_mul_f32 v[164:165], v[164:165], v[16:17] op_sel_hi:[1,0]
v_pk_mul_f32 v[166:167], v[166:167], v[16:17] op_sel_hi:[1,0]
v_cvt_pk_bf16_f32 v160, v160, v161
v_cvt_pk_bf16_f32 v161, v162, v163
v_cvt_pk_bf16_f32 v162, v164, v165
v_cvt_pk_bf16_f32 v163, v166, v167
ds_write_b128 v24, v[160:163] offset:512
v_pk_mul_f32 v[168:169], v[168:169], v[16:17] op_sel_hi:[1,0]
v_pk_mul_f32 v[170:171], v[170:171], v[16:17] op_sel_hi:[1,0]
v_pk_mul_f32 v[172:173], v[172:173], v[16:17] op_sel_hi:[1,0]
v_pk_mul_f32 v[174:175], v[174:175], v[16:17] op_sel_hi:[1,0]
v_cvt_pk_bf16_f32 v168, v168, v169
v_cvt_pk_bf16_f32 v169, v170, v171
v_cvt_pk_bf16_f32 v170, v172, v173
v_cvt_pk_bf16_f32 v171, v174, v175
ds_write_b128 v24, v[168:171] offset:640
v_pk_mul_f32 v[176:177], v[176:177], v[16:17] op_sel_hi:[1,0]
v_pk_mul_f32 v[178:179], v[178:179], v[16:17] op_sel_hi:[1,0]
v_pk_mul_f32 v[180:181], v[180:181], v[16:17] op_sel_hi:[1,0]
v_pk_mul_f32 v[182:183], v[182:183], v[16:17] op_sel_hi:[1,0]
v_cvt_pk_bf16_f32 v176, v176, v177
v_cvt_pk_bf16_f32 v177, v178, v179
v_cvt_pk_bf16_f32 v178, v180, v181
v_cvt_pk_bf16_f32 v179, v182, v183
ds_write_b128 v24, v[176:179] offset:768
v_pk_mul_f32 v[184:185], v[184:185], v[16:17] op_sel_hi:[1,0]
v_pk_mul_f32 v[186:187], v[186:187], v[16:17] op_sel_hi:[1,0]
v_pk_mul_f32 v[188:189], v[188:189], v[16:17] op_sel_hi:[1,0]
v_pk_mul_f32 v[190:191], v[190:191], v[16:17] op_sel_hi:[1,0]
v_cvt_pk_bf16_f32 v184, v184, v185
v_cvt_pk_bf16_f32 v185, v186, v187
v_cvt_pk_bf16_f32 v186, v188, v189
v_cvt_pk_bf16_f32 v187, v190, v191
ds_write_b128 v24, v[184:187] offset:896
v_pk_mul_f32 v[192:193], v[192:193], v[16:17] op_sel_hi:[1,0]
v_pk_mul_f32 v[194:195], v[194:195], v[16:17] op_sel_hi:[1,0]
v_pk_mul_f32 v[196:197], v[196:197], v[16:17] op_sel_hi:[1,0]
v_pk_mul_f32 v[198:199], v[198:199], v[16:17] op_sel_hi:[1,0]
v_cvt_pk_bf16_f32 v192, v192, v193
v_cvt_pk_bf16_f32 v193, v194, v195
v_cvt_pk_bf16_f32 v194, v196, v197
v_cvt_pk_bf16_f32 v195, v198, v199
ds_write_b128 v24, v[192:195] offset:1024
s_waitcnt vmcnt(19) lgkmcnt(0)
s_barrier
s_lshl_b32 s33, s24, 10
s_add_u32 s33, s33, 147456
v_add_u32 v12, s33, v11
ds_read_b128 v[208:211], v12 offset:0
ds_read_b128 v[212:215], v12 offset:4096
ds_read_b128 v[216:219], v12 offset:8192
ds_read_b128 v[64:67], v25 offset:0
ds_read_b128 v[68:71], v25 offset:18432
ds_read_b128 v[72:75], v25 offset:256
ds_read_b128 v[76:79], v25 offset:18688
ds_read_b128 v[80:83], v25 offset:512
ds_read_b128 v[84:87], v25 offset:18944
ds_read_b128 v[88:91], v25 offset:768
ds_read_b128 v[92:95], v25 offset:19200
ds_read_b128 v[96:99], v25 offset:1024
ds_read_b128 v[100:103], v25 offset:19456
s_waitcnt lgkmcnt(10)
s_add_u32 s33, s24, 0
s_cmp_ge_u32 s33, 5
s_cselect_b32 s34, 1, 0
s_mul_i32 s35, s34, 5
s_sub_u32 s35, s33, s35
s_lshl_b32 s35, s35, 2
s_add_u32 s35, s35, s49
s_lshl_b32 s47, s48, 1
s_add_u32 s34, s34, s47
s_mul_i32 s34, s34, 18
s_add_u32 s34, s34, s35
s_lshl_b32 s34, s34, 10
s_cmp_ge_u32 s35, 18
s_cselect_b32 s34, 0x7fff0000, s34
s_cmp_ge_u32 s33, 10
s_cselect_b32 s34, 0x7fff0000, s34
buffer_store_dwordx4 v[208:211], v11, s[20:23], s34 offen sc1
s_add_u32 s33, s24, 4
s_cmp_ge_u32 s33, 5
s_cselect_b32 s34, 1, 0
s_mul_i32 s35, s34, 5
s_sub_u32 s35, s33, s35
s_lshl_b32 s35, s35, 2
s_add_u32 s35, s35, s49
s_lshl_b32 s47, s48, 1
s_add_u32 s34, s34, s47
s_mul_i32 s34, s34, 18
s_add_u32 s34, s34, s35
s_lshl_b32 s34, s34, 10
s_cmp_ge_u32 s35, 18
s_cselect_b32 s34, 0x7fff0000, s34
s_cmp_ge_u32 s33, 10
s_cselect_b32 s34, 0x7fff0000, s34
buffer_store_dwordx4 v[212:215], v11, s[20:23], s34 offen sc1
s_add_u32 s33, s24, 8
s_cmp_ge_u32 s33, 5
s_cselect_b32 s34, 1, 0
s_mul_i32 s35, s34, 5
s_sub_u32 s35, s33, s35
s_lshl_b32 s35, s35, 2
s_add_u32 s35, s35, s49
s_lshl_b32 s47, s48, 1
s_add_u32 s34, s34, s47
s_mul_i32 s34, s34, 18
s_add_u32 s34, s34, s35
s_lshl_b32 s34, s34, 10
s_cmp_ge_u32 s35, 18
s_cselect_b32 s34, 0x7fff0000, s34
s_cmp_ge_u32 s33, 10
s_cselect_b32 s34, 0x7fff0000, s34
buffer_store_dwordx4 v[216:219], v11, s[20:23], s34 offen sc1
ds_read_b64_tr_b16 a[168:169], v49 offset:0
ds_read_b64_tr_b16 a[170:171], v49 offset:1152
ds_read_b64_tr_b16 a[172:173], v49 offset:32
ds_read_b64_tr_b16 a[174:175], v49 offset:1184
ds_read_b64_tr_b16 a[176:177], v49 offset:64
ds_read_b64_tr_b16 a[178:179], v49 offset:1216
ds_read_b64_tr_b16 a[180:181], v49 offset:96
ds_read_b64_tr_b16 a[182:183], v49 offset:1248
ds_read_b64_tr_b16 a[184:185], v49 offset:128
ds_read_b64_tr_b16 a[186:187], v49 offset:1280
ds_read_b64_tr_b16 a[188:189], v49 offset:160
ds_read_b64_tr_b16 a[190:191], v49 offset:1312
ds_read_b64_tr_b16 a[192:193], v49 offset:192
ds_read_b64_tr_b16 a[194:195], v49 offset:1344
ds_read_b64_tr_b16 a[196:197], v49 offset:224
ds_read_b64_tr_b16 a[198:199], v49 offset:1376
ds_read_b64_tr_b16 a[200:201], v49 offset:256
ds_read_b64_tr_b16 a[202:203], v49 offset:1408
s_waitcnt lgkmcnt(0)
s_barrier
s_cmp_lt_u32 s24, 2
s_cbranch_scc1 L_b4ok
v_mov_b32 v96, 0
v_mov_b32 v97, 0
v_mov_b32 v98, 0
v_mov_b32 v99, 0
v_mov_b32 v100, 0
v_mov_b32 v101, 0
v_mov_b32 v102, 0
v_mov_b32 v103, 0
L_b4ok:
s_add_u32 m0, s30, 110592
s_add_u32 s3, s25, 442368
buffer_load_dwordx4 v1, s[4:7], s3 offen offset:0 lds
s_add_u32 m0, s30, 110592
s_add_u32 s3, s25, 442368
buffer_load_dwordx4 v2, s[4:7], s3 offen offset:1024 lds
s_add_u32 m0, s30, 110592
s_add_u32 s3, s25, 442368
buffer_load_dwordx4 v3, s[4:7], s3 offen offset:2048 lds
s_add_u32 m0, s30, 110592
s_add_u32 s3, s25, 442368
buffer_load_dwordx4 v4, s[4:7], s3 offen offset:3072 lds
s_add_u32 m0, s30, 114688
s_add_u32 s3, s25, 442368
buffer_load_dwordx4 v5, s[4:7], s3 offen offset:0 lds
s_add_u32 m0, s30, 114688
s_add_u32 s3, s25, 442368
buffer_load_dwordx4 v6, s[4:7], s3 offen offset:1024 lds
s_add_u32 m0, s30, 114688
s_add_u32 s3, s25, 442368
buffer_load_dwordx4 v7, s[4:7], s3 offen offset:2048 lds
s_add_u32 m0, s30, 114688
s_add_u32 s3, s25, 442368
buffer_load_dwordx4 v8, s[4:7], s3 offen offset:3072 lds
s_add_u32 m0, s30, 118784
s_add_u32 s3, s25, 442368
buffer_load_dwordx4 v9, s[4:7], s3 offen offset:0 lds
s_add_u32 m0, s30, 0
s_add_u32 s3, s25, 589824
buffer_load_dwordx4 v1, s[4:7], s3 offen offset:0 lds
s_add_u32 m0, s30, 0
s_add_u32 s3, s25, 589824
buffer_load_dwordx4 v2, s[4:7], s3 offen offset:1024 lds
s_add_u32 m0, s30, 0
s_add_u32 s3, s25, 589824
buffer_load_dwordx4 v3, s[4:7], s3 offen offset:2048 lds
s_add_u32 m0, s30, 0
s_add_u32 s3, s25, 589824
buffer_load_dwordx4 v4, s[4:7], s3 offen offset:3072 lds
s_add_u32 m0, s30, 4096
s_add_u32 s3, s25, 589824
buffer_load_dwordx4 v5, s[4:7], s3 offen offset:0 lds
s_add_u32 m0, s30, 4096
s_add_u32 s3, s25, 589824
buffer_load_dwordx4 v6, s[4:7], s3 offen offset:1024 lds
s_add_u32 m0, s30, 4096
s_add_u32 s3, s25, 589824
buffer_load_dwordx4 v7, s[4:7], s3 offen offset:2048 lds
s_add_u32 m0, s30, 4096
s_add_u32 s3, s25, 589824
buffer_load_dwordx4 v8, s[4:7], s3 offen offset:3072 lds
s_add_u32 m0, s30, 8192
s_add_u32 s3, s25, 589824
buffer_load_dwordx4 v9, s[4:7], s3 offen offset:0 lds
s_mov_b32 s16, s70
s_mov_b32 s17, s71
s_mov_b32 s18, 0x480000
s_mov_b32 s19, 0x00020000
s_mul_i32 s35, s0, 36
v_min_u32 v12, 35, v0
v_add_u32 v12, s35, v12
v_add_u32 v12, 0, v12
v_lshrrev_b32 v13, 3, v12
v_and_b32 v12, 7, v12
v_lshlrev_b32 v12, 7, v12
v_lshl_add_u32 v12, v13, 13, v12
s_and_b32 s35, s2, 7
s_lshl_b32 s35, s35, 10
buffer_load_dword v10, v12, s[16:19], s35 offen
s_waitcnt vmcnt(32) lgkmcnt(0)
v_mfma_f32_16x16x32_bf16 a[96:99], a[168:171], v[64:67], 0
ds_read_b64_tr_b16 a[204:205], v49 offset:36864
v_mfma_f32_16x16x32_bf16 a[132:135], a[168:171], v[68:71], 0
ds_read_b64_tr_b16 a[206:207], v49 offset:38016
v_mfma_f32_16x16x32_bf16 a[100:103], a[172:175], v[64:67], 0
ds_read_b64_tr_b16 a[208:209], v49 offset:36896
v_mfma_f32_16x16x32_bf16 a[136:139], a[172:175], v[68:71], 0
ds_read_b64_tr_b16 a[210:211], v49 offset:38048
v_mfma_f32_16x16x32_bf16 a[104:107], a[176:179], v[64:67], 0
ds_read_b64_tr_b16 a[212:213], v49 offset:36928
v_mfma_f32_16x16x32_bf16 a[140:143], a[176:179], v[68:71], 0
ds_read_b64_tr_b16 a[214:215], v49 offset:38080
v_mfma_f32_16x16x32_bf16 a[108:111], a[180:183], v[64:67], 0
ds_read_b64_tr_b16 a[216:217], v49 offset:36960
v_mfma_f32_16x16x32_bf16 a[144:147], a[180:183], v[68:71], 0
ds_read_b64_tr_b16 a[218:219], v49 offset:38112
v_mfma_f32_16x16x32_bf16 a[112:115], a[184:187], v[64:67], 0
ds_read_b64_tr_b16 a[220:221], v49 offset:36992
v_mfma_f32_16x16x32_bf16 a[148:151], a[184:187], v[68:71], 0
ds_read_b64_tr_b16 a[222:223], v49 offset:38144
v_mfma_f32_16x16x32_bf16 a[116:119], a[188:191], v[64:67], 0
ds_read_b64_tr_b16 a[224:225], v49 offset:37024
v_mfma_f32_16x16x32_bf16 a[152:155], a[188:191], v[68:71], 0
ds_read_b64_tr_b16 a[226:227], v49 offset:38176
v_mfma_f32_16x16x32_bf16 a[120:123], a[192:195], v[64:67], 0
ds_read_b64_tr_b16 a[228:229], v49 offset:37056
v_mfma_f32_16x16x32_bf16 a[156:159], a[192:195], v[68:71], 0
ds_read_b64_tr_b16 a[230:231], v49 offset:38208
v_mfma_f32_16x16x32_bf16 a[124:127], a[196:199], v[64:67], 0
ds_read_b64_tr_b16 a[232:233], v49 offset:37088
v_mfma_f32_16x16x32_bf16 a[160:163], a[196:199], v[68:71], 0
ds_read_b64_tr_b16 a[234:235], v49 offset:38240
v_mfma_f32_16x16x32_bf16 a[128:131], a[200:203], v[64:67], 0
ds_read_b64_tr_b16 a[236:237], v49 offset:37120
v_mfma_f32_16x16x32_bf16 a[164:167], a[200:203], v[68:71], 0
ds_read_b64_tr_b16 a[238:239], v49 offset:38272
s_waitcnt vmcnt(19) lgkmcnt(0)
s_barrier
s_lshr_b32 s33, s48, 3
s_lshl_b32 s33, s33, 5
s_add_u32 s33, s33, 4
s_cmp_lg_u32 s24, 0
s_cbranch_scc1 L_sig1
v_mov_b32 v12, 0
v_mov_b32 v13, 0x100
s_mov_b64 exec, 1
buffer_atomic_add v13, v12, s[56:59], s33 offen
s_mov_b64 exec, -1
L_sig1:
v_mfma_f32_16x16x32_bf16 a[96:99], a[204:207], v[72:75], a[96:99]
ds_read_b64_tr_b16 a[168:169], v50 offset:9216
v_mfma_f32_16x16x32_bf16 a[132:135], a[204:207], v[76:79], a[132:135]
ds_read_b64_tr_b16 a[170:171], v50 offset:10368
v_mfma_f32_16x16x32_bf16 a[100:103], a[208:211], v[72:75], a[100:103]
ds_read_b64_tr_b16 a[172:173], v50 offset:9248
v_mfma_f32_16x16x32_bf16 a[136:139], a[208:211], v[76:79], a[136:139]
ds_read_b64_tr_b16 a[174:175], v50 offset:10400
v_mfma_f32_16x16x32_bf16 a[104:107], a[212:215], v[72:75], a[104:107]
ds_read_b64_tr_b16 a[176:177], v50 offset:9280
v_mfma_f32_16x16x32_bf16 a[140:143], a[212:215], v[76:79], a[140:143]
ds_read_b64_tr_b16 a[178:179], v50 offset:10432
v_mfma_f32_16x16x32_bf16 a[108:111], a[216:219], v[72:75], a[108:111]
ds_read_b64_tr_b16 a[180:181], v50 offset:9312
v_mfma_f32_16x16x32_bf16 a[144:147], a[216:219], v[76:79], a[144:147]
ds_read_b64_tr_b16 a[182:183], v50 offset:10464
v_mfma_f32_16x16x32_bf16 a[112:115], a[220:223], v[72:75], a[112:115]
ds_read_b64_tr_b16 a[184:185], v50 offset:9344
v_mfma_f32_16x16x32_bf16 a[148:151], a[220:223], v[76:79], a[148:151]
ds_read_b64_tr_b16 a[186:187], v50 offset:10496
v_mfma_f32_16x16x32_bf16 a[116:119], a[224:227], v[72:75], a[116:119]
ds_read_b64_tr_b16 a[188:189], v50 offset:9376
v_mfma_f32_16x16x32_bf16 a[152:155], a[224:227], v[76:79], a[152:155]
ds_read_b64_tr_b16 a[190:191], v50 offset:10528
v_mfma_f32_16x16x32_bf16 a[120:123], a[228:231], v[72:75], a[120:123]
ds_read_b64_tr_b16 a[192:193], v50 offset:9408
v_mfma_f32_16x16x32_bf16 a[156:159], a[228:231], v[76:79], a[156:159]
ds_read_b64_tr_b16 a[194:195], v50 offset:10560
v_mfma_f32_16x16x32_bf16 a[124:127], a[232:235], v[72:75], a[124:127]
ds_read_b64_tr_b16 a[196:197], v50 offset:9440
v_mfma_f32_16x16x32_bf16 a[160:163], a[232:235], v[76:79], a[160:163]
ds_read_b64_tr_b16 a[198:199], v50 offset:10592
v_mfma_f32_16x16x32_bf16 a[128:131], a[236:239], v[72:75], a[128:131]
ds_read_b64_tr_b16 a[200:201], v50 offset:9472
v_mfma_f32_16x16x32_bf16 a[164:167], a[236:239], v[76:79], a[164:167]
ds_read_b64_tr_b16 a[202:203], v50 offset:10624
s_waitcnt vmcnt(10) lgkmcnt(0)
v_mfma_f32_16x16x32_bf16 a[96:99], a[168:171], v[80:83], a[96:99]
ds_read_b64_tr_b16 a[204:205], v50 offset:46080
v_mfma_f32_16x16x32_bf16 a[132:135], a[168:171], v[84:87], a[132:135]
ds_read_b64_tr_b16 a[206:207], v50 offset:47232
v_mfma_f32_16x16x32_bf16 a[100:103], a[172:175], v[80:83], a[100:103]
ds_read_b64_tr_b16 a[208:209], v50 offset:46112
v_mfma_f32_16x16x32_bf16 a[136:139], a[172:175], v[84:87], a[136:139]
ds_read_b64_tr_b16 a[210:211], v50 offset:47264
v_mfma_f32_16x16x32_bf16 a[104:107], a[176:179], v[80:83], a[104:107]
ds_read_b64_tr_b16 a[212:213], v50 offset:46144
v_mfma_f32_16x16x32_bf16 a[140:143], a[176:179], v[84:87], a[140:143]
ds_read_b64_tr_b16 a[214:215], v50 offset:47296
v_mfma_f32_16x16x32_bf16 a[108:111], a[180:183], v[80:83], a[108:111]
ds_read_b64_tr_b16 a[216:217], v50 offset:46176
v_mfma_f32_16x16x32_bf16 a[144:147], a[180:183], v[84:87], a[144:147]
ds_read_b64_tr_b16 a[218:219], v50 offset:47328
v_mfma_f32_16x16x32_bf16 a[112:115], a[184:187], v[80:83], a[112:115]
ds_read_b64_tr_b16 a[220:221], v50 offset:46208
v_mfma_f32_16x16x32_bf16 a[148:151], a[184:187], v[84:87], a[148:151]
ds_read_b64_tr_b16 a[222:223], v50 offset:47360
v_mfma_f32_16x16x32_bf16 a[116:119], a[188:191], v[80:83], a[116:119]
ds_read_b64_tr_b16 a[224:225], v50 offset:46240
v_mfma_f32_16x16x32_bf16 a[152:155], a[188:191], v[84:87], a[152:155]
ds_read_b64_tr_b16 a[226:227], v50 offset:47392
v_mfma_f32_16x16x32_bf16 a[120:123], a[192:195], v[80:83], a[120:123]
ds_read_b64_tr_b16 a[228:229], v50 offset:46272
v_mfma_f32_16x16x32_bf16 a[156:159], a[192:195], v[84:87], a[156:159]
ds_read_b64_tr_b16 a[230:231], v50 offset:47424
v_mfma_f32_16x16x32_bf16 a[124:127], a[196:199], v[80:83], a[124:127]
ds_read_b64_tr_b16 a[232:233], v50 offset:46304
v_mfma_f32_16x16x32_bf16 a[160:163], a[196:199], v[84:87], a[160:163]
ds_read_b64_tr_b16 a[234:235], v50 offset:47456
v_mfma_f32_16x16x32_bf16 a[128:131], a[200:203], v[80:83], a[128:131]
ds_read_b64_tr_b16 a[236:237], v50 offset:46336
v_mfma_f32_16x16x32_bf16 a[164:167], a[200:203], v[84:87], a[164:167]
ds_read_b64_tr_b16 a[238:239], v50 offset:47488
s_waitcnt vmcnt(1) lgkmcnt(0)
v_mfma_f32_16x16x32_bf16 a[96:99], a[204:207], v[88:91], a[96:99]
ds_read_b64_tr_b16 a[168:169], v49 offset:0
v_mfma_f32_16x16x32_bf16 a[132:135], a[204:207], v[92:95], a[132:135]
ds_read_b64_tr_b16 a[170:171], v49 offset:1152
v_mfma_f32_16x16x32_bf16 a[100:103], a[208:211], v[88:91], a[100:103]
ds_read_b64_tr_b16 a[172:173], v49 offset:32
v_mfma_f32_16x16x32_bf16 a[136:139], a[208:211], v[92:95], a[136:139]
ds_read_b64_tr_b16 a[174:175], v49 offset:1184
v_mfma_f32_16x16x32_bf16 a[104:107], a[212:215], v[88:91], a[104:107]
ds_read_b64_tr_b16 a[176:177], v49 offset:64
v_mfma_f32_16x16x32_bf16 a[140:143], a[212:215], v[92:95], a[140:143]
ds_read_b64_tr_b16 a[178:179], v49 offset:1216
v_mfma_f32_16x16x32_bf16 a[108:111], a[216:219], v[88:91], a[108:111]
ds_read_b64_tr_b16 a[180:181], v49 offset:96
v_mfma_f32_16x16x32_bf16 a[144:147], a[216:219], v[92:95], a[144:147]
ds_read_b64_tr_b16 a[182:183], v49 offset:1248
v_mfma_f32_16x16x32_bf16 a[112:115], a[220:223], v[88:91], a[112:115]
ds_read_b64_tr_b16 a[184:185], v49 offset:128
v_mfma_f32_16x16x32_bf16 a[148:151], a[220:223], v[92:95], a[148:151]
ds_read_b64_tr_b16 a[186:187], v49 offset:1280
v_mfma_f32_16x16x32_bf16 a[116:119], a[224:227], v[88:91], a[116:119]
ds_read_b64_tr_b16 a[188:189], v49 offset:160
v_mfma_f32_16x16x32_bf16 a[152:155], a[224:227], v[92:95], a[152:155]
ds_read_b64_tr_b16 a[190:191], v49 offset:1312
v_mfma_f32_16x16x32_bf16 a[120:123], a[228:231], v[88:91], a[120:123]
ds_read_b64_tr_b16 a[192:193], v49 offset:192
v_mfma_f32_16x16x32_bf16 a[156:159], a[228:231], v[92:95], a[156:159]
ds_read_b64_tr_b16 a[194:195], v49 offset:1344
v_mfma_f32_16x16x32_bf16 a[124:127], a[232:235], v[88:91], a[124:127]
ds_read_b64_tr_b16 a[196:197], v49 offset:224
v_mfma_f32_16x16x32_bf16 a[160:163], a[232:235], v[92:95], a[160:163]
ds_read_b64_tr_b16 a[198:199], v49 offset:1376
v_mfma_f32_16x16x32_bf16 a[128:131], a[236:239], v[88:91], a[128:131]
ds_read_b64_tr_b16 a[200:201], v49 offset:256
v_mfma_f32_16x16x32_bf16 a[164:167], a[236:239], v[92:95], a[164:167]
ds_read_b64_tr_b16 a[202:203], v49 offset:1408
s_waitcnt vmcnt(1) lgkmcnt(0)
v_mfma_f32_16x16x32_bf16 a[96:99], a[168:171], v[96:99], a[96:99]
v_mfma_f32_16x16x32_bf16 a[132:135], a[168:171], v[100:103], a[132:135]
v_mfma_f32_16x16x32_bf16 a[100:103], a[172:175], v[96:99], a[100:103]
v_mfma_f32_16x16x32_bf16 a[136:139], a[172:175], v[100:103], a[136:139]
v_mfma_f32_16x16x32_bf16 a[104:107], a[176:179], v[96:99], a[104:107]
v_mfma_f32_16x16x32_bf16 a[140:143], a[176:179], v[100:103], a[140:143]
v_mfma_f32_16x16x32_bf16 a[108:111], a[180:183], v[96:99], a[108:111]
v_mfma_f32_16x16x32_bf16 a[144:147], a[180:183], v[100:103], a[144:147]
v_mfma_f32_16x16x32_bf16 a[112:115], a[184:187], v[96:99], a[112:115]
v_mfma_f32_16x16x32_bf16 a[148:151], a[184:187], v[100:103], a[148:151]
v_mfma_f32_16x16x32_bf16 a[116:119], a[188:191], v[96:99], a[116:119]
v_mfma_f32_16x16x32_bf16 a[152:155], a[188:191], v[100:103], a[152:155]
v_mfma_f32_16x16x32_bf16 a[120:123], a[192:195], v[96:99], a[120:123]
v_mfma_f32_16x16x32_bf16 a[156:159], a[192:195], v[100:103], a[156:159]
v_mfma_f32_16x16x32_bf16 a[124:127], a[196:199], v[96:99], a[124:127]
v_mfma_f32_16x16x32_bf16 a[160:163], a[196:199], v[100:103], a[160:163]
v_mfma_f32_16x16x32_bf16 a[128:131], a[200:203], v[96:99], a[128:131]
v_mfma_f32_16x16x32_bf16 a[164:167], a[200:203], v[100:103], a[164:167]
s_nop 7
s_barrier
s_mul_i32 s33, s24, 18432
s_add_u32 s33, s33, 90112
v_add_u32 v12, s33, v11
ds_write_b128 v12, a[96:99] offset:0
ds_write_b128 v12, a[100:103] offset:1024
ds_write_b128 v12, a[104:107] offset:2048
ds_write_b128 v12, a[108:111] offset:3072
ds_write_b128 v12, a[112:115] offset:4096
ds_write_b128 v12, a[116:119] offset:5120
ds_write_b128 v12, a[120:123] offset:6144
ds_write_b128 v12, a[124:127] offset:7168
ds_write_b128 v12, a[128:131] offset:8192
ds_write_b128 v12, a[132:135] offset:9216
ds_write_b128 v12, a[136:139] offset:10240
ds_write_b128 v12, a[140:143] offset:11264
ds_write_b128 v12, a[144:147] offset:12288
ds_write_b128 v12, a[148:151] offset:13312
ds_write_b128 v12, a[152:155] offset:14336
ds_write_b128 v12, a[156:159] offset:15360
ds_write_b128 v12, a[160:163] offset:16384
ds_write_b128 v12, a[164:167] offset:17408
s_lshl_b32 s33, s32, 3
s_add_u32 s33, s33, 1
v_cmp_eq_u32 vcc, s33, v0
s_nop 1
s_mov_b64 s[42:43], vcc
s_cmp_eq_u32 s24, 0
s_cselect_b64 vcc, s[42:43], 0
v_mov_b32 v12, 0x7fff0000
v_lshlrev_b32 v13, 2, v0
v_cndmask_b32 v62, v12, v13, vcc
buffer_load_dword v61, v62, s[56:59], 0 offen sc1
v_lshrrev_b32 v14, 2, v0
v_mul_u32_u24 v14, 288, v14
v_and_b32 v15, 3, v0
v_lshl_add_u32 v49, v15, 3, v14
v_add_u32 v49, s30, v49
v_add_u32 v50, 64512, v49
v_add_u32 v51, 129024, v49
s_waitcnt lgkmcnt(0)
s_barrier
s_add_u32 s33, s53, 90112
v_add_u32 v12, s33, v11
ds_read_b128 v[84:87], v12 offset:0
s_add_u32 m0, s55, 0
s_bfe_u32 s3, s74, 0x80000
s_lshl_b32 s3, s3, 16
s_add_u32 s3, s3, s44
buffer_load_dwordx4 v38, s[12:15], s3 offen lds
ds_read_b128 v[88:91], v12 offset:18432
ds_read_b128 v[92:95], v12 offset:36864
ds_read_b128 v[96:99], v12 offset:55296
ds_read_b128 v[100:103], v12 offset:1024
ds_read_b128 v[104:107], v12 offset:19456
ds_read_b128 v[108:111], v12 offset:37888
ds_read_b128 v[112:115], v12 offset:56320
s_waitcnt lgkmcnt(4)
v_pk_add_f32 v[84:85], v[84:85], v[88:89]
v_pk_add_f32 v[92:93], v[92:93], v[96:97]
v_pk_add_f32 v[64:65], v[84:85], v[92:93]
v_pk_add_f32 v[86:87], v[86:87], v[90:91]
v_pk_add_f32 v[94:95], v[94:95], v[98:99]
v_pk_add_f32 v[66:67], v[86:87], v[94:95]
ds_read_b128 v[84:87], v12 offset:2048
s_add_u32 m0, s55, 1024
s_bfe_u32 s3, s74, 0x80000
s_lshl_b32 s3, s3, 16
s_add_u32 s3, s3, s44
s_add_u32 s3, s3, 32768
buffer_load_dwordx4 v38, s[12:15], s3 offen lds
ds_read_b128 v[88:91], v12 offset:20480
ds_read_b128 v[92:95], v12 offset:38912
ds_read_b128 v[96:99], v12 offset:57344
s_waitcnt lgkmcnt(4)
v_pk_add_f32 v[100:101], v[100:101], v[104:105]
v_pk_add_f32 v[108:109], v[108:109], v[112:113]
v_pk_add_f32 v[68:69], v[100:101], v[108:109]
v_pk_add_f32 v[102:103], v[102:103], v[106:107]
v_pk_add_f32 v[110:111], v[110:111], v[114:115]
v_pk_add_f32 v[70:71], v[102:103], v[110:111]
ds_read_b128 v[100:103], v12 offset:3072
ds_read_b128 v[104:107], v12 offset:21504
ds_read_b128 v[108:111], v12 offset:39936
ds_read_b128 v[112:115], v12 offset:58368
s_waitcnt lgkmcnt(4)
v_pk_add_f32 v[84:85], v[84:85], v[88:89]
s_add_u32 m0, s55, 2048
s_bfe_u32 s3, s74, 0x80000
s_lshl_b32 s3, s3, 16
s_add_u32 s3, s3, s44
s_add_u32 s3, s3, 65536
buffer_load_dwordx4 v39, s[12:15], s3 offen lds
v_pk_add_f32 v[92:93], v[92:93], v[96:97]
v_pk_add_f32 v[72:73], v[84:85], v[92:93]
v_pk_add_f32 v[86:87], v[86:87], v[90:91]
v_pk_add_f32 v[94:95], v[94:95], v[98:99]
v_pk_add_f32 v[74:75], v[86:87], v[94:95]
ds_read_b128 v[84:87], v12 offset:4096
ds_read_b128 v[88:91], v12 offset:22528
ds_read_b128 v[92:95], v12 offset:40960
ds_read_b128 v[96:99], v12 offset:59392
s_waitcnt lgkmcnt(4)
v_pk_add_f32 v[100:101], v[100:101], v[104:105]
v_pk_add_f32 v[108:109], v[108:109], v[112:113]
v_pk_add_f32 v[76:77], v[100:101], v[108:109]
v_pk_add_f32 v[102:103], v[102:103], v[106:107]
s_add_u32 m0, s55, 3072
s_bfe_u32 s3, s74, 0x80000
s_lshl_b32 s3, s3, 16
s_add_u32 s3, s3, s44
s_add_u32 s3, s3, 98304
buffer_load_dwordx4 v39, s[12:15], s3 offen lds
v_pk_add_f32 v[110:111], v[110:111], v[114:115]
v_pk_add_f32 v[78:79], v[102:103], v[110:111]
s_waitcnt lgkmcnt(0)
v_pk_add_f32 v[84:85], v[84:85], v[88:89]
v_pk_add_f32 v[92:93], v[92:93], v[96:97]
v_pk_add_f32 v[80:81], v[84:85], v[92:93]
v_pk_add_f32 v[86:87], v[86:87], v[90:91]
v_pk_add_f32 v[94:95], v[94:95], v[98:99]
v_pk_add_f32 v[82:83], v[86:87], v[94:95]
s_cmp_lg_u32 s24, 0
s_cbranch_scc1 L_poll2_ok
s_waitcnt vmcnt(4)
s_mov_b32 s35, 400000
L_poll2:
v_bfe_u32 v12, v61, 8, 8
v_cmp_gt_u32 vcc, 32, v12
s_nop 1
s_and_b64 vcc, vcc, s[42:43]
s_cmp_eq_u64 vcc, 0
s_cbranch_scc1 L_poll2_ok
s_sleep 2
buffer_load_dword v61, v62, s[56:59], 0 offen sc1
s_waitcnt vmcnt(0)
s_sub_u32 s35, s35, 1
s_cmp_lg_u32 s35, 0
s_cbranch_scc1 L_poll2
L_poll2_ok:
s_barrier
s_mov_b32 s92, 0xbdd2d3e8
s_mov_b32 s93, 0xbdd2d3e8
v_mov_b32 v16, 0xc0135761
v_mov_b32 v17, 0xc0135761
s_add_u32 s16, s88, 0x480000
s_addc_u32 s17, s89, 0
s_mov_b32 s18, 0x240000
s_mov_b32 s19, 0x00020000
s_cmp_eq_u32 s49, 0
s_cselect_b32 s47, 1, -1
s_cmp_eq_u32 s49, 2
s_cselect_b32 s47, 2, s47
s_cmp_eq_u32 s49, 3
s_cselect_b32 s47, -2, s47
s_lshl_b32 s33, s62, 4
s_add_u32 s33, s33, s47
v_and_b32 v12, 15, v0
s_bfe_u32 s3, s74, 0x80000
s_lshl_b32 s3, s3, 8
s_add_u32 s3, s3, s27
buffer_load_dwordx4 a[0:3], v11, s[20:23], s3 offen offset:0
v_add_u32 v12, s33, v12
v_cmp_gt_u32 vcc, 0x800, v12
v_and_b32 v12, 0x7ff, v12
v_lshrrev_b32 v13, 4, v12
v_mul_u32_u24 v13, 18432, v13
v_and_b32 v12, 15, v12
v_lshl_add_u32 v13, v12, 4, v13
v_and_b32 v12, 0x30, v0
v_lshl_add_u32 v14, v12, 4, v13
v_pk_mul_f32 v[84:85], v[64:65], v[64:65]
v_pk_mul_f32 v[86:87], v[66:67], v[66:67]
v_pk_fma_f32 v[84:85], v[84:85], s[92:93], v[16:17]
v_pk_fma_f32 v[86:87], v[86:87], s[92:93], v[16:17]
v_pk_mul_f32 v[84:85], v[84:85], v[64:65]
v_pk_mul_f32 v[86:87], v[86:87], v[66:67]
s_bfe_u32 s3, s74, 0x80000
s_lshl_b32 s3, s3, 8
s_add_u32 s3, s3, s27
buffer_load_dwordx4 a[16:19], v11, s[20:23], s3 offen offset:1024
v_exp_f32 v84, v84
v_exp_f32 v85, v85
v_exp_f32 v86, v86
v_exp_f32 v87, v87
v_pk_add_f32 v[84:85], v[84:85], 1.0 op_sel_hi:[1,0]
v_pk_add_f32 v[86:87], v[86:87], 1.0 op_sel_hi:[1,0]
v_rcp_f32 v84, v84
v_rcp_f32 v85, v85
v_rcp_f32 v86, v86
v_rcp_f32 v87, v87
s_bfe_u32 s3, s74, 0x80000
s_lshl_b32 s3, s3, 8
s_add_u32 s3, s3, s28
buffer_load_dwordx4 a[4:7], v11, s[20:23], s3 offen offset:0
s_nop 0
v_pk_mul_f32 v[64:65], v[64:65], v[84:85]
v_pk_mul_f32 v[66:67], v[66:67], v[86:87]
v_cvt_pk_bf16_f32 v64, v64, v65
v_cvt_pk_bf16_f32 v65, v66, v67
v_cndmask_b32 v64, 0, v64, vcc
v_cndmask_b32 v65, 0, v65, vcc
s_add_u32 s33, s60, 0
s_lshr_b32 s35, s33, 1
s_lshl_b32 s35, s35, 10
s_and_b32 s33, s33, 1
s_lshl_b32 s33, s33, 3
s_add_u32 s35, s35, s33
buffer_store_dwordx2 v[64:65], v14, s[16:19], s35 offen sc1
v_pk_mul_f32 v[88:89], v[68:69], v[68:69]
v_pk_mul_f32 v[90:91], v[70:71], v[70:71]
v_pk_fma_f32 v[88:89], v[88:89], s[92:93], v[16:17]
v_pk_fma_f32 v[90:91], v[90:91], s[92:93], v[16:17]
v_pk_mul_f32 v[88:89], v[88:89], v[68:69]
v_pk_mul_f32 v[90:91], v[90:91], v[70:71]
v_exp_f32 v88, v88
v_exp_f32 v89, v89
v_exp_f32 v90, v90
v_exp_f32 v91, v91
v_pk_add_f32 v[88:89], v[88:89], 1.0 op_sel_hi:[1,0]
s_bfe_u32 s3, s74, 0x80000
s_lshl_b32 s3, s3, 8
s_add_u32 s3, s3, s28
buffer_load_dwordx4 a[20:23], v11, s[20:23], s3 offen offset:1024
v_pk_add_f32 v[90:91], v[90:91], 1.0 op_sel_hi:[1,0]
v_rcp_f32 v88, v88
v_rcp_f32 v89, v89
v_rcp_f32 v90, v90
v_rcp_f32 v91, v91
s_nop 0
v_pk_mul_f32 v[68:69], v[68:69], v[88:89]
v_pk_mul_f32 v[70:71], v[70:71], v[90:91]
v_cvt_pk_bf16_f32 v68, v68, v69
v_cvt_pk_bf16_f32 v69, v70, v71
v_cndmask_b32 v68, 0, v68, vcc
v_cndmask_b32 v69, 0, v69, vcc
s_add_u32 s33, s60, 1
s_lshr_b32 s35, s33, 1
s_lshl_b32 s35, s35, 10
s_and_b32 s33, s33, 1
s_lshl_b32 s33, s33, 3
s_add_u32 s35, s35, s33
buffer_store_dwordx2 v[68:69], v14, s[16:19], s35 offen sc1
v_pk_mul_f32 v[84:85], v[72:73], v[72:73]
v_pk_mul_f32 v[86:87], v[74:75], v[74:75]
v_pk_fma_f32 v[84:85], v[84:85], s[92:93], v[16:17]
v_pk_fma_f32 v[86:87], v[86:87], s[92:93], v[16:17]
v_pk_mul_f32 v[84:85], v[84:85], v[72:73]
v_pk_mul_f32 v[86:87], v[86:87], v[74:75]
v_exp_f32 v84, v84
v_exp_f32 v85, v85
v_exp_f32 v86, v86
v_exp_f32 v87, v87
v_pk_add_f32 v[84:85], v[84:85], 1.0 op_sel_hi:[1,0]
s_bfe_u32 s3, s74, 0x80000
s_lshl_b32 s3, s3, 8
s_add_u32 s3, s3, s29
buffer_load_dwordx4 a[8:11], v11, s[20:23], s3 offen offset:0
v_pk_add_f32 v[86:87], v[86:87], 1.0 op_sel_hi:[1,0]
v_rcp_f32 v84, v84
v_rcp_f32 v85, v85
v_rcp_f32 v86, v86
v_rcp_f32 v87, v87
s_nop 0
v_pk_mul_f32 v[72:73], v[72:73], v[84:85]
v_pk_mul_f32 v[74:75], v[74:75], v[86:87]
v_cvt_pk_bf16_f32 v72, v72, v73
v_cvt_pk_bf16_f32 v73, v74, v75
v_cndmask_b32 v72, 0, v72, vcc
v_cndmask_b32 v73, 0, v73, vcc
s_add_u32 s33, s60, 2
s_lshr_b32 s35, s33, 1
s_lshl_b32 s35, s35, 10
s_and_b32 s33, s33, 1
s_lshl_b32 s33, s33, 3
s_add_u32 s35, s35, s33
buffer_store_dwordx2 v[72:73], v14, s[16:19], s35 offen sc1
v_pk_mul_f32 v[88:89], v[76:77], v[76:77]
v_pk_mul_f32 v[90:91], v[78:79], v[78:79]
v_pk_fma_f32 v[88:89], v[88:89], s[92:93], v[16:17]
v_pk_fma_f32 v[90:91], v[90:91], s[92:93], v[16:17]
v_pk_mul_f32 v[88:89], v[88:89], v[76:77]
v_pk_mul_f32 v[90:91], v[90:91], v[78:79]
v_exp_f32 v88, v88
v_exp_f32 v89, v89
v_exp_f32 v90, v90
v_exp_f32 v91, v91
v_pk_add_f32 v[88:89], v[88:89], 1.0 op_sel_hi:[1,0]
s_bfe_u32 s3, s74, 0x80000
s_lshl_b32 s3, s3, 8
s_add_u32 s3, s3, s29
buffer_load_dwordx4 a[24:27], v11, s[20:23], s3 offen offset:1024
v_pk_add_f32 v[90:91], v[90:91], 1.0 op_sel_hi:[1,0]
v_rcp_f32 v88, v88
v_rcp_f32 v89, v89
v_rcp_f32 v90, v90
v_rcp_f32 v91, v91
s_nop 0
v_pk_mul_f32 v[76:77], v[76:77], v[88:89]
v_pk_mul_f32 v[78:79], v[78:79], v[90:91]
v_cvt_pk_bf16_f32 v76, v76, v77
v_cvt_pk_bf16_f32 v77, v78, v79
v_cndmask_b32 v76, 0, v76, vcc
v_cndmask_b32 v77, 0, v77, vcc
s_add_u32 s33, s60, 3
s_lshr_b32 s35, s33, 1
s_lshl_b32 s35, s35, 10
s_and_b32 s33, s33, 1
s_lshl_b32 s33, s33, 3
s_add_u32 s35, s35, s33
buffer_store_dwordx2 v[76:77], v14, s[16:19], s35 offen sc1
v_pk_mul_f32 v[84:85], v[80:81], v[80:81]
v_pk_mul_f32 v[86:87], v[82:83], v[82:83]
v_pk_fma_f32 v[84:85], v[84:85], s[92:93], v[16:17]
v_pk_fma_f32 v[86:87], v[86:87], s[92:93], v[16:17]
v_pk_mul_f32 v[84:85], v[84:85], v[80:81]
v_pk_mul_f32 v[86:87], v[86:87], v[82:83]
v_exp_f32 v84, v84
v_exp_f32 v85, v85
v_exp_f32 v86, v86
v_exp_f32 v87, v87
v_pk_add_f32 v[84:85], v[84:85], 1.0 op_sel_hi:[1,0]
s_bfe_u32 s3, s74, 0x80000
s_lshl_b32 s3, s3, 8
s_add_u32 s3, s3, s45
buffer_load_dwordx4 a[12:15], v11, s[20:23], s3 offen offset:0
v_pk_add_f32 v[86:87], v[86:87], 1.0 op_sel_hi:[1,0]
v_rcp_f32 v84, v84
v_rcp_f32 v85, v85
v_rcp_f32 v86, v86
v_rcp_f32 v87, v87
s_nop 0
v_pk_mul_f32 v[80:81], v[80:81], v[84:85]
v_pk_mul_f32 v[82:83], v[82:83], v[86:87]
v_cvt_pk_bf16_f32 v80, v80, v81
v_cvt_pk_bf16_f32 v81, v82, v83
v_cndmask_b32 v80, 0, v80, vcc
v_cndmask_b32 v81, 0, v81, vcc
s_add_u32 s33, s60, 4
s_lshr_b32 s35, s33, 1
s_lshl_b32 s35, s35, 10
s_and_b32 s33, s33, 1
s_lshl_b32 s33, s33, 3
s_add_u32 s35, s35, s33
s_cmp_ge_u32 s24, 2
s_cselect_b32 s35, 0x7fff0000, s35
buffer_store_dwordx2 v[80:81], v14, s[16:19], s35 offen sc1
s_mul_i32 s33, s49, 288
s_add_u32 s4, s78, s33
s_addc_u32 s5, s79, 0
s_mov_b32 s6, 0x0
s_mov_b32 s7, 0x00020000
s_sub_u32 s6, 663552, s33
s_mul_i32 s26, s48, 36864
s_lshl_b32 s33, s24, 10
s_add_u32 s26, s26, s33
s_add_u32 s94, s26, 18432
s_add_u32 s95, s26, 16384
s_add_u32 s47, s94, 16384
s_cmp_ge_u32 s24, 2
s_cselect_b32 s95, 0x7fff0000, s95
s_cselect_b32 s47, 0x7fff0000, s47
v_and_b32 v26, 15, v0
v_lshlrev_b32 v26, 4, v26
v_bfe_u32 v27, v0, 5, 1
s_bfe_u32 s3, s74, 0x80000
s_lshl_b32 s3, s3, 8
s_add_u32 s3, s3, s45
buffer_load_dwordx4 a[28:31], v11, s[20:23], s3 offen offset:1024
v_lshl_add_u32 v26, v27, 8, v26
v_bfe_u32 v27, v0, 4, 1
v_lshl_add_u32 v26, v27, 3, v26
s_mul_i32 s63, s62, 18432
s_lshl_b32 s34, s60, 9
s_add_u32 s63, s63, s34
s_waitcnt vmcnt(13)
s_barrier
ds_read_b64_tr_b16 a[128:129], v40 offset:0
ds_read_b64_tr_b16 a[130:131], v40 offset:1024
ds_read_b64_tr_b16 a[132:133], v40 offset:8
ds_read_b64_tr_b16 a[134:135], v40 offset:1032
s_bfe_u32 s3, s74, 0x80008
s_lshl_b32 s3, s3, 8
s_add_u32 s3, s3, s27
buffer_load_dwordx4 a[32:35], v11, s[20:23], s3 offen offset:0
ds_read_b64_tr_b16 a[136:137], v41 offset:0
ds_read_b64_tr_b16 a[138:139], v41 offset:1024
ds_read_b64_tr_b16 a[140:141], v41 offset:8
ds_read_b64_tr_b16 a[142:143], v41 offset:1032
ds_read_b64_tr_b16 a[144:145], v42 offset:0
ds_read_b64_tr_b16 a[146:147], v42 offset:1024
ds_read_b64_tr_b16 a[148:149], v42 offset:8
ds_read_b64_tr_b16 a[150:151], v42 offset:1032
ds_read_b64_tr_b16 a[152:153], v43 offset:0
ds_read_b64_tr_b16 a[154:155], v43 offset:1024
ds_read_b64_tr_b16 a[156:157], v43 offset:8
ds_read_b64_tr_b16 a[158:159], v43 offset:1032
s_waitcnt vmcnt(1) lgkmcnt(0)
v_mfma_f32_16x16x32_bf16 v[128:131], a[128:131], a[0:3], 0
ds_read_b64_tr_b16 a[160:161], v40 offset:8192
s_bfe_u32 s3, s74, 0x80008
s_lshl_b32 s3, s3, 8
s_add_u32 s3, s3, s27
buffer_load_dwordx4 a[48:51], v11, s[20:23], s3 offen offset:1024
v_mfma_f32_16x16x32_bf16 v[160:163], a[128:131], a[4:7], 0
ds_read_b64_tr_b16 a[162:163], v40 offset:9216
v_mfma_f32_16x16x32_bf16 v[192:195], a[128:131], a[8:11], 0
v_mfma_f32_16x16x32_bf16 v[224:227], a[128:131], a[12:15], 0
ds_read_b64_tr_b16 a[164:165], v40 offset:8200
v_mfma_f32_16x16x32_bf16 v[132:135], a[132:135], a[0:3], 0
s_bfe_u32 s3, s74, 0x80008
s_lshl_b32 s3, s3, 8
s_add_u32 s3, s3, s28
buffer_load_dwordx4 a[36:39], v11, s[20:23], s3 offen offset:0
ds_read_b64_tr_b16 a[166:167], v40 offset:9224
v_mfma_f32_16x16x32_bf16 v[164:167], a[132:135], a[4:7], 0
v_mfma_f32_16x16x32_bf16 v[196:199], a[132:135], a[8:11], 0
ds_read_b64_tr_b16 a[168:169], v41 offset:8192
v_mfma_f32_16x16x32_bf16 v[228:231], a[132:135], a[12:15], 0
ds_read_b64_tr_b16 a[170:171], v41 offset:9216
v_mfma_f32_16x16x32_bf16 v[136:139], a[136:139], a[0:3], 0
s_bfe_u32 s3, s74, 0x80008
s_lshl_b32 s3, s3, 8
s_add_u32 s3, s3, s28
buffer_load_dwordx4 a[52:55], v11, s[20:23], s3 offen offset:1024
v_mfma_f32_16x16x32_bf16 v[168:171], a[136:139], a[4:7], 0
ds_read_b64_tr_b16 a[172:173], v41 offset:8200
v_mfma_f32_16x16x32_bf16 v[200:203], a[136:139], a[8:11], 0
ds_read_b64_tr_b16 a[174:175], v41 offset:9224
v_mfma_f32_16x16x32_bf16 v[232:235], a[136:139], a[12:15], 0
v_mfma_f32_16x16x32_bf16 v[140:143], a[140:143], a[0:3], 0
s_bfe_u32 s3, s74, 0x80008
s_lshl_b32 s3, s3, 8
s_add_u32 s3, s3, s29
buffer_load_dwordx4 a[40:43], v11, s[20:23], s3 offen offset:0
ds_read_b64_tr_b16 a[176:177], v42 offset:8192
v_mfma_f32_16x16x32_bf16 v[172:175], a[140:143], a[4:7], 0
ds_read_b64_tr_b16 a[178:179], v42 offset:9216
v_mfma_f32_16x16x32_bf16 v[204:207], a[140:143], a[8:11], 0
v_mfma_f32_16x16x32_bf16 v[236:239], a[140:143], a[12:15], 0
ds_read_b64_tr_b16 a[180:181], v42 offset:8200
v_mfma_f32_16x16x32_bf16 v[144:147], a[144:147], a[0:3], 0
s_bfe_u32 s3, s74, 0x80008
s_lshl_b32 s3, s3, 8
s_add_u32 s3, s3, s29
buffer_load_dwordx4 a[56:59], v11, s[20:23], s3 offen offset:1024
ds_read_b64_tr_b16 a[182:183], v42 offset:9224
v_mfma_f32_16x16x32_bf16 v[176:179], a[144:147], a[4:7], 0
v_mfma_f32_16x16x32_bf16 v[208:211], a[144:147], a[8:11], 0
ds_read_b64_tr_b16 a[184:185], v43 offset:8192
v_mfma_f32_16x16x32_bf16 v[240:243], a[144:147], a[12:15], 0
ds_read_b64_tr_b16 a[186:187], v43 offset:9216
v_mfma_f32_16x16x32_bf16 v[148:151], a[148:151], a[0:3], 0
s_bfe_u32 s3, s74, 0x80008
s_lshl_b32 s3, s3, 8
s_add_u32 s3, s3, s45
buffer_load_dwordx4 a[44:47], v11, s[20:23], s3 offen offset:0
v_mfma_f32_16x16x32_bf16 v[180:183], a[148:151], a[4:7], 0
ds_read_b64_tr_b16 a[188:189], v43 offset:8200
v_mfma_f32_16x16x32_bf16 v[212:215], a[148:151], a[8:11], 0
ds_read_b64_tr_b16 a[190:191], v43 offset:9224
v_mfma_f32_16x16x32_bf16 v[244:247], a[148:151], a[12:15], 0
v_mfma_f32_16x16x32_bf16 v[152:155], a[152:155], a[0:3], 0
s_bfe_u32 s3, s74, 0x80008
s_lshl_b32 s3, s3, 8
s_add_u32 s3, s3, s45
buffer_load_dwordx4 a[60:63], v11, s[20:23], s3 offen offset:1024
v_mfma_f32_16x16x32_bf16 v[184:187], a[152:155], a[4:7], 0
v_mfma_f32_16x16x32_bf16 v[216:219], a[152:155], a[8:11], 0
v_mfma_f32_16x16x32_bf16 v[248:251], a[152:155], a[12:15], 0
v_mfma_f32_16x16x32_bf16 v[156:159], a[156:159], a[0:3], 0
v_mfma_f32_16x16x32_bf16 v[188:191], a[156:159], a[4:7], 0
s_add_u32 m0, s55, 16384
s_bfe_u32 s3, s74, 0x80008
s_lshl_b32 s3, s3, 16
s_add_u32 s3, s3, s44
buffer_load_dwordx4 v38, s[12:15], s3 offen lds
v_mfma_f32_16x16x32_bf16 v[220:223], a[156:159], a[8:11], 0
v_mfma_f32_16x16x32_bf16 v[252:255], a[156:159], a[12:15], 0
s_add_u32 m0, s55, 17408
s_bfe_u32 s3, s74, 0x80008
s_lshl_b32 s3, s3, 16
s_add_u32 s3, s3, s44
s_add_u32 s3, s3, 32768
buffer_load_dwordx4 v38, s[12:15], s3 offen lds
s_add_u32 m0, s55, 18432
s_bfe_u32 s3, s74, 0x80008
s_lshl_b32 s3, s3, 16
s_add_u32 s3, s3, s44
s_add_u32 s3, s3, 65536
buffer_load_dwordx4 v39, s[12:15], s3 offen lds
s_add_u32 m0, s55, 19456
s_bfe_u32 s3, s74, 0x80008
s_lshl_b32 s3, s3, 16
s_add_u32 s3, s3, s44
s_add_u32 s3, s3, 98304
buffer_load_dwordx4 v39, s[12:15], s3 offen lds
s_waitcnt vmcnt(0) lgkmcnt(0)
s_barrier
v_mfma_f32_16x16x32_bf16 v[128:131], a[160:163], a[16:19], v[128:131]
ds_read_b64_tr_b16 a[128:129], v40 offset:16384
v_mfma_f32_16x16x32_bf16 v[160:163], a[160:163], a[20:23], v[160:163]
ds_read_b64_tr_b16 a[130:131], v40 offset:17408
s_add_u32 m0, s55, 32768
s_bfe_u32 s3, s74, 0x80010
s_lshl_b32 s3, s3, 16
s_add_u32 s3, s3, s44
buffer_load_dwordx4 v38, s[12:15], s3 offen lds
v_mfma_f32_16x16x32_bf16 v[192:195], a[160:163], a[24:27], v[192:195]
v_mfma_f32_16x16x32_bf16 v[224:227], a[160:163], a[28:31], v[224:227]
ds_read_b64_tr_b16 a[132:133], v40 offset:16392
v_mfma_f32_16x16x32_bf16 v[132:135], a[164:167], a[16:19], v[132:135]
ds_read_b64_tr_b16 a[134:135], v40 offset:17416
v_mfma_f32_16x16x32_bf16 v[164:167], a[164:167], a[20:23], v[164:167]
s_add_u32 m0, s55, 33792
s_bfe_u32 s3, s74, 0x80010
s_lshl_b32 s3, s3, 16
s_add_u32 s3, s3, s44
s_add_u32 s3, s3, 32768
buffer_load_dwordx4 v38, s[12:15], s3 offen lds
v_mfma_f32_16x16x32_bf16 v[196:199], a[164:167], a[24:27], v[196:199]
ds_read_b64_tr_b16 a[136:137], v41 offset:16384
v_mfma_f32_16x16x32_bf16 v[228:231], a[164:167], a[28:31], v[228:231]
ds_read_b64_tr_b16 a[138:139], v41 offset:17408
v_mfma_f32_16x16x32_bf16 v[136:139], a[168:171], a[16:19], v[136:139]
v_mfma_f32_16x16x32_bf16 v[168:171], a[168:171], a[20:23], v[168:171]
s_add_u32 m0, s55, 34816
s_bfe_u32 s3, s74, 0x80010
s_lshl_b32 s3, s3, 16
s_add_u32 s3, s3, s44
s_add_u32 s3, s3, 65536
buffer_load_dwordx4 v39, s[12:15], s3 offen lds
ds_read_b64_tr_b16 a[140:141], v41 offset:16392
v_mfma_f32_16x16x32_bf16 v[200:203], a[168:171], a[24:27], v[200:203]
ds_read_b64_tr_b16 a[142:143], v41 offset:17416
v_mfma_f32_16x16x32_bf16 v[232:235], a[168:171], a[28:31], v[232:235]
v_mfma_f32_16x16x32_bf16 v[140:143], a[172:175], a[16:19], v[140:143]
ds_read_b64_tr_b16 a[144:145], v42 offset:16384
v_mfma_f32_16x16x32_bf16 v[172:175], a[172:175], a[20:23], v[172:175]
s_add_u32 m0, s55, 35840
s_bfe_u32 s3, s74, 0x80010
s_lshl_b32 s3, s3, 16
s_add_u32 s3, s3, s44
s_add_u32 s3, s3, 98304
buffer_load_dwordx4 v39, s[12:15], s3 offen lds
ds_read_b64_tr_b16 a[146:147], v42 offset:17408
v_mfma_f32_16x16x32_bf16 v[204:207], a[172:175], a[24:27], v[204:207]
v_mfma_f32_16x16x32_bf16 v[236:239], a[172:175], a[28:31], v[236:239]
ds_read_b64_tr_b16 a[148:149], v42 offset:16392
v_mfma_f32_16x16x32_bf16 v[144:147], a[176:179], a[16:19], v[144:147]
ds_read_b64_tr_b16 a[150:151], v42 offset:17416
v_mfma_f32_16x16x32_bf16 v[176:179], a[176:179], a[20:23], v[176:179]
s_bfe_u32 s3, s74, 0x80010
s_lshl_b32 s3, s3, 8
s_add_u32 s3, s3, s27
buffer_load_dwordx4 a[64:67], v11, s[20:23], s3 offen offset:0
v_mfma_f32_16x16x32_bf16 v[208:211], a[176:179], a[24:27], v[208:211]
ds_read_b64_tr_b16 a[152:153], v43 offset:16384
v_mfma_f32_16x16x32_bf16 v[240:243], a[176:179], a[28:31], v[240:243]
ds_read_b64_tr_b16 a[154:155], v43 offset:17408
v_mfma_f32_16x16x32_bf16 v[148:151], a[180:183], a[16:19], v[148:151]
v_mfma_f32_16x16x32_bf16 v[180:183], a[180:183], a[20:23], v[180:183]
s_bfe_u32 s3, s74, 0x80010
s_lshl_b32 s3, s3, 8
s_add_u32 s3, s3, s27
buffer_load_dwordx4 a[80:83], v11, s[20:23], s3 offen offset:1024
ds_read_b64_tr_b16 a[156:157], v43 offset:16392
v_mfma_f32_16x16x32_bf16 v[212:215], a[180:183], a[24:27], v[212:215]
ds_read_b64_tr_b16 a[158:159], v43 offset:17416
v_mfma_f32_16x16x32_bf16 v[244:247], a[180:183], a[28:31], v[244:247]
v_mfma_f32_16x16x32_bf16 v[152:155], a[184:187], a[16:19], v[152:155]
v_mfma_f32_16x16x32_bf16 v[184:187], a[184:187], a[20:23], v[184:187]
s_bfe_u32 s3, s74, 0x80010
s_lshl_b32 s3, s3, 8
s_add_u32 s3, s3, s28
buffer_load_dwordx4 a[68:71], v11, s[20:23], s3 offen offset:0
v_mfma_f32_16x16x32_bf16 v[216:219], a[184:187], a[24:27], v[216:219]
v_mfma_f32_16x16x32_bf16 v[248:251], a[184:187], a[28:31], v[248:251]
v_mfma_f32_16x16x32_bf16 v[156:159], a[188:191], a[16:19], v[156:159]
v_mfma_f32_16x16x32_bf16 v[188:191], a[188:191], a[20:23], v[188:191]
v_mfma_f32_16x16x32_bf16 v[220:223], a[188:191], a[24:27], v[220:223]
s_bfe_u32 s3, s74, 0x80010
s_lshl_b32 s3, s3, 8
s_add_u32 s3, s3, s28
buffer_load_dwordx4 a[84:87], v11, s[20:23], s3 offen offset:1024
v_mfma_f32_16x16x32_bf16 v[252:255], a[188:191], a[28:31], v[252:255]
s_mov_b32 s56, s78
s_mov_b32 s57, s79
s_mov_b32 s58, 0xa2000
s_mov_b32 s59, 0x00020000
s_mul_i32 s35, s0, 5184
v_lshlrev_b32 v21, 7, v0
buffer_load_dword v10, v21, s[56:59], s35 offen
s_mov_b32 s56, s86
s_mov_b32 s57, s87
s_mov_b32 s58, 0x100
s_mov_b32 s59, 0x00020000
s_waitcnt vmcnt(9) lgkmcnt(0)
v_mfma_f32_16x16x32_bf16 v[128:131], a[128:131], a[32:35], v[128:131]
ds_read_b64_tr_b16 a[160:161], v40 offset:24576
v_mfma_f32_16x16x32_bf16 v[160:163], a[128:131], a[36:39], v[160:163]
ds_read_b64_tr_b16 a[162:163], v40 offset:25600
v_mfma_f32_16x16x32_bf16 v[192:195], a[128:131], a[40:43], v[192:195]
s_bfe_u32 s3, s74, 0x80010
s_lshl_b32 s3, s3, 8
s_add_u32 s3, s3, s29
buffer_load_dwordx4 a[72:75], v11, s[20:23], s3 offen offset:0
v_mfma_f32_16x16x32_bf16 v[224:227], a[128:131], a[44:47], v[224:227]
ds_read_b64_tr_b16 a[164:165], v40 offset:24584
v_mfma_f32_16x16x32_bf16 v[132:135], a[132:135], a[32:35], v[132:135]
ds_read_b64_tr_b16 a[166:167], v40 offset:25608
v_mfma_f32_16x16x32_bf16 v[164:167], a[132:135], a[36:39], v[164:167]
v_mfma_f32_16x16x32_bf16 v[196:199], a[132:135], a[40:43], v[196:199]
s_bfe_u32 s3, s74, 0x80010
s_lshl_b32 s3, s3, 8
s_add_u32 s3, s3, s29
buffer_load_dwordx4 a[88:91], v11, s[20:23], s3 offen offset:1024
ds_read_b64_tr_b16 a[168:169], v41 offset:24576
v_mfma_f32_16x16x32_bf16 v[228:231], a[132:135], a[44:47], v[228:231]
ds_read_b64_tr_b16 a[170:171], v41 offset:25600
v_mfma_f32_16x16x32_bf16 v[136:139], a[136:139], a[32:35], v[136:139]
v_mfma_f32_16x16x32_bf16 v[168:171], a[136:139], a[36:39], v[168:171]
ds_read_b64_tr_b16 a[172:173], v41 offset:24584
v_mfma_f32_16x16x32_bf16 v[200:203], a[136:139], a[40:43], v[200:203]
s_bfe_u32 s3, s74, 0x80010
s_lshl_b32 s3, s3, 8
s_add_u32 s3, s3, s45
buffer_load_dwordx4 a[76:79], v11, s[20:23], s3 offen offset:0
ds_read_b64_tr_b16 a[174:175], v41 offset:25608
v_mfma_f32_16x16x32_bf16 v[232:235], a[136:139], a[44:47], v[232:235]
v_mfma_f32_16x16x32_bf16 v[140:143], a[140:143], a[32:35], v[140:143]
ds_read_b64_tr_b16 a[176:177], v42 offset:24576
v_mfma_f32_16x16x32_bf16 v[172:175], a[140:143], a[36:39], v[172:175]
ds_read_b64_tr_b16 a[178:179], v42 offset:25600
v_mfma_f32_16x16x32_bf16 v[204:207], a[140:143], a[40:43], v[204:207]
s_bfe_u32 s3, s74, 0x80010
s_lshl_b32 s3, s3, 8
s_add_u32 s3, s3, s45
buffer_load_dwordx4 a[92:95], v11, s[20:23], s3 offen offset:1024
v_mfma_f32_16x16x32_bf16 v[236:239], a[140:143], a[44:47], v[236:239]
ds_read_b64_tr_b16 a[180:181], v42 offset:24584
v_mfma_f32_16x16x32_bf16 v[144:147], a[144:147], a[32:35], v[144:147]
ds_read_b64_tr_b16 a[182:183], v42 offset:25608
v_mfma_f32_16x16x32_bf16 v[176:179], a[144:147], a[36:39], v[176:179]
v_mfma_f32_16x16x32_bf16 v[208:211], a[144:147], a[40:43], v[208:211]
s_add_u32 m0, s55, 49152
s_bfe_u32 s3, s74, 0x80018
s_lshl_b32 s3, s3, 16
s_add_u32 s3, s3, s44
buffer_load_dwordx4 v38, s[12:15], s3 offen lds
ds_read_b64_tr_b16 a[184:185], v43 offset:24576
v_mfma_f32_16x16x32_bf16 v[240:243], a[144:147], a[44:47], v[240:243]
ds_read_b64_tr_b16 a[186:187], v43 offset:25600
v_mfma_f32_16x16x32_bf16 v[148:151], a[148:151], a[32:35], v[148:151]
v_mfma_f32_16x16x32_bf16 v[180:183], a[148:151], a[36:39], v[180:183]
ds_read_b64_tr_b16 a[188:189], v43 offset:24584
v_mfma_f32_16x16x32_bf16 v[212:215], a[148:151], a[40:43], v[212:215]
s_add_u32 m0, s55, 50176
s_bfe_u32 s3, s74, 0x80018
s_lshl_b32 s3, s3, 16
s_add_u32 s3, s3, s44
s_add_u32 s3, s3, 32768
buffer_load_dwordx4 v38, s[12:15], s3 offen lds
ds_read_b64_tr_b16 a[190:191], v43 offset:25608
v_mfma_f32_16x16x32_bf16 v[244:247], a[148:151], a[44:47], v[244:247]
v_mfma_f32_16x16x32_bf16 v[152:155], a[152:155], a[32:35], v[152:155]
v_mfma_f32_16x16x32_bf16 v[184:187], a[152:155], a[36:39], v[184:187]
v_mfma_f32_16x16x32_bf16 v[216:219], a[152:155], a[40:43], v[216:219]
v_mfma_f32_16x16x32_bf16 v[248:251], a[152:155], a[44:47], v[248:251]
s_add_u32 m0, s55, 51200
s_bfe_u32 s3, s74, 0x80018
s_lshl_b32 s3, s3, 16
s_add_u32 s3, s3, s44
s_add_u32 s3, s3, 65536
buffer_load_dwordx4 v39, s[12:15], s3 offen lds
v_mfma_f32_16x16x32_bf16 v[156:159], a[156:159], a[32:35], v[156:159]
v_mfma_f32_16x16x32_bf16 v[188:191], a[156:159], a[36:39], v[188:191]
v_mfma_f32_16x16x32_bf16 v[220:223], a[156:159], a[40:43], v[220:223]
v_mfma_f32_16x16x32_bf16 v[252:255], a[156:159], a[44:47], v[252:255]
s_waitcnt vmcnt(12) lgkmcnt(0)
s_barrier
v_mfma_f32_16x16x32_bf16 v[128:131], a[160:163], a[48:51], v[128:131]
s_add_u32 m0, s55, 52224
s_bfe_u32 s3, s74, 0x80018
s_lshl_b32 s3, s3, 16
s_add_u32 s3, s3, s44
s_add_u32 s3, s3, 98304
buffer_load_dwordx4 v39, s[12:15], s3 offen lds
ds_read_b64_tr_b16 a[128:129], v40 offset:32768
v_mfma_f32_16x16x32_bf16 v[160:163], a[160:163], a[52:55], v[160:163]
ds_read_b64_tr_b16 a[130:131], v40 offset:33792
v_mfma_f32_16x16x32_bf16 v[192:195], a[160:163], a[56:59], v[192:195]
v_mfma_f32_16x16x32_bf16 v[224:227], a[160:163], a[60:63], v[224:227]
ds_read_b64_tr_b16 a[132:133], v40 offset:32776
v_mfma_f32_16x16x32_bf16 v[132:135], a[164:167], a[48:51], v[132:135]
s_bfe_u32 s3, s74, 0x80018
s_lshl_b32 s3, s3, 8
s_add_u32 s3, s3, s27
buffer_load_dwordx4 a[96:99], v11, s[20:23], s3 offen offset:0
ds_read_b64_tr_b16 a[134:135], v40 offset:33800
v_mfma_f32_16x16x32_bf16 v[164:167], a[164:167], a[52:55], v[164:167]
v_mfma_f32_16x16x32_bf16 v[196:199], a[164:167], a[56:59], v[196:199]
ds_read_b64_tr_b16 a[136:137], v41 offset:32768
v_mfma_f32_16x16x32_bf16 v[228:231], a[164:167], a[60:63], v[228:231]
ds_read_b64_tr_b16 a[138:139], v41 offset:33792
v_mfma_f32_16x16x32_bf16 v[136:139], a[168:171], a[48:51], v[136:139]
s_bfe_u32 s3, s74, 0x80018
s_lshl_b32 s3, s3, 8
s_add_u32 s3, s3, s27
buffer_load_dwordx4 a[112:115], v11, s[20:23], s3 offen offset:1024
v_mfma_f32_16x16x32_bf16 v[168:171], a[168:171], a[52:55], v[168:171]
ds_read_b64_tr_b16 a[140:141], v41 offset:32776
v_mfma_f32_16x16x32_bf16 v[200:203], a[168:171], a[56:59], v[200:203]
ds_read_b64_tr_b16 a[142:143], v41 offset:33800
v_mfma_f32_16x16x32_bf16 v[232:235], a[168:171], a[60:63], v[232:235]
v_mfma_f32_16x16x32_bf16 v[140:143], a[172:175], a[48:51], v[140:143]
s_bfe_u32 s3, s74, 0x80018
s_lshl_b32 s3, s3, 8
s_add_u32 s3, s3, s28
buffer_load_dwordx4 a[100:103], v11, s[20:23], s3 offen offset:0
ds_read_b64_tr_b16 a[144:145], v42 offset:32768
v_mfma_f32_16x16x32_bf16 v[172:175], a[172:175], a[52:55], v[172:175]
ds_read_b64_tr_b16 a[146:147], v42 offset:33792
v_mfma_f32_16x16x32_bf16 v[204:207], a[172:175], a[56:59], v[204:207]
v_mfma_f32_16x16x32_bf16 v[236:239], a[172:175], a[60:63], v[236:239]
ds_read_b64_tr_b16 a[148:149], v42 offset:32776
v_mfma_f32_16x16x32_bf16 v[144:147], a[176:179], a[48:51], v[144:147]
s_bfe_u32 s3, s74, 0x80018
s_lshl_b32 s3, s3, 8
s_add_u32 s3, s3, s28
buffer_load_dwordx4 a[116:119], v11, s[20:23], s3 offen offset:1024
ds_read_b64_tr_b16 a[150:151], v42 offset:33800
v_mfma_f32_16x16x32_bf16 v[176:179], a[176:179], a[52:55], v[176:179]
v_mfma_f32_16x16x32_bf16 v[208:211], a[176:179], a[56:59], v[208:211]
ds_read_b64_tr_b16 a[152:153], v43 offset:32768
v_mfma_f32_16x16x32_bf16 v[240:243], a[176:179], a[60:63], v[240:243]
ds_read_b64_tr_b16 a[154:155], v43 offset:33792
v_mfma_f32_16x16x32_bf16 v[148:151], a[180:183], a[48:51], v[148:151]
s_bfe_u32 s3, s74, 0x80018
s_lshl_b32 s3, s3, 8
s_add_u32 s3, s3, s29
buffer_load_dwordx4 a[104:107], v11, s[20:23], s3 offen offset:0
v_mfma_f32_16x16x32_bf16 v[180:183], a[180:183], a[52:55], v[180:183]
ds_read_b64_tr_b16 a[156:157], v43 offset:32776
v_mfma_f32_16x16x32_bf16 v[212:215], a[180:183], a[56:59], v[212:215]
ds_read_b64_tr_b16 a[158:159], v43 offset:33800
v_mfma_f32_16x16x32_bf16 v[244:247], a[180:183], a[60:63], v[244:247]
v_mfma_f32_16x16x32_bf16 v[152:155], a[184:187], a[48:51], v[152:155]
s_bfe_u32 s3, s74, 0x80018
s_lshl_b32 s3, s3, 8
s_add_u32 s3, s3, s29
buffer_load_dwordx4 a[120:123], v11, s[20:23], s3 offen offset:1024
v_mfma_f32_16x16x32_bf16 v[184:187], a[184:187], a[52:55], v[184:187]
v_mfma_f32_16x16x32_bf16 v[216:219], a[184:187], a[56:59], v[216:219]
v_mfma_f32_16x16x32_bf16 v[248:251], a[184:187], a[60:63], v[248:251]
v_mfma_f32_16x16x32_bf16 v[156:159], a[188:191], a[48:51], v[156:159]
v_mfma_f32_16x16x32_bf16 v[188:191], a[188:191], a[52:55], v[188:191]
s_bfe_u32 s3, s74, 0x80018
s_lshl_b32 s3, s3, 8
s_add_u32 s3, s3, s45
buffer_load_dwordx4 a[108:111], v11, s[20:23], s3 offen offset:0
v_mfma_f32_16x16x32_bf16 v[220:223], a[188:191], a[56:59], v[220:223]
v_mfma_f32_16x16x32_bf16 v[252:255], a[188:191], a[60:63], v[252:255]
s_waitcnt vmcnt(11) lgkmcnt(0)
v_mfma_f32_16x16x32_bf16 v[128:131], a[128:131], a[64:67], v[128:131]
ds_read_b64_tr_b16 a[160:161], v40 offset:40960
v_mfma_f32_16x16x32_bf16 v[160:163], a[128:131], a[68:71], v[160:163]
s_bfe_u32 s3, s74, 0x80018
s_lshl_b32 s3, s3, 8
s_add_u32 s3, s3, s45
buffer_load_dwordx4 a[124:127], v11, s[20:23], s3 offen offset:1024
ds_read_b64_tr_b16 a[162:163], v40 offset:41984
v_mfma_f32_16x16x32_bf16 v[192:195], a[128:131], a[72:75], v[192:195]
v_mfma_f32_16x16x32_bf16 v[224:227], a[128:131], a[76:79], v[224:227]
ds_read_b64_tr_b16 a[164:165], v40 offset:40968
v_mfma_f32_16x16x32_bf16 v[132:135], a[132:135], a[64:67], v[132:135]
ds_read_b64_tr_b16 a[166:167], v40 offset:41992
v_mfma_f32_16x16x32_bf16 v[164:167], a[132:135], a[68:71], v[164:167]
s_add_u32 m0, s55, 65536
s_bfe_u32 s3, s75, 0x80000
s_lshl_b32 s3, s3, 16
s_add_u32 s3, s3, s44
buffer_load_dwordx4 v38, s[12:15], s3 offen lds
v_mfma_f32_16x16x32_bf16 v[196:199], a[132:135], a[72:75], v[196:199]
ds_read_b64_tr_b16 a[168:169], v41 offset:40960
v_mfma_f32_16x16x32_bf16 v[228:231], a[132:135], a[76:79], v[228:231]
ds_read_b64_tr_b16 a[170:171], v41 offset:41984
v_mfma_f32_16x16x32_bf16 v[136:139], a[136:139], a[64:67], v[136:139]
v_mfma_f32_16x16x32_bf16 v[168:171], a[136:139], a[68:71], v[168:171]
s_add_u32 m0, s55, 66560
s_bfe_u32 s3, s75, 0x80000
s_lshl_b32 s3, s3, 16
s_add_u32 s3, s3, s44
s_add_u32 s3, s3, 32768
buffer_load_dwordx4 v38, s[12:15], s3 offen lds
ds_read_b64_tr_b16 a[172:173], v41 offset:40968
v_mfma_f32_16x16x32_bf16 v[200:203], a[136:139], a[72:75], v[200:203]
ds_read_b64_tr_b16 a[174:175], v41 offset:41992
v_mfma_f32_16x16x32_bf16 v[232:235], a[136:139], a[76:79], v[232:235]
v_mfma_f32_16x16x32_bf16 v[140:143], a[140:143], a[64:67], v[140:143]
ds_read_b64_tr_b16 a[176:177], v42 offset:40960
v_mfma_f32_16x16x32_bf16 v[172:175], a[140:143], a[68:71], v[172:175]
s_add_u32 m0, s55, 67584
s_bfe_u32 s3, s75, 0x80000
s_lshl_b32 s3, s3, 16
s_add_u32 s3, s3, s44
s_add_u32 s3, s3, 65536
buffer_load_dwordx4 v39, s[12:15], s3 offen lds
ds_read_b64_tr_b16 a[178:179], v42 offset:41984
v_mfma_f32_16x16x32_bf16 v[204:207], a[140:143], a[72:75], v[204:207]
v_mfma_f32_16x16x32_bf16 v[236:239], a[140:143], a[76:79], v[236:239]
ds_read_b64_tr_b16 a[180:181], v42 offset:40968
v_mfma_f32_16x16x32_bf16 v[144:147], a[144:147], a[64:67], v[144:147]
ds_read_b64_tr_b16 a[182:183], v42 offset:41992
v_mfma_f32_16x16x32_bf16 v[176:179], a[144:147], a[68:71], v[176:179]
s_add_u32 m0, s55, 68608
s_bfe_u32 s3, s75, 0x80000
s_lshl_b32 s3, s3, 16
s_add_u32 s3, s3, s44
s_add_u32 s3, s3, 98304
buffer_load_dwordx4 v39, s[12:15], s3 offen lds
v_mfma_f32_16x16x32_bf16 v[208:211], a[144:147], a[72:75], v[208:211]
ds_read_b64_tr_b16 a[184:185], v43 offset:40960
v_mfma_f32_16x16x32_bf16 v[240:243], a[144:147], a[76:79], v[240:243]
ds_read_b64_tr_b16 a[186:187], v43 offset:41984
v_mfma_f32_16x16x32_bf16 v[148:151], a[148:151], a[64:67], v[148:151]
v_mfma_f32_16x16x32_bf16 v[180:183], a[148:151], a[68:71], v[180:183]
s_bfe_u32 s3, s75, 0x80000
s_lshl_b32 s3, s3, 8
s_add_u32 s3, s3, s27
buffer_load_dwordx4 a[192:195], v11, s[20:23], s3 offen offset:0
ds_read_b64_tr_b16 a[188:189], v43 offset:40968
v_mfma_f32_16x16x32_bf16 v[212:215], a[148:151], a[72:75], v[212:215]
ds_read_b64_tr_b16 a[190:191], v43 offset:41992
v_mfma_f32_16x16x32_bf16 v[244:247], a[148:151], a[76:79], v[244:247]
v_mfma_f32_16x16x32_bf16 v[152:155], a[152:155], a[64:67], v[152:155]
v_mfma_f32_16x16x32_bf16 v[184:187], a[152:155], a[68:71], v[184:187]
s_bfe_u32 s3, s75, 0x80000
s_lshl_b32 s3, s3, 8
s_add_u32 s3, s3, s27
buffer_load_dwordx4 a[208:211], v11, s[20:23], s3 offen offset:1024
v_mfma_f32_16x16x32_bf16 v[216:219], a[152:155], a[72:75], v[216:219]
v_mfma_f32_16x16x32_bf16 v[248:251], a[152:155], a[76:79], v[248:251]
v_mfma_f32_16x16x32_bf16 v[156:159], a[156:159], a[64:67], v[156:159]
v_mfma_f32_16x16x32_bf16 v[188:191], a[156:159], a[68:71], v[188:191]
v_mfma_f32_16x16x32_bf16 v[220:223], a[156:159], a[72:75], v[220:223]
s_bfe_u32 s3, s75, 0x80000
s_lshl_b32 s3, s3, 8
s_add_u32 s3, s3, s28
buffer_load_dwordx4 a[196:199], v11, s[20:23], s3 offen offset:0
v_mfma_f32_16x16x32_bf16 v[252:255], a[156:159], a[76:79], v[252:255]
s_waitcnt vmcnt(15) lgkmcnt(0)
s_barrier
s_lshl_b32 s33, s48, 2
s_cmp_lg_u32 s24, 0
s_cbranch_scc1 L_sig3
v_mov_b32 v12, 0
v_mov_b32 v13, 0x1
s_mov_b64 exec, 1
buffer_atomic_add v13, v12, s[56:59], s33 offen
s_mov_b64 exec, -1
L_sig3:
v_mfma_f32_16x16x32_bf16 v[128:131], a[160:163], a[80:83], v[128:131]
ds_read_b64_tr_b16 a[128:129], v40 offset:49152
v_mfma_f32_16x16x32_bf16 v[160:163], a[160:163], a[84:87], v[160:163]
ds_read_b64_tr_b16 a[130:131], v40 offset:50176
v_mfma_f32_16x16x32_bf16 v[192:195], a[160:163], a[88:91], v[192:195]
v_mfma_f32_16x16x32_bf16 v[224:227], a[160:163], a[92:95], v[224:227]
s_bfe_u32 s3, s75, 0x80000
s_lshl_b32 s3, s3, 8
s_add_u32 s3, s3, s28
buffer_load_dwordx4 a[212:215], v11, s[20:23], s3 offen offset:1024
ds_read_b64_tr_b16 a[132:133], v40 offset:49160
v_mfma_f32_16x16x32_bf16 v[132:135], a[164:167], a[80:83], v[132:135]
ds_read_b64_tr_b16 a[134:135], v40 offset:50184
v_mfma_f32_16x16x32_bf16 v[164:167], a[164:167], a[84:87], v[164:167]
v_mfma_f32_16x16x32_bf16 v[196:199], a[164:167], a[88:91], v[196:199]
ds_read_b64_tr_b16 a[136:137], v41 offset:49152
v_mfma_f32_16x16x32_bf16 v[228:231], a[164:167], a[92:95], v[228:231]
s_bfe_u32 s3, s75, 0x80000
s_lshl_b32 s3, s3, 8
s_add_u32 s3, s3, s29
buffer_load_dwordx4 a[200:203], v11, s[20:23], s3 offen offset:0
ds_read_b64_tr_b16 a[138:139], v41 offset:50176
v_mfma_f32_16x16x32_bf16 v[136:139], a[168:171], a[80:83], v[136:139]
v_mfma_f32_16x16x32_bf16 v[168:171], a[168:171], a[84:87], v[168:171]
ds_read_b64_tr_b16 a[140:141], v41 offset:49160
v_mfma_f32_16x16x32_bf16 v[200:203], a[168:171], a[88:91], v[200:203]
ds_read_b64_tr_b16 a[142:143], v41 offset:50184
v_mfma_f32_16x16x32_bf16 v[232:235], a[168:171], a[92:95], v[232:235]
s_bfe_u32 s3, s75, 0x80000
s_lshl_b32 s3, s3, 8
s_add_u32 s3, s3, s29
buffer_load_dwordx4 a[216:219], v11, s[20:23], s3 offen offset:1024
v_mfma_f32_16x16x32_bf16 v[140:143], a[172:175], a[80:83], v[140:143]
ds_read_b64_tr_b16 a[144:145], v42 offset:49152
v_mfma_f32_16x16x32_bf16 v[172:175], a[172:175], a[84:87], v[172:175]
ds_read_b64_tr_b16 a[146:147], v42 offset:50176
v_mfma_f32_16x16x32_bf16 v[204:207], a[172:175], a[88:91], v[204:207]
v_mfma_f32_16x16x32_bf16 v[236:239], a[172:175], a[92:95], v[236:239]
s_bfe_u32 s3, s75, 0x80000
s_lshl_b32 s3, s3, 8
s_add_u32 s3, s3, s45
buffer_load_dwordx4 a[204:207], v11, s[20:23], s3 offen offset:0
ds_read_b64_tr_b16 a[148:149], v42 offset:49160
v_mfma_f32_16x16x32_bf16 v[144:147], a[176:179], a[80:83], v[144:147]
ds_read_b64_tr_b16 a[150:151], v42 offset:50184
v_mfma_f32_16x16x32_bf16 v[176:179], a[176:179], a[84:87], v[176:179]
v_mfma_f32_16x16x32_bf16 v[208:211], a[176:179], a[88:91], v[208:211]
ds_read_b64_tr_b16 a[152:153], v43 offset:49152
v_mfma_f32_16x16x32_bf16 v[240:243], a[176:179], a[92:95], v[240:243]
s_bfe_u32 s3, s75, 0x80000
s_lshl_b32 s3, s3, 8
s_add_u32 s3, s3, s45
buffer_load_dwordx4 a[220:223], v11, s[20:23], s3 offen offset:1024
ds_read_b64_tr_b16 a[154:155], v43 offset:50176
v_mfma_f32_16x16x32_bf16 v[148:151], a[180:183], a[80:83], v[148:151]
v_mfma_f32_16x16x32_bf16 v[180:183], a[180:183], a[84:87], v[180:183]
ds_read_b64_tr_b16 a[156:157], v43 offset:49160
v_mfma_f32_16x16x32_bf16 v[212:215], a[180:183], a[88:91], v[212:215]
ds_read_b64_tr_b16 a[158:159], v43 offset:50184
v_mfma_f32_16x16x32_bf16 v[244:247], a[180:183], a[92:95], v[244:247]
s_bfe_u32 s3, s75, 0x80008
s_lshl_b32 s3, s3, 8
s_add_u32 s3, s3, s27
buffer_load_dwordx4 a[224:227], v11, s[20:23], s3 offen offset:0
v_mfma_f32_16x16x32_bf16 v[152:155], a[184:187], a[80:83], v[152:155]
v_mfma_f32_16x16x32_bf16 v[184:187], a[184:187], a[84:87], v[184:187]
v_mfma_f32_16x16x32_bf16 v[216:219], a[184:187], a[88:91], v[216:219]
v_mfma_f32_16x16x32_bf16 v[248:251], a[184:187], a[92:95], v[248:251]
v_mfma_f32_16x16x32_bf16 v[156:159], a[188:191], a[80:83], v[156:159]
s_bfe_u32 s3, s75, 0x80008
s_lshl_b32 s3, s3, 8
s_add_u32 s3, s3, s27
buffer_load_dwordx4 a[240:243], v11, s[20:23], s3 offen offset:1024
v_mfma_f32_16x16x32_bf16 v[188:191], a[188:191], a[84:87], v[188:191]
v_mfma_f32_16x16x32_bf16 v[220:223], a[188:191], a[88:91], v[220:223]
v_mfma_f32_16x16x32_bf16 v[252:255], a[188:191], a[92:95], v[252:255]
s_waitcnt vmcnt(14) lgkmcnt(0)
v_mfma_f32_16x16x32_bf16 v[128:131], a[128:131], a[96:99], v[128:131]
ds_read_b64_tr_b16 a[160:161], v40 offset:57344
s_bfe_u32 s3, s1, 0x80000
s_lshl_b32 s3, s3, 8
s_add_u32 s3, s3, s27
buffer_load_dwordx4 a[64:67], v11, s[20:23], s3 offen offset:0
v_mfma_f32_16x16x32_bf16 v[160:163], a[128:131], a[100:103], v[160:163]
ds_read_b64_tr_b16 a[162:163], v40 offset:58368
v_mfma_f32_16x16x32_bf16 v[192:195], a[128:131], a[104:107], v[192:195]
v_mfma_f32_16x16x32_bf16 v[224:227], a[128:131], a[108:111], v[224:227]
ds_read_b64_tr_b16 a[164:165], v40 offset:57352
v_mfma_f32_16x16x32_bf16 v[132:135], a[132:135], a[96:99], v[132:135]
s_bfe_u32 s3, s1, 0x80000
s_lshl_b32 s3, s3, 8
s_add_u32 s3, s3, s27
buffer_load_dwordx4 a[80:83], v11, s[20:23], s3 offen offset:1024
ds_read_b64_tr_b16 a[166:167], v40 offset:58376
v_mfma_f32_16x16x32_bf16 v[164:167], a[132:135], a[100:103], v[164:167]
v_mfma_f32_16x16x32_bf16 v[196:199], a[132:135], a[104:107], v[196:199]
ds_read_b64_tr_b16 a[168:169], v41 offset:57344
v_mfma_f32_16x16x32_bf16 v[228:231], a[132:135], a[108:111], v[228:231]
ds_read_b64_tr_b16 a[170:171], v41 offset:58368
v_mfma_f32_16x16x32_bf16 v[136:139], a[136:139], a[96:99], v[136:139]
s_bfe_u32 s3, s1, 0x80000
s_lshl_b32 s3, s3, 8
s_add_u32 s3, s3, s28
buffer_load_dwordx4 a[68:71], v11, s[20:23], s3 offen offset:0
v_mfma_f32_16x16x32_bf16 v[168:171], a[136:139], a[100:103], v[168:171]
ds_read_b64_tr_b16 a[172:173], v41 offset:57352
v_mfma_f32_16x16x32_bf16 v[200:203], a[136:139], a[104:107], v[200:203]
ds_read_b64_tr_b16 a[174:175], v41 offset:58376
v_mfma_f32_16x16x32_bf16 v[232:235], a[136:139], a[108:111], v[232:235]
v_mfma_f32_16x16x32_bf16 v[140:143], a[140:143], a[96:99], v[140:143]
s_bfe_u32 s3, s1, 0x80000
s_lshl_b32 s3, s3, 8
s_add_u32 s3, s3, s28
buffer_load_dwordx4 a[84:87], v11, s[20:23], s3 offen offset:1024
ds_read_b64_tr_b16 a[176:177], v42 offset:57344
v_mfma_f32_16x16x32_bf16 v[172:175], a[140:143], a[100:103], v[172:175]
ds_read_b64_tr_b16 a[178:179], v42 offset:58368
v_mfma_f32_16x16x32_bf16 v[204:207], a[140:143], a[104:107], v[204:207]
v_mfma_f32_16x16x32_bf16 v[236:239], a[140:143], a[108:111], v[236:239]
ds_read_b64_tr_b16 a[180:181], v42 offset:57352
v_mfma_f32_16x16x32_bf16 v[144:147], a[144:147], a[96:99], v[144:147]
s_bfe_u32 s3, s1, 0x80000
s_lshl_b32 s3, s3, 8
s_add_u32 s3, s3, s29
buffer_load_dwordx4 a[72:75], v11, s[20:23], s3 offen offset:0
ds_read_b64_tr_b16 a[182:183], v42 offset:58376
v_mfma_f32_16x16x32_bf16 v[176:179], a[144:147], a[100:103], v[176:179]
v_mfma_f32_16x16x32_bf16 v[208:211], a[144:147], a[104:107], v[208:211]
ds_read_b64_tr_b16 a[184:185], v43 offset:57344
v_mfma_f32_16x16x32_bf16 v[240:243], a[144:147], a[108:111], v[240:243]
ds_read_b64_tr_b16 a[186:187], v43 offset:58368
v_mfma_f32_16x16x32_bf16 v[148:151], a[148:151], a[96:99], v[148:151]
s_bfe_u32 s3, s1, 0x80000
s_lshl_b32 s3, s3, 8
s_add_u32 s3, s3, s29
buffer_load_dwordx4 a[88:91], v11, s[20:23], s3 offen offset:1024
v_mfma_f32_16x16x32_bf16 v[180:183], a[148:151], a[100:103], v[180:183]
ds_read_b64_tr_b16 a[188:189], v43 offset:57352
v_mfma_f32_16x16x32_bf16 v[212:215], a[148:151], a[104:107], v[212:215]
ds_read_b64_tr_b16 a[190:191], v43 offset:58376
v_mfma_f32_16x16x32_bf16 v[244:247], a[148:151], a[108:111], v[244:247]
v_mfma_f32_16x16x32_bf16 v[152:155], a[152:155], a[96:99], v[152:155]
s_bfe_u32 s3, s1, 0x80000
s_lshl_b32 s3, s3, 8
s_add_u32 s3, s3, s45
buffer_load_dwordx4 a[76:79], v11, s[20:23], s3 offen offset:0
v_mfma_f32_16x16x32_bf16 v[184:187], a[152:155], a[100:103], v[184:187]
v_mfma_f32_16x16x32_bf16 v[216:219], a[152:155], a[104:107], v[216:219]
v_mfma_f32_16x16x32_bf16 v[248:251], a[152:155], a[108:111], v[248:251]
v_mfma_f32_16x16x32_bf16 v[156:159], a[156:159], a[96:99], v[156:159]
v_mfma_f32_16x16x32_bf16 v[188:191], a[156:159], a[100:103], v[188:191]
s_bfe_u32 s3, s1, 0x80000
s_lshl_b32 s3, s3, 8
s_add_u32 s3, s3, s45
buffer_load_dwordx4 a[92:95], v11, s[20:23], s3 offen offset:1024
v_mfma_f32_16x16x32_bf16 v[220:223], a[156:159], a[104:107], v[220:223]
v_mfma_f32_16x16x32_bf16 v[252:255], a[156:159], a[108:111], v[252:255]
s_waitcnt vmcnt(18) lgkmcnt(0)
s_barrier
v_add_u32 v40, 0x20000, v40
v_add_u32 v41, 0x20000, v41
s_bfe_u32 s3, s75, 0x80008
s_lshl_b32 s3, s3, 8
s_add_u32 s3, s3, s28
buffer_load_dwordx4 a[228:231], v11, s[20:23], s3 offen offset:0
v_add_u32 v42, 0x20000, v42
v_add_u32 v43, 0x20000, v43
v_mfma_f32_16x16x32_bf16 v[128:131], a[160:163], a[112:115], v[128:131]
ds_read_b64_tr_b16 a[128:129], v44 offset:0
v_mfma_f32_16x16x32_bf16 v[160:163], a[160:163], a[116:119], v[160:163]
ds_read_b64_tr_b16 a[130:131], v44 offset:1024
v_mfma_f32_16x16x32_bf16 v[192:195], a[160:163], a[120:123], v[192:195]
v_mfma_f32_16x16x32_bf16 v[224:227], a[160:163], a[124:127], v[224:227]
s_bfe_u32 s3, s75, 0x80008
s_lshl_b32 s3, s3, 8
s_add_u32 s3, s3, s28
buffer_load_dwordx4 a[244:247], v11, s[20:23], s3 offen offset:1024
ds_read_b64_tr_b16 a[132:133], v44 offset:8
v_mfma_f32_16x16x32_bf16 v[132:135], a[164:167], a[112:115], v[132:135]
ds_read_b64_tr_b16 a[134:135], v44 offset:1032
v_mfma_f32_16x16x32_bf16 v[164:167], a[164:167], a[116:119], v[164:167]
v_mfma_f32_16x16x32_bf16 v[196:199], a[164:167], a[120:123], v[196:199]
ds_read_b64_tr_b16 a[136:137], v45 offset:0
v_mfma_f32_16x16x32_bf16 v[228:231], a[164:167], a[124:127], v[228:231]
s_bfe_u32 s3, s75, 0x80008
s_lshl_b32 s3, s3, 8
s_add_u32 s3, s3, s29
buffer_load_dwordx4 a[232:235], v11, s[20:23], s3 offen offset:0
ds_read_b64_tr_b16 a[138:139], v45 offset:1024
v_mfma_f32_16x16x32_bf16 v[136:139], a[168:171], a[112:115], v[136:139]
v_mfma_f32_16x16x32_bf16 v[168:171], a[168:171], a[116:119], v[168:171]
ds_read_b64_tr_b16 a[140:141], v45 offset:8
v_mfma_f32_16x16x32_bf16 v[200:203], a[168:171], a[120:123], v[200:203]
ds_read_b64_tr_b16 a[142:143], v45 offset:1032
v_mfma_f32_16x16x32_bf16 v[232:235], a[168:171], a[124:127], v[232:235]
s_bfe_u32 s3, s75, 0x80008
s_lshl_b32 s3, s3, 8
s_add_u32 s3, s3, s29
buffer_load_dwordx4 a[248:251], v11, s[20:23], s3 offen offset:1024
v_mfma_f32_16x16x32_bf16 v[140:143], a[172:175], a[112:115], v[140:143]
ds_read_b64_tr_b16 a[144:145], v46 offset:0
v_mfma_f32_16x16x32_bf16 v[172:175], a[172:175], a[116:119], v[172:175]
ds_read_b64_tr_b16 a[146:147], v46 offset:1024
v_mfma_f32_16x16x32_bf16 v[204:207], a[172:175], a[120:123], v[204:207]
v_mfma_f32_16x16x32_bf16 v[236:239], a[172:175], a[124:127], v[236:239]
s_bfe_u32 s3, s75, 0x80008
s_lshl_b32 s3, s3, 8
s_add_u32 s3, s3, s45
buffer_load_dwordx4 a[236:239], v11, s[20:23], s3 offen offset:0
ds_read_b64_tr_b16 a[148:149], v46 offset:8
v_mfma_f32_16x16x32_bf16 v[144:147], a[176:179], a[112:115], v[144:147]
ds_read_b64_tr_b16 a[150:151], v46 offset:1032
v_mfma_f32_16x16x32_bf16 v[176:179], a[176:179], a[116:119], v[176:179]
v_mfma_f32_16x16x32_bf16 v[208:211], a[176:179], a[120:123], v[208:211]
ds_read_b64_tr_b16 a[152:153], v47 offset:0
v_mfma_f32_16x16x32_bf16 v[240:243], a[176:179], a[124:127], v[240:243]
s_bfe_u32 s3, s75, 0x80008
s_lshl_b32 s3, s3, 8
s_add_u32 s3, s3, s45
buffer_load_dwordx4 a[252:255], v11, s[20:23], s3 offen offset:1024
ds_read_b64_tr_b16 a[154:155], v47 offset:1024
v_mfma_f32_16x16x32_bf16 v[148:151], a[180:183], a[112:115], v[148:151]
v_mfma_f32_16x16x32_bf16 v[180:183], a[180:183], a[116:119], v[180:183]
ds_read_b64_tr_b16 a[156:157], v47 offset:8
v_mfma_f32_16x16x32_bf16 v[212:215], a[180:183], a[120:123], v[212:215]
ds_read_b64_tr_b16 a[158:159], v47 offset:1032
v_mfma_f32_16x16x32_bf16 v[244:247], a[180:183], a[124:127], v[244:247]
s_add_u32 m0, s55, 98304
s_bfe_u32 s3, s75, 0x80008
s_lshl_b32 s3, s3, 16
s_add_u32 s3, s3, s44
buffer_load_dwordx4 v38, s[12:15], s3 offen lds
v_mfma_f32_16x16x32_bf16 v[152:155], a[184:187], a[112:115], v[152:155]
v_mfma_f32_16x16x32_bf16 v[184:187], a[184:187], a[116:119], v[184:187]
v_mfma_f32_16x16x32_bf16 v[216:219], a[184:187], a[120:123], v[216:219]
v_mfma_f32_16x16x32_bf16 v[248:251], a[184:187], a[124:127], v[248:251]
v_mfma_f32_16x16x32_bf16 v[156:159], a[188:191], a[112:115], v[156:159]
s_add_u32 m0, s55, 99328
s_bfe_u32 s3, s75, 0x80008
s_lshl_b32 s3, s3, 16
s_add_u32 s3, s3, s44
s_add_u32 s3, s3, 32768
buffer_load_dwordx4 v38, s[12:15], s3 offen lds
v_mfma_f32_16x16x32_bf16 v[188:191], a[188:191], a[116:119], v[188:191]
v_mfma_f32_16x16x32_bf16 v[220:223], a[188:191], a[120:123], v[220:223]
v_mfma_f32_16x16x32_bf16 v[252:255], a[188:191], a[124:127], v[252:255]
s_lshl_b32 s33, s31, 19
s_and_b32 s35, s0, 31
s_lshl_b32 s35, s35, 11
s_add_u32 s35, s35, s33
v_and_b32 v12, 15, v0
v_lshlrev_b32 v12, 7, v12
s_mov_b32 s56, s66
s_mov_b32 s57, s67
s_mov_b32 s58, 0x1000000
s_mov_b32 s59, 0x00020000
buffer_load_dword v10, v12, s[56:59], s35 offen
s_mov_b32 s56, s68
s_mov_b32 s57, s69
s_mov_b32 s58, 0x1000000
s_mov_b32 s59, 0x00020000
buffer_load_dword v10, v12, s[56:59], s35 offen
s_mov_b32 s56, s86
s_mov_b32 s57, s87
s_mov_b32 s58, 0x100
s_mov_b32 s59, 0x00020000
s_waitcnt vmcnt(20) lgkmcnt(0)
v_mfma_f32_16x16x32_bf16 v[128:131], a[128:131], a[192:195], v[128:131]
ds_read_b64_tr_b16 a[160:161], v44 offset:8192
v_mfma_f32_16x16x32_bf16 v[160:163], a[128:131], a[196:199], v[160:163]
ds_read_b64_tr_b16 a[162:163], v44 offset:9216
v_mfma_f32_16x16x32_bf16 v[192:195], a[128:131], a[200:203], v[192:195]
s_add_u32 m0, s55, 100352
s_bfe_u32 s3, s75, 0x80008
s_lshl_b32 s3, s3, 16
s_add_u32 s3, s3, s44
s_add_u32 s3, s3, 65536
buffer_load_dwordx4 v39, s[12:15], s3 offen lds
v_mfma_f32_16x16x32_bf16 v[224:227], a[128:131], a[204:207], v[224:227]
ds_read_b64_tr_b16 a[164:165], v44 offset:8200
v_mfma_f32_16x16x32_bf16 v[132:135], a[132:135], a[192:195], v[132:135]
ds_read_b64_tr_b16 a[166:167], v44 offset:9224
v_mfma_f32_16x16x32_bf16 v[164:167], a[132:135], a[196:199], v[164:167]
v_mfma_f32_16x16x32_bf16 v[196:199], a[132:135], a[200:203], v[196:199]
s_add_u32 m0, s55, 101376
s_bfe_u32 s3, s75, 0x80008
s_lshl_b32 s3, s3, 16
s_add_u32 s3, s3, s44
s_add_u32 s3, s3, 98304
buffer_load_dwordx4 v39, s[12:15], s3 offen lds
ds_read_b64_tr_b16 a[168:169], v45 offset:8192
v_mfma_f32_16x16x32_bf16 v[228:231], a[132:135], a[204:207], v[228:231]
ds_read_b64_tr_b16 a[170:171], v45 offset:9216
v_mfma_f32_16x16x32_bf16 v[136:139], a[136:139], a[192:195], v[136:139]
v_mfma_f32_16x16x32_bf16 v[168:171], a[136:139], a[196:199], v[168:171]
ds_read_b64_tr_b16 a[172:173], v45 offset:8200
v_mfma_f32_16x16x32_bf16 v[200:203], a[136:139], a[200:203], v[200:203]
s_add_u32 m0, s55, 114688
s_bfe_u32 s3, s75, 0x80010
s_lshl_b32 s3, s3, 16
s_add_u32 s3, s3, s44
buffer_load_dwordx4 v38, s[12:15], s3 offen lds
ds_read_b64_tr_b16 a[174:175], v45 offset:9224
v_mfma_f32_16x16x32_bf16 v[232:235], a[136:139], a[204:207], v[232:235]
v_mfma_f32_16x16x32_bf16 v[140:143], a[140:143], a[192:195], v[140:143]
ds_read_b64_tr_b16 a[176:177], v46 offset:8192
v_mfma_f32_16x16x32_bf16 v[172:175], a[140:143], a[196:199], v[172:175]
ds_read_b64_tr_b16 a[178:179], v46 offset:9216
v_mfma_f32_16x16x32_bf16 v[204:207], a[140:143], a[200:203], v[204:207]
s_add_u32 m0, s55, 115712
s_bfe_u32 s3, s75, 0x80010
s_lshl_b32 s3, s3, 16
s_add_u32 s3, s3, s44
s_add_u32 s3, s3, 32768
buffer_load_dwordx4 v38, s[12:15], s3 offen lds
v_mfma_f32_16x16x32_bf16 v[236:239], a[140:143], a[204:207], v[236:239]
ds_read_b64_tr_b16 a[180:181], v46 offset:8200
v_mfma_f32_16x16x32_bf16 v[144:147], a[144:147], a[192:195], v[144:147]
ds_read_b64_tr_b16 a[182:183], v46 offset:9224
v_mfma_f32_16x16x32_bf16 v[176:179], a[144:147], a[196:199], v[176:179]
v_mfma_f32_16x16x32_bf16 v[208:211], a[144:147], a[200:203], v[208:211]
s_add_u32 m0, s55, 116736
s_bfe_u32 s3, s75, 0x80010
s_lshl_b32 s3, s3, 16
s_add_u32 s3, s3, s44
s_add_u32 s3, s3, 65536
buffer_load_dwordx4 v39, s[12:15], s3 offen lds
ds_read_b64_tr_b16 a[184:185], v47 offset:8192
v_mfma_f32_16x16x32_bf16 v[240:243], a[144:147], a[204:207], v[240:243]
ds_read_b64_tr_b16 a[186:187], v47 offset:9216
v_mfma_f32_16x16x32_bf16 v[148:151], a[148:151], a[192:195], v[148:151]
v_mfma_f32_16x16x32_bf16 v[180:183], a[148:151], a[196:199], v[180:183]
ds_read_b64_tr_b16 a[188:189], v47 offset:8200
v_mfma_f32_16x16x32_bf16 v[212:215], a[148:151], a[200:203], v[212:215]
s_add_u32 m0, s55, 117760
s_bfe_u32 s3, s75, 0x80010
s_lshl_b32 s3, s3, 16
s_add_u32 s3, s3, s44
s_add_u32 s3, s3, 98304
buffer_load_dwordx4 v39, s[12:15], s3 offen lds
ds_read_b64_tr_b16 a[190:191], v47 offset:9224
v_mfma_f32_16x16x32_bf16 v[244:247], a[148:151], a[204:207], v[244:247]
v_mfma_f32_16x16x32_bf16 v[152:155], a[152:155], a[192:195], v[152:155]
v_mfma_f32_16x16x32_bf16 v[184:187], a[152:155], a[196:199], v[184:187]
v_mfma_f32_16x16x32_bf16 v[216:219], a[152:155], a[200:203], v[216:219]
v_mfma_f32_16x16x32_bf16 v[248:251], a[152:155], a[204:207], v[248:251]
s_add_u32 m0, s55, 131072
s_bfe_u32 s3, s75, 0x80018
s_lshl_b32 s3, s3, 16
s_add_u32 s3, s3, s44
buffer_load_dwordx4 v38, s[12:15], s3 offen lds
v_mfma_f32_16x16x32_bf16 v[156:159], a[156:159], a[192:195], v[156:159]
v_mfma_f32_16x16x32_bf16 v[188:191], a[156:159], a[196:199], v[188:191]
v_mfma_f32_16x16x32_bf16 v[220:223], a[156:159], a[200:203], v[220:223]
v_mfma_f32_16x16x32_bf16 v[252:255], a[156:159], a[204:207], v[252:255]
s_waitcnt vmcnt(5) lgkmcnt(0)
s_barrier
v_mfma_f32_16x16x32_bf16 v[128:131], a[160:163], a[208:211], v[128:131]
s_add_u32 m0, s55, 132096
s_bfe_u32 s3, s75, 0x80018
s_lshl_b32 s3, s3, 16
s_add_u32 s3, s3, s44
s_add_u32 s3, s3, 32768
buffer_load_dwordx4 v38, s[12:15], s3 offen lds
ds_read_b64_tr_b16 a[128:129], v44 offset:32768
v_mfma_f32_16x16x32_bf16 v[160:163], a[160:163], a[212:215], v[160:163]
ds_read_b64_tr_b16 a[130:131], v44 offset:33792
v_mfma_f32_16x16x32_bf16 v[192:195], a[160:163], a[216:219], v[192:195]
v_mfma_f32_16x16x32_bf16 v[224:227], a[160:163], a[220:223], v[224:227]
ds_read_b64_tr_b16 a[132:133], v44 offset:32776
v_mfma_f32_16x16x32_bf16 v[132:135], a[164:167], a[208:211], v[132:135]
s_add_u32 m0, s55, 133120
s_bfe_u32 s3, s75, 0x80018
s_lshl_b32 s3, s3, 16
s_add_u32 s3, s3, s44
s_add_u32 s3, s3, 65536
buffer_load_dwordx4 v39, s[12:15], s3 offen lds
ds_read_b64_tr_b16 a[134:135], v44 offset:33800
v_mfma_f32_16x16x32_bf16 v[164:167], a[164:167], a[212:215], v[164:167]
v_mfma_f32_16x16x32_bf16 v[196:199], a[164:167], a[216:219], v[196:199]
ds_read_b64_tr_b16 a[136:137], v45 offset:32768
v_mfma_f32_16x16x32_bf16 v[228:231], a[164:167], a[220:223], v[228:231]
ds_read_b64_tr_b16 a[138:139], v45 offset:33792
v_mfma_f32_16x16x32_bf16 v[136:139], a[168:171], a[208:211], v[136:139]
s_add_u32 m0, s55, 134144
s_bfe_u32 s3, s75, 0x80018
s_lshl_b32 s3, s3, 16
s_add_u32 s3, s3, s44
s_add_u32 s3, s3, 98304
buffer_load_dwordx4 v39, s[12:15], s3 offen lds
v_mfma_f32_16x16x32_bf16 v[168:171], a[168:171], a[212:215], v[168:171]
ds_read_b64_tr_b16 a[140:141], v45 offset:32776
v_mfma_f32_16x16x32_bf16 v[200:203], a[168:171], a[216:219], v[200:203]
ds_read_b64_tr_b16 a[142:143], v45 offset:33800
v_mfma_f32_16x16x32_bf16 v[232:235], a[168:171], a[220:223], v[232:235]
v_mfma_f32_16x16x32_bf16 v[140:143], a[172:175], a[208:211], v[140:143]
s_add_u32 m0, s55, 147456
s_bfe_u32 s3, s1, 0x80000
s_lshl_b32 s3, s3, 16
s_add_u32 s3, s3, s44
buffer_load_dwordx4 v38, s[12:15], s3 offen lds
ds_read_b64_tr_b16 a[144:145], v46 offset:32768
v_mfma_f32_16x16x32_bf16 v[172:175], a[172:175], a[212:215], v[172:175]
ds_read_b64_tr_b16 a[146:147], v46 offset:33792
v_mfma_f32_16x16x32_bf16 v[204:207], a[172:175], a[216:219], v[204:207]
v_mfma_f32_16x16x32_bf16 v[236:239], a[172:175], a[220:223], v[236:239]
ds_read_b64_tr_b16 a[148:149], v46 offset:32776
v_mfma_f32_16x16x32_bf16 v[144:147], a[176:179], a[208:211], v[144:147]
s_add_u32 m0, s55, 148480
s_bfe_u32 s3, s1, 0x80000
s_lshl_b32 s3, s3, 16
s_add_u32 s3, s3, s44
s_add_u32 s3, s3, 32768
buffer_load_dwordx4 v38, s[12:15], s3 offen lds
ds_read_b64_tr_b16 a[150:151], v46 offset:33800
v_mfma_f32_16x16x32_bf16 v[176:179], a[176:179], a[212:215], v[176:179]
v_mfma_f32_16x16x32_bf16 v[208:211], a[176:179], a[216:219], v[208:211]
ds_read_b64_tr_b16 a[152:153], v47 offset:32768
v_mfma_f32_16x16x32_bf16 v[240:243], a[176:179], a[220:223], v[240:243]
ds_read_b64_tr_b16 a[154:155], v47 offset:33792
v_mfma_f32_16x16x32_bf16 v[148:151], a[180:183], a[208:211], v[148:151]
s_add_u32 m0, s55, 149504
s_bfe_u32 s3, s1, 0x80000
s_lshl_b32 s3, s3, 16
s_add_u32 s3, s3, s44
s_add_u32 s3, s3, 65536
buffer_load_dwordx4 v39, s[12:15], s3 offen lds
v_mfma_f32_16x16x32_bf16 v[180:183], a[180:183], a[212:215], v[180:183]
ds_read_b64_tr_b16 a[156:157], v47 offset:32776
v_mfma_f32_16x16x32_bf16 v[212:215], a[180:183], a[216:219], v[212:215]
ds_read_b64_tr_b16 a[158:159], v47 offset:33800
v_mfma_f32_16x16x32_bf16 v[244:247], a[180:183], a[220:223], v[244:247]
v_mfma_f32_16x16x32_bf16 v[152:155], a[184:187], a[208:211], v[152:155]
s_add_u32 m0, s55, 150528
s_bfe_u32 s3, s1, 0x80000
s_lshl_b32 s3, s3, 16
s_add_u32 s3, s3, s44
s_add_u32 s3, s3, 98304
buffer_load_dwordx4 v39, s[12:15], s3 offen lds
v_mfma_f32_16x16x32_bf16 v[184:187], a[184:187], a[212:215], v[184:187]
v_mfma_f32_16x16x32_bf16 v[216:219], a[184:187], a[216:219], v[216:219]
v_mfma_f32_16x16x32_bf16 v[248:251], a[184:187], a[220:223], v[248:251]
v_mfma_f32_16x16x32_bf16 v[156:159], a[188:191], a[208:211], v[156:159]
v_mfma_f32_16x16x32_bf16 v[188:191], a[188:191], a[212:215], v[188:191]
s_bfe_u32 s3, s75, 0x80010
s_lshl_b32 s3, s3, 8
s_add_u32 s3, s3, s27
buffer_load_dwordx4 a[0:3], v11, s[20:23], s3 offen offset:0
v_mfma_f32_16x16x32_bf16 v[220:223], a[188:191], a[216:219], v[220:223]
v_mfma_f32_16x16x32_bf16 v[252:255], a[188:191], a[220:223], v[252:255]
s_waitcnt vmcnt(13) lgkmcnt(0)
v_mfma_f32_16x16x32_bf16 v[128:131], a[128:131], a[224:227], v[128:131]
ds_read_b64_tr_b16 a[160:161], v44 offset:40960
v_mfma_f32_16x16x32_bf16 v[160:163], a[128:131], a[228:231], v[160:163]
s_bfe_u32 s3, s75, 0x80010
s_lshl_b32 s3, s3, 8
s_add_u32 s3, s3, s27
buffer_load_dwordx4 a[16:19], v11, s[20:23], s3 offen offset:1024
ds_read_b64_tr_b16 a[162:163], v44 offset:41984
v_mfma_f32_16x16x32_bf16 v[192:195], a[128:131], a[232:235], v[192:195]
v_mfma_f32_16x16x32_bf16 v[224:227], a[128:131], a[236:239], v[224:227]
ds_read_b64_tr_b16 a[164:165], v44 offset:40968
v_mfma_f32_16x16x32_bf16 v[132:135], a[132:135], a[224:227], v[132:135]
ds_read_b64_tr_b16 a[166:167], v44 offset:41992
v_mfma_f32_16x16x32_bf16 v[164:167], a[132:135], a[228:231], v[164:167]
s_bfe_u32 s3, s75, 0x80010
s_lshl_b32 s3, s3, 8
s_add_u32 s3, s3, s28
buffer_load_dwordx4 a[4:7], v11, s[20:23], s3 offen offset:0
v_mfma_f32_16x16x32_bf16 v[196:199], a[132:135], a[232:235], v[196:199]
ds_read_b64_tr_b16 a[168:169], v45 offset:40960
v_mfma_f32_16x16x32_bf16 v[228:231], a[132:135], a[236:239], v[228:231]
ds_read_b64_tr_b16 a[170:171], v45 offset:41984
v_mfma_f32_16x16x32_bf16 v[136:139], a[136:139], a[224:227], v[136:139]
v_mfma_f32_16x16x32_bf16 v[168:171], a[136:139], a[228:231], v[168:171]
s_bfe_u32 s3, s75, 0x80010
s_lshl_b32 s3, s3, 8
s_add_u32 s3, s3, s28
buffer_load_dwordx4 a[20:23], v11, s[20:23], s3 offen offset:1024
ds_read_b64_tr_b16 a[172:173], v45 offset:40968
v_mfma_f32_16x16x32_bf16 v[200:203], a[136:139], a[232:235], v[200:203]
ds_read_b64_tr_b16 a[174:175], v45 offset:41992
v_mfma_f32_16x16x32_bf16 v[232:235], a[136:139], a[236:239], v[232:235]
v_mfma_f32_16x16x32_bf16 v[140:143], a[140:143], a[224:227], v[140:143]
ds_read_b64_tr_b16 a[176:177], v46 offset:40960
v_mfma_f32_16x16x32_bf16 v[172:175], a[140:143], a[228:231], v[172:175]
s_bfe_u32 s3, s75, 0x80010
s_lshl_b32 s3, s3, 8
s_add_u32 s3, s3, s29
buffer_load_dwordx4 a[8:11], v11, s[20:23], s3 offen offset:0
ds_read_b64_tr_b16 a[178:179], v46 offset:41984
v_mfma_f32_16x16x32_bf16 v[204:207], a[140:143], a[232:235], v[204:207]
v_mfma_f32_16x16x32_bf16 v[236:239], a[140:143], a[236:239], v[236:239]
ds_read_b64_tr_b16 a[180:181], v46 offset:40968
v_mfma_f32_16x16x32_bf16 v[144:147], a[144:147], a[224:227], v[144:147]
ds_read_b64_tr_b16 a[182:183], v46 offset:41992
v_mfma_f32_16x16x32_bf16 v[176:179], a[144:147], a[228:231], v[176:179]
s_bfe_u32 s3, s75, 0x80010
s_lshl_b32 s3, s3, 8
s_add_u32 s3, s3, s29
buffer_load_dwordx4 a[24:27], v11, s[20:23], s3 offen offset:1024
v_mfma_f32_16x16x32_bf16 v[208:211], a[144:147], a[232:235], v[208:211]
ds_read_b64_tr_b16 a[184:185], v47 offset:40960
v_mfma_f32_16x16x32_bf16 v[240:243], a[144:147], a[236:239], v[240:243]
ds_read_b64_tr_b16 a[186:187], v47 offset:41984
v_mfma_f32_16x16x32_bf16 v[148:151], a[148:151], a[224:227], v[148:151]
v_mfma_f32_16x16x32_bf16 v[180:183], a[148:151], a[228:231], v[180:183]
s_bfe_u32 s3, s75, 0x80010
s_lshl_b32 s3, s3, 8
s_add_u32 s3, s3, s45
buffer_load_dwordx4 a[12:15], v11, s[20:23], s3 offen offset:0
ds_read_b64_tr_b16 a[188:189], v47 offset:40968
v_mfma_f32_16x16x32_bf16 v[212:215], a[148:151], a[232:235], v[212:215]
ds_read_b64_tr_b16 a[190:191], v47 offset:41992
v_mfma_f32_16x16x32_bf16 v[244:247], a[148:151], a[236:239], v[244:247]
v_mfma_f32_16x16x32_bf16 v[152:155], a[152:155], a[224:227], v[152:155]
v_mfma_f32_16x16x32_bf16 v[184:187], a[152:155], a[228:231], v[184:187]
s_bfe_u32 s3, s75, 0x80010
s_lshl_b32 s3, s3, 8
s_add_u32 s3, s3, s45
buffer_load_dwordx4 a[28:31], v11, s[20:23], s3 offen offset:1024
v_mfma_f32_16x16x32_bf16 v[216:219], a[152:155], a[232:235], v[216:219]
v_mfma_f32_16x16x32_bf16 v[248:251], a[152:155], a[236:239], v[248:251]
v_mfma_f32_16x16x32_bf16 v[156:159], a[156:159], a[224:227], v[156:159]
v_mfma_f32_16x16x32_bf16 v[188:191], a[156:159], a[228:231], v[188:191]
v_mfma_f32_16x16x32_bf16 v[220:223], a[156:159], a[232:235], v[220:223]
s_bfe_u32 s3, s75, 0x80018
s_lshl_b32 s3, s3, 8
s_add_u32 s3, s3, s27
buffer_load_dwordx4 a[32:35], v11, s[20:23], s3 offen offset:0
v_mfma_f32_16x16x32_bf16 v[252:255], a[156:159], a[236:239], v[252:255]
s_waitcnt vmcnt(17) lgkmcnt(0)
s_barrier
v_subrev_u32 v14, s48, v0
v_add_u32 v14, 1, v14
v_and_b32 v14, 63, v14
v_cmp_gt_u32 vcc, 3, v14
s_nop 1
s_mov_b64 s[42:43], vcc
s_cmp_eq_u32 s24, 0
s_cselect_b64 vcc, s[42:43], 0
v_mov_b32 v12, 0x7fff0000
v_lshlrev_b32 v13, 2, v0
v_cndmask_b32 v62, v12, v13, vcc
v_mfma_f32_16x16x32_bf16 v[128:131], a[160:163], a[240:243], v[128:131]
buffer_load_dword v61, v62, s[56:59], 0 offen sc1
ds_read_b64_tr_b16 a[128:129], v44 offset:49152
v_mfma_f32_16x16x32_bf16 v[160:163], a[160:163], a[244:247], v[160:163]
ds_read_b64_tr_b16 a[130:131], v44 offset:50176
v_mfma_f32_16x16x32_bf16 v[192:195], a[160:163], a[248:251], v[192:195]
v_mfma_f32_16x16x32_bf16 v[224:227], a[160:163], a[252:255], v[224:227]
ds_read_b64_tr_b16 a[132:133], v44 offset:49160
v_mfma_f32_16x16x32_bf16 v[132:135], a[164:167], a[240:243], v[132:135]
s_bfe_u32 s3, s75, 0x80018
s_lshl_b32 s3, s3, 8
s_add_u32 s3, s3, s27
buffer_load_dwordx4 a[48:51], v11, s[20:23], s3 offen offset:1024
ds_read_b64_tr_b16 a[134:135], v44 offset:50184
v_mfma_f32_16x16x32_bf16 v[164:167], a[164:167], a[244:247], v[164:167]
v_mfma_f32_16x16x32_bf16 v[196:199], a[164:167], a[248:251], v[196:199]
ds_read_b64_tr_b16 a[136:137], v45 offset:49152
v_mfma_f32_16x16x32_bf16 v[228:231], a[164:167], a[252:255], v[228:231]
ds_read_b64_tr_b16 a[138:139], v45 offset:50176
v_mfma_f32_16x16x32_bf16 v[136:139], a[168:171], a[240:243], v[136:139]
s_bfe_u32 s3, s75, 0x80018
s_lshl_b32 s3, s3, 8
s_add_u32 s3, s3, s28
buffer_load_dwordx4 a[36:39], v11, s[20:23], s3 offen offset:0
v_mfma_f32_16x16x32_bf16 v[168:171], a[168:171], a[244:247], v[168:171]
ds_read_b64_tr_b16 a[140:141], v45 offset:49160
v_mfma_f32_16x16x32_bf16 v[200:203], a[168:171], a[248:251], v[200:203]
ds_read_b64_tr_b16 a[142:143], v45 offset:50184
v_mfma_f32_16x16x32_bf16 v[232:235], a[168:171], a[252:255], v[232:235]
v_mfma_f32_16x16x32_bf16 v[140:143], a[172:175], a[240:243], v[140:143]
s_bfe_u32 s3, s75, 0x80018
s_lshl_b32 s3, s3, 8
s_add_u32 s3, s3, s28
buffer_load_dwordx4 a[52:55], v11, s[20:23], s3 offen offset:1024
ds_read_b64_tr_b16 a[144:145], v46 offset:49152
v_mfma_f32_16x16x32_bf16 v[172:175], a[172:175], a[244:247], v[172:175]
ds_read_b64_tr_b16 a[146:147], v46 offset:50176
v_mfma_f32_16x16x32_bf16 v[204:207], a[172:175], a[248:251], v[204:207]
v_mfma_f32_16x16x32_bf16 v[236:239], a[172:175], a[252:255], v[236:239]
ds_read_b64_tr_b16 a[148:149], v46 offset:49160
v_mfma_f32_16x16x32_bf16 v[144:147], a[176:179], a[240:243], v[144:147]
s_bfe_u32 s3, s75, 0x80018
s_lshl_b32 s3, s3, 8
s_add_u32 s3, s3, s29
buffer_load_dwordx4 a[40:43], v11, s[20:23], s3 offen offset:0
ds_read_b64_tr_b16 a[150:151], v46 offset:50184
v_mfma_f32_16x16x32_bf16 v[176:179], a[176:179], a[244:247], v[176:179]
v_mfma_f32_16x16x32_bf16 v[208:211], a[176:179], a[248:251], v[208:211]
ds_read_b64_tr_b16 a[152:153], v47 offset:49152
v_mfma_f32_16x16x32_bf16 v[240:243], a[176:179], a[252:255], v[240:243]
ds_read_b64_tr_b16 a[154:155], v47 offset:50176
v_mfma_f32_16x16x32_bf16 v[148:151], a[180:183], a[240:243], v[148:151]
s_bfe_u32 s3, s75, 0x80018
s_lshl_b32 s3, s3, 8
s_add_u32 s3, s3, s29
buffer_load_dwordx4 a[56:59], v11, s[20:23], s3 offen offset:1024
v_mfma_f32_16x16x32_bf16 v[180:183], a[180:183], a[244:247], v[180:183]
ds_read_b64_tr_b16 a[156:157], v47 offset:49160
v_mfma_f32_16x16x32_bf16 v[212:215], a[180:183], a[248:251], v[212:215]
ds_read_b64_tr_b16 a[158:159], v47 offset:50184
v_mfma_f32_16x16x32_bf16 v[244:247], a[180:183], a[252:255], v[244:247]
v_mfma_f32_16x16x32_bf16 v[152:155], a[184:187], a[240:243], v[152:155]
s_bfe_u32 s3, s75, 0x80018
s_lshl_b32 s3, s3, 8
s_add_u32 s3, s3, s45
buffer_load_dwordx4 a[44:47], v11, s[20:23], s3 offen offset:0
v_mfma_f32_16x16x32_bf16 v[184:187], a[184:187], a[244:247], v[184:187]
v_mfma_f32_16x16x32_bf16 v[216:219], a[184:187], a[248:251], v[216:219]
v_mfma_f32_16x16x32_bf16 v[248:251], a[184:187], a[252:255], v[248:251]
v_mfma_f32_16x16x32_bf16 v[156:159], a[188:191], a[240:243], v[156:159]
v_mfma_f32_16x16x32_bf16 v[188:191], a[188:191], a[244:247], v[188:191]
s_bfe_u32 s3, s75, 0x80018
s_lshl_b32 s3, s3, 8
s_add_u32 s3, s3, s45
buffer_load_dwordx4 a[60:63], v11, s[20:23], s3 offen offset:1024
v_mfma_f32_16x16x32_bf16 v[220:223], a[188:191], a[248:251], v[220:223]
v_mfma_f32_16x16x32_bf16 v[252:255], a[188:191], a[252:255], v[252:255]
s_waitcnt vmcnt(9) lgkmcnt(0)
v_mfma_f32_16x16x32_bf16 v[128:131], a[128:131], a[0:3], v[128:131]
ds_read_b64_tr_b16 a[160:161], v44 offset:57344
v_mfma_f32_16x16x32_bf16 v[160:163], a[128:131], a[4:7], v[160:163]
s_add_u32 m0, s30, 0
s_add_u32 s3, s25, 0
buffer_load_dwordx4 v1, s[4:7], s3 offen offset:0 lds
ds_read_b64_tr_b16 a[162:163], v44 offset:58368
v_mfma_f32_16x16x32_bf16 v[192:195], a[128:131], a[8:11], v[192:195]
v_mfma_f32_16x16x32_bf16 v[224:227], a[128:131], a[12:15], v[224:227]
ds_read_b64_tr_b16 a[164:165], v44 offset:57352
v_mfma_f32_16x16x32_bf16 v[132:135], a[132:135], a[0:3], v[132:135]
ds_read_b64_tr_b16 a[166:167], v44 offset:58376
v_mfma_f32_16x16x32_bf16 v[164:167], a[132:135], a[4:7], v[164:167]
s_add_u32 m0, s30, 0
s_add_u32 s3, s25, 0
buffer_load_dwordx4 v2, s[4:7], s3 offen offset:1024 lds
v_mfma_f32_16x16x32_bf16 v[196:199], a[132:135], a[8:11], v[196:199]
ds_read_b64_tr_b16 a[168:169], v45 offset:57344
v_mfma_f32_16x16x32_bf16 v[228:231], a[132:135], a[12:15], v[228:231]
ds_read_b64_tr_b16 a[170:171], v45 offset:58368
v_mfma_f32_16x16x32_bf16 v[136:139], a[136:139], a[0:3], v[136:139]
v_mfma_f32_16x16x32_bf16 v[168:171], a[136:139], a[4:7], v[168:171]
s_add_u32 m0, s30, 0
s_add_u32 s3, s25, 0
buffer_load_dwordx4 v3, s[4:7], s3 offen offset:2048 lds
ds_read_b64_tr_b16 a[172:173], v45 offset:57352
v_mfma_f32_16x16x32_bf16 v[200:203], a[136:139], a[8:11], v[200:203]
ds_read_b64_tr_b16 a[174:175], v45 offset:58376
v_mfma_f32_16x16x32_bf16 v[232:235], a[136:139], a[12:15], v[232:235]
v_mfma_f32_16x16x32_bf16 v[140:143], a[140:143], a[0:3], v[140:143]
ds_read_b64_tr_b16 a[176:177], v46 offset:57344
v_mfma_f32_16x16x32_bf16 v[172:175], a[140:143], a[4:7], v[172:175]
s_add_u32 m0, s30, 0
s_add_u32 s3, s25, 0
buffer_load_dwordx4 v4, s[4:7], s3 offen offset:3072 lds
ds_read_b64_tr_b16 a[178:179], v46 offset:58368
v_mfma_f32_16x16x32_bf16 v[204:207], a[140:143], a[8:11], v[204:207]
v_mfma_f32_16x16x32_bf16 v[236:239], a[140:143], a[12:15], v[236:239]
ds_read_b64_tr_b16 a[180:181], v46 offset:57352
v_mfma_f32_16x16x32_bf16 v[144:147], a[144:147], a[0:3], v[144:147]
ds_read_b64_tr_b16 a[182:183], v46 offset:58376
v_mfma_f32_16x16x32_bf16 v[176:179], a[144:147], a[4:7], v[176:179]
s_add_u32 m0, s30, 4096
s_add_u32 s3, s25, 0
buffer_load_dwordx4 v5, s[4:7], s3 offen offset:0 lds
v_mfma_f32_16x16x32_bf16 v[208:211], a[144:147], a[8:11], v[208:211]
ds_read_b64_tr_b16 a[184:185], v47 offset:57344
v_mfma_f32_16x16x32_bf16 v[240:243], a[144:147], a[12:15], v[240:243]
ds_read_b64_tr_b16 a[186:187], v47 offset:58368
v_mfma_f32_16x16x32_bf16 v[148:151], a[148:151], a[0:3], v[148:151]
v_mfma_f32_16x16x32_bf16 v[180:183], a[148:151], a[4:7], v[180:183]
s_add_u32 m0, s30, 4096
s_add_u32 s3, s25, 0
buffer_load_dwordx4 v6, s[4:7], s3 offen offset:1024 lds
ds_read_b64_tr_b16 a[188:189], v47 offset:57352
v_mfma_f32_16x16x32_bf16 v[212:215], a[148:151], a[8:11], v[212:215]
ds_read_b64_tr_b16 a[190:191], v47 offset:58376
v_mfma_f32_16x16x32_bf16 v[244:247], a[148:151], a[12:15], v[244:247]
v_mfma_f32_16x16x32_bf16 v[152:155], a[152:155], a[0:3], v[152:155]
v_mfma_f32_16x16x32_bf16 v[184:187], a[152:155], a[4:7], v[184:187]
s_add_u32 m0, s30, 4096
s_add_u32 s3, s25, 0
buffer_load_dwordx4 v7, s[4:7], s3 offen offset:2048 lds
v_mfma_f32_16x16x32_bf16 v[216:219], a[152:155], a[8:11], v[216:219]
v_mfma_f32_16x16x32_bf16 v[248:251], a[152:155], a[12:15], v[248:251]
v_mfma_f32_16x16x32_bf16 v[156:159], a[156:159], a[0:3], v[156:159]
v_mfma_f32_16x16x32_bf16 v[188:191], a[156:159], a[4:7], v[188:191]
v_mfma_f32_16x16x32_bf16 v[220:223], a[156:159], a[8:11], v[220:223]
s_add_u32 m0, s30, 4096
s_add_u32 s3, s25, 0
buffer_load_dwordx4 v8, s[4:7], s3 offen offset:3072 lds
v_mfma_f32_16x16x32_bf16 v[252:255], a[156:159], a[12:15], v[252:255]
s_cmp_lg_u32 s24, 0
s_cbranch_scc1 L_poll4_ok
s_waitcnt vmcnt(15)
s_mov_b32 s35, 400000
L_poll4:
v_bfe_u32 v12, v61, 0, 8
v_cmp_gt_u32 vcc, 4, v12
s_nop 1
s_and_b64 vcc, vcc, s[42:43]
s_cmp_eq_u64 vcc, 0
s_cbranch_scc1 L_poll4_ok
s_sleep 2
buffer_load_dword v61, v62, s[56:59], 0 offen sc1
s_waitcnt vmcnt(0)
s_sub_u32 s35, s35, 1
s_cmp_lg_u32 s35, 0
s_cbranch_scc1 L_poll4
L_poll4_ok:
s_waitcnt vmcnt(15) lgkmcnt(0)
s_barrier
v_mfma_f32_16x16x32_bf16 v[128:131], a[160:163], a[16:19], v[128:131]
ds_read_b64_tr_b16 a[128:129], v40 offset:0
v_mfma_f32_16x16x32_bf16 v[160:163], a[160:163], a[20:23], v[160:163]
s_add_u32 s3, s26, 0
buffer_load_dwordx4 a[192:195], v11, s[16:19], s3 offen
ds_read_b64_tr_b16 a[130:131], v40 offset:1024
v_mfma_f32_16x16x32_bf16 v[192:195], a[160:163], a[24:27], v[192:195]
v_mfma_f32_16x16x32_bf16 v[224:227], a[160:163], a[28:31], v[224:227]
ds_read_b64_tr_b16 a[132:133], v40 offset:8
v_mfma_f32_16x16x32_bf16 v[132:135], a[164:167], a[16:19], v[132:135]
ds_read_b64_tr_b16 a[134:135], v40 offset:1032
v_mfma_f32_16x16x32_bf16 v[164:167], a[164:167], a[20:23], v[164:167]
s_add_u32 s3, s94, 0
buffer_load_dwordx4 a[196:199], v11, s[16:19], s3 offen
v_mfma_f32_16x16x32_bf16 v[196:199], a[164:167], a[24:27], v[196:199]
ds_read_b64_tr_b16 a[136:137], v41 offset:0
v_mfma_f32_16x16x32_bf16 v[228:231], a[164:167], a[28:31], v[228:231]
ds_read_b64_tr_b16 a[138:139], v41 offset:1024
v_mfma_f32_16x16x32_bf16 v[136:139], a[168:171], a[16:19], v[136:139]
v_mfma_f32_16x16x32_bf16 v[168:171], a[168:171], a[20:23], v[168:171]
s_add_u32 s3, s26, 4096
buffer_load_dwordx4 a[200:203], v11, s[16:19], s3 offen
ds_read_b64_tr_b16 a[140:141], v41 offset:8
v_mfma_f32_16x16x32_bf16 v[200:203], a[168:171], a[24:27], v[200:203]
ds_read_b64_tr_b16 a[142:143], v41 offset:1032
v_mfma_f32_16x16x32_bf16 v[232:235], a[168:171], a[28:31], v[232:235]
v_mfma_f32_16x16x32_bf16 v[140:143], a[172:175], a[16:19], v[140:143]
ds_read_b64_tr_b16 a[144:145], v42 offset:0
v_mfma_f32_16x16x32_bf16 v[172:175], a[172:175], a[20:23], v[172:175]
s_add_u32 s3, s94, 4096
buffer_load_dwordx4 a[204:207], v11, s[16:19], s3 offen
ds_read_b64_tr_b16 a[146:147], v42 offset:1024
v_mfma_f32_16x16x32_bf16 v[204:207], a[172:175], a[24:27], v[204:207]
v_mfma_f32_16x16x32_bf16 v[236:239], a[172:175], a[28:31], v[236:239]
ds_read_b64_tr_b16 a[148:149], v42 offset:8
v_mfma_f32_16x16x32_bf16 v[144:147], a[176:179], a[16:19], v[144:147]
ds_read_b64_tr_b16 a[150:151], v42 offset:1032
v_mfma_f32_16x16x32_bf16 v[176:179], a[176:179], a[20:23], v[176:179]
s_add_u32 s3, s26, 8192
buffer_load_dwordx4 a[208:211], v11, s[16:19], s3 offen
v_mfma_f32_16x16x32_bf16 v[208:211], a[176:179], a[24:27], v[208:211]
ds_read_b64_tr_b16 a[152:153], v43 offset:0
v_mfma_f32_16x16x32_bf16 v[240:243], a[176:179], a[28:31], v[240:243]
ds_read_b64_tr_b16 a[154:155], v43 offset:1024
v_mfma_f32_16x16x32_bf16 v[148:151], a[180:183], a[16:19], v[148:151]
v_mfma_f32_16x16x32_bf16 v[180:183], a[180:183], a[20:23], v[180:183]
s_add_u32 s3, s94, 8192
buffer_load_dwordx4 a[212:215], v11, s[16:19], s3 offen
ds_read_b64_tr_b16 a[156:157], v43 offset:8
v_mfma_f32_16x16x32_bf16 v[212:215], a[180:183], a[24:27], v[212:215]
ds_read_b64_tr_b16 a[158:159], v43 offset:1032
v_mfma_f32_16x16x32_bf16 v[244:247], a[180:183], a[28:31], v[244:247]
v_mfma_f32_16x16x32_bf16 v[152:155], a[184:187], a[16:19], v[152:155]
v_mfma_f32_16x16x32_bf16 v[184:187], a[184:187], a[20:23], v[184:187]
s_add_u32 s3, s26, 12288
buffer_load_dwordx4 a[216:219], v11, s[16:19], s3 offen
v_mfma_f32_16x16x32_bf16 v[216:219], a[184:187], a[24:27], v[216:219]
v_mfma_f32_16x16x32_bf16 v[248:251], a[184:187], a[28:31], v[248:251]
v_mfma_f32_16x16x32_bf16 v[156:159], a[188:191], a[16:19], v[156:159]
v_mfma_f32_16x16x32_bf16 v[188:191], a[188:191], a[20:23], v[188:191]
v_mfma_f32_16x16x32_bf16 v[220:223], a[188:191], a[24:27], v[220:223]
s_add_u32 s3, s94, 12288
buffer_load_dwordx4 a[220:223], v11, s[16:19], s3 offen
v_mfma_f32_16x16x32_bf16 v[252:255], a[188:191], a[28:31], v[252:255]
s_waitcnt vmcnt(16) lgkmcnt(0)
v_mfma_f32_16x16x32_bf16 v[128:131], a[128:131], a[32:35], v[128:131]
ds_read_b64_tr_b16 a[160:161], v40 offset:8192
v_mfma_f32_16x16x32_bf16 v[160:163], a[128:131], a[36:39], v[160:163]
ds_read_b64_tr_b16 a[162:163], v40 offset:9216
v_mfma_f32_16x16x32_bf16 v[192:195], a[128:131], a[40:43], v[192:195]
s_mov_b32 s3, s95
buffer_load_dwordx4 a[224:227], v11, s[16:19], s3 offen
v_mfma_f32_16x16x32_bf16 v[224:227], a[128:131], a[44:47], v[224:227]
ds_read_b64_tr_b16 a[164:165], v40 offset:8200
v_mfma_f32_16x16x32_bf16 v[132:135], a[132:135], a[32:35], v[132:135]
ds_read_b64_tr_b16 a[166:167], v40 offset:9224
v_mfma_f32_16x16x32_bf16 v[164:167], a[132:135], a[36:39], v[164:167]
v_mfma_f32_16x16x32_bf16 v[196:199], a[132:135], a[40:43], v[196:199]
s_mov_b32 s3, s47
buffer_load_dwordx4 a[228:231], v11, s[16:19], s3 offen
ds_read_b64_tr_b16 a[168:169], v41 offset:8192
v_mfma_f32_16x16x32_bf16 v[228:231], a[132:135], a[44:47], v[228:231]
ds_read_b64_tr_b16 a[170:171], v41 offset:9216
v_mfma_f32_16x16x32_bf16 v[136:139], a[136:139], a[32:35], v[136:139]
v_mfma_f32_16x16x32_bf16 v[168:171], a[136:139], a[36:39], v[168:171]
ds_read_b64_tr_b16 a[172:173], v41 offset:8200
v_mfma_f32_16x16x32_bf16 v[200:203], a[136:139], a[40:43], v[200:203]
buffer_load_dwordx2 v[116:117], v26, s[20:23], s63 offen offset:0
ds_read_b64_tr_b16 a[174:175], v41 offset:9224
v_mfma_f32_16x16x32_bf16 v[232:235], a[136:139], a[44:47], v[232:235]
v_mfma_f32_16x16x32_bf16 v[140:143], a[140:143], a[32:35], v[140:143]
ds_read_b64_tr_b16 a[176:177], v42 offset:8192
v_mfma_f32_16x16x32_bf16 v[172:175], a[140:143], a[36:39], v[172:175]
ds_read_b64_tr_b16 a[178:179], v42 offset:9216
v_mfma_f32_16x16x32_bf16 v[204:207], a[140:143], a[40:43], v[204:207]
buffer_load_dwordx2 v[118:119], v26, s[20:23], s63 offen offset:512
v_mfma_f32_16x16x32_bf16 v[236:239], a[140:143], a[44:47], v[236:239]
ds_read_b64_tr_b16 a[180:181], v42 offset:8200
v_mfma_f32_16x16x32_bf16 v[144:147], a[144:147], a[32:35], v[144:147]
ds_read_b64_tr_b16 a[182:183], v42 offset:9224
v_mfma_f32_16x16x32_bf16 v[176:179], a[144:147], a[36:39], v[176:179]
v_mfma_f32_16x16x32_bf16 v[208:211], a[144:147], a[40:43], v[208:211]
buffer_load_dwordx2 v[120:121], v26, s[20:23], s63 offen offset:1024
ds_read_b64_tr_b16 a[184:185], v43 offset:8192
v_mfma_f32_16x16x32_bf16 v[240:243], a[144:147], a[44:47], v[240:243]
ds_read_b64_tr_b16 a[186:187], v43 offset:9216
v_mfma_f32_16x16x32_bf16 v[148:151], a[148:151], a[32:35], v[148:151]
v_mfma_f32_16x16x32_bf16 v[180:183], a[148:151], a[36:39], v[180:183]
ds_read_b64_tr_b16 a[188:189], v43 offset:8200
v_mfma_f32_16x16x32_bf16 v[212:215], a[148:151], a[40:43], v[212:215]
buffer_load_dwordx2 v[122:123], v26, s[20:23], s63 offen offset:1536
ds_read_b64_tr_b16 a[190:191], v43 offset:9224
v_mfma_f32_16x16x32_bf16 v[244:247], a[148:151], a[44:47], v[244:247]
v_mfma_f32_16x16x32_bf16 v[152:155], a[152:155], a[32:35], v[152:155]
v_mfma_f32_16x16x32_bf16 v[184:187], a[152:155], a[36:39], v[184:187]
v_mfma_f32_16x16x32_bf16 v[216:219], a[152:155], a[40:43], v[216:219]
v_mfma_f32_16x16x32_bf16 v[248:251], a[152:155], a[44:47], v[248:251]
buffer_load_dwordx2 v[124:125], v26, s[20:23], s63 offen offset:2048
v_mfma_f32_16x16x32_bf16 v[156:159], a[156:159], a[32:35], v[156:159]
v_mfma_f32_16x16x32_bf16 v[188:191], a[156:159], a[36:39], v[188:191]
v_mfma_f32_16x16x32_bf16 v[220:223], a[156:159], a[40:43], v[220:223]
v_mfma_f32_16x16x32_bf16 v[252:255], a[156:159], a[44:47], v[252:255]
s_waitcnt vmcnt(23) lgkmcnt(0)
s_barrier
v_mfma_f32_16x16x32_bf16 v[128:131], a[160:163], a[48:51], v[128:131]
s_add_u32 m0, s30, 8192
s_add_u32 s3, s25, 0
buffer_load_dwordx4 v9, s[4:7], s3 offen offset:0 lds
ds_read_b64_tr_b16 a[128:129], v40 offset:16384
v_mfma_f32_16x16x32_bf16 v[160:163], a[160:163], a[52:55], v[160:163]
ds_read_b64_tr_b16 a[130:131], v40 offset:17408
v_mfma_f32_16x16x32_bf16 v[192:195], a[160:163], a[56:59], v[192:195]
v_mfma_f32_16x16x32_bf16 v[224:227], a[160:163], a[60:63], v[224:227]
ds_read_b64_tr_b16 a[132:133], v40 offset:16392
v_mfma_f32_16x16x32_bf16 v[132:135], a[164:167], a[48:51], v[132:135]
s_add_u32 m0, s30, 36864
s_add_u32 s3, s25, 147456
buffer_load_dwordx4 v1, s[4:7], s3 offen offset:0 lds
ds_read_b64_tr_b16 a[134:135], v40 offset:17416
v_mfma_f32_16x16x32_bf16 v[164:167], a[164:167], a[52:55], v[164:167]
v_mfma_f32_16x16x32_bf16 v[196:199], a[164:167], a[56:59], v[196:199]
ds_read_b64_tr_b16 a[136:137], v41 offset:16384
v_mfma_f32_16x16x32_bf16 v[228:231], a[164:167], a[60:63], v[228:231]
ds_read_b64_tr_b16 a[138:139], v41 offset:17408
v_mfma_f32_16x16x32_bf16 v[136:139], a[168:171], a[48:51], v[136:139]
s_add_u32 m0, s30, 36864
s_add_u32 s3, s25, 147456
buffer_load_dwordx4 v2, s[4:7], s3 offen offset:1024 lds
v_mfma_f32_16x16x32_bf16 v[168:171], a[168:171], a[52:55], v[168:171]
ds_read_b64_tr_b16 a[140:141], v41 offset:16392
v_mfma_f32_16x16x32_bf16 v[200:203], a[168:171], a[56:59], v[200:203]
ds_read_b64_tr_b16 a[142:143], v41 offset:17416
v_mfma_f32_16x16x32_bf16 v[232:235], a[168:171], a[60:63], v[232:235]
v_mfma_f32_16x16x32_bf16 v[140:143], a[172:175], a[48:51], v[140:143]
s_add_u32 m0, s30, 36864
s_add_u32 s3, s25, 147456
buffer_load_dwordx4 v3, s[4:7], s3 offen offset:2048 lds
ds_read_b64_tr_b16 a[144:145], v42 offset:16384
v_mfma_f32_16x16x32_bf16 v[172:175], a[172:175], a[52:55], v[172:175]
ds_read_b64_tr_b16 a[146:147], v42 offset:17408
v_mfma_f32_16x16x32_bf16 v[204:207], a[172:175], a[56:59], v[204:207]
v_mfma_f32_16x16x32_bf16 v[236:239], a[172:175], a[60:63], v[236:239]
ds_read_b64_tr_b16 a[148:149], v42 offset:16392
v_mfma_f32_16x16x32_bf16 v[144:147], a[176:179], a[48:51], v[144:147]
s_add_u32 m0, s30, 36864
s_add_u32 s3, s25, 147456
buffer_load_dwordx4 v4, s[4:7], s3 offen offset:3072 lds
ds_read_b64_tr_b16 a[150:151], v42 offset:17416
v_mfma_f32_16x16x32_bf16 v[176:179], a[176:179], a[52:55], v[176:179]
v_mfma_f32_16x16x32_bf16 v[208:211], a[176:179], a[56:59], v[208:211]
ds_read_b64_tr_b16 a[152:153], v43 offset:16384
v_mfma_f32_16x16x32_bf16 v[240:243], a[176:179], a[60:63], v[240:243]
ds_read_b64_tr_b16 a[154:155], v43 offset:17408
v_mfma_f32_16x16x32_bf16 v[148:151], a[180:183], a[48:51], v[148:151]
s_add_u32 m0, s30, 40960
s_add_u32 s3, s25, 147456
buffer_load_dwordx4 v5, s[4:7], s3 offen offset:0 lds
v_mfma_f32_16x16x32_bf16 v[180:183], a[180:183], a[52:55], v[180:183]
ds_read_b64_tr_b16 a[156:157], v43 offset:16392
v_mfma_f32_16x16x32_bf16 v[212:215], a[180:183], a[56:59], v[212:215]
ds_read_b64_tr_b16 a[158:159], v43 offset:17416
v_mfma_f32_16x16x32_bf16 v[244:247], a[180:183], a[60:63], v[244:247]
v_mfma_f32_16x16x32_bf16 v[152:155], a[184:187], a[48:51], v[152:155]
s_add_u32 m0, s30, 40960
s_add_u32 s3, s25, 147456
buffer_load_dwordx4 v6, s[4:7], s3 offen offset:1024 lds
v_mfma_f32_16x16x32_bf16 v[184:187], a[184:187], a[52:55], v[184:187]
v_mfma_f32_16x16x32_bf16 v[216:219], a[184:187], a[56:59], v[216:219]
v_mfma_f32_16x16x32_bf16 v[248:251], a[184:187], a[60:63], v[248:251]
v_mfma_f32_16x16x32_bf16 v[156:159], a[188:191], a[48:51], v[156:159]
v_mfma_f32_16x16x32_bf16 v[188:191], a[188:191], a[52:55], v[188:191]
s_add_u32 m0, s30, 40960
s_add_u32 s3, s25, 147456
buffer_load_dwordx4 v7, s[4:7], s3 offen offset:2048 lds
v_mfma_f32_16x16x32_bf16 v[220:223], a[188:191], a[56:59], v[220:223]
v_mfma_f32_16x16x32_bf16 v[252:255], a[188:191], a[60:63], v[252:255]
s_waitcnt vmcnt(31) lgkmcnt(0)
v_mfma_f32_16x16x32_bf16 v[128:131], a[128:131], a[64:67], v[128:131]
ds_read_b64_tr_b16 a[160:161], v40 offset:24576
v_mfma_f32_16x16x32_bf16 v[160:163], a[128:131], a[68:71], v[160:163]
s_add_u32 m0, s30, 40960
s_add_u32 s3, s25, 147456
buffer_load_dwordx4 v8, s[4:7], s3 offen offset:3072 lds
ds_read_b64_tr_b16 a[162:163], v40 offset:25600
v_mfma_f32_16x16x32_bf16 v[192:195], a[128:131], a[72:75], v[192:195]
v_mfma_f32_16x16x32_bf16 v[224:227], a[128:131], a[76:79], v[224:227]
ds_read_b64_tr_b16 a[164:165], v40 offset:24584
v_mfma_f32_16x16x32_bf16 v[132:135], a[132:135], a[64:67], v[132:135]
ds_read_b64_tr_b16 a[166:167], v40 offset:25608
v_mfma_f32_16x16x32_bf16 v[164:167], a[132:135], a[68:71], v[164:167]
s_add_u32 m0, s30, 45056
s_add_u32 s3, s25, 147456
buffer_load_dwordx4 v9, s[4:7], s3 offen offset:0 lds
v_mfma_f32_16x16x32_bf16 v[196:199], a[132:135], a[72:75], v[196:199]
ds_read_b64_tr_b16 a[168:169], v41 offset:24576
v_mfma_f32_16x16x32_bf16 v[228:231], a[132:135], a[76:79], v[228:231]
ds_read_b64_tr_b16 a[170:171], v41 offset:25600
v_mfma_f32_16x16x32_bf16 v[136:139], a[136:139], a[64:67], v[136:139]
v_mfma_f32_16x16x32_bf16 v[168:171], a[136:139], a[68:71], v[168:171]
s_add_u32 m0, s30, 73728
s_add_u32 s3, s25, 294912
buffer_load_dwordx4 v1, s[4:7], s3 offen offset:0 lds
ds_read_b64_tr_b16 a[172:173], v41 offset:24584
v_mfma_f32_16x16x32_bf16 v[200:203], a[136:139], a[72:75], v[200:203]
ds_read_b64_tr_b16 a[174:175], v41 offset:25608
v_mfma_f32_16x16x32_bf16 v[232:235], a[136:139], a[76:79], v[232:235]
v_mfma_f32_16x16x32_bf16 v[140:143], a[140:143], a[64:67], v[140:143]
ds_read_b64_tr_b16 a[176:177], v42 offset:24576
v_mfma_f32_16x16x32_bf16 v[172:175], a[140:143], a[68:71], v[172:175]
s_add_u32 m0, s30, 73728
s_add_u32 s3, s25, 294912
buffer_load_dwordx4 v2, s[4:7], s3 offen offset:1024 lds
ds_read_b64_tr_b16 a[178:179], v42 offset:25600
v_mfma_f32_16x16x32_bf16 v[204:207], a[140:143], a[72:75], v[204:207]
v_mfma_f32_16x16x32_bf16 v[236:239], a[140:143], a[76:79], v[236:239]
ds_read_b64_tr_b16 a[180:181], v42 offset:24584
v_mfma_f32_16x16x32_bf16 v[144:147], a[144:147], a[64:67], v[144:147]
ds_read_b64_tr_b16 a[182:183], v42 offset:25608
v_mfma_f32_16x16x32_bf16 v[176:179], a[144:147], a[68:71], v[176:179]
s_add_u32 m0, s30, 73728
s_add_u32 s3, s25, 294912
buffer_load_dwordx4 v3, s[4:7], s3 offen offset:2048 lds
v_mfma_f32_16x16x32_bf16 v[208:211], a[144:147], a[72:75], v[208:211]
ds_read_b64_tr_b16 a[184:185], v43 offset:24576
v_mfma_f32_16x16x32_bf16 v[240:243], a[144:147], a[76:79], v[240:243]
ds_read_b64_tr_b16 a[186:187], v43 offset:25600
v_mfma_f32_16x16x32_bf16 v[148:151], a[148:151], a[64:67], v[148:151]
v_mfma_f32_16x16x32_bf16 v[180:183], a[148:151], a[68:71], v[180:183]
s_add_u32 m0, s30, 73728
s_add_u32 s3, s25, 294912
buffer_load_dwordx4 v4, s[4:7], s3 offen offset:3072 lds
ds_read_b64_tr_b16 a[188:189], v43 offset:24584
v_mfma_f32_16x16x32_bf16 v[212:215], a[148:151], a[72:75], v[212:215]
ds_read_b64_tr_b16 a[190:191], v43 offset:25608
v_mfma_f32_16x16x32_bf16 v[244:247], a[148:151], a[76:79], v[244:247]
v_mfma_f32_16x16x32_bf16 v[152:155], a[152:155], a[64:67], v[152:155]
v_mfma_f32_16x16x32_bf16 v[184:187], a[152:155], a[68:71], v[184:187]
s_add_u32 m0, s30, 77824
s_add_u32 s3, s25, 294912
buffer_load_dwordx4 v5, s[4:7], s3 offen offset:0 lds
v_mfma_f32_16x16x32_bf16 v[216:219], a[152:155], a[72:75], v[216:219]
v_mfma_f32_16x16x32_bf16 v[248:251], a[152:155], a[76:79], v[248:251]
v_mfma_f32_16x16x32_bf16 v[156:159], a[156:159], a[64:67], v[156:159]
v_mfma_f32_16x16x32_bf16 v[188:191], a[156:159], a[68:71], v[188:191]
v_mfma_f32_16x16x32_bf16 v[220:223], a[156:159], a[72:75], v[220:223]
s_add_u32 m0, s30, 77824
s_add_u32 s3, s25, 294912
buffer_load_dwordx4 v6, s[4:7], s3 offen offset:1024 lds
v_mfma_f32_16x16x32_bf16 v[252:255], a[156:159], a[76:79], v[252:255]
s_waitcnt vmcnt(39) lgkmcnt(0)
v_mfma_f32_16x16x32_bf16 v[128:131], a[160:163], a[80:83], v[128:131]
v_mfma_f32_16x16x32_bf16 v[160:163], a[160:163], a[84:87], v[160:163]
v_mfma_f32_16x16x32_bf16 v[192:195], a[160:163], a[88:91], v[192:195]
v_mfma_f32_16x16x32_bf16 v[224:227], a[160:163], a[92:95], v[224:227]
s_add_u32 m0, s30, 77824
s_add_u32 s3, s25, 294912
buffer_load_dwordx4 v7, s[4:7], s3 offen offset:2048 lds
v_mfma_f32_16x16x32_bf16 v[132:135], a[164:167], a[80:83], v[132:135]
v_mfma_f32_16x16x32_bf16 v[164:167], a[164:167], a[84:87], v[164:167]
v_mfma_f32_16x16x32_bf16 v[196:199], a[164:167], a[88:91], v[196:199]
v_mfma_f32_16x16x32_bf16 v[228:231], a[164:167], a[92:95], v[228:231]
v_mfma_f32_16x16x32_bf16 v[136:139], a[168:171], a[80:83], v[136:139]
s_add_u32 m0, s30, 77824
s_add_u32 s3, s25, 294912
buffer_load_dwordx4 v8, s[4:7], s3 offen offset:3072 lds
v_mfma_f32_16x16x32_bf16 v[168:171], a[168:171], a[84:87], v[168:171]
v_mfma_f32_16x16x32_bf16 v[200:203], a[168:171], a[88:91], v[200:203]
v_mfma_f32_16x16x32_bf16 v[232:235], a[168:171], a[92:95], v[232:235]
v_mfma_f32_16x16x32_bf16 v[140:143], a[172:175], a[80:83], v[140:143]
v_mfma_f32_16x16x32_bf16 v[172:175], a[172:175], a[84:87], v[172:175]
s_add_u32 m0, s30, 81920
s_add_u32 s3, s25, 294912
buffer_load_dwordx4 v9, s[4:7], s3 offen offset:0 lds
v_mfma_f32_16x16x32_bf16 v[204:207], a[172:175], a[88:91], v[204:207]
v_mfma_f32_16x16x32_bf16 v[236:239], a[172:175], a[92:95], v[236:239]
v_mfma_f32_16x16x32_bf16 v[144:147], a[176:179], a[80:83], v[144:147]
v_mfma_f32_16x16x32_bf16 v[176:179], a[176:179], a[84:87], v[176:179]
v_mfma_f32_16x16x32_bf16 v[208:211], a[176:179], a[88:91], v[208:211]
s_add_u32 m0, s30, 110592
s_add_u32 s3, s25, 442368
buffer_load_dwordx4 v1, s[4:7], s3 offen offset:0 lds
v_mfma_f32_16x16x32_bf16 v[240:243], a[176:179], a[92:95], v[240:243]
v_mfma_f32_16x16x32_bf16 v[148:151], a[180:183], a[80:83], v[148:151]
v_mfma_f32_16x16x32_bf16 v[180:183], a[180:183], a[84:87], v[180:183]
v_mfma_f32_16x16x32_bf16 v[212:215], a[180:183], a[88:91], v[212:215]
v_mfma_f32_16x16x32_bf16 v[244:247], a[180:183], a[92:95], v[244:247]
s_add_u32 m0, s30, 110592
s_add_u32 s3, s25, 442368
buffer_load_dwordx4 v2, s[4:7], s3 offen offset:1024 lds
v_mfma_f32_16x16x32_bf16 v[152:155], a[184:187], a[80:83], v[152:155]
v_mfma_f32_16x16x32_bf16 v[184:187], a[184:187], a[84:87], v[184:187]
v_mfma_f32_16x16x32_bf16 v[216:219], a[184:187], a[88:91], v[216:219]
v_mfma_f32_16x16x32_bf16 v[248:251], a[184:187], a[92:95], v[248:251]
v_mfma_f32_16x16x32_bf16 v[156:159], a[188:191], a[80:83], v[156:159]
s_add_u32 m0, s30, 110592
s_add_u32 s3, s25, 442368
buffer_load_dwordx4 v3, s[4:7], s3 offen offset:2048 lds
v_mfma_f32_16x16x32_bf16 v[188:191], a[188:191], a[84:87], v[188:191]
v_mfma_f32_16x16x32_bf16 v[220:223], a[188:191], a[88:91], v[220:223]
v_mfma_f32_16x16x32_bf16 v[252:255], a[188:191], a[92:95], v[252:255]
s_nop 3
v_cvt_pk_bf16_f32 v128, v128, v129
v_cvt_pk_bf16_f32 v129, v130, v131
s_add_u32 m0, s30, 110592
s_add_u32 s3, s25, 442368
buffer_load_dwordx4 v4, s[4:7], s3 offen offset:3072 lds
v_cvt_pk_bf16_f32 v130, v132, v133
v_cvt_pk_bf16_f32 v131, v134, v135
v_accvgpr_write_b32 a128, v128
v_accvgpr_write_b32 a129, v129
v_accvgpr_write_b32 a130, v130
v_accvgpr_write_b32 a131, v131
v_cvt_pk_bf16_f32 v136, v136, v137
v_cvt_pk_bf16_f32 v137, v138, v139
v_cvt_pk_bf16_f32 v138, v140, v141
v_cvt_pk_bf16_f32 v139, v142, v143
v_accvgpr_write_b32 a132, v136
v_accvgpr_write_b32 a133, v137
v_accvgpr_write_b32 a134, v138
v_accvgpr_write_b32 a135, v139
v_cvt_pk_bf16_f32 v144, v144, v145
v_cvt_pk_bf16_f32 v145, v146, v147
v_cvt_pk_bf16_f32 v146, v148, v149
v_cvt_pk_bf16_f32 v147, v150, v151
s_add_u32 m0, s30, 114688
s_add_u32 s3, s25, 442368
buffer_load_dwordx4 v5, s[4:7], s3 offen offset:0 lds
v_accvgpr_write_b32 a136, v144
v_accvgpr_write_b32 a137, v145
v_accvgpr_write_b32 a138, v146
v_accvgpr_write_b32 a139, v147
v_cvt_pk_bf16_f32 v152, v152, v153
v_cvt_pk_bf16_f32 v153, v154, v155
v_cvt_pk_bf16_f32 v154, v156, v157
v_cvt_pk_bf16_f32 v155, v158, v159
v_accvgpr_write_b32 a140, v152
v_accvgpr_write_b32 a141, v153
v_accvgpr_write_b32 a142, v154
v_accvgpr_write_b32 a143, v155
v_cvt_pk_bf16_f32 v160, v160, v161
v_cvt_pk_bf16_f32 v161, v162, v163
v_cvt_pk_bf16_f32 v162, v164, v165
v_cvt_pk_bf16_f32 v163, v166, v167
v_accvgpr_write_b32 a144, v160
v_accvgpr_write_b32 a145, v161
s_add_u32 m0, s30, 114688
s_add_u32 s3, s25, 442368
buffer_load_dwordx4 v6, s[4:7], s3 offen offset:1024 lds
v_accvgpr_write_b32 a146, v162
v_accvgpr_write_b32 a147, v163
v_cvt_pk_bf16_f32 v168, v168, v169
v_cvt_pk_bf16_f32 v169, v170, v171
v_cvt_pk_bf16_f32 v170, v172, v173
v_cvt_pk_bf16_f32 v171, v174, v175
v_accvgpr_write_b32 a148, v168
v_accvgpr_write_b32 a149, v169
v_accvgpr_write_b32 a150, v170
v_accvgpr_write_b32 a151, v171
v_cvt_pk_bf16_f32 v176, v176, v177
v_cvt_pk_bf16_f32 v177, v178, v179
v_cvt_pk_bf16_f32 v178, v180, v181
v_cvt_pk_bf16_f32 v179, v182, v183
v_accvgpr_write_b32 a152, v176
v_accvgpr_write_b32 a153, v177
v_accvgpr_write_b32 a154, v178
v_accvgpr_write_b32 a155, v179
s_add_u32 m0, s30, 114688
s_add_u32 s3, s25, 442368
buffer_load_dwordx4 v7, s[4:7], s3 offen offset:2048 lds
v_cvt_pk_bf16_f32 v184, v184, v185
v_cvt_pk_bf16_f32 v185, v186, v187
v_cvt_pk_bf16_f32 v186, v188, v189
v_cvt_pk_bf16_f32 v187, v190, v191
v_accvgpr_write_b32 a156, v184
v_accvgpr_write_b32 a157, v185
v_accvgpr_write_b32 a158, v186
v_accvgpr_write_b32 a159, v187
v_cvt_pk_bf16_f32 v192, v192, v193
v_cvt_pk_bf16_f32 v193, v194, v195
v_cvt_pk_bf16_f32 v194, v196, v197
v_cvt_pk_bf16_f32 v195, v198, v199
v_accvgpr_write_b32 a160, v192
v_accvgpr_write_b32 a161, v193
v_accvgpr_write_b32 a162, v194
v_accvgpr_write_b32 a163, v195
v_cvt_pk_bf16_f32 v200, v200, v201
v_cvt_pk_bf16_f32 v201, v202, v203
s_add_u32 m0, s30, 114688
s_add_u32 s3, s25, 442368
buffer_load_dwordx4 v8, s[4:7], s3 offen offset:3072 lds
v_cvt_pk_bf16_f32 v202, v204, v205
v_cvt_pk_bf16_f32 v203, v206, v207
v_accvgpr_write_b32 a164, v200
v_accvgpr_write_b32 a165, v201
v_accvgpr_write_b32 a166, v202
v_accvgpr_write_b32 a167, v203
v_cvt_pk_bf16_f32 v208, v208, v209
v_cvt_pk_bf16_f32 v209, v210, v211
v_cvt_pk_bf16_f32 v210, v212, v213
v_cvt_pk_bf16_f32 v211, v214, v215
v_accvgpr_write_b32 a168, v208
v_accvgpr_write_b32 a169, v209
v_accvgpr_write_b32 a170, v210
v_accvgpr_write_b32 a171, v211
v_cvt_pk_bf16_f32 v216, v216, v217
v_cvt_pk_bf16_f32 v217, v218, v219
v_cvt_pk_bf16_f32 v218, v220, v221
v_cvt_pk_bf16_f32 v219, v222, v223
s_add_u32 m0, s30, 118784
s_add_u32 s3, s25, 442368
buffer_load_dwordx4 v9, s[4:7], s3 offen offset:0 lds
v_accvgpr_write_b32 a172, v216
v_accvgpr_write_b32 a173, v217
v_accvgpr_write_b32 a174, v218
v_accvgpr_write_b32 a175, v219
v_cvt_pk_bf16_f32 v224, v224, v225
v_cvt_pk_bf16_f32 v225, v226, v227
v_cvt_pk_bf16_f32 v226, v228, v229
v_cvt_pk_bf16_f32 v227, v230, v231
v_accvgpr_write_b32 a176, v224
v_accvgpr_write_b32 a177, v225
v_accvgpr_write_b32 a178, v226
v_accvgpr_write_b32 a179, v227
v_cvt_pk_bf16_f32 v232, v232, v233
v_cvt_pk_bf16_f32 v233, v234, v235
v_cvt_pk_bf16_f32 v234, v236, v237
v_cvt_pk_bf16_f32 v235, v238, v239
v_accvgpr_write_b32 a180, v232
v_accvgpr_write_b32 a181, v233
v_accvgpr_write_b32 a182, v234
v_accvgpr_write_b32 a183, v235
v_cvt_pk_bf16_f32 v240, v240, v241
v_cvt_pk_bf16_f32 v241, v242, v243
v_cvt_pk_bf16_f32 v242, v244, v245
v_cvt_pk_bf16_f32 v243, v246, v247
v_accvgpr_write_b32 a184, v240
v_accvgpr_write_b32 a185, v241
v_accvgpr_write_b32 a186, v242
v_accvgpr_write_b32 a187, v243
v_cvt_pk_bf16_f32 v248, v248, v249
v_cvt_pk_bf16_f32 v249, v250, v251
v_cvt_pk_bf16_f32 v250, v252, v253
v_cvt_pk_bf16_f32 v251, v254, v255
v_accvgpr_write_b32 a188, v248
v_accvgpr_write_b32 a189, v249
v_accvgpr_write_b32 a190, v250
v_accvgpr_write_b32 a191, v251
s_waitcnt vmcnt(27)
ds_read_b64_tr_b16 a[0:1], v49 offset:0
ds_read_b64_tr_b16 a[2:3], v49 offset:4608
ds_read_b64_tr_b16 a[4:5], v49 offset:32
ds_read_b64_tr_b16 a[6:7], v49 offset:4640
ds_read_b64_tr_b16 a[8:9], v49 offset:64
ds_read_b64_tr_b16 a[10:11], v49 offset:4672
ds_read_b64_tr_b16 a[12:13], v49 offset:96
ds_read_b64_tr_b16 a[14:15], v49 offset:4704
ds_read_b64_tr_b16 a[16:17], v49 offset:128
ds_read_b64_tr_b16 a[18:19], v49 offset:4736
ds_read_b64_tr_b16 a[20:21], v49 offset:160
ds_read_b64_tr_b16 a[22:23], v49 offset:4768
ds_read_b64_tr_b16 a[24:25], v49 offset:192
ds_read_b64_tr_b16 a[26:27], v49 offset:4800
ds_read_b64_tr_b16 a[28:29], v49 offset:224
ds_read_b64_tr_b16 a[30:31], v49 offset:4832
ds_read_b64_tr_b16 a[32:33], v49 offset:256
ds_read_b64_tr_b16 a[34:35], v49 offset:4864
s_waitcnt vmcnt(18) lgkmcnt(0)
v_mfma_f32_16x16x32_bf16 v[128:131], a[0:3], a[192:195], 0
s_add_u32 m0, s30, 0
s_add_u32 s3, s25, 589824
buffer_load_dwordx4 v1, s[4:7], s3 offen offset:0 lds
ds_read_b64_tr_b16 a[36:37], v49 offset:36864
v_mfma_f32_16x16x32_bf16 v[164:167], a[0:3], a[196:199], 0
ds_read_b64_tr_b16 a[38:39], v49 offset:41472
v_mfma_f32_16x16x32_bf16 v[132:135], a[4:7], a[192:195], 0
ds_read_b64_tr_b16 a[40:41], v49 offset:36896
v_mfma_f32_16x16x32_bf16 v[168:171], a[4:7], a[196:199], 0
ds_read_b64_tr_b16 a[42:43], v49 offset:41504
v_mfma_f32_16x16x32_bf16 v[136:139], a[8:11], a[192:195], 0
s_add_u32 m0, s30, 0
s_add_u32 s3, s25, 589824
buffer_load_dwordx4 v2, s[4:7], s3 offen offset:1024 lds
ds_read_b64_tr_b16 a[44:45], v49 offset:36928
v_mfma_f32_16x16x32_bf16 v[172:175], a[8:11], a[196:199], 0
ds_read_b64_tr_b16 a[46:47], v49 offset:41536
v_mfma_f32_16x16x32_bf16 v[140:143], a[12:15], a[192:195], 0
ds_read_b64_tr_b16 a[48:49], v49 offset:36960
v_mfma_f32_16x16x32_bf16 v[176:179], a[12:15], a[196:199], 0
ds_read_b64_tr_b16 a[50:51], v49 offset:41568
v_mfma_f32_16x16x32_bf16 v[144:147], a[16:19], a[192:195], 0
s_add_u32 m0, s30, 0
s_add_u32 s3, s25, 589824
buffer_load_dwordx4 v3, s[4:7], s3 offen offset:2048 lds
ds_read_b64_tr_b16 a[52:53], v49 offset:36992
v_mfma_f32_16x16x32_bf16 v[180:183], a[16:19], a[196:199], 0
ds_read_b64_tr_b16 a[54:55], v49 offset:41600
v_mfma_f32_16x16x32_bf16 v[148:151], a[20:23], a[192:195], 0
ds_read_b64_tr_b16 a[56:57], v49 offset:37024
v_mfma_f32_16x16x32_bf16 v[184:187], a[20:23], a[196:199], 0
ds_read_b64_tr_b16 a[58:59], v49 offset:41632
v_mfma_f32_16x16x32_bf16 v[152:155], a[24:27], a[192:195], 0
s_add_u32 m0, s30, 0
s_add_u32 s3, s25, 589824
buffer_load_dwordx4 v4, s[4:7], s3 offen offset:3072 lds
ds_read_b64_tr_b16 a[60:61], v49 offset:37056
v_mfma_f32_16x16x32_bf16 v[188:191], a[24:27], a[196:199], 0
ds_read_b64_tr_b16 a[62:63], v49 offset:41664
v_mfma_f32_16x16x32_bf16 v[156:159], a[28:31], a[192:195], 0
ds_read_b64_tr_b16 a[64:65], v49 offset:37088
v_mfma_f32_16x16x32_bf16 v[192:195], a[28:31], a[196:199], 0
ds_read_b64_tr_b16 a[66:67], v49 offset:41696
v_mfma_f32_16x16x32_bf16 v[160:163], a[32:35], a[192:195], 0
s_add_u32 m0, s30, 4096
s_add_u32 s3, s25, 589824
buffer_load_dwordx4 v5, s[4:7], s3 offen offset:0 lds
ds_read_b64_tr_b16 a[68:69], v49 offset:37120
v_mfma_f32_16x16x32_bf16 v[196:199], a[32:35], a[196:199], 0
ds_read_b64_tr_b16 a[70:71], v49 offset:41728
s_waitcnt vmcnt(14) lgkmcnt(0)
v_mfma_f32_16x16x32_bf16 v[128:131], a[36:39], a[200:203], v[128:131]
ds_read_b64_tr_b16 a[0:1], v50 offset:9216
v_mfma_f32_16x16x32_bf16 v[164:167], a[36:39], a[204:207], v[164:167]
ds_read_b64_tr_b16 a[2:3], v50 offset:13824
v_mfma_f32_16x16x32_bf16 v[132:135], a[40:43], a[200:203], v[132:135]
s_add_u32 m0, s30, 4096
s_add_u32 s3, s25, 589824
buffer_load_dwordx4 v6, s[4:7], s3 offen offset:1024 lds
ds_read_b64_tr_b16 a[4:5], v50 offset:9248
v_mfma_f32_16x16x32_bf16 v[168:171], a[40:43], a[204:207], v[168:171]
ds_read_b64_tr_b16 a[6:7], v50 offset:13856
v_mfma_f32_16x16x32_bf16 v[136:139], a[44:47], a[200:203], v[136:139]
ds_read_b64_tr_b16 a[8:9], v50 offset:9280
v_mfma_f32_16x16x32_bf16 v[172:175], a[44:47], a[204:207], v[172:175]
ds_read_b64_tr_b16 a[10:11], v50 offset:13888
v_mfma_f32_16x16x32_bf16 v[140:143], a[48:51], a[200:203], v[140:143]
s_add_u32 m0, s30, 4096
s_add_u32 s3, s25, 589824
buffer_load_dwordx4 v7, s[4:7], s3 offen offset:2048 lds
ds_read_b64_tr_b16 a[12:13], v50 offset:9312
v_mfma_f32_16x16x32_bf16 v[176:179], a[48:51], a[204:207], v[176:179]
ds_read_b64_tr_b16 a[14:15], v50 offset:13920
v_mfma_f32_16x16x32_bf16 v[144:147], a[52:55], a[200:203], v[144:147]
ds_read_b64_tr_b16 a[16:17], v50 offset:9344
v_mfma_f32_16x16x32_bf16 v[180:183], a[52:55], a[204:207], v[180:183]
ds_read_b64_tr_b16 a[18:19], v50 offset:13952
v_mfma_f32_16x16x32_bf16 v[148:151], a[56:59], a[200:203], v[148:151]
s_add_u32 m0, s30, 4096
s_add_u32 s3, s25, 589824
buffer_load_dwordx4 v8, s[4:7], s3 offen offset:3072 lds
ds_read_b64_tr_b16 a[20:21], v50 offset:9376
v_mfma_f32_16x16x32_bf16 v[184:187], a[56:59], a[204:207], v[184:187]
ds_read_b64_tr_b16 a[22:23], v50 offset:13984
v_mfma_f32_16x16x32_bf16 v[152:155], a[60:63], a[200:203], v[152:155]
ds_read_b64_tr_b16 a[24:25], v50 offset:9408
v_mfma_f32_16x16x32_bf16 v[188:191], a[60:63], a[204:207], v[188:191]
ds_read_b64_tr_b16 a[26:27], v50 offset:14016
v_mfma_f32_16x16x32_bf16 v[156:159], a[64:67], a[200:203], v[156:159]
s_add_u32 m0, s30, 8192
s_add_u32 s3, s25, 589824
buffer_load_dwordx4 v9, s[4:7], s3 offen offset:0 lds
ds_read_b64_tr_b16 a[28:29], v50 offset:9440
v_mfma_f32_16x16x32_bf16 v[192:195], a[64:67], a[204:207], v[192:195]
ds_read_b64_tr_b16 a[30:31], v50 offset:14048
v_mfma_f32_16x16x32_bf16 v[160:163], a[68:71], a[200:203], v[160:163]
ds_read_b64_tr_b16 a[32:33], v50 offset:9472
v_mfma_f32_16x16x32_bf16 v[196:199], a[68:71], a[204:207], v[196:199]
ds_read_b64_tr_b16 a[34:35], v50 offset:14080
s_waitcnt vmcnt(9) lgkmcnt(0)
v_mfma_f32_16x16x32_bf16 v[128:131], a[0:3], a[208:211], v[128:131]
ds_read_b64_tr_b16 a[36:37], v50 offset:46080
v_mfma_f32_16x16x32_bf16 v[164:167], a[0:3], a[212:215], v[164:167]
ds_read_b64_tr_b16 a[38:39], v50 offset:50688
v_mfma_f32_16x16x32_bf16 v[132:135], a[4:7], a[208:211], v[132:135]
ds_read_b64_tr_b16 a[40:41], v50 offset:46112
v_mfma_f32_16x16x32_bf16 v[168:171], a[4:7], a[212:215], v[168:171]
ds_read_b64_tr_b16 a[42:43], v50 offset:50720
v_mfma_f32_16x16x32_bf16 v[136:139], a[8:11], a[208:211], v[136:139]
ds_read_b64_tr_b16 a[44:45], v50 offset:46144
v_mfma_f32_16x16x32_bf16 v[172:175], a[8:11], a[212:215], v[172:175]
ds_read_b64_tr_b16 a[46:47], v50 offset:50752
v_mfma_f32_16x16x32_bf16 v[140:143], a[12:15], a[208:211], v[140:143]
ds_read_b64_tr_b16 a[48:49], v50 offset:46176
v_mfma_f32_16x16x32_bf16 v[176:179], a[12:15], a[212:215], v[176:179]
ds_read_b64_tr_b16 a[50:51], v50 offset:50784
v_mfma_f32_16x16x32_bf16 v[144:147], a[16:19], a[208:211], v[144:147]
ds_read_b64_tr_b16 a[52:53], v50 offset:46208
v_mfma_f32_16x16x32_bf16 v[180:183], a[16:19], a[212:215], v[180:183]
ds_read_b64_tr_b16 a[54:55], v50 offset:50816
v_mfma_f32_16x16x32_bf16 v[148:151], a[20:23], a[208:211], v[148:151]
ds_read_b64_tr_b16 a[56:57], v50 offset:46240
v_mfma_f32_16x16x32_bf16 v[184:187], a[20:23], a[212:215], v[184:187]
ds_read_b64_tr_b16 a[58:59], v50 offset:50848
v_mfma_f32_16x16x32_bf16 v[152:155], a[24:27], a[208:211], v[152:155]
ds_read_b64_tr_b16 a[60:61], v50 offset:46272
v_mfma_f32_16x16x32_bf16 v[188:191], a[24:27], a[212:215], v[188:191]
ds_read_b64_tr_b16 a[62:63], v50 offset:50880
v_mfma_f32_16x16x32_bf16 v[156:159], a[28:31], a[208:211], v[156:159]
ds_read_b64_tr_b16 a[64:65], v50 offset:46304
v_mfma_f32_16x16x32_bf16 v[192:195], a[28:31], a[212:215], v[192:195]
ds_read_b64_tr_b16 a[66:67], v50 offset:50912
v_mfma_f32_16x16x32_bf16 v[160:163], a[32:35], a[208:211], v[160:163]
ds_read_b64_tr_b16 a[68:69], v50 offset:46336
v_mfma_f32_16x16x32_bf16 v[196:199], a[32:35], a[212:215], v[196:199]
ds_read_b64_tr_b16 a[70:71], v50 offset:50944
s_waitcnt vmcnt(0) lgkmcnt(0)
v_mfma_f32_16x16x32_bf16 v[128:131], a[36:39], a[216:219], v[128:131]
ds_read_b64_tr_b16 a[0:1], v49 offset:0
v_mfma_f32_16x16x32_bf16 v[164:167], a[36:39], a[220:223], v[164:167]
ds_read_b64_tr_b16 a[2:3], v49 offset:4608
v_mfma_f32_16x16x32_bf16 v[132:135], a[40:43], a[216:219], v[132:135]
ds_read_b64_tr_b16 a[4:5], v49 offset:32
v_mfma_f32_16x16x32_bf16 v[168:171], a[40:43], a[220:223], v[168:171]
ds_read_b64_tr_b16 a[6:7], v49 offset:4640
v_mfma_f32_16x16x32_bf16 v[136:139], a[44:47], a[216:219], v[136:139]
ds_read_b64_tr_b16 a[8:9], v49 offset:64
v_mfma_f32_16x16x32_bf16 v[172:175], a[44:47], a[220:223], v[172:175]
ds_read_b64_tr_b16 a[10:11], v49 offset:4672
v_mfma_f32_16x16x32_bf16 v[140:143], a[48:51], a[216:219], v[140:143]
ds_read_b64_tr_b16 a[12:13], v49 offset:96
v_mfma_f32_16x16x32_bf16 v[176:179], a[48:51], a[220:223], v[176:179]
ds_read_b64_tr_b16 a[14:15], v49 offset:4704
v_mfma_f32_16x16x32_bf16 v[144:147], a[52:55], a[216:219], v[144:147]
ds_read_b64_tr_b16 a[16:17], v49 offset:128
v_mfma_f32_16x16x32_bf16 v[180:183], a[52:55], a[220:223], v[180:183]
ds_read_b64_tr_b16 a[18:19], v49 offset:4736
v_mfma_f32_16x16x32_bf16 v[148:151], a[56:59], a[216:219], v[148:151]
ds_read_b64_tr_b16 a[20:21], v49 offset:160
v_mfma_f32_16x16x32_bf16 v[184:187], a[56:59], a[220:223], v[184:187]
ds_read_b64_tr_b16 a[22:23], v49 offset:4768
v_mfma_f32_16x16x32_bf16 v[152:155], a[60:63], a[216:219], v[152:155]
ds_read_b64_tr_b16 a[24:25], v49 offset:192
v_mfma_f32_16x16x32_bf16 v[188:191], a[60:63], a[220:223], v[188:191]
ds_read_b64_tr_b16 a[26:27], v49 offset:4800
v_mfma_f32_16x16x32_bf16 v[156:159], a[64:67], a[216:219], v[156:159]
ds_read_b64_tr_b16 a[28:29], v49 offset:224
v_mfma_f32_16x16x32_bf16 v[192:195], a[64:67], a[220:223], v[192:195]
ds_read_b64_tr_b16 a[30:31], v49 offset:4832
v_mfma_f32_16x16x32_bf16 v[160:163], a[68:71], a[216:219], v[160:163]
ds_read_b64_tr_b16 a[32:33], v49 offset:256
v_mfma_f32_16x16x32_bf16 v[196:199], a[68:71], a[220:223], v[196:199]
ds_read_b64_tr_b16 a[34:35], v49 offset:4864
s_waitcnt vmcnt(0) lgkmcnt(0)
v_mfma_f32_16x16x32_bf16 v[128:131], a[0:3], a[224:227], v[128:131]
v_mfma_f32_16x16x32_bf16 v[164:167], a[0:3], a[228:231], v[164:167]
v_mfma_f32_16x16x32_bf16 v[132:135], a[4:7], a[224:227], v[132:135]
v_mfma_f32_16x16x32_bf16 v[168:171], a[4:7], a[228:231], v[168:171]
v_mfma_f32_16x16x32_bf16 v[136:139], a[8:11], a[224:227], v[136:139]
v_mfma_f32_16x16x32_bf16 v[172:175], a[8:11], a[228:231], v[172:175]
v_mfma_f32_16x16x32_bf16 v[140:143], a[12:15], a[224:227], v[140:143]
v_mfma_f32_16x16x32_bf16 v[176:179], a[12:15], a[228:231], v[176:179]
v_mfma_f32_16x16x32_bf16 v[144:147], a[16:19], a[224:227], v[144:147]
v_mfma_f32_16x16x32_bf16 v[180:183], a[16:19], a[228:231], v[180:183]
v_mfma_f32_16x16x32_bf16 v[148:151], a[20:23], a[224:227], v[148:151]
v_mfma_f32_16x16x32_bf16 v[184:187], a[20:23], a[228:231], v[184:187]
v_mfma_f32_16x16x32_bf16 v[152:155], a[24:27], a[224:227], v[152:155]
v_mfma_f32_16x16x32_bf16 v[188:191], a[24:27], a[228:231], v[188:191]
v_mfma_f32_16x16x32_bf16 v[156:159], a[28:31], a[224:227], v[156:159]
v_mfma_f32_16x16x32_bf16 v[192:195], a[28:31], a[228:231], v[192:195]
v_mfma_f32_16x16x32_bf16 v[160:163], a[32:35], a[224:227], v[160:163]
v_mfma_f32_16x16x32_bf16 v[196:199], a[32:35], a[228:231], v[196:199]
s_nop 7
s_barrier
s_mul_i32 s33, s24, 18432
s_add_u32 s33, s33, 90112
v_add_u32 v12, s33, v11
s_lshl_b32 s33, s31, 19
s_mov_b32 s30, s55
s_mov_b32 s25, s55
s_mov_b32 s26, s55
s_add_u32 s4, s66, s33
s_addc_u32 s5, s67, 0
s_mov_b32 s6, 0x80000
s_mov_b32 s7, 0x00020000
s_add_u32 s8, s68, s33
s_addc_u32 s9, s69, 0
s_mov_b32 s10, 0x80000
s_mov_b32 s11, 0x00020000
ds_write_b128 v12, v[128:131] offset:0
s_add_u32 m0, s30, 0
s_nop 0
buffer_load_dwordx4 v32, s[4:7], s25 offen offset:0 lds
ds_write_b128 v12, v[132:135] offset:1024
ds_write_b128 v12, v[136:139] offset:2048
ds_write_b128 v12, v[140:143] offset:3072
ds_write_b128 v12, v[144:147] offset:4096
ds_write_b128 v12, v[148:151] offset:5120
ds_write_b128 v12, v[152:155] offset:6144
ds_write_b128 v12, v[156:159] offset:7168
ds_write_b128 v12, v[160:163] offset:8192
ds_write_b128 v12, v[164:167] offset:9216
ds_write_b128 v12, v[168:171] offset:10240
ds_write_b128 v12, v[172:175] offset:11264
ds_write_b128 v12, v[176:179] offset:12288
ds_write_b128 v12, v[180:183] offset:13312
ds_write_b128 v12, v[184:187] offset:14336
ds_write_b128 v12, v[188:191] offset:15360
ds_write_b128 v12, v[192:195] offset:16384
ds_write_b128 v12, v[196:199] offset:17408
s_waitcnt lgkmcnt(0)
s_barrier
s_add_u32 s33, s53, 90112
v_add_u32 v12, s33, v11
s_add_u32 m0, s30, 0
s_nop 0
buffer_load_dwordx4 v33, s[4:7], s25 offen offset:1024 lds
ds_read_b128 v[84:87], v12 offset:0
ds_read_b128 v[88:91], v12 offset:18432
ds_read_b128 v[92:95], v12 offset:36864
ds_read_b128 v[96:99], v12 offset:55296
ds_read_b128 v[100:103], v12 offset:1024
ds_read_b128 v[104:107], v12 offset:19456
ds_read_b128 v[108:111], v12 offset:37888
ds_read_b128 v[112:115], v12 offset:56320
s_waitcnt lgkmcnt(4)
v_pk_add_f32 v[84:85], v[84:85], v[88:89]
v_pk_add_f32 v[92:93], v[92:93], v[96:97]
v_pk_add_f32 v[64:65], v[84:85], v[92:93]
v_pk_add_f32 v[86:87], v[86:87], v[90:91]
v_pk_add_f32 v[94:95], v[94:95], v[98:99]
v_pk_add_f32 v[66:67], v[86:87], v[94:95]
s_add_u32 m0, s30, 0
s_nop 0
buffer_load_dwordx4 v34, s[4:7], s25 offen offset:2048 lds
ds_read_b128 v[84:87], v12 offset:2048
ds_read_b128 v[88:91], v12 offset:20480
ds_read_b128 v[92:95], v12 offset:38912
ds_read_b128 v[96:99], v12 offset:57344
s_waitcnt lgkmcnt(4)
v_pk_add_f32 v[100:101], v[100:101], v[104:105]
v_pk_add_f32 v[108:109], v[108:109], v[112:113]
v_pk_add_f32 v[68:69], v[100:101], v[108:109]
v_pk_add_f32 v[102:103], v[102:103], v[106:107]
v_pk_add_f32 v[110:111], v[110:111], v[114:115]
v_pk_add_f32 v[70:71], v[102:103], v[110:111]
ds_read_b128 v[100:103], v12 offset:3072
ds_read_b128 v[104:107], v12 offset:21504
ds_read_b128 v[108:111], v12 offset:39936
ds_read_b128 v[112:115], v12 offset:58368
s_add_u32 m0, s30, 0
s_nop 0
buffer_load_dwordx4 v35, s[4:7], s25 offen offset:3072 lds
s_waitcnt lgkmcnt(4)
v_pk_add_f32 v[84:85], v[84:85], v[88:89]
v_pk_add_f32 v[92:93], v[92:93], v[96:97]
v_pk_add_f32 v[72:73], v[84:85], v[92:93]
v_pk_add_f32 v[86:87], v[86:87], v[90:91]
v_pk_add_f32 v[94:95], v[94:95], v[98:99]
v_pk_add_f32 v[74:75], v[86:87], v[94:95]
ds_read_b128 v[84:87], v12 offset:4096
ds_read_b128 v[88:91], v12 offset:22528
ds_read_b128 v[92:95], v12 offset:40960
ds_read_b128 v[96:99], v12 offset:59392
s_waitcnt lgkmcnt(4)
v_pk_add_f32 v[100:101], v[100:101], v[104:105]
v_pk_add_f32 v[108:109], v[108:109], v[112:113]
s_add_u32 s25, s25, 16384
s_add_u32 m0, s30, 16384
s_nop 0
buffer_load_dwordx4 v32, s[4:7], s25 offen offset:0 lds
v_pk_add_f32 v[76:77], v[100:101], v[108:109]
v_pk_add_f32 v[102:103], v[102:103], v[106:107]
v_pk_add_f32 v[110:111], v[110:111], v[114:115]
v_pk_add_f32 v[78:79], v[102:103], v[110:111]
s_waitcnt lgkmcnt(0)
v_pk_add_f32 v[84:85], v[84:85], v[88:89]
v_pk_add_f32 v[92:93], v[92:93], v[96:97]
v_pk_add_f32 v[80:81], v[84:85], v[92:93]
v_pk_add_f32 v[86:87], v[86:87], v[90:91]
v_pk_add_f32 v[94:95], v[94:95], v[98:99]
v_pk_add_f32 v[82:83], v[86:87], v[94:95]
s_add_u32 s16, s88, 0x6c0000
s_addc_u32 s17, s89, 0
s_mov_b32 s18, 0x240000
s_mov_b32 s19, 0x00020000
s_mul_i32 s47, s62, 18432
v_add_u32 v14, s47, v11
s_add_u32 m0, s30, 16384
s_nop 0
buffer_load_dwordx4 v33, s[4:7], s25 offen offset:1024 lds
v_mov_b32 v18, 0x40faf233
s_add_u32 s33, s60, 0
s_lshr_b32 s35, s33, 1
s_lshl_b32 s35, s35, 10
s_and_b32 s33, s33, 1
s_lshl_b32 s33, s33, 3
s_add_u32 s35, s35, s33
v_lshlrev_b32 v84, 16, v116
v_and_b32 v85, 0xffff0000, v116
v_lshlrev_b32 v86, 16, v117
v_and_b32 v87, 0xffff0000, v117
v_pk_fma_f32 v[64:65], v[84:85], v[18:19], v[64:65] op_sel_hi:[1,0,1]
v_pk_fma_f32 v[66:67], v[86:87], v[18:19], v[66:67] op_sel_hi:[1,0,1]
v_cvt_pk_bf16_f32 v88, v64, v65
v_cvt_pk_bf16_f32 v89, v66, v67
buffer_store_dwordx2 v[88:89], v14, s[16:19], s35 offen sc1
v_lshlrev_b32 v64, 16, v88
v_and_b32 v65, 0xffff0000, v88
v_lshlrev_b32 v66, 16, v89
v_and_b32 v67, 0xffff0000, v89
s_add_u32 s33, s60, 1
s_lshr_b32 s35, s33, 1
s_lshl_b32 s35, s35, 10
s_and_b32 s33, s33, 1
s_lshl_b32 s33, s33, 3
s_add_u32 s35, s35, s33
v_lshlrev_b32 v92, 16, v118
v_and_b32 v93, 0xffff0000, v118
v_lshlrev_b32 v94, 16, v119
v_and_b32 v95, 0xffff0000, v119
v_pk_fma_f32 v[68:69], v[92:93], v[18:19], v[68:69] op_sel_hi:[1,0,1]
v_pk_fma_f32 v[70:71], v[94:95], v[18:19], v[70:71] op_sel_hi:[1,0,1]
v_cvt_pk_bf16_f32 v96, v68, v69
s_add_u32 m0, s30, 16384
s_nop 0
buffer_load_dwordx4 v34, s[4:7], s25 offen offset:2048 lds
v_cvt_pk_bf16_f32 v97, v70, v71
buffer_store_dwordx2 v[96:97], v14, s[16:19], s35 offen sc1
v_lshlrev_b32 v68, 16, v96
v_and_b32 v69, 0xffff0000, v96
v_lshlrev_b32 v70, 16, v97
v_and_b32 v71, 0xffff0000, v97
s_add_u32 s33, s60, 2
s_lshr_b32 s35, s33, 1
s_lshl_b32 s35, s35, 10
s_and_b32 s33, s33, 1
s_lshl_b32 s33, s33, 3
s_add_u32 s35, s35, s33
v_lshlrev_b32 v84, 16, v120
v_and_b32 v85, 0xffff0000, v120
v_lshlrev_b32 v86, 16, v121
v_and_b32 v87, 0xffff0000, v121
v_pk_fma_f32 v[72:73], v[84:85], v[18:19], v[72:73] op_sel_hi:[1,0,1]
v_pk_fma_f32 v[74:75], v[86:87], v[18:19], v[74:75] op_sel_hi:[1,0,1]
v_cvt_pk_bf16_f32 v88, v72, v73
s_add_u32 m0, s30, 16384
s_nop 0
buffer_load_dwordx4 v35, s[4:7], s25 offen offset:3072 lds
v_cvt_pk_bf16_f32 v89, v74, v75
buffer_store_dwordx2 v[88:89], v14, s[16:19], s35 offen sc1
v_lshlrev_b32 v72, 16, v88
v_and_b32 v73, 0xffff0000, v88
v_lshlrev_b32 v74, 16, v89
v_and_b32 v75, 0xffff0000, v89
s_add_u32 s33, s60, 3
s_lshr_b32 s35, s33, 1
s_lshl_b32 s35, s35, 10
s_and_b32 s33, s33, 1
s_lshl_b32 s33, s33, 3
s_add_u32 s35, s35, s33
v_lshlrev_b32 v92, 16, v122
v_and_b32 v93, 0xffff0000, v122
v_lshlrev_b32 v94, 16, v123
v_and_b32 v95, 0xffff0000, v123
v_pk_fma_f32 v[76:77], v[92:93], v[18:19], v[76:77] op_sel_hi:[1,0,1]
v_pk_fma_f32 v[78:79], v[94:95], v[18:19], v[78:79] op_sel_hi:[1,0,1]
v_cvt_pk_bf16_f32 v96, v76, v77
s_add_u32 s25, s25, 16384
s_add_u32 m0, s30, 65536
s_nop 0
buffer_load_dwordx4 v36, s[8:11], s26 offen offset:0 lds
v_cvt_pk_bf16_f32 v97, v78, v79
buffer_store_dwordx2 v[96:97], v14, s[16:19], s35 offen sc1
v_lshlrev_b32 v76, 16, v96
v_and_b32 v77, 0xffff0000, v96
v_lshlrev_b32 v78, 16, v97
v_and_b32 v79, 0xffff0000, v97
s_add_u32 s33, s60, 4
s_lshr_b32 s35, s33, 1
s_lshl_b32 s35, s35, 10
s_and_b32 s33, s33, 1
s_lshl_b32 s33, s33, 3
s_add_u32 s35, s35, s33
s_cmp_ge_u32 s24, 2
s_cselect_b32 s35, 0x7fff0000, s35
v_lshlrev_b32 v84, 16, v124
v_and_b32 v85, 0xffff0000, v124
v_lshlrev_b32 v86, 16, v125
v_and_b32 v87, 0xffff0000, v125
v_pk_fma_f32 v[80:81], v[84:85], v[18:19], v[80:81] op_sel_hi:[1,0,1]
v_pk_fma_f32 v[82:83], v[86:87], v[18:19], v[82:83] op_sel_hi:[1,0,1]
s_add_u32 m0, s30, 65536
s_nop 0
buffer_load_dwordx4 v37, s[8:11], s26 offen offset:1024 lds
v_cvt_pk_bf16_f32 v88, v80, v81
v_cvt_pk_bf16_f32 v89, v82, v83
buffer_store_dwordx2 v[88:89], v14, s[16:19], s35 offen sc1
v_lshlrev_b32 v80, 16, v88
v_and_b32 v81, 0xffff0000, v88
v_lshlrev_b32 v82, 16, v89
v_and_b32 v83, 0xffff0000, v89
s_cmp_ge_u32 s24, 2
s_cselect_b32 s92, 0, 1.0
s_mov_b32 s93, 0x3c4ccccd
s_cbranch_scc0 L_five
s_mov_b32 s93, 0x3c800000
v_mov_b32 v80, 0
v_mov_b32 v81, 0
v_mov_b32 v82, 0
v_mov_b32 v83, 0
L_five:
v_add_f32 v16, v64, v65
v_add_f32 v16, v16, v66
v_add_f32 v16, v16, v67
v_add_f32 v16, v16, v68
v_add_f32 v16, v16, v69
s_add_u32 m0, s30, 65536
s_nop 0
buffer_load_dwordx4 v36, s[8:11], s26 offen offset:2048 lds
v_add_f32 v16, v16, v70
v_add_f32 v16, v16, v71
v_add_f32 v16, v16, v72
v_add_f32 v16, v16, v73
v_add_f32 v16, v16, v74
v_add_f32 v16, v16, v75
v_add_f32 v16, v16, v76
v_add_f32 v16, v16, v77
v_add_f32 v16, v16, v78
v_add_f32 v16, v16, v79
v_add_f32 v16, v16, v80
v_add_f32 v16, v16, v81
v_add_f32 v16, v16, v82
v_add_f32 v16, v16, v83
v_mov_b32 v17, v16
s_nop 1
v_permlane16_swap_b32 v16, v17
s_add_u32 m0, s30, 65536
s_nop 0
buffer_load_dwordx4 v37, s[8:11], s26 offen offset:3072 lds
s_nop 1
v_add_f32 v16, v16, v17
v_mov_b32 v17, v16
s_nop 1
v_permlane32_swap_b32 v16, v17
s_nop 1
v_add_f32 v16, v16, v17
v_mul_f32 v18, s93, v16
v_mul_f32 v19, s92, v18
v_mov_b32 v20, 0
v_sub_f32 v64, v64, v18
v_fmac_f32 v20, v64, v64
v_sub_f32 v65, v65, v18
v_fmac_f32 v20, v65, v65
v_sub_f32 v66, v66, v18
s_add_u32 s26, s26, 16384
s_add_u32 m0, s30, 32768
s_nop 0
buffer_load_dwordx4 v32, s[4:7], s25 offen offset:0 lds
v_fmac_f32 v20, v66, v66
v_sub_f32 v67, v67, v18
v_fmac_f32 v20, v67, v67
v_sub_f32 v68, v68, v18
v_fmac_f32 v20, v68, v68
v_sub_f32 v69, v69, v18
v_fmac_f32 v20, v69, v69
v_sub_f32 v70, v70, v18
v_fmac_f32 v20, v70, v70
v_sub_f32 v71, v71, v18
v_fmac_f32 v20, v71, v71
v_sub_f32 v72, v72, v18
v_fmac_f32 v20, v72, v72
v_sub_f32 v73, v73, v18
v_fmac_f32 v20, v73, v73
v_sub_f32 v74, v74, v18
v_fmac_f32 v20, v74, v74
v_sub_f32 v75, v75, v18
s_add_u32 m0, s30, 32768
s_nop 0
buffer_load_dwordx4 v33, s[4:7], s25 offen offset:1024 lds
v_fmac_f32 v20, v75, v75
v_sub_f32 v76, v76, v18
v_fmac_f32 v20, v76, v76
v_sub_f32 v77, v77, v18
v_fmac_f32 v20, v77, v77
v_sub_f32 v78, v78, v18
v_fmac_f32 v20, v78, v78
v_sub_f32 v79, v79, v18
v_fmac_f32 v20, v79, v79
v_sub_f32 v80, v80, v19
v_fmac_f32 v20, v80, v80
v_sub_f32 v81, v81, v19
v_fmac_f32 v20, v81, v81
v_sub_f32 v82, v82, v19
v_fmac_f32 v20, v82, v82
v_sub_f32 v83, v83, v19
v_fmac_f32 v20, v83, v83
v_mov_b32 v21, v20
s_add_u32 m0, s30, 32768
s_nop 0
buffer_load_dwordx4 v34, s[4:7], s25 offen offset:2048 lds
s_nop 1
v_permlane16_swap_b32 v20, v21
s_nop 1
v_add_f32 v20, v20, v21
v_mov_b32 v21, v20
s_nop 1
v_permlane32_swap_b32 v20, v21
s_nop 1
v_add_f32 v20, v20, v21
s_add_u32 s16, s88, 0x900000
s_addc_u32 s17, s89, 0
s_mov_b32 s18, 0x20000
s_mov_b32 s19, 0x00020000
v_mov_b32 v17, v20
s_add_u32 m0, s30, 32768
s_nop 0
buffer_load_dwordx4 v35, s[4:7], s25 offen offset:3072 lds
s_add_u32 s25, s25, 16384
s_lshl_b32 s33, s62, 10
s_lshl_b32 s34, s49, 4
s_add_u32 s33, s33, s34
s_lshr_b32 s34, s24, 1
s_lshl_b32 s34, s34, 3
s_add_u32 s33, s33, s34
v_lshlrev_b32 v12, 6, v0
v_cmp_gt_u32 vcc, 16, v0
v_mov_b32 v13, 0x7fff0000
s_nop 0
v_cndmask_b32 v12, v13, v12, vcc
buffer_store_dwordx2 v[16:17], v12, s[16:19], s33 offen sc1
v_lshrrev_b32 v12, 4, v0
v_and_b32 v13, 15, v0
v_xor_b32 v14, v13, v12
v_lshlrev_b32 v14, 4, v14
v_lshl_add_u32 v64, v13, 8, v14
v_xor_b32 v65, 64, v64
v_xor_b32 v66, 0x80, v64
v_xor_b32 v67, 0xc0, v64
v_lshrrev_b32 v12, 2, v0
v_and_b32 v13, 7, v12
v_and_b32 v14, 3, v0
v_lshlrev_b32 v15, 8, v12
v_lshl_add_u32 v16, v13, 5, v15
v_lshl_add_u32 v16, v14, 3, v16
v_add_u32 v68, 65536, v16
v_xor_b32 v69, 32, v68
v_xor_b32 v70, 64, v68
v_xor_b32 v71, 96, v68
v_xor_b32 v72, 128, v68
v_xor_b32 v73, 160, v68
v_xor_b32 v74, 192, v68
v_xor_b32 v75, 224, v68
v_mov_b32 v76, 0x3f803f80
v_mov_b32 v77, 0x3f803f80
v_mov_b32 v78, 0x3f803f80
v_mov_b32 v79, 0x3f803f80
s_waitcnt vmcnt(18)
s_barrier
ds_read_b128 a[192:195], v64 offset:0
s_add_u32 m0, s30, 81920
s_nop 0
buffer_load_dwordx4 v36, s[8:11], s26 offen offset:0 lds
ds_read_b128 a[196:199], v65 offset:0
ds_read_b128 a[200:203], v66 offset:0
ds_read_b128 a[204:207], v67 offset:0
ds_read_b128 a[208:211], v64 offset:4096
ds_read_b128 a[212:215], v65 offset:4096
ds_read_b128 a[216:219], v66 offset:4096
ds_read_b128 a[220:223], v67 offset:4096
s_waitcnt lgkmcnt(0)
v_mfma_f32_16x16x32_bf16 v[128:131], a[192:195], a[128:131], 0
v_mfma_f32_16x16x32_bf16 v[128:131], a[196:199], a[132:135], v[128:131]
v_mfma_f32_16x16x32_bf16 v[128:131], a[200:203], a[136:139], v[128:131]
s_add_u32 m0, s30, 81920
s_nop 0
buffer_load_dwordx4 v37, s[8:11], s26 offen offset:1024 lds
v_mfma_f32_16x16x32_bf16 v[128:131], a[204:207], a[140:143], v[128:131]
v_mfma_f32_16x16x32_bf16 v[132:135], a[208:211], a[128:131], 0
v_mfma_f32_16x16x32_bf16 v[132:135], a[212:215], a[132:135], v[132:135]
v_mfma_f32_16x16x32_bf16 v[132:135], a[216:219], a[136:139], v[132:135]
v_mfma_f32_16x16x32_bf16 v[132:135], a[220:223], a[140:143], v[132:135]
s_add_u32 m0, s30, 81920
s_nop 0
buffer_load_dwordx4 v36, s[8:11], s26 offen offset:2048 lds
v_mfma_f32_16x16x32_bf16 v[136:139], a[192:195], a[144:147], 0
v_mfma_f32_16x16x32_bf16 v[136:139], a[196:199], a[148:151], v[136:139]
v_mfma_f32_16x16x32_bf16 v[136:139], a[200:203], a[152:155], v[136:139]
v_mfma_f32_16x16x32_bf16 v[136:139], a[204:207], a[156:159], v[136:139]
v_mfma_f32_16x16x32_bf16 v[140:143], a[208:211], a[144:147], 0
s_add_u32 m0, s30, 81920
s_nop 0
buffer_load_dwordx4 v37, s[8:11], s26 offen offset:3072 lds
v_mfma_f32_16x16x32_bf16 v[140:143], a[212:215], a[148:151], v[140:143]
v_mfma_f32_16x16x32_bf16 v[140:143], a[216:219], a[152:155], v[140:143]
v_mfma_f32_16x16x32_bf16 v[140:143], a[220:223], a[156:159], v[140:143]
v_mfma_f32_16x16x32_bf16 v[144:147], a[192:195], a[160:163], 0
v_mfma_f32_16x16x32_bf16 v[144:147], a[196:199], a[164:167], v[144:147]
s_add_u32 s26, s26, 16384
s_add_u32 m0, s30, 49152
s_nop 0
buffer_load_dwordx4 v32, s[4:7], s25 offen offset:0 lds
v_mfma_f32_16x16x32_bf16 v[144:147], a[200:203], a[168:171], v[144:147]
v_mfma_f32_16x16x32_bf16 v[144:147], a[204:207], a[172:175], v[144:147]
v_mfma_f32_16x16x32_bf16 v[148:151], a[208:211], a[160:163], 0
v_mfma_f32_16x16x32_bf16 v[148:151], a[212:215], a[164:167], v[148:151]
v_mfma_f32_16x16x32_bf16 v[148:151], a[216:219], a[168:171], v[148:151]
s_add_u32 m0, s30, 49152
s_nop 0
buffer_load_dwordx4 v33, s[4:7], s25 offen offset:1024 lds
v_mfma_f32_16x16x32_bf16 v[148:151], a[220:223], a[172:175], v[148:151]
v_mfma_f32_16x16x32_bf16 v[152:155], a[192:195], a[176:179], 0
v_mfma_f32_16x16x32_bf16 v[152:155], a[196:199], a[180:183], v[152:155]
v_mfma_f32_16x16x32_bf16 v[152:155], a[200:203], a[184:187], v[152:155]
v_mfma_f32_16x16x32_bf16 v[152:155], a[204:207], a[188:191], v[152:155]
s_add_u32 m0, s30, 49152
s_nop 0
buffer_load_dwordx4 v34, s[4:7], s25 offen offset:2048 lds
v_mfma_f32_16x16x32_bf16 v[156:159], a[208:211], a[176:179], 0
v_mfma_f32_16x16x32_bf16 v[156:159], a[212:215], a[180:183], v[156:159]
v_mfma_f32_16x16x32_bf16 v[156:159], a[216:219], a[184:187], v[156:159]
v_mfma_f32_16x16x32_bf16 v[156:159], a[220:223], a[188:191], v[156:159]
ds_read_b128 a[192:195], v64 offset:8192
ds_read_b128 a[196:199], v65 offset:8192
s_add_u32 m0, s30, 49152
s_nop 0
buffer_load_dwordx4 v35, s[4:7], s25 offen offset:3072 lds
ds_read_b128 a[200:203], v66 offset:8192
ds_read_b128 a[204:207], v67 offset:8192
ds_read_b128 a[208:211], v64 offset:12288
ds_read_b128 a[212:215], v65 offset:12288
ds_read_b128 a[216:219], v66 offset:12288
ds_read_b128 a[220:223], v67 offset:12288
s_add_u32 s25, s25, 16384
s_add_u32 m0, s30, 98304
s_nop 0
buffer_load_dwordx4 v36, s[8:11], s26 offen offset:0 lds
s_add_u32 m0, s30, 98304
s_nop 0
buffer_load_dwordx4 v37, s[8:11], s26 offen offset:1024 lds
s_add_u32 m0, s30, 98304
s_nop 0
buffer_load_dwordx4 v36, s[8:11], s26 offen offset:2048 lds
s_add_u32 m0, s30, 98304
s_nop 0
buffer_load_dwordx4 v37, s[8:11], s26 offen offset:3072 lds
s_add_u32 s26, s26, 16384
s_mov_b32 s90, 715827883
v_add_u32 v12, 0, v0
v_mul_hi_u32 v13, v12, s90
v_mul_u32_u24 v14, 6, v13
v_sub_u32 v14, v12, v14
v_mul_u32_u24 v13, 1152, v13
v_lshl_add_u32 v1, v14, 4, v13
v_add_u32 v12, 64, v0
v_mul_hi_u32 v13, v12, s90
v_mul_u32_u24 v14, 6, v13
v_sub_u32 v14, v12, v14
v_mul_u32_u24 v13, 1152, v13
v_lshl_add_u32 v2, v14, 4, v13
v_subrev_u32 v2, 1024, v2
v_add_u32 v12, 128, v0
v_mul_hi_u32 v13, v12, s90
v_mul_u32_u24 v14, 6, v13
v_sub_u32 v14, v12, v14
v_mul_u32_u24 v13, 1152, v13
v_lshl_add_u32 v3, v14, 4, v13
v_subrev_u32 v3, 2048, v3
v_lshrrev_b32 v12, 2, v0
v_mul_u32_u24 v12, 96, v12
v_and_b32 v13, 3, v0
v_lshl_add_u32 v80, v13, 3, v12
s_add_u32 s91, s55, 0x20000
v_add_u32 v80, s91, v80
s_lshl_b32 s33, s2, 2
s_add_u32 s33, s33, s24
s_mul_i32 s63, s33, 9216
s_add_u32 s92, s33, 64
s_mul_i32 s92, s92, 36864
s_add_u32 s92, s92, 864
s_add_u32 s93, s63, 9437184
s_cmp_ge_u32 s33, 64
s_cselect_b32 s92, 0x7fff0000, s92
s_cselect_b32 s93, 0x7fff0000, s93
s_cmp_lt_u32 s33, 576
s_cselect_b32 s12, s82, s72
s_cselect_b32 s13, s83, s73
s_mov_b32 s14, 0x510000
s_mov_b32 s34, 0x1c71c72
s_mov_b32 s35, 144
s_cbranch_scc1 L_pk0
s_sub_u32 s33, s33, 576
s_mov_b32 s14, 0x480000
s_mov_b32 s34, 0x2000000
s_mov_b32 s35, 128
L_pk0:
s_mov_b32 s15, 0x00020000
s_mul_hi_u32 s34, s33, s34
s_mul_i32 s35, s34, s35
s_sub_u32 s33, s33, s35
s_mul_i32 s33, s33, 36864
s_mul_i32 s34, s34, 288
s_add_u32 s94, s33, s34
s_mov_b32 s95, 0x7fff0000
s_add_u32 s20, s88, 0x5000000
s_addc_u32 s21, s89, 0
s_mov_b32 s22, 0x2800000
s_mov_b32 s23, 0x00020000
s_add_u32 s16, s88, 0x4000000
s_addc_u32 s17, s89, 0
s_mov_b32 s18, 0x990000
s_mov_b32 s19, 0x00020000
s_lshl_b32 s44, s52, 2
s_add_u32 s44, s44, s49
s_lshl_b32 s44, s44, 2
s_add_u32 s44, s44, s54
s_mul_i32 s44, s44, 40960
s_mul_i32 s33, s61, 5120
s_add_u32 s44, s44, s33
s_add_u32 s44, s44, 10485760
s_add_u32 s45, s44, 3072
s_cmp_ge_u32 s24, 2
s_cselect_b32 s44, s45, s44
s_add_u32 s45, s44, 2048
s_cmp_ge_u32 s24, 2
s_cselect_b32 s45, 0x7fff0000, s45
v_mov_b32 v84, -1
v_mov_b32 v85, -1
v_mov_b32 v86, -1
v_mov_b32 v87, -1
v_max3_f32 v12, v128, v129, v130
v_max3_f32 v12, v12, v131, v132
v_max3_f32 v12, v12, v133, v134
v_max_f32 v12, v12, v135
v_mov_b32 v13, v12
s_nop 1
v_permlane16_swap_b32 v12, v13
s_nop 1
v_max_f32 v12, v12, v13
v_mov_b32 v13, v12
s_nop 1
v_permlane32_swap_b32 v12, v13
s_nop 1
v_max_f32 v12, v12, v13
v_sub_f32 v96, 0, v12
v_sub_f32 v97, 0, v12
v_sub_f32 v98, 0, v12
v_sub_f32 v99, 0, v12
v_sub_f32 v128, v128, v12
v_sub_f32 v129, v129, v12
v_sub_f32 v130, v130, v12
v_sub_f32 v131, v131, v12
v_sub_f32 v132, v132, v12
v_sub_f32 v133, v133, v12
v_sub_f32 v134, v134, v12
v_sub_f32 v135, v135, v12
v_max3_f32 v12, v136, v137, v138
v_max3_f32 v12, v12, v139, v140
v_max3_f32 v12, v12, v141, v142
v_max_f32 v12, v12, v143
v_mov_b32 v13, v12
s_nop 1
v_permlane16_swap_b32 v12, v13
s_nop 1
v_max_f32 v12, v12, v13
v_mov_b32 v13, v12
s_nop 1
v_permlane32_swap_b32 v12, v13
s_nop 1
v_max_f32 v12, v12, v13
v_sub_f32 v100, 0, v12
v_sub_f32 v101, 0, v12
v_sub_f32 v102, 0, v12
v_sub_f32 v103, 0, v12
v_sub_f32 v136, v136, v12
v_sub_f32 v137, v137, v12
v_sub_f32 v138, v138, v12
v_sub_f32 v139, v139, v12
v_sub_f32 v140, v140, v12
v_sub_f32 v141, v141, v12
v_sub_f32 v142, v142, v12
v_sub_f32 v143, v143, v12
v_max3_f32 v12, v144, v145, v146
v_max3_f32 v12, v12, v147, v148
v_max3_f32 v12, v12, v149, v150
v_max_f32 v12, v12, v151
v_mov_b32 v13, v12
s_nop 1
v_permlane16_swap_b32 v12, v13
s_nop 1
v_max_f32 v12, v12, v13
v_mov_b32 v13, v12
s_nop 1
v_permlane32_swap_b32 v12, v13
s_nop 1
v_max_f32 v12, v12, v13
v_sub_f32 v104, 0, v12
v_sub_f32 v105, 0, v12
v_sub_f32 v106, 0, v12
v_sub_f32 v107, 0, v12
v_sub_f32 v144, v144, v12
v_sub_f32 v145, v145, v12
v_sub_f32 v146, v146, v12
v_sub_f32 v147, v147, v12
v_sub_f32 v148, v148, v12
v_sub_f32 v149, v149, v12
v_sub_f32 v150, v150, v12
v_sub_f32 v151, v151, v12
v_max3_f32 v12, v152, v153, v154
v_max3_f32 v12, v12, v155, v156
v_max3_f32 v12, v12, v157, v158
v_max_f32 v12, v12, v159
v_mov_b32 v13, v12
s_nop 1
v_permlane16_swap_b32 v12, v13
s_nop 1
v_max_f32 v12, v12, v13
v_mov_b32 v13, v12
s_nop 1
v_permlane32_swap_b32 v12, v13
s_nop 1
v_max_f32 v12, v12, v13
v_sub_f32 v108, 0, v12
v_sub_f32 v109, 0, v12
v_sub_f32 v110, 0, v12
v_sub_f32 v111, 0, v12
v_sub_f32 v152, v152, v12
v_sub_f32 v153, v153, v12
v_sub_f32 v154, v154, v12
v_sub_f32 v155, v155, v12
v_sub_f32 v156, v156, v12
v_sub_f32 v157, v157, v12
v_sub_f32 v158, v158, v12
v_sub_f32 v159, v159, v12
s_nop 1
s_waitcnt lgkmcnt(0)
v_mfma_f32_16x16x32_bf16 v[160:163], a[192:195], a[128:131], v[96:99]
v_exp_f32_e64 v128, v128
v_mfma_f32_16x16x32_bf16 v[160:163], a[196:199], a[132:135], v[160:163]
v_mfma_f32_16x16x32_bf16 v[160:163], a[200:203], a[136:139], v[160:163]
v_mfma_f32_16x16x32_bf16 v[160:163], a[204:207], a[140:143], v[160:163]
v_mfma_f32_16x16x32_bf16 v[164:167], a[208:211], a[128:131], v[96:99]
v_exp_f32_e64 v129, v129
v_mfma_f32_16x16x32_bf16 v[164:167], a[212:215], a[132:135], v[164:167]
v_mfma_f32_16x16x32_bf16 v[164:167], a[216:219], a[136:139], v[164:167]
v_exp_f32_e64 v130, v130
v_mfma_f32_16x16x32_bf16 v[164:167], a[220:223], a[140:143], v[164:167]
v_mfma_f32_16x16x32_bf16 v[168:171], a[192:195], a[144:147], v[100:103]
v_exp_f32_e64 v131, v131
v_mfma_f32_16x16x32_bf16 v[168:171], a[196:199], a[148:151], v[168:171]
v_mfma_f32_16x16x32_bf16 v[168:171], a[200:203], a[152:155], v[168:171]
v_exp_f32_e64 v132, v132
v_mfma_f32_16x16x32_bf16 v[168:171], a[204:207], a[156:159], v[168:171]
v_mfma_f32_16x16x32_bf16 v[172:175], a[208:211], a[144:147], v[100:103]
v_exp_f32_e64 v133, v133
v_mfma_f32_16x16x32_bf16 v[172:175], a[212:215], a[148:151], v[172:175]
v_mfma_f32_16x16x32_bf16 v[172:175], a[216:219], a[152:155], v[172:175]
v_cvt_pk_bf16_f32 v128, v128, v129
v_cvt_pk_bf16_f32 v129, v130, v131
v_mfma_f32_16x16x32_bf16 v[172:175], a[220:223], a[156:159], v[172:175]
v_mfma_f32_16x16x32_bf16 v[176:179], a[192:195], a[160:163], v[104:107]
v_exp_f32_e64 v134, v134
v_mfma_f32_16x16x32_bf16 v[176:179], a[196:199], a[164:167], v[176:179]
v_mfma_f32_16x16x32_bf16 v[176:179], a[200:203], a[168:171], v[176:179]
v_exp_f32_e64 v135, v135
v_mfma_f32_16x16x32_bf16 v[176:179], a[204:207], a[172:175], v[176:179]
v_mfma_f32_16x16x32_bf16 v[180:183], a[208:211], a[160:163], v[104:107]
v_exp_f32_e64 v136, v136
v_mfma_f32_16x16x32_bf16 v[180:183], a[212:215], a[164:167], v[180:183]
v_mfma_f32_16x16x32_bf16 v[180:183], a[216:219], a[168:171], v[180:183]
v_exp_f32_e64 v137, v137
v_mfma_f32_16x16x32_bf16 v[180:183], a[220:223], a[172:175], v[180:183]
v_mfma_f32_16x16x32_bf16 v[184:187], a[192:195], a[176:179], v[108:111]
v_cvt_pk_bf16_f32 v130, v132, v133
v_cvt_pk_bf16_f32 v131, v134, v135
v_mfma_f32_16x16x32_bf16 v[184:187], a[196:199], a[180:183], v[184:187]
v_mfma_f32_16x16x32_bf16 v[184:187], a[200:203], a[184:187], v[184:187]
v_exp_f32_e64 v138, v138
v_mfma_f32_16x16x32_bf16 v[184:187], a[204:207], a[188:191], v[184:187]
v_mfma_f32_16x16x32_bf16 v[188:191], a[208:211], a[176:179], v[108:111]
v_exp_f32_e64 v139, v139
v_mfma_f32_16x16x32_bf16 v[188:191], a[212:215], a[180:183], v[188:191]
v_mfma_f32_16x16x32_bf16 v[188:191], a[216:219], a[184:187], v[188:191]
v_exp_f32_e64 v140, v140
v_mfma_f32_16x16x32_bf16 v[188:191], a[220:223], a[188:191], v[188:191]
s_waitcnt vmcnt(17) lgkmcnt(0)
s_barrier
v_exp_f32_e64 v141, v141
v_cvt_pk_bf16_f32 v136, v136, v137
v_cvt_pk_bf16_f32 v137, v138, v139
ds_read_b128 a[192:195], v64 offset:16384
v_exp_f32_e64 v142, v142
ds_read_b128 a[196:199], v65 offset:16384
v_exp_f32_e64 v143, v143
v_exp_f32_e64 v144, v144
v_cvt_pk_bf16_f32 v138, v140, v141
v_cvt_pk_bf16_f32 v139, v142, v143
ds_read_b128 a[200:203], v66 offset:16384
v_exp_f32_e64 v145, v145
ds_read_b128 a[204:207], v67 offset:16384
v_exp_f32_e64 v146, v146
v_exp_f32_e64 v147, v147
s_add_u32 m0, s30, 0
s_nop 0
buffer_load_dwordx4 v32, s[4:7], s25 offen offset:0 lds
v_exp_f32_e64 v148, v148
v_cvt_pk_bf16_f32 v144, v144, v145
v_cvt_pk_bf16_f32 v145, v146, v147
ds_read_b128 a[208:211], v64 offset:20480
v_exp_f32_e64 v149, v149
ds_read_b128 a[212:215], v65 offset:20480
v_exp_f32_e64 v150, v150
buffer_load_dwordx4 v33, s[4:7], s25 offen offset:1024 lds
v_exp_f32_e64 v151, v151
v_exp_f32_e64 v152, v152
v_cvt_pk_bf16_f32 v146, v148, v149
v_cvt_pk_bf16_f32 v147, v150, v151
ds_read_b128 a[216:219], v66 offset:20480
v_exp_f32_e64 v153, v153
ds_read_b128 a[220:223], v67 offset:20480
v_exp_f32_e64 v154, v154
buffer_load_dwordx4 v34, s[4:7], s25 offen offset:2048 lds
v_exp_f32_e64 v155, v155
v_exp_f32_e64 v156, v156
v_cvt_pk_bf16_f32 v152, v152, v153
v_cvt_pk_bf16_f32 v153, v154, v155
v_exp_f32_e64 v157, v157
buffer_load_dwordx4 v35, s[4:7], s25 offen offset:3072 lds
s_add_u32 s25, s25, 16384
v_exp_f32_e64 v158, v158
v_exp_f32_e64 v159, v159
s_waitcnt lgkmcnt(0)
v_mfma_f32_16x16x32_bf16 v[192:195], a[192:195], a[128:131], v[96:99]
v_exp_f32_e64 v160, v160
v_mfma_f32_16x16x32_bf16 v[192:195], a[196:199], a[132:135], v[192:195]
ds_read_b64_tr_b16 a[224:225], v68 offset:0
v_mfma_f32_16x16x32_bf16 v[192:195], a[200:203], a[136:139], v[192:195]
v_cvt_pk_bf16_f32 v154, v156, v157
v_cvt_pk_bf16_f32 v155, v158, v159
v_mfma_f32_16x16x32_bf16 v[192:195], a[204:207], a[140:143], v[192:195]
ds_read_b64_tr_b16 a[226:227], v68 offset:4096
v_mfma_f32_16x16x32_bf16 v[196:199], a[208:211], a[128:131], v[96:99]
v_exp_f32_e64 v161, v161
v_mfma_f32_16x16x32_bf16 v[196:199], a[212:215], a[132:135], v[196:199]
ds_read_b64_tr_b16 a[228:229], v69 offset:0
v_mfma_f32_16x16x32_bf16 v[196:199], a[216:219], a[136:139], v[196:199]
v_exp_f32_e64 v162, v162
v_mfma_f32_16x16x32_bf16 v[196:199], a[220:223], a[140:143], v[196:199]
ds_read_b64_tr_b16 a[230:231], v69 offset:4096
v_mfma_f32_16x16x32_bf16 v[200:203], a[192:195], a[144:147], v[100:103]
v_exp_f32_e64 v163, v163
v_mfma_f32_16x16x32_bf16 v[200:203], a[196:199], a[148:151], v[200:203]
ds_read_b64_tr_b16 a[232:233], v70 offset:0
v_mfma_f32_16x16x32_bf16 v[200:203], a[200:203], a[152:155], v[200:203]
v_exp_f32_e64 v164, v164
v_mfma_f32_16x16x32_bf16 v[200:203], a[204:207], a[156:159], v[200:203]
ds_read_b64_tr_b16 a[234:235], v70 offset:4096
v_mfma_f32_16x16x32_bf16 v[204:207], a[208:211], a[144:147], v[100:103]
v_exp_f32_e64 v165, v165
v_mfma_f32_16x16x32_bf16 v[204:207], a[212:215], a[148:151], v[204:207]
ds_read_b64_tr_b16 a[236:237], v71 offset:0
v_mfma_f32_16x16x32_bf16 v[204:207], a[216:219], a[152:155], v[204:207]
v_cvt_pk_bf16_f32 v160, v160, v161
v_cvt_pk_bf16_f32 v161, v162, v163
v_mfma_f32_16x16x32_bf16 v[204:207], a[220:223], a[156:159], v[204:207]
ds_read_b64_tr_b16 a[238:239], v71 offset:4096
v_mfma_f32_16x16x32_bf16 v[208:211], a[192:195], a[160:163], v[104:107]
v_exp_f32_e64 v166, v166
v_mfma_f32_16x16x32_bf16 v[208:211], a[196:199], a[164:167], v[208:211]
ds_read_b64_tr_b16 a[240:241], v72 offset:0
v_mfma_f32_16x16x32_bf16 v[208:211], a[200:203], a[168:171], v[208:211]
v_exp_f32_e64 v167, v167
v_mfma_f32_16x16x32_bf16 v[208:211], a[204:207], a[172:175], v[208:211]
ds_read_b64_tr_b16 a[242:243], v72 offset:4096
v_mfma_f32_16x16x32_bf16 v[212:215], a[208:211], a[160:163], v[104:107]
v_exp_f32_e64 v168, v168
v_mfma_f32_16x16x32_bf16 v[212:215], a[212:215], a[164:167], v[212:215]
ds_read_b64_tr_b16 a[244:245], v73 offset:0
v_mfma_f32_16x16x32_bf16 v[212:215], a[216:219], a[168:171], v[212:215]
v_exp_f32_e64 v169, v169
v_mfma_f32_16x16x32_bf16 v[212:215], a[220:223], a[172:175], v[212:215]
ds_read_b64_tr_b16 a[246:247], v73 offset:4096
v_mfma_f32_16x16x32_bf16 v[216:219], a[192:195], a[176:179], v[108:111]
v_cvt_pk_bf16_f32 v162, v164, v165
v_cvt_pk_bf16_f32 v163, v166, v167
v_mfma_f32_16x16x32_bf16 v[216:219], a[196:199], a[180:183], v[216:219]
ds_read_b64_tr_b16 a[248:249], v74 offset:0
v_mfma_f32_16x16x32_bf16 v[216:219], a[200:203], a[184:187], v[216:219]
v_exp_f32_e64 v170, v170
v_mfma_f32_16x16x32_bf16 v[216:219], a[204:207], a[188:191], v[216:219]
ds_read_b64_tr_b16 a[250:251], v74 offset:4096
v_mfma_f32_16x16x32_bf16 v[220:223], a[208:211], a[176:179], v[108:111]
v_exp_f32_e64 v171, v171
v_mfma_f32_16x16x32_bf16 v[220:223], a[212:215], a[180:183], v[220:223]
ds_read_b64_tr_b16 a[252:253], v75 offset:0
v_mfma_f32_16x16x32_bf16 v[220:223], a[216:219], a[184:187], v[220:223]
v_exp_f32_e64 v172, v172
v_mfma_f32_16x16x32_bf16 v[220:223], a[220:223], a[188:191], v[220:223]
ds_read_b64_tr_b16 a[254:255], v75 offset:4096
s_waitcnt lgkmcnt(8)
v_mfma_f32_16x16x32_bf16 a[0:3], a[224:227], v[128:131], 0
v_exp_f32_e64 v173, v173
v_mfma_f32_16x16x32_bf16 a[32:35], a[224:227], v[136:139], 0
v_cvt_pk_bf16_f32 v168, v168, v169
v_cvt_pk_bf16_f32 v169, v170, v171
v_mfma_f32_16x16x32_bf16 a[64:67], a[224:227], v[144:147], 0
ds_read_b128 a[192:195], v64 offset:24576
v_mfma_f32_16x16x32_bf16 a[96:99], a[224:227], v[152:155], 0
v_exp_f32_e64 v174, v174
v_mfma_f32_16x16x32_bf16 a[4:7], a[228:231], v[128:131], 0
ds_read_b128 a[196:199], v65 offset:24576
v_mfma_f32_16x16x32_bf16 a[36:39], a[228:231], v[136:139], 0
v_exp_f32_e64 v175, v175
v_mfma_f32_16x16x32_bf16 a[68:71], a[228:231], v[144:147], 0
v_exp_f32_e64 v176, v176
v_mfma_f32_16x16x32_bf16 a[100:103], a[228:231], v[152:155], 0
v_cvt_pk_bf16_f32 v170, v172, v173
v_cvt_pk_bf16_f32 v171, v174, v175
v_mfma_f32_16x16x32_bf16 v[112:115], v[76:79], v[128:131], 0
ds_read_b128 a[200:203], v66 offset:24576
v_mfma_f32_16x16x32_bf16 a[8:11], a[232:235], v[128:131], 0
v_exp_f32_e64 v177, v177
v_mfma_f32_16x16x32_bf16 a[40:43], a[232:235], v[136:139], 0
ds_read_b128 a[204:207], v67 offset:24576
v_mfma_f32_16x16x32_bf16 a[72:75], a[232:235], v[144:147], 0
v_exp_f32_e64 v178, v178
v_mfma_f32_16x16x32_bf16 a[104:107], a[232:235], v[152:155], 0
v_exp_f32_e64 v179, v179
v_mfma_f32_16x16x32_bf16 a[12:15], a[236:239], v[128:131], 0
s_add_u32 m0, s30, 114688
s_nop 0
buffer_load_dwordx4 v36, s[8:11], s26 offen offset:0 lds
v_mfma_f32_16x16x32_bf16 a[44:47], a[236:239], v[136:139], 0
v_exp_f32_e64 v180, v180
v_mfma_f32_16x16x32_bf16 a[76:79], a[236:239], v[144:147], 0
v_cvt_pk_bf16_f32 v176, v176, v177
v_cvt_pk_bf16_f32 v177, v178, v179
v_mfma_f32_16x16x32_bf16 a[108:111], a[236:239], v[152:155], 0
ds_read_b128 a[208:211], v64 offset:28672
v_mfma_f32_16x16x32_bf16 v[116:119], v[76:79], v[136:139], 0
v_exp_f32_e64 v181, v181
s_waitcnt lgkmcnt(5)
v_mfma_f32_16x16x32_bf16 a[16:19], a[240:243], v[128:131], 0
ds_read_b128 a[212:215], v65 offset:28672
v_mfma_f32_16x16x32_bf16 a[48:51], a[240:243], v[136:139], 0
v_exp_f32_e64 v182, v182
v_mfma_f32_16x16x32_bf16 a[80:83], a[240:243], v[144:147], 0
buffer_load_dwordx4 v37, s[8:11], s26 offen offset:1024 lds
v_mfma_f32_16x16x32_bf16 a[112:115], a[240:243], v[152:155], 0
v_exp_f32_e64 v183, v183
v_mfma_f32_16x16x32_bf16 a[20:23], a[244:247], v[128:131], 0
v_exp_f32_e64 v184, v184
v_mfma_f32_16x16x32_bf16 a[52:55], a[244:247], v[136:139], 0
v_cvt_pk_bf16_f32 v178, v180, v181
v_cvt_pk_bf16_f32 v179, v182, v183
v_mfma_f32_16x16x32_bf16 a[84:87], a[244:247], v[144:147], 0
ds_read_b128 a[216:219], v66 offset:28672
v_mfma_f32_16x16x32_bf16 a[116:119], a[244:247], v[152:155], 0
v_exp_f32_e64 v185, v185
v_mfma_f32_16x16x32_bf16 v[120:123], v[76:79], v[144:147], 0
ds_read_b128 a[220:223], v67 offset:28672
v_mfma_f32_16x16x32_bf16 a[24:27], a[248:251], v[128:131], 0
v_exp_f32_e64 v186, v186
v_mfma_f32_16x16x32_bf16 a[56:59], a[248:251], v[136:139], 0
buffer_load_dwordx4 v36, s[8:11], s26 offen offset:2048 lds
v_mfma_f32_16x16x32_bf16 a[88:91], a[248:251], v[144:147], 0
v_exp_f32_e64 v187, v187
v_mfma_f32_16x16x32_bf16 a[120:123], a[248:251], v[152:155], 0
v_exp_f32_e64 v188, v188
v_mfma_f32_16x16x32_bf16 a[28:31], a[252:255], v[128:131], 0
v_cvt_pk_bf16_f32 v184, v184, v185
v_cvt_pk_bf16_f32 v185, v186, v187
v_mfma_f32_16x16x32_bf16 a[60:63], a[252:255], v[136:139], 0
v_exp_f32_e64 v189, v189
v_mfma_f32_16x16x32_bf16 a[92:95], a[252:255], v[144:147], 0
buffer_load_dwordx4 v37, s[8:11], s26 offen offset:3072 lds
s_add_u32 s26, s26, 16384
v_mfma_f32_16x16x32_bf16 a[124:127], a[252:255], v[152:155], 0
v_exp_f32_e64 v190, v190
v_mfma_f32_16x16x32_bf16 v[124:127], v[76:79], v[152:155], 0
v_exp_f32_e64 v191, v191
s_waitcnt lgkmcnt(0)
v_mfma_f32_16x16x32_bf16 v[224:227], a[192:195], a[128:131], v[96:99]
v_exp_f32_e64 v192, v192
v_mfma_f32_16x16x32_bf16 v[224:227], a[196:199], a[132:135], v[224:227]
ds_read_b64_tr_b16 a[224:225], v68 offset:8192
v_mfma_f32_16x16x32_bf16 v[224:227], a[200:203], a[136:139], v[224:227]
v_cvt_pk_bf16_f32 v186, v188, v189
v_cvt_pk_bf16_f32 v187, v190, v191
v_mfma_f32_16x16x32_bf16 v[224:227], a[204:207], a[140:143], v[224:227]
ds_read_b64_tr_b16 a[226:227], v68 offset:12288
v_mfma_f32_16x16x32_bf16 v[228:231], a[208:211], a[128:131], v[96:99]
v_exp_f32_e64 v193, v193
v_mfma_f32_16x16x32_bf16 v[228:231], a[212:215], a[132:135], v[228:231]
ds_read_b64_tr_b16 a[228:229], v69 offset:8192
v_mfma_f32_16x16x32_bf16 v[228:231], a[216:219], a[136:139], v[228:231]
v_exp_f32_e64 v194, v194
v_mfma_f32_16x16x32_bf16 v[228:231], a[220:223], a[140:143], v[228:231]
ds_read_b64_tr_b16 a[230:231], v69 offset:12288
v_mfma_f32_16x16x32_bf16 v[232:235], a[192:195], a[144:147], v[100:103]
v_exp_f32_e64 v195, v195
v_mfma_f32_16x16x32_bf16 v[232:235], a[196:199], a[148:151], v[232:235]
ds_read_b64_tr_b16 a[232:233], v70 offset:8192
v_mfma_f32_16x16x32_bf16 v[232:235], a[200:203], a[152:155], v[232:235]
v_exp_f32_e64 v196, v196
v_mfma_f32_16x16x32_bf16 v[232:235], a[204:207], a[156:159], v[232:235]
ds_read_b64_tr_b16 a[234:235], v70 offset:12288
v_mfma_f32_16x16x32_bf16 v[236:239], a[208:211], a[144:147], v[100:103]
v_exp_f32_e64 v197, v197
v_mfma_f32_16x16x32_bf16 v[236:239], a[212:215], a[148:151], v[236:239]
ds_read_b64_tr_b16 a[236:237], v71 offset:8192
v_mfma_f32_16x16x32_bf16 v[236:239], a[216:219], a[152:155], v[236:239]
v_cvt_pk_bf16_f32 v192, v192, v193
v_cvt_pk_bf16_f32 v193, v194, v195
v_mfma_f32_16x16x32_bf16 v[236:239], a[220:223], a[156:159], v[236:239]
ds_read_b64_tr_b16 a[238:239], v71 offset:12288
v_mfma_f32_16x16x32_bf16 v[240:243], a[192:195], a[160:163], v[104:107]
v_exp_f32_e64 v198, v198
v_mfma_f32_16x16x32_bf16 v[240:243], a[196:199], a[164:167], v[240:243]
ds_read_b64_tr_b16 a[240:241], v72 offset:8192
v_mfma_f32_16x16x32_bf16 v[240:243], a[200:203], a[168:171], v[240:243]
v_exp_f32_e64 v199, v199
v_mfma_f32_16x16x32_bf16 v[240:243], a[204:207], a[172:175], v[240:243]
ds_read_b64_tr_b16 a[242:243], v72 offset:12288
v_mfma_f32_16x16x32_bf16 v[244:247], a[208:211], a[160:163], v[104:107]
v_exp_f32_e64 v200, v200
v_mfma_f32_16x16x32_bf16 v[244:247], a[212:215], a[164:167], v[244:247]
ds_read_b64_tr_b16 a[244:245], v73 offset:8192
v_mfma_f32_16x16x32_bf16 v[244:247], a[216:219], a[168:171], v[244:247]
v_exp_f32_e64 v201, v201
v_mfma_f32_16x16x32_bf16 v[244:247], a[220:223], a[172:175], v[244:247]
ds_read_b64_tr_b16 a[246:247], v73 offset:12288
v_mfma_f32_16x16x32_bf16 v[248:251], a[192:195], a[176:179], v[108:111]
v_cvt_pk_bf16_f32 v194, v196, v197
v_cvt_pk_bf16_f32 v195, v198, v199
v_mfma_f32_16x16x32_bf16 v[248:251], a[196:199], a[180:183], v[248:251]
ds_read_b64_tr_b16 a[248:249], v74 offset:8192
v_mfma_f32_16x16x32_bf16 v[248:251], a[200:203], a[184:187], v[248:251]
v_exp_f32_e64 v202, v202
v_mfma_f32_16x16x32_bf16 v[248:251], a[204:207], a[188:191], v[248:251]
ds_read_b64_tr_b16 a[250:251], v74 offset:12288
v_mfma_f32_16x16x32_bf16 v[252:255], a[208:211], a[176:179], v[108:111]
v_exp_f32_e64 v203, v203
v_mfma_f32_16x16x32_bf16 v[252:255], a[212:215], a[180:183], v[252:255]
ds_read_b64_tr_b16 a[252:253], v75 offset:8192
v_mfma_f32_16x16x32_bf16 v[252:255], a[216:219], a[184:187], v[252:255]
v_exp_f32_e64 v204, v204
v_mfma_f32_16x16x32_bf16 v[252:255], a[220:223], a[188:191], v[252:255]
ds_read_b64_tr_b16 a[254:255], v75 offset:12288
s_waitcnt vmcnt(16) lgkmcnt(8)
s_barrier
v_mfma_f32_16x16x32_bf16 a[0:3], a[224:227], v[160:163], a[0:3]
v_exp_f32_e64 v205, v205
v_mfma_f32_16x16x32_bf16 a[32:35], a[224:227], v[168:171], a[32:35]
v_cvt_pk_bf16_f32 v200, v200, v201
v_cvt_pk_bf16_f32 v201, v202, v203
v_mfma_f32_16x16x32_bf16 a[64:67], a[224:227], v[176:179], a[64:67]
ds_read_b128 a[192:195], v64 offset:32768
v_mfma_f32_16x16x32_bf16 a[96:99], a[224:227], v[184:187], a[96:99]
v_exp_f32_e64 v206, v206
v_mfma_f32_16x16x32_bf16 a[4:7], a[228:231], v[160:163], a[4:7]
ds_read_b128 a[196:199], v65 offset:32768
v_mfma_f32_16x16x32_bf16 a[36:39], a[228:231], v[168:171], a[36:39]
v_exp_f32_e64 v207, v207
v_mfma_f32_16x16x32_bf16 a[68:71], a[228:231], v[176:179], a[68:71]
v_exp_f32_e64 v208, v208
v_mfma_f32_16x16x32_bf16 a[100:103], a[228:231], v[184:187], a[100:103]
v_cvt_pk_bf16_f32 v202, v204, v205
v_cvt_pk_bf16_f32 v203, v206, v207
v_mfma_f32_16x16x32_bf16 v[112:115], v[76:79], v[160:163], v[112:115]
ds_read_b128 a[200:203], v66 offset:32768
v_mfma_f32_16x16x32_bf16 a[8:11], a[232:235], v[160:163], a[8:11]
v_exp_f32_e64 v209, v209
v_mfma_f32_16x16x32_bf16 a[40:43], a[232:235], v[168:171], a[40:43]
ds_read_b128 a[204:207], v67 offset:32768
v_mfma_f32_16x16x32_bf16 a[72:75], a[232:235], v[176:179], a[72:75]
v_exp_f32_e64 v210, v210
v_mfma_f32_16x16x32_bf16 a[104:107], a[232:235], v[184:187], a[104:107]
v_exp_f32_e64 v211, v211
v_mfma_f32_16x16x32_bf16 a[12:15], a[236:239], v[160:163], a[12:15]
s_add_u32 m0, s30, 16384
s_nop 0
buffer_load_dwordx4 v32, s[4:7], s25 offen offset:0 lds
v_mfma_f32_16x16x32_bf16 a[44:47], a[236:239], v[168:171], a[44:47]
v_exp_f32_e64 v212, v212
v_mfma_f32_16x16x32_bf16 a[76:79], a[236:239], v[176:179], a[76:79]
v_cvt_pk_bf16_f32 v208, v208, v209
v_cvt_pk_bf16_f32 v209, v210, v211
v_mfma_f32_16x16x32_bf16 a[108:111], a[236:239], v[184:187], a[108:111]
ds_read_b128 a[208:211], v64 offset:36864
v_mfma_f32_16x16x32_bf16 v[116:119], v[76:79], v[168:171], v[116:119]
v_exp_f32_e64 v213, v213
s_waitcnt lgkmcnt(5)
v_mfma_f32_16x16x32_bf16 a[16:19], a[240:243], v[160:163], a[16:19]
ds_read_b128 a[212:215], v65 offset:36864
v_mfma_f32_16x16x32_bf16 a[48:51], a[240:243], v[168:171], a[48:51]
v_exp_f32_e64 v214, v214
v_mfma_f32_16x16x32_bf16 a[80:83], a[240:243], v[176:179], a[80:83]
buffer_load_dwordx4 v33, s[4:7], s25 offen offset:1024 lds
v_mfma_f32_16x16x32_bf16 a[112:115], a[240:243], v[184:187], a[112:115]
v_exp_f32_e64 v215, v215
v_mfma_f32_16x16x32_bf16 a[20:23], a[244:247], v[160:163], a[20:23]
v_exp_f32_e64 v216, v216
v_mfma_f32_16x16x32_bf16 a[52:55], a[244:247], v[168:171], a[52:55]
v_cvt_pk_bf16_f32 v210, v212, v213
v_cvt_pk_bf16_f32 v211, v214, v215
v_mfma_f32_16x16x32_bf16 a[84:87], a[244:247], v[176:179], a[84:87]
ds_read_b128 a[216:219], v66 offset:36864
v_mfma_f32_16x16x32_bf16 a[116:119], a[244:247], v[184:187], a[116:119]
v_exp_f32_e64 v217, v217
v_mfma_f32_16x16x32_bf16 v[120:123], v[76:79], v[176:179], v[120:123]
ds_read_b128 a[220:223], v67 offset:36864
v_mfma_f32_16x16x32_bf16 a[24:27], a[248:251], v[160:163], a[24:27]
v_exp_f32_e64 v218, v218
v_mfma_f32_16x16x32_bf16 a[56:59], a[248:251], v[168:171], a[56:59]
buffer_load_dwordx4 v34, s[4:7], s25 offen offset:2048 lds
v_mfma_f32_16x16x32_bf16 a[88:91], a[248:251], v[176:179], a[88:91]
v_exp_f32_e64 v219, v219
v_mfma_f32_16x16x32_bf16 a[120:123], a[248:251], v[184:187], a[120:123]
v_exp_f32_e64 v220, v220
v_mfma_f32_16x16x32_bf16 a[28:31], a[252:255], v[160:163], a[28:31]
v_cvt_pk_bf16_f32 v216, v216, v217
v_cvt_pk_bf16_f32 v217, v218, v219
v_mfma_f32_16x16x32_bf16 a[60:63], a[252:255], v[168:171], a[60:63]
v_exp_f32_e64 v221, v221
v_mfma_f32_16x16x32_bf16 a[92:95], a[252:255], v[176:179], a[92:95]
buffer_load_dwordx4 v35, s[4:7], s25 offen offset:3072 lds
s_add_u32 s25, s25, 16384
v_mfma_f32_16x16x32_bf16 a[124:127], a[252:255], v[184:187], a[124:127]
v_exp_f32_e64 v222, v222
v_mfma_f32_16x16x32_bf16 v[124:127], v[76:79], v[184:187], v[124:127]
v_exp_f32_e64 v223, v223
s_lshr_b32 s33, s48, 3
s_lshl_b32 s33, s33, 5
s_cmp_lg_u32 s24, 0
s_cbranch_scc1 L_sig5
v_mov_b32 v12, 0
v_mov_b32 v13, 0x100
s_mov_b64 exec, 1
buffer_atomic_add v13, v12, s[56:59], s33 offen
s_mov_b64 exec, -1
L_sig5:
s_waitcnt lgkmcnt(0)
v_mfma_f32_16x16x32_bf16 v[128:131], a[192:195], a[128:131], v[96:99]
v_exp_f32_e64 v224, v224
v_mfma_f32_16x16x32_bf16 v[128:131], a[196:199], a[132:135], v[128:131]
ds_read_b64_tr_b16 a[224:225], v68 offset:16384
v_mfma_f32_16x16x32_bf16 v[128:131], a[200:203], a[136:139], v[128:131]
v_cvt_pk_bf16_f32 v218, v220, v221
v_cvt_pk_bf16_f32 v219, v222, v223
v_mfma_f32_16x16x32_bf16 v[128:131], a[204:207], a[140:143], v[128:131]
ds_read_b64_tr_b16 a[226:227], v68 offset:20480
v_mfma_f32_16x16x32_bf16 v[132:135], a[208:211], a[128:131], v[96:99]
v_exp_f32_e64 v225, v225
v_mfma_f32_16x16x32_bf16 v[132:135], a[212:215], a[132:135], v[132:135]
ds_read_b64_tr_b16 a[228:229], v69 offset:16384
v_mfma_f32_16x16x32_bf16 v[132:135], a[216:219], a[136:139], v[132:135]
v_exp_f32_e64 v226, v226
v_mfma_f32_16x16x32_bf16 v[132:135], a[220:223], a[140:143], v[132:135]
ds_read_b64_tr_b16 a[230:231], v69 offset:20480
v_mfma_f32_16x16x32_bf16 v[136:139], a[192:195], a[144:147], v[100:103]
v_exp_f32_e64 v227, v227
v_mfma_f32_16x16x32_bf16 v[136:139], a[196:199], a[148:151], v[136:139]
ds_read_b64_tr_b16 a[232:233], v70 offset:16384
v_mfma_f32_16x16x32_bf16 v[136:139], a[200:203], a[152:155], v[136:139]
v_exp_f32_e64 v228, v228
v_mfma_f32_16x16x32_bf16 v[136:139], a[204:207], a[156:159], v[136:139]
ds_read_b64_tr_b16 a[234:235], v70 offset:20480
v_mfma_f32_16x16x32_bf16 v[140:143], a[208:211], a[144:147], v[100:103]
v_exp_f32_e64 v229, v229
v_mfma_f32_16x16x32_bf16 v[140:143], a[212:215], a[148:151], v[140:143]
ds_read_b64_tr_b16 a[236:237], v71 offset:16384
v_mfma_f32_16x16x32_bf16 v[140:143], a[216:219], a[152:155], v[140:143]
v_cvt_pk_bf16_f32 v224, v224, v225
v_cvt_pk_bf16_f32 v225, v226, v227
v_mfma_f32_16x16x32_bf16 v[140:143], a[220:223], a[156:159], v[140:143]
ds_read_b64_tr_b16 a[238:239], v71 offset:20480
v_mfma_f32_16x16x32_bf16 v[144:147], a[192:195], a[160:163], v[104:107]
v_exp_f32_e64 v230, v230
v_mfma_f32_16x16x32_bf16 v[144:147], a[196:199], a[164:167], v[144:147]
ds_read_b64_tr_b16 a[240:241], v72 offset:16384
v_mfma_f32_16x16x32_bf16 v[144:147], a[200:203], a[168:171], v[144:147]
v_exp_f32_e64 v231, v231
v_mfma_f32_16x16x32_bf16 v[144:147], a[204:207], a[172:175], v[144:147]
ds_read_b64_tr_b16 a[242:243], v72 offset:20480
v_mfma_f32_16x16x32_bf16 v[148:151], a[208:211], a[160:163], v[104:107]
v_exp_f32_e64 v232, v232
v_mfma_f32_16x16x32_bf16 v[148:151], a[212:215], a[164:167], v[148:151]
ds_read_b64_tr_b16 a[244:245], v73 offset:16384
v_mfma_f32_16x16x32_bf16 v[148:151], a[216:219], a[168:171], v[148:151]
v_exp_f32_e64 v233, v233
v_mfma_f32_16x16x32_bf16 v[148:151], a[220:223], a[172:175], v[148:151]
ds_read_b64_tr_b16 a[246:247], v73 offset:20480
v_mfma_f32_16x16x32_bf16 v[152:155], a[192:195], a[176:179], v[108:111]
v_cvt_pk_bf16_f32 v226, v228, v229
v_cvt_pk_bf16_f32 v227, v230, v231
v_mfma_f32_16x16x32_bf16 v[152:155], a[196:199], a[180:183], v[152:155]
ds_read_b64_tr_b16 a[248:249], v74 offset:16384
v_mfma_f32_16x16x32_bf16 v[152:155], a[200:203], a[184:187], v[152:155]
v_exp_f32_e64 v234, v234
v_mfma_f32_16x16x32_bf16 v[152:155], a[204:207], a[188:191], v[152:155]
ds_read_b64_tr_b16 a[250:251], v74 offset:20480
v_mfma_f32_16x16x32_bf16 v[156:159], a[208:211], a[176:179], v[108:111]
v_exp_f32_e64 v235, v235
v_mfma_f32_16x16x32_bf16 v[156:159], a[212:215], a[180:183], v[156:159]
ds_read_b64_tr_b16 a[252:253], v75 offset:16384
v_mfma_f32_16x16x32_bf16 v[156:159], a[216:219], a[184:187], v[156:159]
v_exp_f32_e64 v236, v236
v_mfma_f32_16x16x32_bf16 v[156:159], a[220:223], a[188:191], v[156:159]
ds_read_b64_tr_b16 a[254:255], v75 offset:20480
s_waitcnt lgkmcnt(8)
v_mfma_f32_16x16x32_bf16 a[0:3], a[224:227], v[192:195], a[0:3]
v_exp_f32_e64 v237, v237
v_mfma_f32_16x16x32_bf16 a[32:35], a[224:227], v[200:203], a[32:35]
v_cvt_pk_bf16_f32 v232, v232, v233
v_cvt_pk_bf16_f32 v233, v234, v235
v_mfma_f32_16x16x32_bf16 a[64:67], a[224:227], v[208:211], a[64:67]
ds_read_b128 a[192:195], v64 offset:40960
v_mfma_f32_16x16x32_bf16 a[96:99], a[224:227], v[216:219], a[96:99]
v_exp_f32_e64 v238, v238
v_mfma_f32_16x16x32_bf16 a[4:7], a[228:231], v[192:195], a[4:7]
ds_read_b128 a[196:199], v65 offset:40960
v_mfma_f32_16x16x32_bf16 a[36:39], a[228:231], v[200:203], a[36:39]
v_exp_f32_e64 v239, v239
v_mfma_f32_16x16x32_bf16 a[68:71], a[228:231], v[208:211], a[68:71]
v_exp_f32_e64 v240, v240
v_mfma_f32_16x16x32_bf16 a[100:103], a[228:231], v[216:219], a[100:103]
v_cvt_pk_bf16_f32 v234, v236, v237
v_cvt_pk_bf16_f32 v235, v238, v239
v_mfma_f32_16x16x32_bf16 v[112:115], v[76:79], v[192:195], v[112:115]
ds_read_b128 a[200:203], v66 offset:40960
v_mfma_f32_16x16x32_bf16 a[8:11], a[232:235], v[192:195], a[8:11]
v_exp_f32_e64 v241, v241
v_mfma_f32_16x16x32_bf16 a[40:43], a[232:235], v[200:203], a[40:43]
ds_read_b128 a[204:207], v67 offset:40960
v_mfma_f32_16x16x32_bf16 a[72:75], a[232:235], v[208:211], a[72:75]
v_exp_f32_e64 v242, v242
v_mfma_f32_16x16x32_bf16 a[104:107], a[232:235], v[216:219], a[104:107]
v_exp_f32_e64 v243, v243
v_mfma_f32_16x16x32_bf16 a[12:15], a[236:239], v[192:195], a[12:15]
s_add_u32 m0, s30, 65536
s_nop 0
buffer_load_dwordx4 v36, s[8:11], s26 offen offset:0 lds
v_mfma_f32_16x16x32_bf16 a[44:47], a[236:239], v[200:203], a[44:47]
v_exp_f32_e64 v244, v244
v_mfma_f32_16x16x32_bf16 a[76:79], a[236:239], v[208:211], a[76:79]
v_cvt_pk_bf16_f32 v240, v240, v241
v_cvt_pk_bf16_f32 v241, v242, v243
v_mfma_f32_16x16x32_bf16 a[108:111], a[236:239], v[216:219], a[108:111]
ds_read_b128 a[208:211], v64 offset:45056
v_mfma_f32_16x16x32_bf16 v[116:119], v[76:79], v[200:203], v[116:119]
v_exp_f32_e64 v245, v245
s_waitcnt lgkmcnt(5)
v_mfma_f32_16x16x32_bf16 a[16:19], a[240:243], v[192:195], a[16:19]
ds_read_b128 a[212:215], v65 offset:45056
v_mfma_f32_16x16x32_bf16 a[48:51], a[240:243], v[200:203], a[48:51]
v_exp_f32_e64 v246, v246
v_mfma_f32_16x16x32_bf16 a[80:83], a[240:243], v[208:211], a[80:83]
buffer_load_dwordx4 v37, s[8:11], s26 offen offset:1024 lds
v_mfma_f32_16x16x32_bf16 a[112:115], a[240:243], v[216:219], a[112:115]
v_exp_f32_e64 v247, v247
v_mfma_f32_16x16x32_bf16 a[20:23], a[244:247], v[192:195], a[20:23]
v_exp_f32_e64 v248, v248
v_mfma_f32_16x16x32_bf16 a[52:55], a[244:247], v[200:203], a[52:55]
v_cvt_pk_bf16_f32 v242, v244, v245
v_cvt_pk_bf16_f32 v243, v246, v247
v_mfma_f32_16x16x32_bf16 a[84:87], a[244:247], v[208:211], a[84:87]
ds_read_b128 a[216:219], v66 offset:45056
v_mfma_f32_16x16x32_bf16 a[116:119], a[244:247], v[216:219], a[116:119]
v_exp_f32_e64 v249, v249
v_mfma_f32_16x16x32_bf16 v[120:123], v[76:79], v[208:211], v[120:123]
ds_read_b128 a[220:223], v67 offset:45056
v_mfma_f32_16x16x32_bf16 a[24:27], a[248:251], v[192:195], a[24:27]
v_exp_f32_e64 v250, v250
v_mfma_f32_16x16x32_bf16 a[56:59], a[248:251], v[200:203], a[56:59]
buffer_load_dwordx4 v36, s[8:11], s26 offen offset:2048 lds
v_mfma_f32_16x16x32_bf16 a[88:91], a[248:251], v[208:211], a[88:91]
v_exp_f32_e64 v251, v251
v_mfma_f32_16x16x32_bf16 a[120:123], a[248:251], v[216:219], a[120:123]
v_exp_f32_e64 v252, v252
v_mfma_f32_16x16x32_bf16 a[28:31], a[252:255], v[192:195], a[28:31]
v_cvt_pk_bf16_f32 v248, v248, v249
v_cvt_pk_bf16_f32 v249, v250, v251
v_mfma_f32_16x16x32_bf16 a[60:63], a[252:255], v[200:203], a[60:63]
v_exp_f32_e64 v253, v253
v_mfma_f32_16x16x32_bf16 a[92:95], a[252:255], v[208:211], a[92:95]
buffer_load_dwordx4 v37, s[8:11], s26 offen offset:3072 lds
s_add_u32 s26, s26, 16384
v_mfma_f32_16x16x32_bf16 a[124:127], a[252:255], v[216:219], a[124:127]
v_exp_f32_e64 v254, v254
v_mfma_f32_16x16x32_bf16 v[124:127], v[76:79], v[216:219], v[124:127]
v_exp_f32_e64 v255, v255
s_waitcnt lgkmcnt(0)
v_mfma_f32_16x16x32_bf16 v[160:163], a[192:195], a[128:131], v[96:99]
v_exp_f32_e64 v128, v128
v_mfma_f32_16x16x32_bf16 v[160:163], a[196:199], a[132:135], v[160:163]
ds_read_b64_tr_b16 a[224:225], v68 offset:24576
v_mfma_f32_16x16x32_bf16 v[160:163], a[200:203], a[136:139], v[160:163]
v_cvt_pk_bf16_f32 v250, v252, v253
v_cvt_pk_bf16_f32 v251, v254, v255
v_mfma_f32_16x16x32_bf16 v[160:163], a[204:207], a[140:143], v[160:163]
ds_read_b64_tr_b16 a[226:227], v68 offset:28672
v_mfma_f32_16x16x32_bf16 v[164:167], a[208:211], a[128:131], v[96:99]
v_exp_f32_e64 v129, v129
v_mfma_f32_16x16x32_bf16 v[164:167], a[212:215], a[132:135], v[164:167]
ds_read_b64_tr_b16 a[228:229], v69 offset:24576
v_mfma_f32_16x16x32_bf16 v[164:167], a[216:219], a[136:139], v[164:167]
v_exp_f32_e64 v130, v130
v_mfma_f32_16x16x32_bf16 v[164:167], a[220:223], a[140:143], v[164:167]
ds_read_b64_tr_b16 a[230:231], v69 offset:28672
v_mfma_f32_16x16x32_bf16 v[168:171], a[192:195], a[144:147], v[100:103]
v_exp_f32_e64 v131, v131
v_mfma_f32_16x16x32_bf16 v[168:171], a[196:199], a[148:151], v[168:171]
ds_read_b64_tr_b16 a[232:233], v70 offset:24576
v_mfma_f32_16x16x32_bf16 v[168:171], a[200:203], a[152:155], v[168:171]
v_exp_f32_e64 v132, v132
v_mfma_f32_16x16x32_bf16 v[168:171], a[204:207], a[156:159], v[168:171]
ds_read_b64_tr_b16 a[234:235], v70 offset:28672
v_mfma_f32_16x16x32_bf16 v[172:175], a[208:211], a[144:147], v[100:103]
v_exp_f32_e64 v133, v133
v_mfma_f32_16x16x32_bf16 v[172:175], a[212:215], a[148:151], v[172:175]
ds_read_b64_tr_b16 a[236:237], v71 offset:24576
v_mfma_f32_16x16x32_bf16 v[172:175], a[216:219], a[152:155], v[172:175]
v_cvt_pk_bf16_f32 v128, v128, v129
v_cvt_pk_bf16_f32 v129, v130, v131
v_mfma_f32_16x16x32_bf16 v[172:175], a[220:223], a[156:159], v[172:175]
ds_read_b64_tr_b16 a[238:239], v71 offset:28672
v_mfma_f32_16x16x32_bf16 v[176:179], a[192:195], a[160:163], v[104:107]
v_exp_f32_e64 v134, v134
v_mfma_f32_16x16x32_bf16 v[176:179], a[196:199], a[164:167], v[176:179]
ds_read_b64_tr_b16 a[240:241], v72 offset:24576
v_mfma_f32_16x16x32_bf16 v[176:179], a[200:203], a[168:171], v[176:179]
v_exp_f32_e64 v135, v135
v_mfma_f32_16x16x32_bf16 v[176:179], a[204:207], a[172:175], v[176:179]
ds_read_b64_tr_b16 a[242:243], v72 offset:28672
v_mfma_f32_16x16x32_bf16 v[180:183], a[208:211], a[160:163], v[104:107]
v_exp_f32_e64 v136, v136
v_mfma_f32_16x16x32_bf16 v[180:183], a[212:215], a[164:167], v[180:183]
ds_read_b64_tr_b16 a[244:245], v73 offset:24576
v_mfma_f32_16x16x32_bf16 v[180:183], a[216:219], a[168:171], v[180:183]
v_exp_f32_e64 v137, v137
v_mfma_f32_16x16x32_bf16 v[180:183], a[220:223], a[172:175], v[180:183]
ds_read_b64_tr_b16 a[246:247], v73 offset:28672
v_mfma_f32_16x16x32_bf16 v[184:187], a[192:195], a[176:179], v[108:111]
v_cvt_pk_bf16_f32 v130, v132, v133
v_cvt_pk_bf16_f32 v131, v134, v135
v_mfma_f32_16x16x32_bf16 v[184:187], a[196:199], a[180:183], v[184:187]
ds_read_b64_tr_b16 a[248:249], v74 offset:24576
v_mfma_f32_16x16x32_bf16 v[184:187], a[200:203], a[184:187], v[184:187]
v_exp_f32_e64 v138, v138
v_mfma_f32_16x16x32_bf16 v[184:187], a[204:207], a[188:191], v[184:187]
ds_read_b64_tr_b16 a[250:251], v74 offset:28672
v_mfma_f32_16x16x32_bf16 v[188:191], a[208:211], a[176:179], v[108:111]
v_exp_f32_e64 v139, v139
v_mfma_f32_16x16x32_bf16 v[188:191], a[212:215], a[180:183], v[188:191]
ds_read_b64_tr_b16 a[252:253], v75 offset:24576
v_mfma_f32_16x16x32_bf16 v[188:191], a[216:219], a[184:187], v[188:191]
v_exp_f32_e64 v140, v140
v_mfma_f32_16x16x32_bf16 v[188:191], a[220:223], a[188:191], v[188:191]
ds_read_b64_tr_b16 a[254:255], v75 offset:28672
s_waitcnt vmcnt(16) lgkmcnt(8)
s_barrier
v_mfma_f32_16x16x32_bf16 a[0:3], a[224:227], v[224:227], a[0:3]
v_exp_f32_e64 v141, v141
v_mfma_f32_16x16x32_bf16 a[32:35], a[224:227], v[232:235], a[32:35]
v_cvt_pk_bf16_f32 v136, v136, v137
v_cvt_pk_bf16_f32 v137, v138, v139
v_mfma_f32_16x16x32_bf16 a[64:67], a[224:227], v[240:243], a[64:67]
ds_read_b128 a[192:195], v64 offset:49152
v_mfma_f32_16x16x32_bf16 a[96:99], a[224:227], v[248:251], a[96:99]
v_exp_f32_e64 v142, v142
v_mfma_f32_16x16x32_bf16 a[4:7], a[228:231], v[224:227], a[4:7]
ds_read_b128 a[196:199], v65 offset:49152
v_mfma_f32_16x16x32_bf16 a[36:39], a[228:231], v[232:235], a[36:39]
v_exp_f32_e64 v143, v143
v_mfma_f32_16x16x32_bf16 a[68:71], a[228:231], v[240:243], a[68:71]
v_exp_f32_e64 v144, v144
v_mfma_f32_16x16x32_bf16 a[100:103], a[228:231], v[248:251], a[100:103]
v_cvt_pk_bf16_f32 v138, v140, v141
v_cvt_pk_bf16_f32 v139, v142, v143
v_mfma_f32_16x16x32_bf16 v[112:115], v[76:79], v[224:227], v[112:115]
ds_read_b128 a[200:203], v66 offset:49152
v_mfma_f32_16x16x32_bf16 a[8:11], a[232:235], v[224:227], a[8:11]
v_exp_f32_e64 v145, v145
v_mfma_f32_16x16x32_bf16 a[40:43], a[232:235], v[232:235], a[40:43]
ds_read_b128 a[204:207], v67 offset:49152
v_mfma_f32_16x16x32_bf16 a[72:75], a[232:235], v[240:243], a[72:75]
v_exp_f32_e64 v146, v146
v_mfma_f32_16x16x32_bf16 a[104:107], a[232:235], v[248:251], a[104:107]
v_exp_f32_e64 v147, v147
v_mfma_f32_16x16x32_bf16 a[12:15], a[236:239], v[224:227], a[12:15]
s_add_u32 m0, s30, 32768
s_nop 0
buffer_load_dwordx4 v32, s[4:7], s25 offen offset:0 lds
v_mfma_f32_16x16x32_bf16 a[44:47], a[236:239], v[232:235], a[44:47]
v_exp_f32_e64 v148, v148
v_mfma_f32_16x16x32_bf16 a[76:79], a[236:239], v[240:243], a[76:79]
v_cvt_pk_bf16_f32 v144, v144, v145
v_cvt_pk_bf16_f32 v145, v146, v147
v_mfma_f32_16x16x32_bf16 a[108:111], a[236:239], v[248:251], a[108:111]
ds_read_b128 a[208:211], v64 offset:53248
v_mfma_f32_16x16x32_bf16 v[116:119], v[76:79], v[232:235], v[116:119]
v_exp_f32_e64 v149, v149
s_waitcnt lgkmcnt(5)
v_mfma_f32_16x16x32_bf16 a[16:19], a[240:243], v[224:227], a[16:19]
ds_read_b128 a[212:215], v65 offset:53248
v_mfma_f32_16x16x32_bf16 a[48:51], a[240:243], v[232:235], a[48:51]
v_exp_f32_e64 v150, v150
v_mfma_f32_16x16x32_bf16 a[80:83], a[240:243], v[240:243], a[80:83]
buffer_load_dwordx4 v33, s[4:7], s25 offen offset:1024 lds
v_mfma_f32_16x16x32_bf16 a[112:115], a[240:243], v[248:251], a[112:115]
v_exp_f32_e64 v151, v151
v_mfma_f32_16x16x32_bf16 a[20:23], a[244:247], v[224:227], a[20:23]
v_exp_f32_e64 v152, v152
v_mfma_f32_16x16x32_bf16 a[52:55], a[244:247], v[232:235], a[52:55]
v_cvt_pk_bf16_f32 v146, v148, v149
v_cvt_pk_bf16_f32 v147, v150, v151
v_mfma_f32_16x16x32_bf16 a[84:87], a[244:247], v[240:243], a[84:87]
ds_read_b128 a[216:219], v66 offset:53248
v_mfma_f32_16x16x32_bf16 a[116:119], a[244:247], v[248:251], a[116:119]
v_exp_f32_e64 v153, v153
v_mfma_f32_16x16x32_bf16 v[120:123], v[76:79], v[240:243], v[120:123]
ds_read_b128 a[220:223], v67 offset:53248
v_mfma_f32_16x16x32_bf16 a[24:27], a[248:251], v[224:227], a[24:27]
v_exp_f32_e64 v154, v154
v_mfma_f32_16x16x32_bf16 a[56:59], a[248:251], v[232:235], a[56:59]
buffer_load_dwordx4 v34, s[4:7], s25 offen offset:2048 lds
v_mfma_f32_16x16x32_bf16 a[88:91], a[248:251], v[240:243], a[88:91]
v_exp_f32_e64 v155, v155
v_mfma_f32_16x16x32_bf16 a[120:123], a[248:251], v[248:251], a[120:123]
v_exp_f32_e64 v156, v156
v_mfma_f32_16x16x32_bf16 a[28:31], a[252:255], v[224:227], a[28:31]
v_cvt_pk_bf16_f32 v152, v152, v153
v_cvt_pk_bf16_f32 v153, v154, v155
v_mfma_f32_16x16x32_bf16 a[60:63], a[252:255], v[232:235], a[60:63]
v_exp_f32_e64 v157, v157
v_mfma_f32_16x16x32_bf16 a[92:95], a[252:255], v[240:243], a[92:95]
buffer_load_dwordx4 v35, s[4:7], s25 offen offset:3072 lds
s_add_u32 s25, s25, 16384
v_mfma_f32_16x16x32_bf16 a[124:127], a[252:255], v[248:251], a[124:127]
v_exp_f32_e64 v158, v158
v_mfma_f32_16x16x32_bf16 v[124:127], v[76:79], v[248:251], v[124:127]
v_exp_f32_e64 v159, v159
s_waitcnt lgkmcnt(0)
v_mfma_f32_16x16x32_bf16 v[192:195], a[192:195], a[128:131], v[96:99]
v_exp_f32_e64 v160, v160
v_mfma_f32_16x16x32_bf16 v[192:195], a[196:199], a[132:135], v[192:195]
ds_read_b64_tr_b16 a[224:225], v68 offset:32768
v_mfma_f32_16x16x32_bf16 v[192:195], a[200:203], a[136:139], v[192:195]
v_cvt_pk_bf16_f32 v154, v156, v157
v_cvt_pk_bf16_f32 v155, v158, v159
v_mfma_f32_16x16x32_bf16 v[192:195], a[204:207], a[140:143], v[192:195]
ds_read_b64_tr_b16 a[226:227], v68 offset:36864
v_mfma_f32_16x16x32_bf16 v[196:199], a[208:211], a[128:131], v[96:99]
v_exp_f32_e64 v161, v161
v_mfma_f32_16x16x32_bf16 v[196:199], a[212:215], a[132:135], v[196:199]
ds_read_b64_tr_b16 a[228:229], v69 offset:32768
v_mfma_f32_16x16x32_bf16 v[196:199], a[216:219], a[136:139], v[196:199]
v_exp_f32_e64 v162, v162
v_mfma_f32_16x16x32_bf16 v[196:199], a[220:223], a[140:143], v[196:199]
ds_read_b64_tr_b16 a[230:231], v69 offset:36864
v_mfma_f32_16x16x32_bf16 v[200:203], a[192:195], a[144:147], v[100:103]
v_exp_f32_e64 v163, v163
v_mfma_f32_16x16x32_bf16 v[200:203], a[196:199], a[148:151], v[200:203]
ds_read_b64_tr_b16 a[232:233], v70 offset:32768
v_mfma_f32_16x16x32_bf16 v[200:203], a[200:203], a[152:155], v[200:203]
v_exp_f32_e64 v164, v164
v_mfma_f32_16x16x32_bf16 v[200:203], a[204:207], a[156:159], v[200:203]
ds_read_b64_tr_b16 a[234:235], v70 offset:36864
v_mfma_f32_16x16x32_bf16 v[204:207], a[208:211], a[144:147], v[100:103]
v_exp_f32_e64 v165, v165
v_mfma_f32_16x16x32_bf16 v[204:207], a[212:215], a[148:151], v[204:207]
ds_read_b64_tr_b16 a[236:237], v71 offset:32768
v_mfma_f32_16x16x32_bf16 v[204:207], a[216:219], a[152:155], v[204:207]
v_cvt_pk_bf16_f32 v160, v160, v161
v_cvt_pk_bf16_f32 v161, v162, v163
v_mfma_f32_16x16x32_bf16 v[204:207], a[220:223], a[156:159], v[204:207]
ds_read_b64_tr_b16 a[238:239], v71 offset:36864
v_mfma_f32_16x16x32_bf16 v[208:211], a[192:195], a[160:163], v[104:107]
v_exp_f32_e64 v166, v166
v_mfma_f32_16x16x32_bf16 v[208:211], a[196:199], a[164:167], v[208:211]
ds_read_b64_tr_b16 a[240:241], v72 offset:32768
v_mfma_f32_16x16x32_bf16 v[208:211], a[200:203], a[168:171], v[208:211]
v_exp_f32_e64 v167, v167
v_mfma_f32_16x16x32_bf16 v[208:211], a[204:207], a[172:175], v[208:211]
ds_read_b64_tr_b16 a[242:243], v72 offset:36864
v_mfma_f32_16x16x32_bf16 v[212:215], a[208:211], a[160:163], v[104:107]
v_exp_f32_e64 v168, v168
v_mfma_f32_16x16x32_bf16 v[212:215], a[212:215], a[164:167], v[212:215]
ds_read_b64_tr_b16 a[244:245], v73 offset:32768
v_mfma_f32_16x16x32_bf16 v[212:215], a[216:219], a[168:171], v[212:215]
v_exp_f32_e64 v169, v169
v_mfma_f32_16x16x32_bf16 v[212:215], a[220:223], a[172:175], v[212:215]
ds_read_b64_tr_b16 a[246:247], v73 offset:36864
v_mfma_f32_16x16x32_bf16 v[216:219], a[192:195], a[176:179], v[108:111]
v_cvt_pk_bf16_f32 v162, v164, v165
v_cvt_pk_bf16_f32 v163, v166, v167
v_mfma_f32_16x16x32_bf16 v[216:219], a[196:199], a[180:183], v[216:219]
ds_read_b64_tr_b16 a[248:249], v74 offset:32768
v_mfma_f32_16x16x32_bf16 v[216:219], a[200:203], a[184:187], v[216:219]
v_exp_f32_e64 v170, v170
v_mfma_f32_16x16x32_bf16 v[216:219], a[204:207], a[188:191], v[216:219]
ds_read_b64_tr_b16 a[250:251], v74 offset:36864
v_mfma_f32_16x16x32_bf16 v[220:223], a[208:211], a[176:179], v[108:111]
v_exp_f32_e64 v171, v171
v_mfma_f32_16x16x32_bf16 v[220:223], a[212:215], a[180:183], v[220:223]
ds_read_b64_tr_b16 a[252:253], v75 offset:32768
v_mfma_f32_16x16x32_bf16 v[220:223], a[216:219], a[184:187], v[220:223]
v_exp_f32_e64 v172, v172
v_mfma_f32_16x16x32_bf16 v[220:223], a[220:223], a[188:191], v[220:223]
ds_read_b64_tr_b16 a[254:255], v75 offset:36864
s_waitcnt lgkmcnt(8)
v_mfma_f32_16x16x32_bf16 a[0:3], a[224:227], v[128:131], a[0:3]
v_exp_f32_e64 v173, v173
v_mfma_f32_16x16x32_bf16 a[32:35], a[224:227], v[136:139], a[32:35]
v_cvt_pk_bf16_f32 v168, v168, v169
v_cvt_pk_bf16_f32 v169, v170, v171
v_mfma_f32_16x16x32_bf16 a[64:67], a[224:227], v[144:147], a[64:67]
ds_read_b128 a[192:195], v64 offset:57344
v_mfma_f32_16x16x32_bf16 a[96:99], a[224:227], v[152:155], a[96:99]
v_exp_f32_e64 v174, v174
v_mfma_f32_16x16x32_bf16 a[4:7], a[228:231], v[128:131], a[4:7]
ds_read_b128 a[196:199], v65 offset:57344
v_mfma_f32_16x16x32_bf16 a[36:39], a[228:231], v[136:139], a[36:39]
v_exp_f32_e64 v175, v175
v_mfma_f32_16x16x32_bf16 a[68:71], a[228:231], v[144:147], a[68:71]
v_exp_f32_e64 v176, v176
v_mfma_f32_16x16x32_bf16 a[100:103], a[228:231], v[152:155], a[100:103]
v_cvt_pk_bf16_f32 v170, v172, v173
v_cvt_pk_bf16_f32 v171, v174, v175
v_mfma_f32_16x16x32_bf16 v[112:115], v[76:79], v[128:131], v[112:115]
ds_read_b128 a[200:203], v66 offset:57344
v_mfma_f32_16x16x32_bf16 a[8:11], a[232:235], v[128:131], a[8:11]
v_exp_f32_e64 v177, v177
v_mfma_f32_16x16x32_bf16 a[40:43], a[232:235], v[136:139], a[40:43]
ds_read_b128 a[204:207], v67 offset:57344
v_mfma_f32_16x16x32_bf16 a[72:75], a[232:235], v[144:147], a[72:75]
v_exp_f32_e64 v178, v178
v_mfma_f32_16x16x32_bf16 a[104:107], a[232:235], v[152:155], a[104:107]
v_exp_f32_e64 v179, v179
v_mfma_f32_16x16x32_bf16 a[12:15], a[236:239], v[128:131], a[12:15]
s_add_u32 m0, s30, 81920
s_nop 0
buffer_load_dwordx4 v36, s[8:11], s26 offen offset:0 lds
v_mfma_f32_16x16x32_bf16 a[44:47], a[236:239], v[136:139], a[44:47]
v_exp_f32_e64 v180, v180
v_mfma_f32_16x16x32_bf16 a[76:79], a[236:239], v[144:147], a[76:79]
v_cvt_pk_bf16_f32 v176, v176, v177
v_cvt_pk_bf16_f32 v177, v178, v179
v_mfma_f32_16x16x32_bf16 a[108:111], a[236:239], v[152:155], a[108:111]
ds_read_b128 a[208:211], v64 offset:61440
v_mfma_f32_16x16x32_bf16 v[116:119], v[76:79], v[136:139], v[116:119]
v_exp_f32_e64 v181, v181
s_waitcnt lgkmcnt(5)
v_mfma_f32_16x16x32_bf16 a[16:19], a[240:243], v[128:131], a[16:19]
ds_read_b128 a[212:215], v65 offset:61440
v_mfma_f32_16x16x32_bf16 a[48:51], a[240:243], v[136:139], a[48:51]
v_exp_f32_e64 v182, v182
v_mfma_f32_16x16x32_bf16 a[80:83], a[240:243], v[144:147], a[80:83]
buffer_load_dwordx4 v37, s[8:11], s26 offen offset:1024 lds
v_mfma_f32_16x16x32_bf16 a[112:115], a[240:243], v[152:155], a[112:115]
v_exp_f32_e64 v183, v183
v_mfma_f32_16x16x32_bf16 a[20:23], a[244:247], v[128:131], a[20:23]
v_exp_f32_e64 v184, v184
v_mfma_f32_16x16x32_bf16 a[52:55], a[244:247], v[136:139], a[52:55]
v_cvt_pk_bf16_f32 v178, v180, v181
v_cvt_pk_bf16_f32 v179, v182, v183
v_mfma_f32_16x16x32_bf16 a[84:87], a[244:247], v[144:147], a[84:87]
ds_read_b128 a[216:219], v66 offset:61440
v_mfma_f32_16x16x32_bf16 a[116:119], a[244:247], v[152:155], a[116:119]
v_exp_f32_e64 v185, v185
v_mfma_f32_16x16x32_bf16 v[120:123], v[76:79], v[144:147], v[120:123]
ds_read_b128 a[220:223], v67 offset:61440
v_mfma_f32_16x16x32_bf16 a[24:27], a[248:251], v[128:131], a[24:27]
v_exp_f32_e64 v186, v186
v_mfma_f32_16x16x32_bf16 a[56:59], a[248:251], v[136:139], a[56:59]
buffer_load_dwordx4 v36, s[8:11], s26 offen offset:2048 lds
v_mfma_f32_16x16x32_bf16 a[88:91], a[248:251], v[144:147], a[88:91]
v_exp_f32_e64 v187, v187
v_mfma_f32_16x16x32_bf16 a[120:123], a[248:251], v[152:155], a[120:123]
v_exp_f32_e64 v188, v188
v_mfma_f32_16x16x32_bf16 a[28:31], a[252:255], v[128:131], a[28:31]
v_cvt_pk_bf16_f32 v184, v184, v185
v_cvt_pk_bf16_f32 v185, v186, v187
v_mfma_f32_16x16x32_bf16 a[60:63], a[252:255], v[136:139], a[60:63]
v_exp_f32_e64 v189, v189
v_mfma_f32_16x16x32_bf16 a[92:95], a[252:255], v[144:147], a[92:95]
buffer_load_dwordx4 v37, s[8:11], s26 offen offset:3072 lds
s_add_u32 s26, s26, 16384
v_mfma_f32_16x16x32_bf16 a[124:127], a[252:255], v[152:155], a[124:127]
v_exp_f32_e64 v190, v190
v_mfma_f32_16x16x32_bf16 v[124:127], v[76:79], v[152:155], v[124:127]
v_exp_f32_e64 v191, v191
s_waitcnt lgkmcnt(0)
v_mfma_f32_16x16x32_bf16 v[224:227], a[192:195], a[128:131], v[96:99]
v_exp_f32_e64 v192, v192
v_mfma_f32_16x16x32_bf16 v[224:227], a[196:199], a[132:135], v[224:227]
ds_read_b64_tr_b16 a[224:225], v68 offset:40960
v_mfma_f32_16x16x32_bf16 v[224:227], a[200:203], a[136:139], v[224:227]
v_cvt_pk_bf16_f32 v186, v188, v189
v_cvt_pk_bf16_f32 v187, v190, v191
v_mfma_f32_16x16x32_bf16 v[224:227], a[204:207], a[140:143], v[224:227]
ds_read_b64_tr_b16 a[226:227], v68 offset:45056
v_mfma_f32_16x16x32_bf16 v[228:231], a[208:211], a[128:131], v[96:99]
v_exp_f32_e64 v193, v193
v_mfma_f32_16x16x32_bf16 v[228:231], a[212:215], a[132:135], v[228:231]
ds_read_b64_tr_b16 a[228:229], v69 offset:40960
v_mfma_f32_16x16x32_bf16 v[228:231], a[216:219], a[136:139], v[228:231]
v_exp_f32_e64 v194, v194
buffer_store_dwordx4 v[84:87], v11, s[16:19], s95 offen offset:0 sc1
v_mfma_f32_16x16x32_bf16 v[228:231], a[220:223], a[140:143], v[228:231]
ds_read_b64_tr_b16 a[230:231], v69 offset:45056
v_mfma_f32_16x16x32_bf16 v[232:235], a[192:195], a[144:147], v[100:103]
v_exp_f32_e64 v195, v195
v_mfma_f32_16x16x32_bf16 v[232:235], a[196:199], a[148:151], v[232:235]
ds_read_b64_tr_b16 a[232:233], v70 offset:40960
v_mfma_f32_16x16x32_bf16 v[232:235], a[200:203], a[152:155], v[232:235]
v_exp_f32_e64 v196, v196
v_mfma_f32_16x16x32_bf16 v[232:235], a[204:207], a[156:159], v[232:235]
ds_read_b64_tr_b16 a[234:235], v70 offset:45056
v_mfma_f32_16x16x32_bf16 v[236:239], a[208:211], a[144:147], v[100:103]
v_exp_f32_e64 v197, v197
v_mfma_f32_16x16x32_bf16 v[236:239], a[212:215], a[148:151], v[236:239]
ds_read_b64_tr_b16 a[236:237], v71 offset:40960
v_mfma_f32_16x16x32_bf16 v[236:239], a[216:219], a[152:155], v[236:239]
v_cvt_pk_bf16_f32 v192, v192, v193
v_cvt_pk_bf16_f32 v193, v194, v195
v_mfma_f32_16x16x32_bf16 v[236:239], a[220:223], a[156:159], v[236:239]
ds_read_b64_tr_b16 a[238:239], v71 offset:45056
v_mfma_f32_16x16x32_bf16 v[240:243], a[192:195], a[160:163], v[104:107]
v_exp_f32_e64 v198, v198
v_mfma_f32_16x16x32_bf16 v[240:243], a[196:199], a[164:167], v[240:243]
ds_read_b64_tr_b16 a[240:241], v72 offset:40960
v_mfma_f32_16x16x32_bf16 v[240:243], a[200:203], a[168:171], v[240:243]
v_exp_f32_e64 v199, v199
buffer_store_dwordx4 v[88:91], v11, s[16:19], s95 offen offset:1024 sc1
v_mfma_f32_16x16x32_bf16 v[240:243], a[204:207], a[172:175], v[240:243]
ds_read_b64_tr_b16 a[242:243], v72 offset:45056
v_mfma_f32_16x16x32_bf16 v[244:247], a[208:211], a[160:163], v[104:107]
v_exp_f32_e64 v200, v200
v_mfma_f32_16x16x32_bf16 v[244:247], a[212:215], a[164:167], v[244:247]
ds_read_b64_tr_b16 a[244:245], v73 offset:40960
v_mfma_f32_16x16x32_bf16 v[244:247], a[216:219], a[168:171], v[244:247]
v_exp_f32_e64 v201, v201
v_mfma_f32_16x16x32_bf16 v[244:247], a[220:223], a[172:175], v[244:247]
ds_read_b64_tr_b16 a[246:247], v73 offset:45056
v_mfma_f32_16x16x32_bf16 v[248:251], a[192:195], a[176:179], v[108:111]
v_cvt_pk_bf16_f32 v194, v196, v197
v_cvt_pk_bf16_f32 v195, v198, v199
v_mfma_f32_16x16x32_bf16 v[248:251], a[196:199], a[180:183], v[248:251]
ds_read_b64_tr_b16 a[248:249], v74 offset:40960
v_mfma_f32_16x16x32_bf16 v[248:251], a[200:203], a[184:187], v[248:251]
v_exp_f32_e64 v202, v202
v_mfma_f32_16x16x32_bf16 v[248:251], a[204:207], a[188:191], v[248:251]
ds_read_b64_tr_b16 a[250:251], v74 offset:45056
v_mfma_f32_16x16x32_bf16 v[252:255], a[208:211], a[176:179], v[108:111]
v_exp_f32_e64 v203, v203
v_mfma_f32_16x16x32_bf16 v[252:255], a[212:215], a[180:183], v[252:255]
ds_read_b64_tr_b16 a[252:253], v75 offset:40960
v_mfma_f32_16x16x32_bf16 v[252:255], a[216:219], a[184:187], v[252:255]
v_exp_f32_e64 v204, v204
v_mfma_f32_16x16x32_bf16 v[252:255], a[220:223], a[188:191], v[252:255]
ds_read_b64_tr_b16 a[254:255], v75 offset:45056
s_waitcnt vmcnt(18) lgkmcnt(8)
s_barrier
v_mfma_f32_16x16x32_bf16 a[0:3], a[224:227], v[160:163], a[0:3]
v_exp_f32_e64 v205, v205
v_mfma_f32_16x16x32_bf16 a[32:35], a[224:227], v[168:171], a[32:35]
v_cvt_pk_bf16_f32 v200, v200, v201
v_cvt_pk_bf16_f32 v201, v202, v203
v_mfma_f32_16x16x32_bf16 a[64:67], a[224:227], v[176:179], a[64:67]
ds_read_b128 a[192:195], v64 offset:0
v_mfma_f32_16x16x32_bf16 a[96:99], a[224:227], v[184:187], a[96:99]
v_exp_f32_e64 v206, v206
v_mfma_f32_16x16x32_bf16 a[4:7], a[228:231], v[160:163], a[4:7]
ds_read_b128 a[196:199], v65 offset:0
v_mfma_f32_16x16x32_bf16 a[36:39], a[228:231], v[168:171], a[36:39]
v_exp_f32_e64 v207, v207
v_mfma_f32_16x16x32_bf16 a[68:71], a[228:231], v[176:179], a[68:71]
v_exp_f32_e64 v208, v208
v_mfma_f32_16x16x32_bf16 a[100:103], a[228:231], v[184:187], a[100:103]
v_cvt_pk_bf16_f32 v202, v204, v205
v_cvt_pk_bf16_f32 v203, v206, v207
v_mfma_f32_16x16x32_bf16 v[112:115], v[76:79], v[160:163], v[112:115]
ds_read_b128 a[200:203], v66 offset:0
v_mfma_f32_16x16x32_bf16 a[8:11], a[232:235], v[160:163], a[8:11]
v_exp_f32_e64 v209, v209
v_mfma_f32_16x16x32_bf16 a[40:43], a[232:235], v[168:171], a[40:43]
ds_read_b128 a[204:207], v67 offset:0
v_mfma_f32_16x16x32_bf16 a[72:75], a[232:235], v[176:179], a[72:75]
v_exp_f32_e64 v210, v210
v_mfma_f32_16x16x32_bf16 a[104:107], a[232:235], v[184:187], a[104:107]
v_exp_f32_e64 v211, v211
v_mfma_f32_16x16x32_bf16 a[12:15], a[236:239], v[160:163], a[12:15]
s_add_u32 m0, s30, 49152
s_nop 0
buffer_load_dwordx4 v32, s[4:7], s25 offen offset:0 lds
v_mfma_f32_16x16x32_bf16 a[44:47], a[236:239], v[168:171], a[44:47]
v_exp_f32_e64 v212, v212
v_mfma_f32_16x16x32_bf16 a[76:79], a[236:239], v[176:179], a[76:79]
v_cvt_pk_bf16_f32 v208, v208, v209
v_cvt_pk_bf16_f32 v209, v210, v211
v_mfma_f32_16x16x32_bf16 a[108:111], a[236:239], v[184:187], a[108:111]
ds_read_b128 a[208:211], v64 offset:4096
v_mfma_f32_16x16x32_bf16 v[116:119], v[76:79], v[168:171], v[116:119]
v_exp_f32_e64 v213, v213
s_waitcnt lgkmcnt(5)
v_mfma_f32_16x16x32_bf16 a[16:19], a[240:243], v[160:163], a[16:19]
ds_read_b128 a[212:215], v65 offset:4096
v_mfma_f32_16x16x32_bf16 a[48:51], a[240:243], v[168:171], a[48:51]
v_exp_f32_e64 v214, v214
v_mfma_f32_16x16x32_bf16 a[80:83], a[240:243], v[176:179], a[80:83]
buffer_load_dwordx4 v33, s[4:7], s25 offen offset:1024 lds
v_mfma_f32_16x16x32_bf16 a[112:115], a[240:243], v[184:187], a[112:115]
v_exp_f32_e64 v215, v215
v_mfma_f32_16x16x32_bf16 a[20:23], a[244:247], v[160:163], a[20:23]
v_exp_f32_e64 v216, v216
v_mfma_f32_16x16x32_bf16 a[52:55], a[244:247], v[168:171], a[52:55]
v_cvt_pk_bf16_f32 v210, v212, v213
v_cvt_pk_bf16_f32 v211, v214, v215
v_mfma_f32_16x16x32_bf16 a[84:87], a[244:247], v[176:179], a[84:87]
ds_read_b128 a[216:219], v66 offset:4096
v_mfma_f32_16x16x32_bf16 a[116:119], a[244:247], v[184:187], a[116:119]
v_exp_f32_e64 v217, v217
v_mfma_f32_16x16x32_bf16 v[120:123], v[76:79], v[176:179], v[120:123]
ds_read_b128 a[220:223], v67 offset:4096
v_mfma_f32_16x16x32_bf16 a[24:27], a[248:251], v[160:163], a[24:27]
v_exp_f32_e64 v218, v218
v_mfma_f32_16x16x32_bf16 a[56:59], a[248:251], v[168:171], a[56:59]
buffer_load_dwordx4 v34, s[4:7], s25 offen offset:2048 lds
v_mfma_f32_16x16x32_bf16 a[88:91], a[248:251], v[176:179], a[88:91]
v_exp_f32_e64 v219, v219
v_mfma_f32_16x16x32_bf16 a[120:123], a[248:251], v[184:187], a[120:123]
v_exp_f32_e64 v220, v220
v_mfma_f32_16x16x32_bf16 a[28:31], a[252:255], v[160:163], a[28:31]
v_cvt_pk_bf16_f32 v216, v216, v217
v_cvt_pk_bf16_f32 v217, v218, v219
v_mfma_f32_16x16x32_bf16 a[60:63], a[252:255], v[168:171], a[60:63]
v_exp_f32_e64 v221, v221
v_mfma_f32_16x16x32_bf16 a[92:95], a[252:255], v[176:179], a[92:95]
buffer_load_dwordx4 v35, s[4:7], s25 offen offset:3072 lds
s_add_u32 s25, s25, 16384
v_mfma_f32_16x16x32_bf16 a[124:127], a[252:255], v[184:187], a[124:127]
v_exp_f32_e64 v222, v222
v_mfma_f32_16x16x32_bf16 v[124:127], v[76:79], v[184:187], v[124:127]
v_exp_f32_e64 v223, v223
s_waitcnt lgkmcnt(0)
v_mfma_f32_16x16x32_bf16 v[128:131], a[192:195], a[128:131], v[96:99]
v_exp_f32_e64 v224, v224
v_mfma_f32_16x16x32_bf16 v[128:131], a[196:199], a[132:135], v[128:131]
ds_read_b64_tr_b16 a[224:225], v68 offset:49152
v_mfma_f32_16x16x32_bf16 v[128:131], a[200:203], a[136:139], v[128:131]
v_cvt_pk_bf16_f32 v218, v220, v221
v_cvt_pk_bf16_f32 v219, v222, v223
v_mfma_f32_16x16x32_bf16 v[128:131], a[204:207], a[140:143], v[128:131]
ds_read_b64_tr_b16 a[226:227], v68 offset:53248
v_mfma_f32_16x16x32_bf16 v[132:135], a[208:211], a[128:131], v[96:99]
v_exp_f32_e64 v225, v225
v_mfma_f32_16x16x32_bf16 v[132:135], a[212:215], a[132:135], v[132:135]
ds_read_b64_tr_b16 a[228:229], v69 offset:49152
v_mfma_f32_16x16x32_bf16 v[132:135], a[216:219], a[136:139], v[132:135]
v_exp_f32_e64 v226, v226
buffer_store_dwordx4 v[92:95], v11, s[16:19], s95 offen offset:2048 sc1
v_mfma_f32_16x16x32_bf16 v[132:135], a[220:223], a[140:143], v[132:135]
ds_read_b64_tr_b16 a[230:231], v69 offset:53248
v_mfma_f32_16x16x32_bf16 v[136:139], a[192:195], a[144:147], v[100:103]
v_exp_f32_e64 v227, v227
v_mfma_f32_16x16x32_bf16 v[136:139], a[196:199], a[148:151], v[136:139]
ds_read_b64_tr_b16 a[232:233], v70 offset:49152
v_mfma_f32_16x16x32_bf16 v[136:139], a[200:203], a[152:155], v[136:139]
v_exp_f32_e64 v228, v228
v_mfma_f32_16x16x32_bf16 v[136:139], a[204:207], a[156:159], v[136:139]
ds_read_b64_tr_b16 a[234:235], v70 offset:53248
v_mfma_f32_16x16x32_bf16 v[140:143], a[208:211], a[144:147], v[100:103]
v_exp_f32_e64 v229, v229
v_mfma_f32_16x16x32_bf16 v[140:143], a[212:215], a[148:151], v[140:143]
ds_read_b64_tr_b16 a[236:237], v71 offset:49152
v_mfma_f32_16x16x32_bf16 v[140:143], a[216:219], a[152:155], v[140:143]
v_cvt_pk_bf16_f32 v224, v224, v225
v_cvt_pk_bf16_f32 v225, v226, v227
v_mfma_f32_16x16x32_bf16 v[140:143], a[220:223], a[156:159], v[140:143]
ds_read_b64_tr_b16 a[238:239], v71 offset:53248
v_mfma_f32_16x16x32_bf16 v[144:147], a[192:195], a[160:163], v[104:107]
v_exp_f32_e64 v230, v230
v_mfma_f32_16x16x32_bf16 v[144:147], a[196:199], a[164:167], v[144:147]
ds_read_b64_tr_b16 a[240:241], v72 offset:49152
v_mfma_f32_16x16x32_bf16 v[144:147], a[200:203], a[168:171], v[144:147]
v_exp_f32_e64 v231, v231
v_mfma_f32_16x16x32_bf16 v[144:147], a[204:207], a[172:175], v[144:147]
ds_read_b64_tr_b16 a[242:243], v72 offset:53248
v_mfma_f32_16x16x32_bf16 v[148:151], a[208:211], a[160:163], v[104:107]
v_exp_f32_e64 v232, v232
v_mfma_f32_16x16x32_bf16 v[148:151], a[212:215], a[164:167], v[148:151]
ds_read_b64_tr_b16 a[244:245], v73 offset:49152
v_mfma_f32_16x16x32_bf16 v[148:151], a[216:219], a[168:171], v[148:151]
v_exp_f32_e64 v233, v233
v_mfma_f32_16x16x32_bf16 v[148:151], a[220:223], a[172:175], v[148:151]
ds_read_b64_tr_b16 a[246:247], v73 offset:53248
v_mfma_f32_16x16x32_bf16 v[152:155], a[192:195], a[176:179], v[108:111]
v_cvt_pk_bf16_f32 v226, v228, v229
v_cvt_pk_bf16_f32 v227, v230, v231
v_mfma_f32_16x16x32_bf16 v[152:155], a[196:199], a[180:183], v[152:155]
ds_read_b64_tr_b16 a[248:249], v74 offset:49152
v_mfma_f32_16x16x32_bf16 v[152:155], a[200:203], a[184:187], v[152:155]
v_exp_f32_e64 v234, v234
v_mfma_f32_16x16x32_bf16 v[152:155], a[204:207], a[188:191], v[152:155]
ds_read_b64_tr_b16 a[250:251], v74 offset:53248
v_mfma_f32_16x16x32_bf16 v[156:159], a[208:211], a[176:179], v[108:111]
v_exp_f32_e64 v235, v235
v_mfma_f32_16x16x32_bf16 v[156:159], a[212:215], a[180:183], v[156:159]
ds_read_b64_tr_b16 a[252:253], v75 offset:49152
v_mfma_f32_16x16x32_bf16 v[156:159], a[216:219], a[184:187], v[156:159]
v_exp_f32_e64 v236, v236
v_mfma_f32_16x16x32_bf16 v[156:159], a[220:223], a[188:191], v[156:159]
ds_read_b64_tr_b16 a[254:255], v75 offset:53248
s_waitcnt lgkmcnt(8)
v_mfma_f32_16x16x32_bf16 a[0:3], a[224:227], v[192:195], a[0:3]
v_exp_f32_e64 v237, v237
v_mfma_f32_16x16x32_bf16 a[32:35], a[224:227], v[200:203], a[32:35]
v_cvt_pk_bf16_f32 v232, v232, v233
v_cvt_pk_bf16_f32 v233, v234, v235
v_mfma_f32_16x16x32_bf16 a[64:67], a[224:227], v[208:211], a[64:67]
ds_read_b128 a[192:195], v64 offset:8192
v_mfma_f32_16x16x32_bf16 a[96:99], a[224:227], v[216:219], a[96:99]
v_exp_f32_e64 v238, v238
v_mfma_f32_16x16x32_bf16 a[4:7], a[228:231], v[192:195], a[4:7]
ds_read_b128 a[196:199], v65 offset:8192
v_mfma_f32_16x16x32_bf16 a[36:39], a[228:231], v[200:203], a[36:39]
v_exp_f32_e64 v239, v239
v_mfma_f32_16x16x32_bf16 a[68:71], a[228:231], v[208:211], a[68:71]
v_exp_f32_e64 v240, v240
v_mfma_f32_16x16x32_bf16 a[100:103], a[228:231], v[216:219], a[100:103]
v_cvt_pk_bf16_f32 v234, v236, v237
v_cvt_pk_bf16_f32 v235, v238, v239
v_mfma_f32_16x16x32_bf16 v[112:115], v[76:79], v[192:195], v[112:115]
ds_read_b128 a[200:203], v66 offset:8192
v_mfma_f32_16x16x32_bf16 a[8:11], a[232:235], v[192:195], a[8:11]
v_exp_f32_e64 v241, v241
v_mfma_f32_16x16x32_bf16 a[40:43], a[232:235], v[200:203], a[40:43]
ds_read_b128 a[204:207], v67 offset:8192
v_mfma_f32_16x16x32_bf16 a[72:75], a[232:235], v[208:211], a[72:75]
v_exp_f32_e64 v242, v242
v_mfma_f32_16x16x32_bf16 a[104:107], a[232:235], v[216:219], a[104:107]
v_exp_f32_e64 v243, v243
v_mfma_f32_16x16x32_bf16 a[12:15], a[236:239], v[192:195], a[12:15]
s_add_u32 m0, s30, 98304
s_nop 0
buffer_load_dwordx4 v36, s[8:11], s26 offen offset:0 lds
v_mfma_f32_16x16x32_bf16 a[44:47], a[236:239], v[200:203], a[44:47]
v_exp_f32_e64 v244, v244
v_mfma_f32_16x16x32_bf16 a[76:79], a[236:239], v[208:211], a[76:79]
v_cvt_pk_bf16_f32 v240, v240, v241
v_cvt_pk_bf16_f32 v241, v242, v243
v_mfma_f32_16x16x32_bf16 a[108:111], a[236:239], v[216:219], a[108:111]
ds_read_b128 a[208:211], v64 offset:12288
v_mfma_f32_16x16x32_bf16 v[116:119], v[76:79], v[200:203], v[116:119]
v_exp_f32_e64 v245, v245
s_waitcnt lgkmcnt(5)
v_mfma_f32_16x16x32_bf16 a[16:19], a[240:243], v[192:195], a[16:19]
ds_read_b128 a[212:215], v65 offset:12288
v_mfma_f32_16x16x32_bf16 a[48:51], a[240:243], v[200:203], a[48:51]
v_exp_f32_e64 v246, v246
v_mfma_f32_16x16x32_bf16 a[80:83], a[240:243], v[208:211], a[80:83]
buffer_load_dwordx4 v37, s[8:11], s26 offen offset:1024 lds
v_mfma_f32_16x16x32_bf16 a[112:115], a[240:243], v[216:219], a[112:115]
v_exp_f32_e64 v247, v247
v_mfma_f32_16x16x32_bf16 a[20:23], a[244:247], v[192:195], a[20:23]
v_exp_f32_e64 v248, v248
v_mfma_f32_16x16x32_bf16 a[52:55], a[244:247], v[200:203], a[52:55]
v_cvt_pk_bf16_f32 v242, v244, v245
v_cvt_pk_bf16_f32 v243, v246, v247
v_mfma_f32_16x16x32_bf16 a[84:87], a[244:247], v[208:211], a[84:87]
ds_read_b128 a[216:219], v66 offset:12288
v_mfma_f32_16x16x32_bf16 a[116:119], a[244:247], v[216:219], a[116:119]
v_exp_f32_e64 v249, v249
v_mfma_f32_16x16x32_bf16 v[120:123], v[76:79], v[208:211], v[120:123]
ds_read_b128 a[220:223], v67 offset:12288
v_mfma_f32_16x16x32_bf16 a[24:27], a[248:251], v[192:195], a[24:27]
v_exp_f32_e64 v250, v250
v_mfma_f32_16x16x32_bf16 a[56:59], a[248:251], v[200:203], a[56:59]
buffer_load_dwordx4 v36, s[8:11], s26 offen offset:2048 lds
v_mfma_f32_16x16x32_bf16 a[88:91], a[248:251], v[208:211], a[88:91]
v_exp_f32_e64 v251, v251
v_mfma_f32_16x16x32_bf16 a[120:123], a[248:251], v[216:219], a[120:123]
v_exp_f32_e64 v252, v252
v_mfma_f32_16x16x32_bf16 a[28:31], a[252:255], v[192:195], a[28:31]
v_cvt_pk_bf16_f32 v248, v248, v249
v_cvt_pk_bf16_f32 v249, v250, v251
v_mfma_f32_16x16x32_bf16 a[60:63], a[252:255], v[200:203], a[60:63]
v_exp_f32_e64 v253, v253
v_mfma_f32_16x16x32_bf16 a[92:95], a[252:255], v[208:211], a[92:95]
buffer_load_dwordx4 v37, s[8:11], s26 offen offset:3072 lds
s_add_u32 s26, s26, 16384
v_mfma_f32_16x16x32_bf16 a[124:127], a[252:255], v[216:219], a[124:127]
v_exp_f32_e64 v254, v254
v_mfma_f32_16x16x32_bf16 v[124:127], v[76:79], v[216:219], v[124:127]
v_exp_f32_e64 v255, v255
s_add_u32 s20, s88, 0x2400000
s_addc_u32 s21, s89, 0
s_mov_b32 s22, 0x1000000
s_mov_b32 s23, 0x00020000
s_mov_b32 s27, 6
.p2align 6
L_att_loop:
s_waitcnt lgkmcnt(0)
v_mfma_f32_16x16x32_bf16 v[160:163], a[192:195], a[128:131], v[96:99]
v_exp_f32_e64 v128, v128
v_mfma_f32_16x16x32_bf16 v[160:163], a[196:199], a[132:135], v[160:163]
ds_read_b64_tr_b16 a[224:225], v68 offset:57344
v_mfma_f32_16x16x32_bf16 v[160:163], a[200:203], a[136:139], v[160:163]
v_cvt_pk_bf16_f32 v250, v252, v253
v_cvt_pk_bf16_f32 v251, v254, v255
v_mfma_f32_16x16x32_bf16 v[160:163], a[204:207], a[140:143], v[160:163]
ds_read_b64_tr_b16 a[226:227], v68 offset:61440
v_mfma_f32_16x16x32_bf16 v[164:167], a[208:211], a[128:131], v[96:99]
v_exp_f32_e64 v129, v129
v_mfma_f32_16x16x32_bf16 v[164:167], a[212:215], a[132:135], v[164:167]
ds_read_b64_tr_b16 a[228:229], v69 offset:57344
v_mfma_f32_16x16x32_bf16 v[164:167], a[216:219], a[136:139], v[164:167]
v_exp_f32_e64 v130, v130
s_mov_b32 m0, s91
s_nop 0
buffer_load_dwordx4 v1, s[12:15], s94 offen offset:0 nt lds
v_mfma_f32_16x16x32_bf16 v[164:167], a[220:223], a[140:143], v[164:167]
ds_read_b64_tr_b16 a[230:231], v69 offset:61440
v_mfma_f32_16x16x32_bf16 v[168:171], a[192:195], a[144:147], v[100:103]
v_exp_f32_e64 v131, v131
v_mfma_f32_16x16x32_bf16 v[168:171], a[196:199], a[148:151], v[168:171]
ds_read_b64_tr_b16 a[232:233], v70 offset:57344
v_mfma_f32_16x16x32_bf16 v[168:171], a[200:203], a[152:155], v[168:171]
v_exp_f32_e64 v132, v132
v_mfma_f32_16x16x32_bf16 v[168:171], a[204:207], a[156:159], v[168:171]
ds_read_b64_tr_b16 a[234:235], v70 offset:61440
v_mfma_f32_16x16x32_bf16 v[172:175], a[208:211], a[144:147], v[100:103]
v_exp_f32_e64 v133, v133
v_mfma_f32_16x16x32_bf16 v[172:175], a[212:215], a[148:151], v[172:175]
ds_read_b64_tr_b16 a[236:237], v71 offset:57344
v_mfma_f32_16x16x32_bf16 v[172:175], a[216:219], a[152:155], v[172:175]
v_cvt_pk_bf16_f32 v128, v128, v129
v_cvt_pk_bf16_f32 v129, v130, v131
v_mfma_f32_16x16x32_bf16 v[172:175], a[220:223], a[156:159], v[172:175]
ds_read_b64_tr_b16 a[238:239], v71 offset:61440
v_mfma_f32_16x16x32_bf16 v[176:179], a[192:195], a[160:163], v[104:107]
v_exp_f32_e64 v134, v134
v_mfma_f32_16x16x32_bf16 v[176:179], a[196:199], a[164:167], v[176:179]
ds_read_b64_tr_b16 a[240:241], v72 offset:57344
v_mfma_f32_16x16x32_bf16 v[176:179], a[200:203], a[168:171], v[176:179]
v_exp_f32_e64 v135, v135
v_mfma_f32_16x16x32_bf16 v[176:179], a[204:207], a[172:175], v[176:179]
ds_read_b64_tr_b16 a[242:243], v72 offset:61440
v_mfma_f32_16x16x32_bf16 v[180:183], a[208:211], a[160:163], v[104:107]
v_exp_f32_e64 v136, v136
v_mfma_f32_16x16x32_bf16 v[180:183], a[212:215], a[164:167], v[180:183]
ds_read_b64_tr_b16 a[244:245], v73 offset:57344
v_mfma_f32_16x16x32_bf16 v[180:183], a[216:219], a[168:171], v[180:183]
v_exp_f32_e64 v137, v137
v_mfma_f32_16x16x32_bf16 v[180:183], a[220:223], a[172:175], v[180:183]
ds_read_b64_tr_b16 a[246:247], v73 offset:61440
v_mfma_f32_16x16x32_bf16 v[184:187], a[192:195], a[176:179], v[108:111]
v_cvt_pk_bf16_f32 v130, v132, v133
v_cvt_pk_bf16_f32 v131, v134, v135
v_mfma_f32_16x16x32_bf16 v[184:187], a[196:199], a[180:183], v[184:187]
ds_read_b64_tr_b16 a[248:249], v74 offset:57344
v_mfma_f32_16x16x32_bf16 v[184:187], a[200:203], a[184:187], v[184:187]
v_exp_f32_e64 v138, v138
v_mfma_f32_16x16x32_bf16 v[184:187], a[204:207], a[188:191], v[184:187]
ds_read_b64_tr_b16 a[250:251], v74 offset:61440
v_mfma_f32_16x16x32_bf16 v[188:191], a[208:211], a[176:179], v[108:111]
v_exp_f32_e64 v139, v139
v_mfma_f32_16x16x32_bf16 v[188:191], a[212:215], a[180:183], v[188:191]
ds_read_b64_tr_b16 a[252:253], v75 offset:57344
v_mfma_f32_16x16x32_bf16 v[188:191], a[216:219], a[184:187], v[188:191]
v_exp_f32_e64 v140, v140
v_mfma_f32_16x16x32_bf16 v[188:191], a[220:223], a[188:191], v[188:191]
ds_read_b64_tr_b16 a[254:255], v75 offset:61440
s_waitcnt vmcnt(20) lgkmcnt(8)
s_barrier
v_mfma_f32_16x16x32_bf16 a[0:3], a[224:227], v[224:227], a[0:3]
v_exp_f32_e64 v141, v141
v_mfma_f32_16x16x32_bf16 a[32:35], a[224:227], v[232:235], a[32:35]
v_cvt_pk_bf16_f32 v136, v136, v137
v_cvt_pk_bf16_f32 v137, v138, v139
v_mfma_f32_16x16x32_bf16 a[64:67], a[224:227], v[240:243], a[64:67]
ds_read_b128 a[192:195], v64 offset:16384
v_mfma_f32_16x16x32_bf16 a[96:99], a[224:227], v[248:251], a[96:99]
v_exp_f32_e64 v142, v142
v_mfma_f32_16x16x32_bf16 a[4:7], a[228:231], v[224:227], a[4:7]
ds_read_b128 a[196:199], v65 offset:16384
v_mfma_f32_16x16x32_bf16 a[36:39], a[228:231], v[232:235], a[36:39]
v_exp_f32_e64 v143, v143
v_mfma_f32_16x16x32_bf16 a[68:71], a[228:231], v[240:243], a[68:71]
v_exp_f32_e64 v144, v144
v_mfma_f32_16x16x32_bf16 a[100:103], a[228:231], v[248:251], a[100:103]
v_cvt_pk_bf16_f32 v138, v140, v141
v_cvt_pk_bf16_f32 v139, v142, v143
v_mfma_f32_16x16x32_bf16 v[112:115], v[76:79], v[224:227], v[112:115]
ds_read_b128 a[200:203], v66 offset:16384
v_mfma_f32_16x16x32_bf16 a[8:11], a[232:235], v[224:227], a[8:11]
v_exp_f32_e64 v145, v145
v_mfma_f32_16x16x32_bf16 a[40:43], a[232:235], v[232:235], a[40:43]
ds_read_b128 a[204:207], v67 offset:16384
v_mfma_f32_16x16x32_bf16 a[72:75], a[232:235], v[240:243], a[72:75]
v_exp_f32_e64 v146, v146
v_mfma_f32_16x16x32_bf16 a[104:107], a[232:235], v[248:251], a[104:107]
v_exp_f32_e64 v147, v147
v_mfma_f32_16x16x32_bf16 a[12:15], a[236:239], v[224:227], a[12:15]
s_add_u32 m0, s30, 0
s_nop 0
buffer_load_dwordx4 v32, s[4:7], s25 offen offset:0 lds
v_mfma_f32_16x16x32_bf16 a[44:47], a[236:239], v[232:235], a[44:47]
v_exp_f32_e64 v148, v148
v_mfma_f32_16x16x32_bf16 a[76:79], a[236:239], v[240:243], a[76:79]
v_cvt_pk_bf16_f32 v144, v144, v145
v_cvt_pk_bf16_f32 v145, v146, v147
v_mfma_f32_16x16x32_bf16 a[108:111], a[236:239], v[248:251], a[108:111]
ds_read_b128 a[208:211], v64 offset:20480
v_mfma_f32_16x16x32_bf16 v[116:119], v[76:79], v[232:235], v[116:119]
v_exp_f32_e64 v149, v149
s_waitcnt lgkmcnt(5)
v_mfma_f32_16x16x32_bf16 a[16:19], a[240:243], v[224:227], a[16:19]
ds_read_b128 a[212:215], v65 offset:20480
v_mfma_f32_16x16x32_bf16 a[48:51], a[240:243], v[232:235], a[48:51]
v_exp_f32_e64 v150, v150
v_mfma_f32_16x16x32_bf16 a[80:83], a[240:243], v[240:243], a[80:83]
buffer_load_dwordx4 v33, s[4:7], s25 offen offset:1024 lds
v_mfma_f32_16x16x32_bf16 a[112:115], a[240:243], v[248:251], a[112:115]
v_exp_f32_e64 v151, v151
v_mfma_f32_16x16x32_bf16 a[20:23], a[244:247], v[224:227], a[20:23]
v_exp_f32_e64 v152, v152
v_mfma_f32_16x16x32_bf16 a[52:55], a[244:247], v[232:235], a[52:55]
v_cvt_pk_bf16_f32 v146, v148, v149
v_cvt_pk_bf16_f32 v147, v150, v151
v_mfma_f32_16x16x32_bf16 a[84:87], a[244:247], v[240:243], a[84:87]
ds_read_b128 a[216:219], v66 offset:20480
v_mfma_f32_16x16x32_bf16 a[116:119], a[244:247], v[248:251], a[116:119]
v_exp_f32_e64 v153, v153
v_mfma_f32_16x16x32_bf16 v[120:123], v[76:79], v[240:243], v[120:123]
ds_read_b128 a[220:223], v67 offset:20480
v_mfma_f32_16x16x32_bf16 a[24:27], a[248:251], v[224:227], a[24:27]
v_exp_f32_e64 v154, v154
v_mfma_f32_16x16x32_bf16 a[56:59], a[248:251], v[232:235], a[56:59]
buffer_load_dwordx4 v34, s[4:7], s25 offen offset:2048 lds
v_mfma_f32_16x16x32_bf16 a[88:91], a[248:251], v[240:243], a[88:91]
v_exp_f32_e64 v155, v155
v_mfma_f32_16x16x32_bf16 a[120:123], a[248:251], v[248:251], a[120:123]
v_exp_f32_e64 v156, v156
v_mfma_f32_16x16x32_bf16 a[28:31], a[252:255], v[224:227], a[28:31]
v_cvt_pk_bf16_f32 v152, v152, v153
v_cvt_pk_bf16_f32 v153, v154, v155
v_mfma_f32_16x16x32_bf16 a[60:63], a[252:255], v[232:235], a[60:63]
v_exp_f32_e64 v157, v157
v_mfma_f32_16x16x32_bf16 a[92:95], a[252:255], v[240:243], a[92:95]
buffer_load_dwordx4 v35, s[4:7], s25 offen offset:3072 lds
s_add_u32 s25, s25, 16384
v_mfma_f32_16x16x32_bf16 a[124:127], a[252:255], v[248:251], a[124:127]
v_exp_f32_e64 v158, v158
v_mfma_f32_16x16x32_bf16 v[124:127], v[76:79], v[248:251], v[124:127]
v_exp_f32_e64 v159, v159
s_waitcnt lgkmcnt(0)
v_mfma_f32_16x16x32_bf16 v[192:195], a[192:195], a[128:131], v[96:99]
v_exp_f32_e64 v160, v160
v_mfma_f32_16x16x32_bf16 v[192:195], a[196:199], a[132:135], v[192:195]
ds_read_b64_tr_b16 a[224:225], v68 offset:0
v_mfma_f32_16x16x32_bf16 v[192:195], a[200:203], a[136:139], v[192:195]
v_cvt_pk_bf16_f32 v154, v156, v157
v_cvt_pk_bf16_f32 v155, v158, v159
v_mfma_f32_16x16x32_bf16 v[192:195], a[204:207], a[140:143], v[192:195]
ds_read_b64_tr_b16 a[226:227], v68 offset:4096
v_mfma_f32_16x16x32_bf16 v[196:199], a[208:211], a[128:131], v[96:99]
v_exp_f32_e64 v161, v161
v_mfma_f32_16x16x32_bf16 v[196:199], a[212:215], a[132:135], v[196:199]
ds_read_b64_tr_b16 a[228:229], v69 offset:0
v_mfma_f32_16x16x32_bf16 v[196:199], a[216:219], a[136:139], v[196:199]
v_exp_f32_e64 v162, v162
s_mov_b32 m0, s91
s_nop 0
buffer_load_dwordx4 v2, s[12:15], s94 offen offset:1024 nt lds
v_mfma_f32_16x16x32_bf16 v[196:199], a[220:223], a[140:143], v[196:199]
ds_read_b64_tr_b16 a[230:231], v69 offset:4096
v_mfma_f32_16x16x32_bf16 v[200:203], a[192:195], a[144:147], v[100:103]
v_exp_f32_e64 v163, v163
v_mfma_f32_16x16x32_bf16 v[200:203], a[196:199], a[148:151], v[200:203]
ds_read_b64_tr_b16 a[232:233], v70 offset:0
v_mfma_f32_16x16x32_bf16 v[200:203], a[200:203], a[152:155], v[200:203]
v_exp_f32_e64 v164, v164
v_mfma_f32_16x16x32_bf16 v[200:203], a[204:207], a[156:159], v[200:203]
ds_read_b64_tr_b16 a[234:235], v70 offset:4096
v_mfma_f32_16x16x32_bf16 v[204:207], a[208:211], a[144:147], v[100:103]
v_exp_f32_e64 v165, v165
v_mfma_f32_16x16x32_bf16 v[204:207], a[212:215], a[148:151], v[204:207]
ds_read_b64_tr_b16 a[236:237], v71 offset:0
v_mfma_f32_16x16x32_bf16 v[204:207], a[216:219], a[152:155], v[204:207]
v_cvt_pk_bf16_f32 v160, v160, v161
v_cvt_pk_bf16_f32 v161, v162, v163
v_mfma_f32_16x16x32_bf16 v[204:207], a[220:223], a[156:159], v[204:207]
ds_read_b64_tr_b16 a[238:239], v71 offset:4096
v_mfma_f32_16x16x32_bf16 v[208:211], a[192:195], a[160:163], v[104:107]
v_exp_f32_e64 v166, v166
v_mfma_f32_16x16x32_bf16 v[208:211], a[196:199], a[164:167], v[208:211]
ds_read_b64_tr_b16 a[240:241], v72 offset:0
v_mfma_f32_16x16x32_bf16 v[208:211], a[200:203], a[168:171], v[208:211]
v_exp_f32_e64 v167, v167
v_mfma_f32_16x16x32_bf16 v[208:211], a[204:207], a[172:175], v[208:211]
ds_read_b64_tr_b16 a[242:243], v72 offset:4096
v_mfma_f32_16x16x32_bf16 v[212:215], a[208:211], a[160:163], v[104:107]
v_exp_f32_e64 v168, v168
v_mfma_f32_16x16x32_bf16 v[212:215], a[212:215], a[164:167], v[212:215]
ds_read_b64_tr_b16 a[244:245], v73 offset:0
v_mfma_f32_16x16x32_bf16 v[212:215], a[216:219], a[168:171], v[212:215]
v_exp_f32_e64 v169, v169
v_mfma_f32_16x16x32_bf16 v[212:215], a[220:223], a[172:175], v[212:215]
ds_read_b64_tr_b16 a[246:247], v73 offset:4096
v_mfma_f32_16x16x32_bf16 v[216:219], a[192:195], a[176:179], v[108:111]
v_cvt_pk_bf16_f32 v162, v164, v165
v_cvt_pk_bf16_f32 v163, v166, v167
v_mfma_f32_16x16x32_bf16 v[216:219], a[196:199], a[180:183], v[216:219]
ds_read_b64_tr_b16 a[248:249], v74 offset:0
v_mfma_f32_16x16x32_bf16 v[216:219], a[200:203], a[184:187], v[216:219]
v_exp_f32_e64 v170, v170
v_mfma_f32_16x16x32_bf16 v[216:219], a[204:207], a[188:191], v[216:219]
ds_read_b64_tr_b16 a[250:251], v74 offset:4096
v_mfma_f32_16x16x32_bf16 v[220:223], a[208:211], a[176:179], v[108:111]
v_exp_f32_e64 v171, v171
v_mfma_f32_16x16x32_bf16 v[220:223], a[212:215], a[180:183], v[220:223]
ds_read_b64_tr_b16 a[252:253], v75 offset:0
v_mfma_f32_16x16x32_bf16 v[220:223], a[216:219], a[184:187], v[220:223]
v_exp_f32_e64 v172, v172
v_mfma_f32_16x16x32_bf16 v[220:223], a[220:223], a[188:191], v[220:223]
ds_read_b64_tr_b16 a[254:255], v75 offset:4096
s_waitcnt lgkmcnt(8)
v_mfma_f32_16x16x32_bf16 a[0:3], a[224:227], v[128:131], a[0:3]
v_exp_f32_e64 v173, v173
v_mfma_f32_16x16x32_bf16 a[32:35], a[224:227], v[136:139], a[32:35]
v_cvt_pk_bf16_f32 v168, v168, v169
v_cvt_pk_bf16_f32 v169, v170, v171
v_mfma_f32_16x16x32_bf16 a[64:67], a[224:227], v[144:147], a[64:67]
ds_read_b128 a[192:195], v64 offset:24576
v_mfma_f32_16x16x32_bf16 a[96:99], a[224:227], v[152:155], a[96:99]
v_exp_f32_e64 v174, v174
v_mfma_f32_16x16x32_bf16 a[4:7], a[228:231], v[128:131], a[4:7]
ds_read_b128 a[196:199], v65 offset:24576
v_mfma_f32_16x16x32_bf16 a[36:39], a[228:231], v[136:139], a[36:39]
v_exp_f32_e64 v175, v175
v_mfma_f32_16x16x32_bf16 a[68:71], a[228:231], v[144:147], a[68:71]
v_exp_f32_e64 v176, v176
v_mfma_f32_16x16x32_bf16 a[100:103], a[228:231], v[152:155], a[100:103]
v_cvt_pk_bf16_f32 v170, v172, v173
v_cvt_pk_bf16_f32 v171, v174, v175
v_mfma_f32_16x16x32_bf16 v[112:115], v[76:79], v[128:131], v[112:115]
ds_read_b128 a[200:203], v66 offset:24576
v_mfma_f32_16x16x32_bf16 a[8:11], a[232:235], v[128:131], a[8:11]
v_exp_f32_e64 v177, v177
v_mfma_f32_16x16x32_bf16 a[40:43], a[232:235], v[136:139], a[40:43]
ds_read_b128 a[204:207], v67 offset:24576
v_mfma_f32_16x16x32_bf16 a[72:75], a[232:235], v[144:147], a[72:75]
v_exp_f32_e64 v178, v178
v_mfma_f32_16x16x32_bf16 a[104:107], a[232:235], v[152:155], a[104:107]
v_exp_f32_e64 v179, v179
v_mfma_f32_16x16x32_bf16 a[12:15], a[236:239], v[128:131], a[12:15]
s_add_u32 m0, s30, 114688
s_nop 0
buffer_load_dwordx4 v36, s[8:11], s26 offen offset:0 lds
v_mfma_f32_16x16x32_bf16 a[44:47], a[236:239], v[136:139], a[44:47]
v_exp_f32_e64 v180, v180
v_mfma_f32_16x16x32_bf16 a[76:79], a[236:239], v[144:147], a[76:79]
v_cvt_pk_bf16_f32 v176, v176, v177
v_cvt_pk_bf16_f32 v177, v178, v179
v_mfma_f32_16x16x32_bf16 a[108:111], a[236:239], v[152:155], a[108:111]
ds_read_b128 a[208:211], v64 offset:28672
v_mfma_f32_16x16x32_bf16 v[116:119], v[76:79], v[136:139], v[116:119]
v_exp_f32_e64 v181, v181
s_waitcnt lgkmcnt(5)
v_mfma_f32_16x16x32_bf16 a[16:19], a[240:243], v[128:131], a[16:19]
ds_read_b128 a[212:215], v65 offset:28672
v_mfma_f32_16x16x32_bf16 a[48:51], a[240:243], v[136:139], a[48:51]
v_exp_f32_e64 v182, v182
v_mfma_f32_16x16x32_bf16 a[80:83], a[240:243], v[144:147], a[80:83]
buffer_load_dwordx4 v37, s[8:11], s26 offen offset:1024 lds
v_mfma_f32_16x16x32_bf16 a[112:115], a[240:243], v[152:155], a[112:115]
v_exp_f32_e64 v183, v183
v_mfma_f32_16x16x32_bf16 a[20:23], a[244:247], v[128:131], a[20:23]
v_exp_f32_e64 v184, v184
v_mfma_f32_16x16x32_bf16 a[52:55], a[244:247], v[136:139], a[52:55]
v_cvt_pk_bf16_f32 v178, v180, v181
v_cvt_pk_bf16_f32 v179, v182, v183
v_mfma_f32_16x16x32_bf16 a[84:87], a[244:247], v[144:147], a[84:87]
ds_read_b128 a[216:219], v66 offset:28672
v_mfma_f32_16x16x32_bf16 a[116:119], a[244:247], v[152:155], a[116:119]
v_exp_f32_e64 v185, v185
v_mfma_f32_16x16x32_bf16 v[120:123], v[76:79], v[144:147], v[120:123]
ds_read_b128 a[220:223], v67 offset:28672
v_mfma_f32_16x16x32_bf16 a[24:27], a[248:251], v[128:131], a[24:27]
v_exp_f32_e64 v186, v186
v_mfma_f32_16x16x32_bf16 a[56:59], a[248:251], v[136:139], a[56:59]
buffer_load_dwordx4 v36, s[8:11], s26 offen offset:2048 lds
v_mfma_f32_16x16x32_bf16 a[88:91], a[248:251], v[144:147], a[88:91]
v_exp_f32_e64 v187, v187
v_mfma_f32_16x16x32_bf16 a[120:123], a[248:251], v[152:155], a[120:123]
v_exp_f32_e64 v188, v188
v_mfma_f32_16x16x32_bf16 a[28:31], a[252:255], v[128:131], a[28:31]
v_cvt_pk_bf16_f32 v184, v184, v185
v_cvt_pk_bf16_f32 v185, v186, v187
v_mfma_f32_16x16x32_bf16 a[60:63], a[252:255], v[136:139], a[60:63]
v_exp_f32_e64 v189, v189
v_mfma_f32_16x16x32_bf16 a[92:95], a[252:255], v[144:147], a[92:95]
buffer_load_dwordx4 v37, s[8:11], s26 offen offset:3072 lds
s_add_u32 s26, s26, 16384
v_mfma_f32_16x16x32_bf16 a[124:127], a[252:255], v[152:155], a[124:127]
v_exp_f32_e64 v190, v190
v_mfma_f32_16x16x32_bf16 v[124:127], v[76:79], v[152:155], v[124:127]
v_exp_f32_e64 v191, v191
s_waitcnt lgkmcnt(0)
v_mfma_f32_16x16x32_bf16 v[224:227], a[192:195], a[128:131], v[96:99]
v_exp_f32_e64 v192, v192
v_mfma_f32_16x16x32_bf16 v[224:227], a[196:199], a[132:135], v[224:227]
ds_read_b64_tr_b16 a[224:225], v68 offset:8192
v_mfma_f32_16x16x32_bf16 v[224:227], a[200:203], a[136:139], v[224:227]
v_cvt_pk_bf16_f32 v186, v188, v189
v_cvt_pk_bf16_f32 v187, v190, v191
v_mfma_f32_16x16x32_bf16 v[224:227], a[204:207], a[140:143], v[224:227]
ds_read_b64_tr_b16 a[226:227], v68 offset:12288
v_mfma_f32_16x16x32_bf16 v[228:231], a[208:211], a[128:131], v[96:99]
v_exp_f32_e64 v193, v193
v_mfma_f32_16x16x32_bf16 v[228:231], a[212:215], a[132:135], v[228:231]
ds_read_b64_tr_b16 a[228:229], v69 offset:8192
v_mfma_f32_16x16x32_bf16 v[228:231], a[216:219], a[136:139], v[228:231]
v_exp_f32_e64 v194, v194
s_mov_b32 m0, s91
s_nop 0
buffer_load_dwordx4 v3, s[12:15], s94 offen offset:2048 nt lds
v_mfma_f32_16x16x32_bf16 v[228:231], a[220:223], a[140:143], v[228:231]
ds_read_b64_tr_b16 a[230:231], v69 offset:12288
v_mfma_f32_16x16x32_bf16 v[232:235], a[192:195], a[144:147], v[100:103]
v_exp_f32_e64 v195, v195
v_mfma_f32_16x16x32_bf16 v[232:235], a[196:199], a[148:151], v[232:235]
ds_read_b64_tr_b16 a[232:233], v70 offset:8192
v_mfma_f32_16x16x32_bf16 v[232:235], a[200:203], a[152:155], v[232:235]
v_exp_f32_e64 v196, v196
v_mfma_f32_16x16x32_bf16 v[232:235], a[204:207], a[156:159], v[232:235]
ds_read_b64_tr_b16 a[234:235], v70 offset:12288
v_mfma_f32_16x16x32_bf16 v[236:239], a[208:211], a[144:147], v[100:103]
v_exp_f32_e64 v197, v197
v_mfma_f32_16x16x32_bf16 v[236:239], a[212:215], a[148:151], v[236:239]
ds_read_b64_tr_b16 a[236:237], v71 offset:8192
v_mfma_f32_16x16x32_bf16 v[236:239], a[216:219], a[152:155], v[236:239]
v_cvt_pk_bf16_f32 v192, v192, v193
v_cvt_pk_bf16_f32 v193, v194, v195
v_mfma_f32_16x16x32_bf16 v[236:239], a[220:223], a[156:159], v[236:239]
ds_read_b64_tr_b16 a[238:239], v71 offset:12288
v_mfma_f32_16x16x32_bf16 v[240:243], a[192:195], a[160:163], v[104:107]
v_exp_f32_e64 v198, v198
v_mfma_f32_16x16x32_bf16 v[240:243], a[196:199], a[164:167], v[240:243]
ds_read_b64_tr_b16 a[240:241], v72 offset:8192
v_mfma_f32_16x16x32_bf16 v[240:243], a[200:203], a[168:171], v[240:243]
v_exp_f32_e64 v199, v199
v_mfma_f32_16x16x32_bf16 v[240:243], a[204:207], a[172:175], v[240:243]
ds_read_b64_tr_b16 a[242:243], v72 offset:12288
v_mfma_f32_16x16x32_bf16 v[244:247], a[208:211], a[160:163], v[104:107]
v_exp_f32_e64 v200, v200
v_mfma_f32_16x16x32_bf16 v[244:247], a[212:215], a[164:167], v[244:247]
ds_read_b64_tr_b16 a[244:245], v73 offset:8192
v_mfma_f32_16x16x32_bf16 v[244:247], a[216:219], a[168:171], v[244:247]
v_exp_f32_e64 v201, v201
v_mfma_f32_16x16x32_bf16 v[244:247], a[220:223], a[172:175], v[244:247]
ds_read_b64_tr_b16 a[246:247], v73 offset:12288
v_mfma_f32_16x16x32_bf16 v[248:251], a[192:195], a[176:179], v[108:111]
v_cvt_pk_bf16_f32 v194, v196, v197
v_cvt_pk_bf16_f32 v195, v198, v199
v_mfma_f32_16x16x32_bf16 v[248:251], a[196:199], a[180:183], v[248:251]
ds_read_b64_tr_b16 a[248:249], v74 offset:8192
v_mfma_f32_16x16x32_bf16 v[248:251], a[200:203], a[184:187], v[248:251]
v_exp_f32_e64 v202, v202
v_mfma_f32_16x16x32_bf16 v[248:251], a[204:207], a[188:191], v[248:251]
ds_read_b64_tr_b16 a[250:251], v74 offset:12288
v_mfma_f32_16x16x32_bf16 v[252:255], a[208:211], a[176:179], v[108:111]
v_exp_f32_e64 v203, v203
v_mfma_f32_16x16x32_bf16 v[252:255], a[212:215], a[180:183], v[252:255]
ds_read_b64_tr_b16 a[252:253], v75 offset:8192
v_mfma_f32_16x16x32_bf16 v[252:255], a[216:219], a[184:187], v[252:255]
v_exp_f32_e64 v204, v204
v_mfma_f32_16x16x32_bf16 v[252:255], a[220:223], a[188:191], v[252:255]
ds_read_b64_tr_b16 a[254:255], v75 offset:12288
s_waitcnt vmcnt(22) lgkmcnt(8)
s_barrier
v_mfma_f32_16x16x32_bf16 a[0:3], a[224:227], v[160:163], a[0:3]
v_exp_f32_e64 v205, v205
v_mfma_f32_16x16x32_bf16 a[32:35], a[224:227], v[168:171], a[32:35]
v_cvt_pk_bf16_f32 v200, v200, v201
v_cvt_pk_bf16_f32 v201, v202, v203
v_mfma_f32_16x16x32_bf16 a[64:67], a[224:227], v[176:179], a[64:67]
ds_read_b128 a[192:195], v64 offset:32768
v_mfma_f32_16x16x32_bf16 a[96:99], a[224:227], v[184:187], a[96:99]
v_exp_f32_e64 v206, v206
v_mfma_f32_16x16x32_bf16 a[4:7], a[228:231], v[160:163], a[4:7]
ds_read_b128 a[196:199], v65 offset:32768
v_mfma_f32_16x16x32_bf16 a[36:39], a[228:231], v[168:171], a[36:39]
v_exp_f32_e64 v207, v207
v_mfma_f32_16x16x32_bf16 a[68:71], a[228:231], v[176:179], a[68:71]
v_exp_f32_e64 v208, v208
v_mfma_f32_16x16x32_bf16 a[100:103], a[228:231], v[184:187], a[100:103]
v_cvt_pk_bf16_f32 v202, v204, v205
v_cvt_pk_bf16_f32 v203, v206, v207
v_mfma_f32_16x16x32_bf16 v[112:115], v[76:79], v[160:163], v[112:115]
ds_read_b128 a[200:203], v66 offset:32768
v_mfma_f32_16x16x32_bf16 a[8:11], a[232:235], v[160:163], a[8:11]
v_exp_f32_e64 v209, v209
v_mfma_f32_16x16x32_bf16 a[40:43], a[232:235], v[168:171], a[40:43]
ds_read_b128 a[204:207], v67 offset:32768
v_mfma_f32_16x16x32_bf16 a[72:75], a[232:235], v[176:179], a[72:75]
v_exp_f32_e64 v210, v210
v_mfma_f32_16x16x32_bf16 a[104:107], a[232:235], v[184:187], a[104:107]
v_exp_f32_e64 v211, v211
v_mfma_f32_16x16x32_bf16 a[12:15], a[236:239], v[160:163], a[12:15]
s_add_u32 m0, s30, 16384
s_nop 0
buffer_load_dwordx4 v32, s[4:7], s25 offen offset:0 lds
v_mfma_f32_16x16x32_bf16 a[44:47], a[236:239], v[168:171], a[44:47]
v_exp_f32_e64 v212, v212
v_mfma_f32_16x16x32_bf16 a[76:79], a[236:239], v[176:179], a[76:79]
v_cvt_pk_bf16_f32 v208, v208, v209
v_cvt_pk_bf16_f32 v209, v210, v211
v_mfma_f32_16x16x32_bf16 a[108:111], a[236:239], v[184:187], a[108:111]
ds_read_b128 a[208:211], v64 offset:36864
v_mfma_f32_16x16x32_bf16 v[116:119], v[76:79], v[168:171], v[116:119]
v_exp_f32_e64 v213, v213
s_waitcnt lgkmcnt(5)
v_mfma_f32_16x16x32_bf16 a[16:19], a[240:243], v[160:163], a[16:19]
ds_read_b128 a[212:215], v65 offset:36864
v_mfma_f32_16x16x32_bf16 a[48:51], a[240:243], v[168:171], a[48:51]
v_exp_f32_e64 v214, v214
v_mfma_f32_16x16x32_bf16 a[80:83], a[240:243], v[176:179], a[80:83]
buffer_load_dwordx4 v33, s[4:7], s25 offen offset:1024 lds
v_mfma_f32_16x16x32_bf16 a[112:115], a[240:243], v[184:187], a[112:115]
v_exp_f32_e64 v215, v215
v_mfma_f32_16x16x32_bf16 a[20:23], a[244:247], v[160:163], a[20:23]
v_exp_f32_e64 v216, v216
v_mfma_f32_16x16x32_bf16 a[52:55], a[244:247], v[168:171], a[52:55]
v_cvt_pk_bf16_f32 v210, v212, v213
v_cvt_pk_bf16_f32 v211, v214, v215
v_mfma_f32_16x16x32_bf16 a[84:87], a[244:247], v[176:179], a[84:87]
ds_read_b128 a[216:219], v66 offset:36864
v_mfma_f32_16x16x32_bf16 a[116:119], a[244:247], v[184:187], a[116:119]
v_exp_f32_e64 v217, v217
v_mfma_f32_16x16x32_bf16 v[120:123], v[76:79], v[176:179], v[120:123]
ds_read_b128 a[220:223], v67 offset:36864
v_mfma_f32_16x16x32_bf16 a[24:27], a[248:251], v[160:163], a[24:27]
v_exp_f32_e64 v218, v218
v_mfma_f32_16x16x32_bf16 a[56:59], a[248:251], v[168:171], a[56:59]
buffer_load_dwordx4 v34, s[4:7], s25 offen offset:2048 lds
v_mfma_f32_16x16x32_bf16 a[88:91], a[248:251], v[176:179], a[88:91]
v_exp_f32_e64 v219, v219
v_mfma_f32_16x16x32_bf16 a[120:123], a[248:251], v[184:187], a[120:123]
v_exp_f32_e64 v220, v220
v_mfma_f32_16x16x32_bf16 a[28:31], a[252:255], v[160:163], a[28:31]
v_cvt_pk_bf16_f32 v216, v216, v217
v_cvt_pk_bf16_f32 v217, v218, v219
v_mfma_f32_16x16x32_bf16 a[60:63], a[252:255], v[168:171], a[60:63]
v_exp_f32_e64 v221, v221
v_mfma_f32_16x16x32_bf16 a[92:95], a[252:255], v[176:179], a[92:95]
buffer_load_dwordx4 v35, s[4:7], s25 offen offset:3072 lds
s_add_u32 s25, s25, 16384
v_mfma_f32_16x16x32_bf16 a[124:127], a[252:255], v[184:187], a[124:127]
v_exp_f32_e64 v222, v222
v_mfma_f32_16x16x32_bf16 v[124:127], v[76:79], v[184:187], v[124:127]
v_exp_f32_e64 v223, v223
s_waitcnt lgkmcnt(0)
v_mfma_f32_16x16x32_bf16 v[128:131], a[192:195], a[128:131], v[96:99]
v_exp_f32_e64 v224, v224
v_mfma_f32_16x16x32_bf16 v[128:131], a[196:199], a[132:135], v[128:131]
ds_read_b64_tr_b16 a[224:225], v68 offset:16384
v_mfma_f32_16x16x32_bf16 v[128:131], a[200:203], a[136:139], v[128:131]
v_cvt_pk_bf16_f32 v218, v220, v221
v_cvt_pk_bf16_f32 v219, v222, v223
v_mfma_f32_16x16x32_bf16 v[128:131], a[204:207], a[140:143], v[128:131]
ds_read_b64_tr_b16 a[226:227], v68 offset:20480
v_mfma_f32_16x16x32_bf16 v[132:135], a[208:211], a[128:131], v[96:99]
v_exp_f32_e64 v225, v225
v_mfma_f32_16x16x32_bf16 v[132:135], a[212:215], a[132:135], v[132:135]
ds_read_b64_tr_b16 a[228:229], v69 offset:16384
v_mfma_f32_16x16x32_bf16 v[132:135], a[216:219], a[136:139], v[132:135]
v_exp_f32_e64 v226, v226
v_mfma_f32_16x16x32_bf16 v[132:135], a[220:223], a[140:143], v[132:135]
ds_read_b64_tr_b16 a[230:231], v69 offset:20480
v_mfma_f32_16x16x32_bf16 v[136:139], a[192:195], a[144:147], v[100:103]
v_exp_f32_e64 v227, v227
v_mfma_f32_16x16x32_bf16 v[136:139], a[196:199], a[148:151], v[136:139]
ds_read_b64_tr_b16 a[232:233], v70 offset:16384
v_mfma_f32_16x16x32_bf16 v[136:139], a[200:203], a[152:155], v[136:139]
v_exp_f32_e64 v228, v228
v_mfma_f32_16x16x32_bf16 v[136:139], a[204:207], a[156:159], v[136:139]
ds_read_b64_tr_b16 a[234:235], v70 offset:20480
v_mfma_f32_16x16x32_bf16 v[140:143], a[208:211], a[144:147], v[100:103]
v_exp_f32_e64 v229, v229
v_mfma_f32_16x16x32_bf16 v[140:143], a[212:215], a[148:151], v[140:143]
ds_read_b64_tr_b16 a[236:237], v71 offset:16384
v_mfma_f32_16x16x32_bf16 v[140:143], a[216:219], a[152:155], v[140:143]
v_cvt_pk_bf16_f32 v224, v224, v225
v_cvt_pk_bf16_f32 v225, v226, v227
v_mfma_f32_16x16x32_bf16 v[140:143], a[220:223], a[156:159], v[140:143]
ds_read_b64_tr_b16 a[238:239], v71 offset:20480
v_mfma_f32_16x16x32_bf16 v[144:147], a[192:195], a[160:163], v[104:107]
v_exp_f32_e64 v230, v230
v_mfma_f32_16x16x32_bf16 v[144:147], a[196:199], a[164:167], v[144:147]
ds_read_b64_tr_b16 a[240:241], v72 offset:16384
v_mfma_f32_16x16x32_bf16 v[144:147], a[200:203], a[168:171], v[144:147]
v_exp_f32_e64 v231, v231
v_mfma_f32_16x16x32_bf16 v[144:147], a[204:207], a[172:175], v[144:147]
ds_read_b64_tr_b16 a[242:243], v72 offset:20480
v_mfma_f32_16x16x32_bf16 v[148:151], a[208:211], a[160:163], v[104:107]
v_exp_f32_e64 v232, v232
v_mfma_f32_16x16x32_bf16 v[148:151], a[212:215], a[164:167], v[148:151]
ds_read_b64_tr_b16 a[244:245], v73 offset:16384
v_mfma_f32_16x16x32_bf16 v[148:151], a[216:219], a[168:171], v[148:151]
v_exp_f32_e64 v233, v233
v_mfma_f32_16x16x32_bf16 v[148:151], a[220:223], a[172:175], v[148:151]
ds_read_b64_tr_b16 a[246:247], v73 offset:20480
v_mfma_f32_16x16x32_bf16 v[152:155], a[192:195], a[176:179], v[108:111]
v_cvt_pk_bf16_f32 v226, v228, v229
v_cvt_pk_bf16_f32 v227, v230, v231
v_mfma_f32_16x16x32_bf16 v[152:155], a[196:199], a[180:183], v[152:155]
ds_read_b64_tr_b16 a[248:249], v74 offset:16384
v_mfma_f32_16x16x32_bf16 v[152:155], a[200:203], a[184:187], v[152:155]
v_exp_f32_e64 v234, v234
v_mfma_f32_16x16x32_bf16 v[152:155], a[204:207], a[188:191], v[152:155]
ds_read_b64_tr_b16 a[250:251], v74 offset:20480
v_mfma_f32_16x16x32_bf16 v[156:159], a[208:211], a[176:179], v[108:111]
v_exp_f32_e64 v235, v235
v_mfma_f32_16x16x32_bf16 v[156:159], a[212:215], a[180:183], v[156:159]
ds_read_b64_tr_b16 a[252:253], v75 offset:16384
v_mfma_f32_16x16x32_bf16 v[156:159], a[216:219], a[184:187], v[156:159]
v_exp_f32_e64 v236, v236
v_mfma_f32_16x16x32_bf16 v[156:159], a[220:223], a[188:191], v[156:159]
ds_read_b64_tr_b16 a[254:255], v75 offset:20480
s_waitcnt lgkmcnt(8)
v_mfma_f32_16x16x32_bf16 a[0:3], a[224:227], v[192:195], a[0:3]
v_exp_f32_e64 v237, v237
v_mfma_f32_16x16x32_bf16 a[32:35], a[224:227], v[200:203], a[32:35]
v_cvt_pk_bf16_f32 v232, v232, v233
v_cvt_pk_bf16_f32 v233, v234, v235
v_mfma_f32_16x16x32_bf16 a[64:67], a[224:227], v[208:211], a[64:67]
ds_read_b128 a[192:195], v64 offset:40960
v_mfma_f32_16x16x32_bf16 a[96:99], a[224:227], v[216:219], a[96:99]
v_exp_f32_e64 v238, v238
v_mfma_f32_16x16x32_bf16 a[4:7], a[228:231], v[192:195], a[4:7]
ds_read_b128 a[196:199], v65 offset:40960
v_mfma_f32_16x16x32_bf16 a[36:39], a[228:231], v[200:203], a[36:39]
v_exp_f32_e64 v239, v239
v_mfma_f32_16x16x32_bf16 a[68:71], a[228:231], v[208:211], a[68:71]
v_exp_f32_e64 v240, v240
v_mfma_f32_16x16x32_bf16 a[100:103], a[228:231], v[216:219], a[100:103]
v_cvt_pk_bf16_f32 v234, v236, v237
v_cvt_pk_bf16_f32 v235, v238, v239
v_mfma_f32_16x16x32_bf16 v[112:115], v[76:79], v[192:195], v[112:115]
ds_read_b128 a[200:203], v66 offset:40960
v_mfma_f32_16x16x32_bf16 a[8:11], a[232:235], v[192:195], a[8:11]
v_exp_f32_e64 v241, v241
v_mfma_f32_16x16x32_bf16 a[40:43], a[232:235], v[200:203], a[40:43]
ds_read_b128 a[204:207], v67 offset:40960
v_mfma_f32_16x16x32_bf16 a[72:75], a[232:235], v[208:211], a[72:75]
v_exp_f32_e64 v242, v242
v_mfma_f32_16x16x32_bf16 a[104:107], a[232:235], v[216:219], a[104:107]
v_exp_f32_e64 v243, v243
v_mfma_f32_16x16x32_bf16 a[12:15], a[236:239], v[192:195], a[12:15]
s_add_u32 m0, s30, 65536
s_nop 0
buffer_load_dwordx4 v36, s[8:11], s26 offen offset:0 lds
v_mfma_f32_16x16x32_bf16 a[44:47], a[236:239], v[200:203], a[44:47]
v_exp_f32_e64 v244, v244
v_mfma_f32_16x16x32_bf16 a[76:79], a[236:239], v[208:211], a[76:79]
v_cvt_pk_bf16_f32 v240, v240, v241
v_cvt_pk_bf16_f32 v241, v242, v243
v_mfma_f32_16x16x32_bf16 a[108:111], a[236:239], v[216:219], a[108:111]
ds_read_b128 a[208:211], v64 offset:45056
v_mfma_f32_16x16x32_bf16 v[116:119], v[76:79], v[200:203], v[116:119]
v_exp_f32_e64 v245, v245
s_waitcnt lgkmcnt(5)
v_mfma_f32_16x16x32_bf16 a[16:19], a[240:243], v[192:195], a[16:19]
ds_read_b128 a[212:215], v65 offset:45056
v_mfma_f32_16x16x32_bf16 a[48:51], a[240:243], v[200:203], a[48:51]
v_exp_f32_e64 v246, v246
v_mfma_f32_16x16x32_bf16 a[80:83], a[240:243], v[208:211], a[80:83]
buffer_load_dwordx4 v37, s[8:11], s26 offen offset:1024 lds
v_mfma_f32_16x16x32_bf16 a[112:115], a[240:243], v[216:219], a[112:115]
v_exp_f32_e64 v247, v247
v_mfma_f32_16x16x32_bf16 a[20:23], a[244:247], v[192:195], a[20:23]
v_exp_f32_e64 v248, v248
v_mfma_f32_16x16x32_bf16 a[52:55], a[244:247], v[200:203], a[52:55]
v_cvt_pk_bf16_f32 v242, v244, v245
v_cvt_pk_bf16_f32 v243, v246, v247
v_mfma_f32_16x16x32_bf16 a[84:87], a[244:247], v[208:211], a[84:87]
ds_read_b128 a[216:219], v66 offset:45056
v_mfma_f32_16x16x32_bf16 a[116:119], a[244:247], v[216:219], a[116:119]
v_exp_f32_e64 v249, v249
v_mfma_f32_16x16x32_bf16 v[120:123], v[76:79], v[208:211], v[120:123]
ds_read_b128 a[220:223], v67 offset:45056
v_mfma_f32_16x16x32_bf16 a[24:27], a[248:251], v[192:195], a[24:27]
v_exp_f32_e64 v250, v250
v_mfma_f32_16x16x32_bf16 a[56:59], a[248:251], v[200:203], a[56:59]
buffer_load_dwordx4 v36, s[8:11], s26 offen offset:2048 lds
v_mfma_f32_16x16x32_bf16 a[88:91], a[248:251], v[208:211], a[88:91]
v_exp_f32_e64 v251, v251
v_mfma_f32_16x16x32_bf16 a[120:123], a[248:251], v[216:219], a[120:123]
v_exp_f32_e64 v252, v252
v_mfma_f32_16x16x32_bf16 a[28:31], a[252:255], v[192:195], a[28:31]
v_cvt_pk_bf16_f32 v248, v248, v249
v_cvt_pk_bf16_f32 v249, v250, v251
v_mfma_f32_16x16x32_bf16 a[60:63], a[252:255], v[200:203], a[60:63]
v_exp_f32_e64 v253, v253
v_mfma_f32_16x16x32_bf16 a[92:95], a[252:255], v[208:211], a[92:95]
buffer_load_dwordx4 v37, s[8:11], s26 offen offset:3072 lds
s_add_u32 s26, s26, 16384
v_mfma_f32_16x16x32_bf16 a[124:127], a[252:255], v[216:219], a[124:127]
v_exp_f32_e64 v254, v254
v_mfma_f32_16x16x32_bf16 v[124:127], v[76:79], v[216:219], v[124:127]
v_exp_f32_e64 v255, v255
s_waitcnt lgkmcnt(0)
v_mfma_f32_16x16x32_bf16 v[160:163], a[192:195], a[128:131], v[96:99]
v_exp_f32_e64 v128, v128
v_mfma_f32_16x16x32_bf16 v[160:163], a[196:199], a[132:135], v[160:163]
ds_read_b64_tr_b16 a[224:225], v68 offset:24576
v_mfma_f32_16x16x32_bf16 v[160:163], a[200:203], a[136:139], v[160:163]
v_cvt_pk_bf16_f32 v250, v252, v253
v_cvt_pk_bf16_f32 v251, v254, v255
v_mfma_f32_16x16x32_bf16 v[160:163], a[204:207], a[140:143], v[160:163]
ds_read_b64_tr_b16 a[226:227], v68 offset:28672
v_mfma_f32_16x16x32_bf16 v[164:167], a[208:211], a[128:131], v[96:99]
v_exp_f32_e64 v129, v129
v_mfma_f32_16x16x32_bf16 v[164:167], a[212:215], a[132:135], v[164:167]
ds_read_b64_tr_b16 a[228:229], v69 offset:24576
v_mfma_f32_16x16x32_bf16 v[164:167], a[216:219], a[136:139], v[164:167]
v_exp_f32_e64 v130, v130
v_mfma_f32_16x16x32_bf16 v[164:167], a[220:223], a[140:143], v[164:167]
ds_read_b64_tr_b16 a[230:231], v69 offset:28672
v_mfma_f32_16x16x32_bf16 v[168:171], a[192:195], a[144:147], v[100:103]
v_exp_f32_e64 v131, v131
v_mfma_f32_16x16x32_bf16 v[168:171], a[196:199], a[148:151], v[168:171]
ds_read_b64_tr_b16 a[232:233], v70 offset:24576
v_mfma_f32_16x16x32_bf16 v[168:171], a[200:203], a[152:155], v[168:171]
v_exp_f32_e64 v132, v132
v_mfma_f32_16x16x32_bf16 v[168:171], a[204:207], a[156:159], v[168:171]
ds_read_b64_tr_b16 a[234:235], v70 offset:28672
v_mfma_f32_16x16x32_bf16 v[172:175], a[208:211], a[144:147], v[100:103]
v_exp_f32_e64 v133, v133
v_mfma_f32_16x16x32_bf16 v[172:175], a[212:215], a[148:151], v[172:175]
ds_read_b64_tr_b16 a[236:237], v71 offset:24576
v_mfma_f32_16x16x32_bf16 v[172:175], a[216:219], a[152:155], v[172:175]
v_cvt_pk_bf16_f32 v128, v128, v129
v_cvt_pk_bf16_f32 v129, v130, v131
v_mfma_f32_16x16x32_bf16 v[172:175], a[220:223], a[156:159], v[172:175]
ds_read_b64_tr_b16 a[238:239], v71 offset:28672
v_mfma_f32_16x16x32_bf16 v[176:179], a[192:195], a[160:163], v[104:107]
v_exp_f32_e64 v134, v134
v_mfma_f32_16x16x32_bf16 v[176:179], a[196:199], a[164:167], v[176:179]
ds_read_b64_tr_b16 a[240:241], v72 offset:24576
v_mfma_f32_16x16x32_bf16 v[176:179], a[200:203], a[168:171], v[176:179]
v_exp_f32_e64 v135, v135
v_mfma_f32_16x16x32_bf16 v[176:179], a[204:207], a[172:175], v[176:179]
ds_read_b64_tr_b16 a[242:243], v72 offset:28672
v_mfma_f32_16x16x32_bf16 v[180:183], a[208:211], a[160:163], v[104:107]
v_exp_f32_e64 v136, v136
v_mfma_f32_16x16x32_bf16 v[180:183], a[212:215], a[164:167], v[180:183]
ds_read_b64_tr_b16 a[244:245], v73 offset:24576
v_mfma_f32_16x16x32_bf16 v[180:183], a[216:219], a[168:171], v[180:183]
v_exp_f32_e64 v137, v137
v_mfma_f32_16x16x32_bf16 v[180:183], a[220:223], a[172:175], v[180:183]
ds_read_b64_tr_b16 a[246:247], v73 offset:28672
v_mfma_f32_16x16x32_bf16 v[184:187], a[192:195], a[176:179], v[108:111]
v_cvt_pk_bf16_f32 v130, v132, v133
v_cvt_pk_bf16_f32 v131, v134, v135
v_mfma_f32_16x16x32_bf16 v[184:187], a[196:199], a[180:183], v[184:187]
ds_read_b64_tr_b16 a[248:249], v74 offset:24576
v_mfma_f32_16x16x32_bf16 v[184:187], a[200:203], a[184:187], v[184:187]
v_exp_f32_e64 v138, v138
v_mfma_f32_16x16x32_bf16 v[184:187], a[204:207], a[188:191], v[184:187]
ds_read_b64_tr_b16 a[250:251], v74 offset:28672
v_mfma_f32_16x16x32_bf16 v[188:191], a[208:211], a[176:179], v[108:111]
v_exp_f32_e64 v139, v139
v_mfma_f32_16x16x32_bf16 v[188:191], a[212:215], a[180:183], v[188:191]
ds_read_b64_tr_b16 a[252:253], v75 offset:24576
v_mfma_f32_16x16x32_bf16 v[188:191], a[216:219], a[184:187], v[188:191]
v_exp_f32_e64 v140, v140
v_mfma_f32_16x16x32_bf16 v[188:191], a[220:223], a[188:191], v[188:191]
ds_read_b64_tr_b16 a[254:255], v75 offset:28672
s_waitcnt vmcnt(19) lgkmcnt(8)
s_barrier
v_mfma_f32_16x16x32_bf16 a[0:3], a[224:227], v[224:227], a[0:3]
v_exp_f32_e64 v141, v141
v_mfma_f32_16x16x32_bf16 a[32:35], a[224:227], v[232:235], a[32:35]
v_cvt_pk_bf16_f32 v136, v136, v137
v_cvt_pk_bf16_f32 v137, v138, v139
v_mfma_f32_16x16x32_bf16 a[64:67], a[224:227], v[240:243], a[64:67]
ds_read_b128 a[192:195], v64 offset:49152
v_mfma_f32_16x16x32_bf16 a[96:99], a[224:227], v[248:251], a[96:99]
v_exp_f32_e64 v142, v142
v_mfma_f32_16x16x32_bf16 a[4:7], a[228:231], v[224:227], a[4:7]
ds_read_b128 a[196:199], v65 offset:49152
v_mfma_f32_16x16x32_bf16 a[36:39], a[228:231], v[232:235], a[36:39]
v_exp_f32_e64 v143, v143
v_mfma_f32_16x16x32_bf16 a[68:71], a[228:231], v[240:243], a[68:71]
v_exp_f32_e64 v144, v144
v_mfma_f32_16x16x32_bf16 a[100:103], a[228:231], v[248:251], a[100:103]
v_cvt_pk_bf16_f32 v138, v140, v141
v_cvt_pk_bf16_f32 v139, v142, v143
v_mfma_f32_16x16x32_bf16 v[112:115], v[76:79], v[224:227], v[112:115]
ds_read_b128 a[200:203], v66 offset:49152
v_mfma_f32_16x16x32_bf16 a[8:11], a[232:235], v[224:227], a[8:11]
v_exp_f32_e64 v145, v145
v_mfma_f32_16x16x32_bf16 a[40:43], a[232:235], v[232:235], a[40:43]
ds_read_b128 a[204:207], v67 offset:49152
v_mfma_f32_16x16x32_bf16 a[72:75], a[232:235], v[240:243], a[72:75]
v_exp_f32_e64 v146, v146
v_mfma_f32_16x16x32_bf16 a[104:107], a[232:235], v[248:251], a[104:107]
v_exp_f32_e64 v147, v147
v_mfma_f32_16x16x32_bf16 a[12:15], a[236:239], v[224:227], a[12:15]
s_add_u32 m0, s30, 32768
s_nop 0
buffer_load_dwordx4 v32, s[4:7], s25 offen offset:0 lds
v_mfma_f32_16x16x32_bf16 a[44:47], a[236:239], v[232:235], a[44:47]
v_exp_f32_e64 v148, v148
v_mfma_f32_16x16x32_bf16 a[76:79], a[236:239], v[240:243], a[76:79]
v_cvt_pk_bf16_f32 v144, v144, v145
v_cvt_pk_bf16_f32 v145, v146, v147
v_mfma_f32_16x16x32_bf16 a[108:111], a[236:239], v[248:251], a[108:111]
ds_read_b128 a[208:211], v64 offset:53248
v_mfma_f32_16x16x32_bf16 v[116:119], v[76:79], v[232:235], v[116:119]
v_exp_f32_e64 v149, v149
s_waitcnt lgkmcnt(5)
v_mfma_f32_16x16x32_bf16 a[16:19], a[240:243], v[224:227], a[16:19]
ds_read_b128 a[212:215], v65 offset:53248
v_mfma_f32_16x16x32_bf16 a[48:51], a[240:243], v[232:235], a[48:51]
v_exp_f32_e64 v150, v150
v_mfma_f32_16x16x32_bf16 a[80:83], a[240:243], v[240:243], a[80:83]
buffer_load_dwordx4 v33, s[4:7], s25 offen offset:1024 lds
v_mfma_f32_16x16x32_bf16 a[112:115], a[240:243], v[248:251], a[112:115]
v_exp_f32_e64 v151, v151
v_mfma_f32_16x16x32_bf16 a[20:23], a[244:247], v[224:227], a[20:23]
v_exp_f32_e64 v152, v152
v_mfma_f32_16x16x32_bf16 a[52:55], a[244:247], v[232:235], a[52:55]
v_cvt_pk_bf16_f32 v146, v148, v149
v_cvt_pk_bf16_f32 v147, v150, v151
v_mfma_f32_16x16x32_bf16 a[84:87], a[244:247], v[240:243], a[84:87]
ds_read_b128 a[216:219], v66 offset:53248
v_mfma_f32_16x16x32_bf16 a[116:119], a[244:247], v[248:251], a[116:119]
v_exp_f32_e64 v153, v153
v_mfma_f32_16x16x32_bf16 v[120:123], v[76:79], v[240:243], v[120:123]
ds_read_b128 a[220:223], v67 offset:53248
v_mfma_f32_16x16x32_bf16 a[24:27], a[248:251], v[224:227], a[24:27]
v_exp_f32_e64 v154, v154
v_mfma_f32_16x16x32_bf16 a[56:59], a[248:251], v[232:235], a[56:59]
buffer_load_dwordx4 v34, s[4:7], s25 offen offset:2048 lds
v_mfma_f32_16x16x32_bf16 a[88:91], a[248:251], v[240:243], a[88:91]
v_exp_f32_e64 v155, v155
v_mfma_f32_16x16x32_bf16 a[120:123], a[248:251], v[248:251], a[120:123]
v_exp_f32_e64 v156, v156
v_mfma_f32_16x16x32_bf16 a[28:31], a[252:255], v[224:227], a[28:31]
v_cvt_pk_bf16_f32 v152, v152, v153
v_cvt_pk_bf16_f32 v153, v154, v155
v_mfma_f32_16x16x32_bf16 a[60:63], a[252:255], v[232:235], a[60:63]
v_exp_f32_e64 v157, v157
v_mfma_f32_16x16x32_bf16 a[92:95], a[252:255], v[240:243], a[92:95]
buffer_load_dwordx4 v35, s[4:7], s25 offen offset:3072 lds
s_add_u32 s25, s25, 16384
v_mfma_f32_16x16x32_bf16 a[124:127], a[252:255], v[248:251], a[124:127]
v_exp_f32_e64 v158, v158
v_mfma_f32_16x16x32_bf16 v[124:127], v[76:79], v[248:251], v[124:127]
v_exp_f32_e64 v159, v159
s_waitcnt lgkmcnt(0)
v_mfma_f32_16x16x32_bf16 v[192:195], a[192:195], a[128:131], v[96:99]
v_exp_f32_e64 v160, v160
v_mfma_f32_16x16x32_bf16 v[192:195], a[196:199], a[132:135], v[192:195]
ds_read_b64_tr_b16 a[224:225], v68 offset:32768
v_mfma_f32_16x16x32_bf16 v[192:195], a[200:203], a[136:139], v[192:195]
v_cvt_pk_bf16_f32 v154, v156, v157
v_cvt_pk_bf16_f32 v155, v158, v159
v_mfma_f32_16x16x32_bf16 v[192:195], a[204:207], a[140:143], v[192:195]
ds_read_b64_tr_b16 a[226:227], v68 offset:36864
v_mfma_f32_16x16x32_bf16 v[196:199], a[208:211], a[128:131], v[96:99]
v_exp_f32_e64 v161, v161
v_mfma_f32_16x16x32_bf16 v[196:199], a[212:215], a[132:135], v[196:199]
ds_read_b64_tr_b16 a[228:229], v69 offset:32768
v_mfma_f32_16x16x32_bf16 v[196:199], a[216:219], a[136:139], v[196:199]
v_exp_f32_e64 v162, v162
v_mfma_f32_16x16x32_bf16 v[196:199], a[220:223], a[140:143], v[196:199]
ds_read_b64_tr_b16 a[230:231], v69 offset:36864
v_mfma_f32_16x16x32_bf16 v[200:203], a[192:195], a[144:147], v[100:103]
v_exp_f32_e64 v163, v163
v_mfma_f32_16x16x32_bf16 v[200:203], a[196:199], a[148:151], v[200:203]
ds_read_b64_tr_b16 a[232:233], v70 offset:32768
v_mfma_f32_16x16x32_bf16 v[200:203], a[200:203], a[152:155], v[200:203]
v_exp_f32_e64 v164, v164
v_mfma_f32_16x16x32_bf16 v[200:203], a[204:207], a[156:159], v[200:203]
ds_read_b64_tr_b16 a[234:235], v70 offset:36864
v_mfma_f32_16x16x32_bf16 v[204:207], a[208:211], a[144:147], v[100:103]
v_exp_f32_e64 v165, v165
v_mfma_f32_16x16x32_bf16 v[204:207], a[212:215], a[148:151], v[204:207]
ds_read_b64_tr_b16 a[236:237], v71 offset:32768
v_mfma_f32_16x16x32_bf16 v[204:207], a[216:219], a[152:155], v[204:207]
v_cvt_pk_bf16_f32 v160, v160, v161
v_cvt_pk_bf16_f32 v161, v162, v163
v_mfma_f32_16x16x32_bf16 v[204:207], a[220:223], a[156:159], v[204:207]
ds_read_b64_tr_b16 a[238:239], v71 offset:36864
v_mfma_f32_16x16x32_bf16 v[208:211], a[192:195], a[160:163], v[104:107]
v_exp_f32_e64 v166, v166
v_mfma_f32_16x16x32_bf16 v[208:211], a[196:199], a[164:167], v[208:211]
ds_read_b64_tr_b16 a[240:241], v72 offset:32768
v_mfma_f32_16x16x32_bf16 v[208:211], a[200:203], a[168:171], v[208:211]
v_exp_f32_e64 v167, v167
v_mfma_f32_16x16x32_bf16 v[208:211], a[204:207], a[172:175], v[208:211]
ds_read_b64_tr_b16 a[242:243], v72 offset:36864
v_mfma_f32_16x16x32_bf16 v[212:215], a[208:211], a[160:163], v[104:107]
v_exp_f32_e64 v168, v168
v_mfma_f32_16x16x32_bf16 v[212:215], a[212:215], a[164:167], v[212:215]
ds_read_b64_tr_b16 a[244:245], v73 offset:32768
v_mfma_f32_16x16x32_bf16 v[212:215], a[216:219], a[168:171], v[212:215]
v_exp_f32_e64 v169, v169
v_mfma_f32_16x16x32_bf16 v[212:215], a[220:223], a[172:175], v[212:215]
ds_read_b64_tr_b16 a[246:247], v73 offset:36864
v_mfma_f32_16x16x32_bf16 v[216:219], a[192:195], a[176:179], v[108:111]
v_cvt_pk_bf16_f32 v162, v164, v165
v_cvt_pk_bf16_f32 v163, v166, v167
v_mfma_f32_16x16x32_bf16 v[216:219], a[196:199], a[180:183], v[216:219]
ds_read_b64_tr_b16 a[248:249], v74 offset:32768
v_mfma_f32_16x16x32_bf16 v[216:219], a[200:203], a[184:187], v[216:219]
v_exp_f32_e64 v170, v170
v_mfma_f32_16x16x32_bf16 v[216:219], a[204:207], a[188:191], v[216:219]
ds_read_b64_tr_b16 a[250:251], v74 offset:36864
v_mfma_f32_16x16x32_bf16 v[220:223], a[208:211], a[176:179], v[108:111]
v_exp_f32_e64 v171, v171
v_mfma_f32_16x16x32_bf16 v[220:223], a[212:215], a[180:183], v[220:223]
ds_read_b64_tr_b16 a[252:253], v75 offset:32768
v_mfma_f32_16x16x32_bf16 v[220:223], a[216:219], a[184:187], v[220:223]
v_exp_f32_e64 v172, v172
v_mfma_f32_16x16x32_bf16 v[220:223], a[220:223], a[188:191], v[220:223]
ds_read_b64_tr_b16 a[254:255], v75 offset:36864
s_waitcnt lgkmcnt(8)
v_mfma_f32_16x16x32_bf16 a[0:3], a[224:227], v[128:131], a[0:3]
v_exp_f32_e64 v173, v173
v_mfma_f32_16x16x32_bf16 a[32:35], a[224:227], v[136:139], a[32:35]
v_cvt_pk_bf16_f32 v168, v168, v169
v_cvt_pk_bf16_f32 v169, v170, v171
v_mfma_f32_16x16x32_bf16 a[64:67], a[224:227], v[144:147], a[64:67]
ds_read_b128 a[192:195], v64 offset:57344
v_mfma_f32_16x16x32_bf16 a[96:99], a[224:227], v[152:155], a[96:99]
v_exp_f32_e64 v174, v174
v_mfma_f32_16x16x32_bf16 a[4:7], a[228:231], v[128:131], a[4:7]
ds_read_b128 a[196:199], v65 offset:57344
v_mfma_f32_16x16x32_bf16 a[36:39], a[228:231], v[136:139], a[36:39]
v_exp_f32_e64 v175, v175
v_mfma_f32_16x16x32_bf16 a[68:71], a[228:231], v[144:147], a[68:71]
v_exp_f32_e64 v176, v176
v_mfma_f32_16x16x32_bf16 a[100:103], a[228:231], v[152:155], a[100:103]
v_cvt_pk_bf16_f32 v170, v172, v173
v_cvt_pk_bf16_f32 v171, v174, v175
v_mfma_f32_16x16x32_bf16 v[112:115], v[76:79], v[128:131], v[112:115]
ds_read_b128 a[200:203], v66 offset:57344
v_mfma_f32_16x16x32_bf16 a[8:11], a[232:235], v[128:131], a[8:11]
v_exp_f32_e64 v177, v177
v_mfma_f32_16x16x32_bf16 a[40:43], a[232:235], v[136:139], a[40:43]
ds_read_b128 a[204:207], v67 offset:57344
v_mfma_f32_16x16x32_bf16 a[72:75], a[232:235], v[144:147], a[72:75]
v_exp_f32_e64 v178, v178
v_mfma_f32_16x16x32_bf16 a[104:107], a[232:235], v[152:155], a[104:107]
v_exp_f32_e64 v179, v179
v_mfma_f32_16x16x32_bf16 a[12:15], a[236:239], v[128:131], a[12:15]
s_add_u32 m0, s30, 81920
s_nop 0
buffer_load_dwordx4 v36, s[8:11], s26 offen offset:0 lds
v_mfma_f32_16x16x32_bf16 a[44:47], a[236:239], v[136:139], a[44:47]
v_exp_f32_e64 v180, v180
v_mfma_f32_16x16x32_bf16 a[76:79], a[236:239], v[144:147], a[76:79]
v_cvt_pk_bf16_f32 v176, v176, v177
v_cvt_pk_bf16_f32 v177, v178, v179
v_mfma_f32_16x16x32_bf16 a[108:111], a[236:239], v[152:155], a[108:111]
ds_read_b128 a[208:211], v64 offset:61440
v_mfma_f32_16x16x32_bf16 v[116:119], v[76:79], v[136:139], v[116:119]
v_exp_f32_e64 v181, v181
s_waitcnt lgkmcnt(5)
v_mfma_f32_16x16x32_bf16 a[16:19], a[240:243], v[128:131], a[16:19]
ds_read_b128 a[212:215], v65 offset:61440
v_mfma_f32_16x16x32_bf16 a[48:51], a[240:243], v[136:139], a[48:51]
v_exp_f32_e64 v182, v182
v_mfma_f32_16x16x32_bf16 a[80:83], a[240:243], v[144:147], a[80:83]
buffer_load_dwordx4 v37, s[8:11], s26 offen offset:1024 lds
s_waitcnt vmcnt(14)
v_mfma_f32_16x16x32_bf16 a[112:115], a[240:243], v[152:155], a[112:115]
v_exp_f32_e64 v183, v183
ds_read_b64_tr_b16 v[84:85], v80 offset:0
v_mfma_f32_16x16x32_bf16 a[20:23], a[244:247], v[128:131], a[20:23]
v_exp_f32_e64 v184, v184
v_mfma_f32_16x16x32_bf16 a[52:55], a[244:247], v[136:139], a[52:55]
v_cvt_pk_bf16_f32 v178, v180, v181
v_cvt_pk_bf16_f32 v179, v182, v183
ds_read_b64_tr_b16 v[86:87], v80 offset:1536
v_mfma_f32_16x16x32_bf16 a[84:87], a[244:247], v[144:147], a[84:87]
ds_read_b128 a[216:219], v66 offset:61440
v_mfma_f32_16x16x32_bf16 a[116:119], a[244:247], v[152:155], a[116:119]
v_exp_f32_e64 v185, v185
ds_read_b64_tr_b16 v[88:89], v80 offset:32
v_mfma_f32_16x16x32_bf16 v[120:123], v[76:79], v[144:147], v[120:123]
ds_read_b128 a[220:223], v67 offset:61440
v_mfma_f32_16x16x32_bf16 a[24:27], a[248:251], v[128:131], a[24:27]
v_exp_f32_e64 v186, v186
ds_read_b64_tr_b16 v[90:91], v80 offset:1568
v_mfma_f32_16x16x32_bf16 a[56:59], a[248:251], v[136:139], a[56:59]
buffer_load_dwordx4 v36, s[8:11], s26 offen offset:2048 lds
v_mfma_f32_16x16x32_bf16 a[88:91], a[248:251], v[144:147], a[88:91]
v_exp_f32_e64 v187, v187
ds_read_b64_tr_b16 v[92:93], v80 offset:64
v_mfma_f32_16x16x32_bf16 a[120:123], a[248:251], v[152:155], a[120:123]
v_exp_f32_e64 v188, v188
v_mfma_f32_16x16x32_bf16 a[28:31], a[252:255], v[128:131], a[28:31]
v_cvt_pk_bf16_f32 v184, v184, v185
v_cvt_pk_bf16_f32 v185, v186, v187
ds_read_b64_tr_b16 v[94:95], v80 offset:1600
v_mfma_f32_16x16x32_bf16 a[60:63], a[252:255], v[136:139], a[60:63]
v_exp_f32_e64 v189, v189
v_mfma_f32_16x16x32_bf16 a[92:95], a[252:255], v[144:147], a[92:95]
buffer_load_dwordx4 v37, s[8:11], s26 offen offset:3072 lds
s_add_u32 s26, s26, 16384
v_mfma_f32_16x16x32_bf16 a[124:127], a[252:255], v[152:155], a[124:127]
v_exp_f32_e64 v190, v190
v_mfma_f32_16x16x32_bf16 v[124:127], v[76:79], v[152:155], v[124:127]
v_exp_f32_e64 v191, v191
s_waitcnt lgkmcnt(0)
v_mfma_f32_16x16x32_bf16 v[224:227], a[192:195], a[128:131], v[96:99]
v_exp_f32_e64 v192, v192
v_mfma_f32_16x16x32_bf16 v[224:227], a[196:199], a[132:135], v[224:227]
ds_read_b64_tr_b16 a[224:225], v68 offset:40960
v_mfma_f32_16x16x32_bf16 v[224:227], a[200:203], a[136:139], v[224:227]
v_cvt_pk_bf16_f32 v186, v188, v189
v_cvt_pk_bf16_f32 v187, v190, v191
v_mfma_f32_16x16x32_bf16 v[224:227], a[204:207], a[140:143], v[224:227]
ds_read_b64_tr_b16 a[226:227], v68 offset:45056
v_mfma_f32_16x16x32_bf16 v[228:231], a[208:211], a[128:131], v[96:99]
v_exp_f32_e64 v193, v193
v_mfma_f32_16x16x32_bf16 v[228:231], a[212:215], a[132:135], v[228:231]
ds_read_b64_tr_b16 a[228:229], v69 offset:40960
v_mfma_f32_16x16x32_bf16 v[228:231], a[216:219], a[136:139], v[228:231]
v_exp_f32_e64 v194, v194
buffer_store_dwordx4 v[84:87], v11, s[16:19], s63 offen offset:0 sc1
v_mfma_f32_16x16x32_bf16 v[228:231], a[220:223], a[140:143], v[228:231]
ds_read_b64_tr_b16 a[230:231], v69 offset:45056
v_mfma_f32_16x16x32_bf16 v[232:235], a[192:195], a[144:147], v[100:103]
v_exp_f32_e64 v195, v195
v_mfma_f32_16x16x32_bf16 v[232:235], a[196:199], a[148:151], v[232:235]
ds_read_b64_tr_b16 a[232:233], v70 offset:40960
v_mfma_f32_16x16x32_bf16 v[232:235], a[200:203], a[152:155], v[232:235]
v_exp_f32_e64 v196, v196
v_mfma_f32_16x16x32_bf16 v[232:235], a[204:207], a[156:159], v[232:235]
ds_read_b64_tr_b16 a[234:235], v70 offset:45056
v_mfma_f32_16x16x32_bf16 v[236:239], a[208:211], a[144:147], v[100:103]
v_exp_f32_e64 v197, v197
v_mfma_f32_16x16x32_bf16 v[236:239], a[212:215], a[148:151], v[236:239]
ds_read_b64_tr_b16 a[236:237], v71 offset:40960
v_mfma_f32_16x16x32_bf16 v[236:239], a[216:219], a[152:155], v[236:239]
v_cvt_pk_bf16_f32 v192, v192, v193
v_cvt_pk_bf16_f32 v193, v194, v195
v_mfma_f32_16x16x32_bf16 v[236:239], a[220:223], a[156:159], v[236:239]
ds_read_b64_tr_b16 a[238:239], v71 offset:45056
v_mfma_f32_16x16x32_bf16 v[240:243], a[192:195], a[160:163], v[104:107]
v_exp_f32_e64 v198, v198
v_mfma_f32_16x16x32_bf16 v[240:243], a[196:199], a[164:167], v[240:243]
ds_read_b64_tr_b16 a[240:241], v72 offset:40960
v_mfma_f32_16x16x32_bf16 v[240:243], a[200:203], a[168:171], v[240:243]
v_exp_f32_e64 v199, v199
buffer_store_dwordx4 v[88:91], v11, s[16:19], s63 offen offset:1024 sc1
v_mfma_f32_16x16x32_bf16 v[240:243], a[204:207], a[172:175], v[240:243]
ds_read_b64_tr_b16 a[242:243], v72 offset:45056
v_mfma_f32_16x16x32_bf16 v[244:247], a[208:211], a[160:163], v[104:107]
v_exp_f32_e64 v200, v200
v_mfma_f32_16x16x32_bf16 v[244:247], a[212:215], a[164:167], v[244:247]
ds_read_b64_tr_b16 a[244:245], v73 offset:40960
v_mfma_f32_16x16x32_bf16 v[244:247], a[216:219], a[168:171], v[244:247]
v_exp_f32_e64 v201, v201
v_mfma_f32_16x16x32_bf16 v[244:247], a[220:223], a[172:175], v[244:247]
ds_read_b64_tr_b16 a[246:247], v73 offset:45056
v_mfma_f32_16x16x32_bf16 v[248:251], a[192:195], a[176:179], v[108:111]
v_cvt_pk_bf16_f32 v194, v196, v197
v_cvt_pk_bf16_f32 v195, v198, v199
v_mfma_f32_16x16x32_bf16 v[248:251], a[196:199], a[180:183], v[248:251]
ds_read_b64_tr_b16 a[248:249], v74 offset:40960
v_mfma_f32_16x16x32_bf16 v[248:251], a[200:203], a[184:187], v[248:251]
v_exp_f32_e64 v202, v202
v_mfma_f32_16x16x32_bf16 v[248:251], a[204:207], a[188:191], v[248:251]
ds_read_b64_tr_b16 a[250:251], v74 offset:45056
v_mfma_f32_16x16x32_bf16 v[252:255], a[208:211], a[176:179], v[108:111]
v_exp_f32_e64 v203, v203
v_mfma_f32_16x16x32_bf16 v[252:255], a[212:215], a[180:183], v[252:255]
ds_read_b64_tr_b16 a[252:253], v75 offset:40960
v_mfma_f32_16x16x32_bf16 v[252:255], a[216:219], a[184:187], v[252:255]
v_exp_f32_e64 v204, v204
v_mfma_f32_16x16x32_bf16 v[252:255], a[220:223], a[188:191], v[252:255]
ds_read_b64_tr_b16 a[254:255], v75 offset:45056
s_waitcnt vmcnt(18) lgkmcnt(8)
s_barrier
v_mfma_f32_16x16x32_bf16 a[0:3], a[224:227], v[160:163], a[0:3]
v_exp_f32_e64 v205, v205
v_mfma_f32_16x16x32_bf16 a[32:35], a[224:227], v[168:171], a[32:35]
v_cvt_pk_bf16_f32 v200, v200, v201
v_cvt_pk_bf16_f32 v201, v202, v203
v_mfma_f32_16x16x32_bf16 a[64:67], a[224:227], v[176:179], a[64:67]
ds_read_b128 a[192:195], v64 offset:0
v_mfma_f32_16x16x32_bf16 a[96:99], a[224:227], v[184:187], a[96:99]
v_exp_f32_e64 v206, v206
v_mfma_f32_16x16x32_bf16 a[4:7], a[228:231], v[160:163], a[4:7]
ds_read_b128 a[196:199], v65 offset:0
v_mfma_f32_16x16x32_bf16 a[36:39], a[228:231], v[168:171], a[36:39]
v_exp_f32_e64 v207, v207
v_mfma_f32_16x16x32_bf16 a[68:71], a[228:231], v[176:179], a[68:71]
v_exp_f32_e64 v208, v208
v_mfma_f32_16x16x32_bf16 a[100:103], a[228:231], v[184:187], a[100:103]
v_cvt_pk_bf16_f32 v202, v204, v205
v_cvt_pk_bf16_f32 v203, v206, v207
v_mfma_f32_16x16x32_bf16 v[112:115], v[76:79], v[160:163], v[112:115]
ds_read_b128 a[200:203], v66 offset:0
v_mfma_f32_16x16x32_bf16 a[8:11], a[232:235], v[160:163], a[8:11]
v_exp_f32_e64 v209, v209
v_mfma_f32_16x16x32_bf16 a[40:43], a[232:235], v[168:171], a[40:43]
ds_read_b128 a[204:207], v67 offset:0
v_mfma_f32_16x16x32_bf16 a[72:75], a[232:235], v[176:179], a[72:75]
v_exp_f32_e64 v210, v210
v_mfma_f32_16x16x32_bf16 a[104:107], a[232:235], v[184:187], a[104:107]
v_exp_f32_e64 v211, v211
v_mfma_f32_16x16x32_bf16 a[12:15], a[236:239], v[160:163], a[12:15]
s_add_u32 m0, s30, 49152
s_nop 0
buffer_load_dwordx4 v32, s[4:7], s25 offen offset:0 lds
v_mfma_f32_16x16x32_bf16 a[44:47], a[236:239], v[168:171], a[44:47]
v_exp_f32_e64 v212, v212
v_mfma_f32_16x16x32_bf16 a[76:79], a[236:239], v[176:179], a[76:79]
v_cvt_pk_bf16_f32 v208, v208, v209
v_cvt_pk_bf16_f32 v209, v210, v211
v_mfma_f32_16x16x32_bf16 a[108:111], a[236:239], v[184:187], a[108:111]
ds_read_b128 a[208:211], v64 offset:4096
v_mfma_f32_16x16x32_bf16 v[116:119], v[76:79], v[168:171], v[116:119]
v_exp_f32_e64 v213, v213
s_waitcnt lgkmcnt(5)
v_mfma_f32_16x16x32_bf16 a[16:19], a[240:243], v[160:163], a[16:19]
ds_read_b128 a[212:215], v65 offset:4096
v_mfma_f32_16x16x32_bf16 a[48:51], a[240:243], v[168:171], a[48:51]
v_exp_f32_e64 v214, v214
v_mfma_f32_16x16x32_bf16 a[80:83], a[240:243], v[176:179], a[80:83]
buffer_load_dwordx4 v33, s[4:7], s25 offen offset:1024 lds
v_mfma_f32_16x16x32_bf16 a[112:115], a[240:243], v[184:187], a[112:115]
v_exp_f32_e64 v215, v215
v_mfma_f32_16x16x32_bf16 a[20:23], a[244:247], v[160:163], a[20:23]
v_exp_f32_e64 v216, v216
v_mfma_f32_16x16x32_bf16 a[52:55], a[244:247], v[168:171], a[52:55]
v_cvt_pk_bf16_f32 v210, v212, v213
v_cvt_pk_bf16_f32 v211, v214, v215
v_mfma_f32_16x16x32_bf16 a[84:87], a[244:247], v[176:179], a[84:87]
ds_read_b128 a[216:219], v66 offset:4096
v_mfma_f32_16x16x32_bf16 a[116:119], a[244:247], v[184:187], a[116:119]
v_exp_f32_e64 v217, v217
v_mfma_f32_16x16x32_bf16 v[120:123], v[76:79], v[176:179], v[120:123]
ds_read_b128 a[220:223], v67 offset:4096
v_mfma_f32_16x16x32_bf16 a[24:27], a[248:251], v[160:163], a[24:27]
v_exp_f32_e64 v218, v218
v_mfma_f32_16x16x32_bf16 a[56:59], a[248:251], v[168:171], a[56:59]
buffer_load_dwordx4 v34, s[4:7], s25 offen offset:2048 lds
v_mfma_f32_16x16x32_bf16 a[88:91], a[248:251], v[176:179], a[88:91]
v_exp_f32_e64 v219, v219
v_mfma_f32_16x16x32_bf16 a[120:123], a[248:251], v[184:187], a[120:123]
v_exp_f32_e64 v220, v220
v_mfma_f32_16x16x32_bf16 a[28:31], a[252:255], v[160:163], a[28:31]
v_cvt_pk_bf16_f32 v216, v216, v217
v_cvt_pk_bf16_f32 v217, v218, v219
v_mfma_f32_16x16x32_bf16 a[60:63], a[252:255], v[168:171], a[60:63]
v_exp_f32_e64 v221, v221
v_mfma_f32_16x16x32_bf16 a[92:95], a[252:255], v[176:179], a[92:95]
buffer_load_dwordx4 v35, s[4:7], s25 offen offset:3072 lds
s_add_u32 s25, s25, 16384
v_mfma_f32_16x16x32_bf16 a[124:127], a[252:255], v[184:187], a[124:127]
v_exp_f32_e64 v222, v222
v_mfma_f32_16x16x32_bf16 v[124:127], v[76:79], v[184:187], v[124:127]
v_exp_f32_e64 v223, v223
s_waitcnt lgkmcnt(0)
v_mfma_f32_16x16x32_bf16 v[128:131], a[192:195], a[128:131], v[96:99]
v_exp_f32_e64 v224, v224
v_mfma_f32_16x16x32_bf16 v[128:131], a[196:199], a[132:135], v[128:131]
ds_read_b64_tr_b16 a[224:225], v68 offset:49152
v_mfma_f32_16x16x32_bf16 v[128:131], a[200:203], a[136:139], v[128:131]
v_cvt_pk_bf16_f32 v218, v220, v221
v_cvt_pk_bf16_f32 v219, v222, v223
v_mfma_f32_16x16x32_bf16 v[128:131], a[204:207], a[140:143], v[128:131]
ds_read_b64_tr_b16 a[226:227], v68 offset:53248
v_mfma_f32_16x16x32_bf16 v[132:135], a[208:211], a[128:131], v[96:99]
v_exp_f32_e64 v225, v225
v_mfma_f32_16x16x32_bf16 v[132:135], a[212:215], a[132:135], v[132:135]
ds_read_b64_tr_b16 a[228:229], v69 offset:49152
v_mfma_f32_16x16x32_bf16 v[132:135], a[216:219], a[136:139], v[132:135]
v_exp_f32_e64 v226, v226
buffer_store_dwordx4 v[92:95], v11, s[16:19], s63 offen offset:2048 sc1
v_mfma_f32_16x16x32_bf16 v[132:135], a[220:223], a[140:143], v[132:135]
ds_read_b64_tr_b16 a[230:231], v69 offset:53248
v_mfma_f32_16x16x32_bf16 v[136:139], a[192:195], a[144:147], v[100:103]
v_exp_f32_e64 v227, v227
v_mfma_f32_16x16x32_bf16 v[136:139], a[196:199], a[148:151], v[136:139]
ds_read_b64_tr_b16 a[232:233], v70 offset:49152
v_mfma_f32_16x16x32_bf16 v[136:139], a[200:203], a[152:155], v[136:139]
v_exp_f32_e64 v228, v228
v_mfma_f32_16x16x32_bf16 v[136:139], a[204:207], a[156:159], v[136:139]
ds_read_b64_tr_b16 a[234:235], v70 offset:53248
v_mfma_f32_16x16x32_bf16 v[140:143], a[208:211], a[144:147], v[100:103]
v_exp_f32_e64 v229, v229
v_mfma_f32_16x16x32_bf16 v[140:143], a[212:215], a[148:151], v[140:143]
ds_read_b64_tr_b16 a[236:237], v71 offset:49152
v_mfma_f32_16x16x32_bf16 v[140:143], a[216:219], a[152:155], v[140:143]
v_cvt_pk_bf16_f32 v224, v224, v225
v_cvt_pk_bf16_f32 v225, v226, v227
v_mfma_f32_16x16x32_bf16 v[140:143], a[220:223], a[156:159], v[140:143]
ds_read_b64_tr_b16 a[238:239], v71 offset:53248
v_mfma_f32_16x16x32_bf16 v[144:147], a[192:195], a[160:163], v[104:107]
v_exp_f32_e64 v230, v230
v_mfma_f32_16x16x32_bf16 v[144:147], a[196:199], a[164:167], v[144:147]
ds_read_b64_tr_b16 a[240:241], v72 offset:49152
v_mfma_f32_16x16x32_bf16 v[144:147], a[200:203], a[168:171], v[144:147]
v_exp_f32_e64 v231, v231
v_mfma_f32_16x16x32_bf16 v[144:147], a[204:207], a[172:175], v[144:147]
ds_read_b64_tr_b16 a[242:243], v72 offset:53248
v_mfma_f32_16x16x32_bf16 v[148:151], a[208:211], a[160:163], v[104:107]
v_exp_f32_e64 v232, v232
v_mfma_f32_16x16x32_bf16 v[148:151], a[212:215], a[164:167], v[148:151]
ds_read_b64_tr_b16 a[244:245], v73 offset:49152
v_mfma_f32_16x16x32_bf16 v[148:151], a[216:219], a[168:171], v[148:151]
v_exp_f32_e64 v233, v233
v_mfma_f32_16x16x32_bf16 v[148:151], a[220:223], a[172:175], v[148:151]
ds_read_b64_tr_b16 a[246:247], v73 offset:53248
v_mfma_f32_16x16x32_bf16 v[152:155], a[192:195], a[176:179], v[108:111]
v_cvt_pk_bf16_f32 v226, v228, v229
v_cvt_pk_bf16_f32 v227, v230, v231
v_mfma_f32_16x16x32_bf16 v[152:155], a[196:199], a[180:183], v[152:155]
ds_read_b64_tr_b16 a[248:249], v74 offset:49152
v_mfma_f32_16x16x32_bf16 v[152:155], a[200:203], a[184:187], v[152:155]
v_exp_f32_e64 v234, v234
v_mfma_f32_16x16x32_bf16 v[152:155], a[204:207], a[188:191], v[152:155]
ds_read_b64_tr_b16 a[250:251], v74 offset:53248
v_mfma_f32_16x16x32_bf16 v[156:159], a[208:211], a[176:179], v[108:111]
v_exp_f32_e64 v235, v235
v_mfma_f32_16x16x32_bf16 v[156:159], a[212:215], a[180:183], v[156:159]
ds_read_b64_tr_b16 a[252:253], v75 offset:49152
v_mfma_f32_16x16x32_bf16 v[156:159], a[216:219], a[184:187], v[156:159]
v_exp_f32_e64 v236, v236
v_mfma_f32_16x16x32_bf16 v[156:159], a[220:223], a[188:191], v[156:159]
ds_read_b64_tr_b16 a[254:255], v75 offset:53248
s_waitcnt lgkmcnt(8)
v_mfma_f32_16x16x32_bf16 a[0:3], a[224:227], v[192:195], a[0:3]
v_exp_f32_e64 v237, v237
v_mfma_f32_16x16x32_bf16 a[32:35], a[224:227], v[200:203], a[32:35]
v_cvt_pk_bf16_f32 v232, v232, v233
v_cvt_pk_bf16_f32 v233, v234, v235
v_mfma_f32_16x16x32_bf16 a[64:67], a[224:227], v[208:211], a[64:67]
ds_read_b128 a[192:195], v64 offset:8192
v_mfma_f32_16x16x32_bf16 a[96:99], a[224:227], v[216:219], a[96:99]
v_exp_f32_e64 v238, v238
v_mfma_f32_16x16x32_bf16 a[4:7], a[228:231], v[192:195], a[4:7]
ds_read_b128 a[196:199], v65 offset:8192
v_mfma_f32_16x16x32_bf16 a[36:39], a[228:231], v[200:203], a[36:39]
v_exp_f32_e64 v239, v239
v_mfma_f32_16x16x32_bf16 a[68:71], a[228:231], v[208:211], a[68:71]
v_exp_f32_e64 v240, v240
v_mfma_f32_16x16x32_bf16 a[100:103], a[228:231], v[216:219], a[100:103]
v_cvt_pk_bf16_f32 v234, v236, v237
v_cvt_pk_bf16_f32 v235, v238, v239
v_mfma_f32_16x16x32_bf16 v[112:115], v[76:79], v[192:195], v[112:115]
ds_read_b128 a[200:203], v66 offset:8192
v_mfma_f32_16x16x32_bf16 a[8:11], a[232:235], v[192:195], a[8:11]
v_exp_f32_e64 v241, v241
v_mfma_f32_16x16x32_bf16 a[40:43], a[232:235], v[200:203], a[40:43]
ds_read_b128 a[204:207], v67 offset:8192
v_mfma_f32_16x16x32_bf16 a[72:75], a[232:235], v[208:211], a[72:75]
v_exp_f32_e64 v242, v242
v_mfma_f32_16x16x32_bf16 a[104:107], a[232:235], v[216:219], a[104:107]
v_exp_f32_e64 v243, v243
v_mfma_f32_16x16x32_bf16 a[12:15], a[236:239], v[192:195], a[12:15]
s_add_u32 m0, s30, 98304
s_nop 0
buffer_load_dwordx4 v36, s[8:11], s26 offen offset:0 lds
v_mfma_f32_16x16x32_bf16 a[44:47], a[236:239], v[200:203], a[44:47]
v_exp_f32_e64 v244, v244
v_mfma_f32_16x16x32_bf16 a[76:79], a[236:239], v[208:211], a[76:79]
v_cvt_pk_bf16_f32 v240, v240, v241
v_cvt_pk_bf16_f32 v241, v242, v243
v_mfma_f32_16x16x32_bf16 a[108:111], a[236:239], v[216:219], a[108:111]
ds_read_b128 a[208:211], v64 offset:12288
v_mfma_f32_16x16x32_bf16 v[116:119], v[76:79], v[200:203], v[116:119]
v_exp_f32_e64 v245, v245
s_waitcnt lgkmcnt(5)
v_mfma_f32_16x16x32_bf16 a[16:19], a[240:243], v[192:195], a[16:19]
ds_read_b128 a[212:215], v65 offset:12288
v_mfma_f32_16x16x32_bf16 a[48:51], a[240:243], v[200:203], a[48:51]
v_exp_f32_e64 v246, v246
v_mfma_f32_16x16x32_bf16 a[80:83], a[240:243], v[208:211], a[80:83]
buffer_load_dwordx4 v37, s[8:11], s26 offen offset:1024 lds
v_mfma_f32_16x16x32_bf16 a[112:115], a[240:243], v[216:219], a[112:115]
v_exp_f32_e64 v247, v247
v_mfma_f32_16x16x32_bf16 a[20:23], a[244:247], v[192:195], a[20:23]
v_exp_f32_e64 v248, v248
v_mfma_f32_16x16x32_bf16 a[52:55], a[244:247], v[200:203], a[52:55]
v_cvt_pk_bf16_f32 v242, v244, v245
v_cvt_pk_bf16_f32 v243, v246, v247
v_mfma_f32_16x16x32_bf16 a[84:87], a[244:247], v[208:211], a[84:87]
ds_read_b128 a[216:219], v66 offset:12288
v_mfma_f32_16x16x32_bf16 a[116:119], a[244:247], v[216:219], a[116:119]
v_exp_f32_e64 v249, v249
v_mfma_f32_16x16x32_bf16 v[120:123], v[76:79], v[208:211], v[120:123]
ds_read_b128 a[220:223], v67 offset:12288
v_mfma_f32_16x16x32_bf16 a[24:27], a[248:251], v[192:195], a[24:27]
v_exp_f32_e64 v250, v250
v_mfma_f32_16x16x32_bf16 a[56:59], a[248:251], v[200:203], a[56:59]
buffer_load_dwordx4 v36, s[8:11], s26 offen offset:2048 lds
v_mfma_f32_16x16x32_bf16 a[88:91], a[248:251], v[208:211], a[88:91]
v_exp_f32_e64 v251, v251
v_mfma_f32_16x16x32_bf16 a[120:123], a[248:251], v[216:219], a[120:123]
v_exp_f32_e64 v252, v252
v_mfma_f32_16x16x32_bf16 a[28:31], a[252:255], v[192:195], a[28:31]
v_cvt_pk_bf16_f32 v248, v248, v249
v_cvt_pk_bf16_f32 v249, v250, v251
v_mfma_f32_16x16x32_bf16 a[60:63], a[252:255], v[200:203], a[60:63]
v_exp_f32_e64 v253, v253
v_mfma_f32_16x16x32_bf16 a[92:95], a[252:255], v[208:211], a[92:95]
buffer_load_dwordx4 v37, s[8:11], s26 offen offset:3072 lds
s_add_u32 s26, s26, 16384
v_mfma_f32_16x16x32_bf16 a[124:127], a[252:255], v[216:219], a[124:127]
v_exp_f32_e64 v254, v254
v_mfma_f32_16x16x32_bf16 v[124:127], v[76:79], v[216:219], v[124:127]
v_exp_f32_e64 v255, v255
s_add_u32 s94, s94, 96
s_add_u32 s63, s63, 3072
s_cmp_eq_u32 s27, 4
s_cselect_b32 s94, s92, s94
s_cselect_b32 s63, s93, s63
s_cselect_b32 s12, s72, s12
s_cselect_b32 s13, s73, s13
s_cselect_b32 s14, 0x480000, s14
s_sub_u32 s27, s27, 1
s_cmp_lg_u32 s27, 0
s_cbranch_scc1 L_att_loop
s_lshl_b32 s33, s50, 3
v_cmp_eq_u32 vcc, s33, v0
s_nop 1
s_mov_b64 s[42:43], vcc
s_cmp_eq_u32 s24, 0
s_cselect_b64 vcc, s[42:43], 0
v_mov_b32 v12, 0x7fff0000
v_lshlrev_b32 v13, 2, v0
v_cndmask_b32 v62, v12, v13, vcc
buffer_load_dword v61, v62, s[56:59], 0 offen sc1
s_waitcnt lgkmcnt(0)
v_mfma_f32_16x16x32_bf16 v[160:163], a[192:195], a[128:131], v[96:99]
v_exp_f32_e64 v128, v128
v_mfma_f32_16x16x32_bf16 v[160:163], a[196:199], a[132:135], v[160:163]
ds_read_b64_tr_b16 a[224:225], v68 offset:57344
v_mfma_f32_16x16x32_bf16 v[160:163], a[200:203], a[136:139], v[160:163]
v_cvt_pk_bf16_f32 v250, v252, v253
v_cvt_pk_bf16_f32 v251, v254, v255
v_mfma_f32_16x16x32_bf16 v[160:163], a[204:207], a[140:143], v[160:163]
ds_read_b64_tr_b16 a[226:227], v68 offset:61440
v_mfma_f32_16x16x32_bf16 v[164:167], a[208:211], a[128:131], v[96:99]
v_exp_f32_e64 v129, v129
v_mfma_f32_16x16x32_bf16 v[164:167], a[212:215], a[132:135], v[164:167]
ds_read_b64_tr_b16 a[228:229], v69 offset:57344
v_mfma_f32_16x16x32_bf16 v[164:167], a[216:219], a[136:139], v[164:167]
v_exp_f32_e64 v130, v130
v_mfma_f32_16x16x32_bf16 v[164:167], a[220:223], a[140:143], v[164:167]
ds_read_b64_tr_b16 a[230:231], v69 offset:61440
v_mfma_f32_16x16x32_bf16 v[168:171], a[192:195], a[144:147], v[100:103]
v_exp_f32_e64 v131, v131
v_mfma_f32_16x16x32_bf16 v[168:171], a[196:199], a[148:151], v[168:171]
ds_read_b64_tr_b16 a[232:233], v70 offset:57344
v_mfma_f32_16x16x32_bf16 v[168:171], a[200:203], a[152:155], v[168:171]
v_exp_f32_e64 v132, v132
v_mfma_f32_16x16x32_bf16 v[168:171], a[204:207], a[156:159], v[168:171]
ds_read_b64_tr_b16 a[234:235], v70 offset:61440
v_mfma_f32_16x16x32_bf16 v[172:175], a[208:211], a[144:147], v[100:103]
v_exp_f32_e64 v133, v133
v_mfma_f32_16x16x32_bf16 v[172:175], a[212:215], a[148:151], v[172:175]
ds_read_b64_tr_b16 a[236:237], v71 offset:57344
v_mfma_f32_16x16x32_bf16 v[172:175], a[216:219], a[152:155], v[172:175]
v_cvt_pk_bf16_f32 v128, v128, v129
v_cvt_pk_bf16_f32 v129, v130, v131
v_mfma_f32_16x16x32_bf16 v[172:175], a[220:223], a[156:159], v[172:175]
ds_read_b64_tr_b16 a[238:239], v71 offset:61440
v_mfma_f32_16x16x32_bf16 v[176:179], a[192:195], a[160:163], v[104:107]
v_exp_f32_e64 v134, v134
v_mfma_f32_16x16x32_bf16 v[176:179], a[196:199], a[164:167], v[176:179]
ds_read_b64_tr_b16 a[240:241], v72 offset:57344
v_mfma_f32_16x16x32_bf16 v[176:179], a[200:203], a[168:171], v[176:179]
v_exp_f32_e64 v135, v135
v_mfma_f32_16x16x32_bf16 v[176:179], a[204:207], a[172:175], v[176:179]
ds_read_b64_tr_b16 a[242:243], v72 offset:61440
v_mfma_f32_16x16x32_bf16 v[180:183], a[208:211], a[160:163], v[104:107]
v_exp_f32_e64 v136, v136
v_mfma_f32_16x16x32_bf16 v[180:183], a[212:215], a[164:167], v[180:183]
ds_read_b64_tr_b16 a[244:245], v73 offset:57344
v_mfma_f32_16x16x32_bf16 v[180:183], a[216:219], a[168:171], v[180:183]
v_exp_f32_e64 v137, v137
v_mfma_f32_16x16x32_bf16 v[180:183], a[220:223], a[172:175], v[180:183]
ds_read_b64_tr_b16 a[246:247], v73 offset:61440
v_mfma_f32_16x16x32_bf16 v[184:187], a[192:195], a[176:179], v[108:111]
v_cvt_pk_bf16_f32 v130, v132, v133
v_cvt_pk_bf16_f32 v131, v134, v135
v_mfma_f32_16x16x32_bf16 v[184:187], a[196:199], a[180:183], v[184:187]
ds_read_b64_tr_b16 a[248:249], v74 offset:57344
v_mfma_f32_16x16x32_bf16 v[184:187], a[200:203], a[184:187], v[184:187]
v_exp_f32_e64 v138, v138
v_mfma_f32_16x16x32_bf16 v[184:187], a[204:207], a[188:191], v[184:187]
ds_read_b64_tr_b16 a[250:251], v74 offset:61440
v_mfma_f32_16x16x32_bf16 v[188:191], a[208:211], a[176:179], v[108:111]
v_exp_f32_e64 v139, v139
v_mfma_f32_16x16x32_bf16 v[188:191], a[212:215], a[180:183], v[188:191]
ds_read_b64_tr_b16 a[252:253], v75 offset:57344
v_mfma_f32_16x16x32_bf16 v[188:191], a[216:219], a[184:187], v[188:191]
v_exp_f32_e64 v140, v140
v_mfma_f32_16x16x32_bf16 v[188:191], a[220:223], a[188:191], v[188:191]
ds_read_b64_tr_b16 a[254:255], v75 offset:61440
s_waitcnt vmcnt(20) lgkmcnt(8)
s_barrier
v_mfma_f32_16x16x32_bf16 a[0:3], a[224:227], v[224:227], a[0:3]
v_exp_f32_e64 v141, v141
v_mfma_f32_16x16x32_bf16 a[32:35], a[224:227], v[232:235], a[32:35]
v_cvt_pk_bf16_f32 v136, v136, v137
v_cvt_pk_bf16_f32 v137, v138, v139
v_mfma_f32_16x16x32_bf16 a[64:67], a[224:227], v[240:243], a[64:67]
ds_read_b128 a[192:195], v64 offset:16384
v_mfma_f32_16x16x32_bf16 a[96:99], a[224:227], v[248:251], a[96:99]
v_exp_f32_e64 v142, v142
v_mfma_f32_16x16x32_bf16 a[4:7], a[228:231], v[224:227], a[4:7]
ds_read_b128 a[196:199], v65 offset:16384
v_mfma_f32_16x16x32_bf16 a[36:39], a[228:231], v[232:235], a[36:39]
v_exp_f32_e64 v143, v143
v_mfma_f32_16x16x32_bf16 a[68:71], a[228:231], v[240:243], a[68:71]
v_exp_f32_e64 v144, v144
v_mfma_f32_16x16x32_bf16 a[100:103], a[228:231], v[248:251], a[100:103]
v_cvt_pk_bf16_f32 v138, v140, v141
v_cvt_pk_bf16_f32 v139, v142, v143
v_mfma_f32_16x16x32_bf16 v[112:115], v[76:79], v[224:227], v[112:115]
ds_read_b128 a[200:203], v66 offset:16384
v_mfma_f32_16x16x32_bf16 a[8:11], a[232:235], v[224:227], a[8:11]
v_exp_f32_e64 v145, v145
v_mfma_f32_16x16x32_bf16 a[40:43], a[232:235], v[232:235], a[40:43]
ds_read_b128 a[204:207], v67 offset:16384
v_mfma_f32_16x16x32_bf16 a[72:75], a[232:235], v[240:243], a[72:75]
v_exp_f32_e64 v146, v146
v_mfma_f32_16x16x32_bf16 a[104:107], a[232:235], v[248:251], a[104:107]
v_exp_f32_e64 v147, v147
v_mfma_f32_16x16x32_bf16 a[12:15], a[236:239], v[224:227], a[12:15]
v_mfma_f32_16x16x32_bf16 a[44:47], a[236:239], v[232:235], a[44:47]
v_exp_f32_e64 v148, v148
v_mfma_f32_16x16x32_bf16 a[76:79], a[236:239], v[240:243], a[76:79]
v_cvt_pk_bf16_f32 v144, v144, v145
v_cvt_pk_bf16_f32 v145, v146, v147
v_mfma_f32_16x16x32_bf16 a[108:111], a[236:239], v[248:251], a[108:111]
ds_read_b128 a[208:211], v64 offset:20480
v_mfma_f32_16x16x32_bf16 v[116:119], v[76:79], v[232:235], v[116:119]
v_exp_f32_e64 v149, v149
s_waitcnt lgkmcnt(5)
v_mfma_f32_16x16x32_bf16 a[16:19], a[240:243], v[224:227], a[16:19]
ds_read_b128 a[212:215], v65 offset:20480
v_mfma_f32_16x16x32_bf16 a[48:51], a[240:243], v[232:235], a[48:51]
v_exp_f32_e64 v150, v150
v_mfma_f32_16x16x32_bf16 a[80:83], a[240:243], v[240:243], a[80:83]
v_mfma_f32_16x16x32_bf16 a[112:115], a[240:243], v[248:251], a[112:115]
v_exp_f32_e64 v151, v151
v_mfma_f32_16x16x32_bf16 a[20:23], a[244:247], v[224:227], a[20:23]
v_exp_f32_e64 v152, v152
v_mfma_f32_16x16x32_bf16 a[52:55], a[244:247], v[232:235], a[52:55]
v_cvt_pk_bf16_f32 v146, v148, v149
v_cvt_pk_bf16_f32 v147, v150, v151
v_mfma_f32_16x16x32_bf16 a[84:87], a[244:247], v[240:243], a[84:87]
ds_read_b128 a[216:219], v66 offset:20480
v_mfma_f32_16x16x32_bf16 a[116:119], a[244:247], v[248:251], a[116:119]
v_exp_f32_e64 v153, v153
v_mfma_f32_16x16x32_bf16 v[120:123], v[76:79], v[240:243], v[120:123]
ds_read_b128 a[220:223], v67 offset:20480
v_mfma_f32_16x16x32_bf16 a[24:27], a[248:251], v[224:227], a[24:27]
v_exp_f32_e64 v154, v154
v_mfma_f32_16x16x32_bf16 a[56:59], a[248:251], v[232:235], a[56:59]
v_mfma_f32_16x16x32_bf16 a[88:91], a[248:251], v[240:243], a[88:91]
v_exp_f32_e64 v155, v155
v_mfma_f32_16x16x32_bf16 a[120:123], a[248:251], v[248:251], a[120:123]
v_exp_f32_e64 v156, v156
v_mfma_f32_16x16x32_bf16 a[28:31], a[252:255], v[224:227], a[28:31]
v_cvt_pk_bf16_f32 v152, v152, v153
v_cvt_pk_bf16_f32 v153, v154, v155
v_mfma_f32_16x16x32_bf16 a[60:63], a[252:255], v[232:235], a[60:63]
v_exp_f32_e64 v157, v157
v_mfma_f32_16x16x32_bf16 a[92:95], a[252:255], v[240:243], a[92:95]
v_mfma_f32_16x16x32_bf16 a[124:127], a[252:255], v[248:251], a[124:127]
v_exp_f32_e64 v158, v158
v_mfma_f32_16x16x32_bf16 v[124:127], v[76:79], v[248:251], v[124:127]
v_exp_f32_e64 v159, v159
s_mov_b32 s56, s80
s_mov_b32 s57, s81
s_mov_b32 s58, 0x510000
s_mov_b32 s59, 0x00020000
s_mul_i32 s35, s0, 81
s_and_b32 s34, s2, 6
s_mul_i32 s34, s34, 1152
s_mov_b32 s33, 238609295
v_min_u32 v12, 63, v0
v_add_u32 v12, s35, v12
v_add_u32 v12, 0, v12
v_mul_hi_u32 v13, v12, s33
v_mul_u32_u24 v14, 18, v13
v_sub_u32 v12, v12, v14
v_lshlrev_b32 v12, 7, v12
v_mul_u32_u24 v13, 9216, v13
v_add_u32 v12, v12, v13
buffer_load_dword v10, v12, s[56:59], s34 offen
v_min_u32 v12, 16, v0
v_add_u32 v12, s35, v12
v_add_u32 v12, 64, v12
v_mul_hi_u32 v13, v12, s33
v_mul_u32_u24 v14, 18, v13
v_sub_u32 v12, v12, v14
v_lshlrev_b32 v12, 7, v12
v_mul_u32_u24 v13, 9216, v13
v_add_u32 v12, v12, v13
buffer_load_dword v10, v12, s[56:59], s34 offen
s_mov_b32 s56, s86
s_mov_b32 s57, s87
s_mov_b32 s58, 0x100
s_mov_b32 s59, 0x00020000
s_waitcnt lgkmcnt(0)
v_mfma_f32_16x16x32_bf16 v[192:195], a[192:195], a[128:131], v[96:99]
v_exp_f32_e64 v160, v160
v_mfma_f32_16x16x32_bf16 v[192:195], a[196:199], a[132:135], v[192:195]
ds_read_b64_tr_b16 a[224:225], v68 offset:0
v_mfma_f32_16x16x32_bf16 v[192:195], a[200:203], a[136:139], v[192:195]
v_cvt_pk_bf16_f32 v154, v156, v157
v_cvt_pk_bf16_f32 v155, v158, v159
v_mfma_f32_16x16x32_bf16 v[192:195], a[204:207], a[140:143], v[192:195]
ds_read_b64_tr_b16 a[226:227], v68 offset:4096
v_mfma_f32_16x16x32_bf16 v[196:199], a[208:211], a[128:131], v[96:99]
v_exp_f32_e64 v161, v161
v_mfma_f32_16x16x32_bf16 v[196:199], a[212:215], a[132:135], v[196:199]
ds_read_b64_tr_b16 a[228:229], v69 offset:0
v_mfma_f32_16x16x32_bf16 v[196:199], a[216:219], a[136:139], v[196:199]
v_exp_f32_e64 v162, v162
v_mfma_f32_16x16x32_bf16 v[196:199], a[220:223], a[140:143], v[196:199]
ds_read_b64_tr_b16 a[230:231], v69 offset:4096
v_mfma_f32_16x16x32_bf16 v[200:203], a[192:195], a[144:147], v[100:103]
v_exp_f32_e64 v163, v163
v_mfma_f32_16x16x32_bf16 v[200:203], a[196:199], a[148:151], v[200:203]
ds_read_b64_tr_b16 a[232:233], v70 offset:0
v_mfma_f32_16x16x32_bf16 v[200:203], a[200:203], a[152:155], v[200:203]
v_exp_f32_e64 v164, v164
v_mfma_f32_16x16x32_bf16 v[200:203], a[204:207], a[156:159], v[200:203]
ds_read_b64_tr_b16 a[234:235], v70 offset:4096
v_mfma_f32_16x16x32_bf16 v[204:207], a[208:211], a[144:147], v[100:103]
v_exp_f32_e64 v165, v165
v_mfma_f32_16x16x32_bf16 v[204:207], a[212:215], a[148:151], v[204:207]
ds_read_b64_tr_b16 a[236:237], v71 offset:0
v_mfma_f32_16x16x32_bf16 v[204:207], a[216:219], a[152:155], v[204:207]
v_cvt_pk_bf16_f32 v160, v160, v161
v_cvt_pk_bf16_f32 v161, v162, v163
v_mfma_f32_16x16x32_bf16 v[204:207], a[220:223], a[156:159], v[204:207]
ds_read_b64_tr_b16 a[238:239], v71 offset:4096
v_mfma_f32_16x16x32_bf16 v[208:211], a[192:195], a[160:163], v[104:107]
v_exp_f32_e64 v166, v166
v_mfma_f32_16x16x32_bf16 v[208:211], a[196:199], a[164:167], v[208:211]
ds_read_b64_tr_b16 a[240:241], v72 offset:0
v_mfma_f32_16x16x32_bf16 v[208:211], a[200:203], a[168:171], v[208:211]
v_exp_f32_e64 v167, v167
v_mfma_f32_16x16x32_bf16 v[208:211], a[204:207], a[172:175], v[208:211]
ds_read_b64_tr_b16 a[242:243], v72 offset:4096
v_mfma_f32_16x16x32_bf16 v[212:215], a[208:211], a[160:163], v[104:107]
v_exp_f32_e64 v168, v168
v_mfma_f32_16x16x32_bf16 v[212:215], a[212:215], a[164:167], v[212:215]
ds_read_b64_tr_b16 a[244:245], v73 offset:0
v_mfma_f32_16x16x32_bf16 v[212:215], a[216:219], a[168:171], v[212:215]
v_exp_f32_e64 v169, v169
v_mfma_f32_16x16x32_bf16 v[212:215], a[220:223], a[172:175], v[212:215]
ds_read_b64_tr_b16 a[246:247], v73 offset:4096
v_mfma_f32_16x16x32_bf16 v[216:219], a[192:195], a[176:179], v[108:111]
v_cvt_pk_bf16_f32 v162, v164, v165
v_cvt_pk_bf16_f32 v163, v166, v167
v_mfma_f32_16x16x32_bf16 v[216:219], a[196:199], a[180:183], v[216:219]
ds_read_b64_tr_b16 a[248:249], v74 offset:0
v_mfma_f32_16x16x32_bf16 v[216:219], a[200:203], a[184:187], v[216:219]
v_exp_f32_e64 v170, v170
v_mfma_f32_16x16x32_bf16 v[216:219], a[204:207], a[188:191], v[216:219]
ds_read_b64_tr_b16 a[250:251], v74 offset:4096
v_mfma_f32_16x16x32_bf16 v[220:223], a[208:211], a[176:179], v[108:111]
v_exp_f32_e64 v171, v171
v_mfma_f32_16x16x32_bf16 v[220:223], a[212:215], a[180:183], v[220:223]
ds_read_b64_tr_b16 a[252:253], v75 offset:0
v_mfma_f32_16x16x32_bf16 v[220:223], a[216:219], a[184:187], v[220:223]
v_exp_f32_e64 v172, v172
v_mfma_f32_16x16x32_bf16 v[220:223], a[220:223], a[188:191], v[220:223]
ds_read_b64_tr_b16 a[254:255], v75 offset:4096
s_waitcnt lgkmcnt(8)
v_mfma_f32_16x16x32_bf16 a[0:3], a[224:227], v[128:131], a[0:3]
v_exp_f32_e64 v173, v173
v_mfma_f32_16x16x32_bf16 a[32:35], a[224:227], v[136:139], a[32:35]
v_cvt_pk_bf16_f32 v168, v168, v169
v_cvt_pk_bf16_f32 v169, v170, v171
v_mfma_f32_16x16x32_bf16 a[64:67], a[224:227], v[144:147], a[64:67]
ds_read_b128 a[192:195], v64 offset:24576
v_mfma_f32_16x16x32_bf16 a[96:99], a[224:227], v[152:155], a[96:99]
v_exp_f32_e64 v174, v174
v_mfma_f32_16x16x32_bf16 a[4:7], a[228:231], v[128:131], a[4:7]
ds_read_b128 a[196:199], v65 offset:24576
v_mfma_f32_16x16x32_bf16 a[36:39], a[228:231], v[136:139], a[36:39]
v_exp_f32_e64 v175, v175
v_mfma_f32_16x16x32_bf16 a[68:71], a[228:231], v[144:147], a[68:71]
v_exp_f32_e64 v176, v176
v_mfma_f32_16x16x32_bf16 a[100:103], a[228:231], v[152:155], a[100:103]
v_cvt_pk_bf16_f32 v170, v172, v173
v_cvt_pk_bf16_f32 v171, v174, v175
v_mfma_f32_16x16x32_bf16 v[112:115], v[76:79], v[128:131], v[112:115]
ds_read_b128 a[200:203], v66 offset:24576
v_mfma_f32_16x16x32_bf16 a[8:11], a[232:235], v[128:131], a[8:11]
v_exp_f32_e64 v177, v177
v_mfma_f32_16x16x32_bf16 a[40:43], a[232:235], v[136:139], a[40:43]
ds_read_b128 a[204:207], v67 offset:24576
v_mfma_f32_16x16x32_bf16 a[72:75], a[232:235], v[144:147], a[72:75]
v_exp_f32_e64 v178, v178
v_mfma_f32_16x16x32_bf16 a[104:107], a[232:235], v[152:155], a[104:107]
v_exp_f32_e64 v179, v179
v_mfma_f32_16x16x32_bf16 a[12:15], a[236:239], v[128:131], a[12:15]
s_add_u32 m0, s30, 114688
s_nop 0
buffer_load_dwordx4 v36, s[8:11], s26 offen offset:0 lds
v_mfma_f32_16x16x32_bf16 a[44:47], a[236:239], v[136:139], a[44:47]
v_exp_f32_e64 v180, v180
v_mfma_f32_16x16x32_bf16 a[76:79], a[236:239], v[144:147], a[76:79]
v_cvt_pk_bf16_f32 v176, v176, v177
v_cvt_pk_bf16_f32 v177, v178, v179
v_mfma_f32_16x16x32_bf16 a[108:111], a[236:239], v[152:155], a[108:111]
ds_read_b128 a[208:211], v64 offset:28672
v_mfma_f32_16x16x32_bf16 v[116:119], v[76:79], v[136:139], v[116:119]
v_exp_f32_e64 v181, v181
s_waitcnt lgkmcnt(5)
v_mfma_f32_16x16x32_bf16 a[16:19], a[240:243], v[128:131], a[16:19]
ds_read_b128 a[212:215], v65 offset:28672
v_mfma_f32_16x16x32_bf16 a[48:51], a[240:243], v[136:139], a[48:51]
v_exp_f32_e64 v182, v182
v_mfma_f32_16x16x32_bf16 a[80:83], a[240:243], v[144:147], a[80:83]
buffer_load_dwordx4 v37, s[8:11], s26 offen offset:1024 lds
v_mfma_f32_16x16x32_bf16 a[112:115], a[240:243], v[152:155], a[112:115]
v_exp_f32_e64 v183, v183
v_mfma_f32_16x16x32_bf16 a[20:23], a[244:247], v[128:131], a[20:23]
v_exp_f32_e64 v184, v184
v_mfma_f32_16x16x32_bf16 a[52:55], a[244:247], v[136:139], a[52:55]
v_cvt_pk_bf16_f32 v178, v180, v181
v_cvt_pk_bf16_f32 v179, v182, v183
v_mfma_f32_16x16x32_bf16 a[84:87], a[244:247], v[144:147], a[84:87]
ds_read_b128 a[216:219], v66 offset:28672
v_mfma_f32_16x16x32_bf16 a[116:119], a[244:247], v[152:155], a[116:119]
v_exp_f32_e64 v185, v185
v_mfma_f32_16x16x32_bf16 v[120:123], v[76:79], v[144:147], v[120:123]
ds_read_b128 a[220:223], v67 offset:28672
v_mfma_f32_16x16x32_bf16 a[24:27], a[248:251], v[128:131], a[24:27]
v_exp_f32_e64 v186, v186
v_mfma_f32_16x16x32_bf16 a[56:59], a[248:251], v[136:139], a[56:59]
buffer_load_dwordx4 v36, s[8:11], s26 offen offset:2048 lds
v_mfma_f32_16x16x32_bf16 a[88:91], a[248:251], v[144:147], a[88:91]
v_exp_f32_e64 v187, v187
v_mfma_f32_16x16x32_bf16 a[120:123], a[248:251], v[152:155], a[120:123]
v_exp_f32_e64 v188, v188
v_mfma_f32_16x16x32_bf16 a[28:31], a[252:255], v[128:131], a[28:31]
v_cvt_pk_bf16_f32 v184, v184, v185
v_cvt_pk_bf16_f32 v185, v186, v187
v_mfma_f32_16x16x32_bf16 a[60:63], a[252:255], v[136:139], a[60:63]
v_exp_f32_e64 v189, v189
v_mfma_f32_16x16x32_bf16 a[92:95], a[252:255], v[144:147], a[92:95]
buffer_load_dwordx4 v37, s[8:11], s26 offen offset:3072 lds
s_add_u32 s26, s26, 16384
v_mfma_f32_16x16x32_bf16 a[124:127], a[252:255], v[152:155], a[124:127]
v_exp_f32_e64 v190, v190
v_mfma_f32_16x16x32_bf16 v[124:127], v[76:79], v[152:155], v[124:127]
v_exp_f32_e64 v191, v191
s_cmp_lg_u32 s24, 0
s_cbranch_scc1 L_poll6_ok
s_waitcnt vmcnt(6)
s_mov_b32 s35, 400000
L_poll6:
v_bfe_u32 v12, v61, 8, 8
v_cmp_gt_u32 vcc, 32, v12
s_nop 1
s_and_b64 vcc, vcc, s[42:43]
s_cmp_eq_u64 vcc, 0
s_cbranch_scc1 L_poll6_ok
s_sleep 2
buffer_load_dword v61, v62, s[56:59], 0 offen sc1
s_waitcnt vmcnt(0)
s_sub_u32 s35, s35, 1
s_cmp_lg_u32 s35, 0
s_cbranch_scc1 L_poll6
L_poll6_ok:
s_waitcnt lgkmcnt(0)
v_mfma_f32_16x16x32_bf16 v[224:227], a[192:195], a[128:131], v[96:99]
v_exp_f32_e64 v192, v192
v_mfma_f32_16x16x32_bf16 v[224:227], a[196:199], a[132:135], v[224:227]
ds_read_b64_tr_b16 a[224:225], v68 offset:8192
v_mfma_f32_16x16x32_bf16 v[224:227], a[200:203], a[136:139], v[224:227]
v_cvt_pk_bf16_f32 v186, v188, v189
v_cvt_pk_bf16_f32 v187, v190, v191
v_mfma_f32_16x16x32_bf16 v[224:227], a[204:207], a[140:143], v[224:227]
ds_read_b64_tr_b16 a[226:227], v68 offset:12288
v_mfma_f32_16x16x32_bf16 v[228:231], a[208:211], a[128:131], v[96:99]
v_exp_f32_e64 v193, v193
v_mfma_f32_16x16x32_bf16 v[228:231], a[212:215], a[132:135], v[228:231]
ds_read_b64_tr_b16 a[228:229], v69 offset:8192
v_mfma_f32_16x16x32_bf16 v[228:231], a[216:219], a[136:139], v[228:231]
v_exp_f32_e64 v194, v194
v_mfma_f32_16x16x32_bf16 v[228:231], a[220:223], a[140:143], v[228:231]
ds_read_b64_tr_b16 a[230:231], v69 offset:12288
v_mfma_f32_16x16x32_bf16 v[232:235], a[192:195], a[144:147], v[100:103]
v_exp_f32_e64 v195, v195
v_mfma_f32_16x16x32_bf16 v[232:235], a[196:199], a[148:151], v[232:235]
ds_read_b64_tr_b16 a[232:233], v70 offset:8192
v_mfma_f32_16x16x32_bf16 v[232:235], a[200:203], a[152:155], v[232:235]
v_exp_f32_e64 v196, v196
v_mfma_f32_16x16x32_bf16 v[232:235], a[204:207], a[156:159], v[232:235]
ds_read_b64_tr_b16 a[234:235], v70 offset:12288
v_mfma_f32_16x16x32_bf16 v[236:239], a[208:211], a[144:147], v[100:103]
v_exp_f32_e64 v197, v197
v_mfma_f32_16x16x32_bf16 v[236:239], a[212:215], a[148:151], v[236:239]
ds_read_b64_tr_b16 a[236:237], v71 offset:8192
v_mfma_f32_16x16x32_bf16 v[236:239], a[216:219], a[152:155], v[236:239]
v_cvt_pk_bf16_f32 v192, v192, v193
v_cvt_pk_bf16_f32 v193, v194, v195
v_mfma_f32_16x16x32_bf16 v[236:239], a[220:223], a[156:159], v[236:239]
ds_read_b64_tr_b16 a[238:239], v71 offset:12288
v_mfma_f32_16x16x32_bf16 v[240:243], a[192:195], a[160:163], v[104:107]
v_exp_f32_e64 v198, v198
v_mfma_f32_16x16x32_bf16 v[240:243], a[196:199], a[164:167], v[240:243]
ds_read_b64_tr_b16 a[240:241], v72 offset:8192
v_mfma_f32_16x16x32_bf16 v[240:243], a[200:203], a[168:171], v[240:243]
v_exp_f32_e64 v199, v199
v_mfma_f32_16x16x32_bf16 v[240:243], a[204:207], a[172:175], v[240:243]
ds_read_b64_tr_b16 a[242:243], v72 offset:12288
v_mfma_f32_16x16x32_bf16 v[244:247], a[208:211], a[160:163], v[104:107]
v_exp_f32_e64 v200, v200
v_mfma_f32_16x16x32_bf16 v[244:247], a[212:215], a[164:167], v[244:247]
ds_read_b64_tr_b16 a[244:245], v73 offset:8192
v_mfma_f32_16x16x32_bf16 v[244:247], a[216:219], a[168:171], v[244:247]
v_exp_f32_e64 v201, v201
v_mfma_f32_16x16x32_bf16 v[244:247], a[220:223], a[172:175], v[244:247]
ds_read_b64_tr_b16 a[246:247], v73 offset:12288
v_mfma_f32_16x16x32_bf16 v[248:251], a[192:195], a[176:179], v[108:111]
v_cvt_pk_bf16_f32 v194, v196, v197
v_cvt_pk_bf16_f32 v195, v198, v199
v_mfma_f32_16x16x32_bf16 v[248:251], a[196:199], a[180:183], v[248:251]
ds_read_b64_tr_b16 a[248:249], v74 offset:8192
v_mfma_f32_16x16x32_bf16 v[248:251], a[200:203], a[184:187], v[248:251]
v_exp_f32_e64 v202, v202
v_mfma_f32_16x16x32_bf16 v[248:251], a[204:207], a[188:191], v[248:251]
ds_read_b64_tr_b16 a[250:251], v74 offset:12288
v_mfma_f32_16x16x32_bf16 v[252:255], a[208:211], a[176:179], v[108:111]
v_exp_f32_e64 v203, v203
v_mfma_f32_16x16x32_bf16 v[252:255], a[212:215], a[180:183], v[252:255]
ds_read_b64_tr_b16 a[252:253], v75 offset:8192
v_mfma_f32_16x16x32_bf16 v[252:255], a[216:219], a[184:187], v[252:255]
v_exp_f32_e64 v204, v204
v_mfma_f32_16x16x32_bf16 v[252:255], a[220:223], a[188:191], v[252:255]
ds_read_b64_tr_b16 a[254:255], v75 offset:12288
s_waitcnt vmcnt(6) lgkmcnt(8)
s_barrier
v_mfma_f32_16x16x32_bf16 a[0:3], a[224:227], v[160:163], a[0:3]
v_exp_f32_e64 v205, v205
v_mfma_f32_16x16x32_bf16 a[32:35], a[224:227], v[168:171], a[32:35]
v_cvt_pk_bf16_f32 v200, v200, v201
v_cvt_pk_bf16_f32 v201, v202, v203
v_mfma_f32_16x16x32_bf16 a[64:67], a[224:227], v[176:179], a[64:67]
ds_read_b128 a[192:195], v64 offset:32768
v_mfma_f32_16x16x32_bf16 a[96:99], a[224:227], v[184:187], a[96:99]
v_exp_f32_e64 v206, v206
v_mfma_f32_16x16x32_bf16 a[4:7], a[228:231], v[160:163], a[4:7]
ds_read_b128 a[196:199], v65 offset:32768
v_mfma_f32_16x16x32_bf16 a[36:39], a[228:231], v[168:171], a[36:39]
v_exp_f32_e64 v207, v207
v_mfma_f32_16x16x32_bf16 a[68:71], a[228:231], v[176:179], a[68:71]
v_exp_f32_e64 v208, v208
v_mfma_f32_16x16x32_bf16 a[100:103], a[228:231], v[184:187], a[100:103]
v_cvt_pk_bf16_f32 v202, v204, v205
v_cvt_pk_bf16_f32 v203, v206, v207
v_mfma_f32_16x16x32_bf16 v[112:115], v[76:79], v[160:163], v[112:115]
ds_read_b128 a[200:203], v66 offset:32768
v_mfma_f32_16x16x32_bf16 a[8:11], a[232:235], v[160:163], a[8:11]
v_exp_f32_e64 v209, v209
v_mfma_f32_16x16x32_bf16 a[40:43], a[232:235], v[168:171], a[40:43]
ds_read_b128 a[204:207], v67 offset:32768
v_mfma_f32_16x16x32_bf16 a[72:75], a[232:235], v[176:179], a[72:75]
v_exp_f32_e64 v210, v210
v_mfma_f32_16x16x32_bf16 a[104:107], a[232:235], v[184:187], a[104:107]
v_exp_f32_e64 v211, v211
v_mfma_f32_16x16x32_bf16 a[12:15], a[236:239], v[160:163], a[12:15]
v_mfma_f32_16x16x32_bf16 a[44:47], a[236:239], v[168:171], a[44:47]
v_exp_f32_e64 v212, v212
v_mfma_f32_16x16x32_bf16 a[76:79], a[236:239], v[176:179], a[76:79]
v_cvt_pk_bf16_f32 v208, v208, v209
v_cvt_pk_bf16_f32 v209, v210, v211
v_mfma_f32_16x16x32_bf16 a[108:111], a[236:239], v[184:187], a[108:111]
ds_read_b128 a[208:211], v64 offset:36864
v_mfma_f32_16x16x32_bf16 v[116:119], v[76:79], v[168:171], v[116:119]
v_exp_f32_e64 v213, v213
s_waitcnt lgkmcnt(5)
v_mfma_f32_16x16x32_bf16 a[16:19], a[240:243], v[160:163], a[16:19]
ds_read_b128 a[212:215], v65 offset:36864
v_mfma_f32_16x16x32_bf16 a[48:51], a[240:243], v[168:171], a[48:51]
v_exp_f32_e64 v214, v214
v_mfma_f32_16x16x32_bf16 a[80:83], a[240:243], v[176:179], a[80:83]
v_mfma_f32_16x16x32_bf16 a[112:115], a[240:243], v[184:187], a[112:115]
v_exp_f32_e64 v215, v215
v_mfma_f32_16x16x32_bf16 a[20:23], a[244:247], v[160:163], a[20:23]
v_exp_f32_e64 v216, v216
v_mfma_f32_16x16x32_bf16 a[52:55], a[244:247], v[168:171], a[52:55]
v_cvt_pk_bf16_f32 v210, v212, v213
v_cvt_pk_bf16_f32 v211, v214, v215
v_mfma_f32_16x16x32_bf16 a[84:87], a[244:247], v[176:179], a[84:87]
ds_read_b128 a[216:219], v66 offset:36864
v_mfma_f32_16x16x32_bf16 a[116:119], a[244:247], v[184:187], a[116:119]
v_exp_f32_e64 v217, v217
v_mfma_f32_16x16x32_bf16 v[120:123], v[76:79], v[176:179], v[120:123]
ds_read_b128 a[220:223], v67 offset:36864
v_mfma_f32_16x16x32_bf16 a[24:27], a[248:251], v[160:163], a[24:27]
v_exp_f32_e64 v218, v218
v_mfma_f32_16x16x32_bf16 a[56:59], a[248:251], v[168:171], a[56:59]
v_mfma_f32_16x16x32_bf16 a[88:91], a[248:251], v[176:179], a[88:91]
v_exp_f32_e64 v219, v219
v_mfma_f32_16x16x32_bf16 a[120:123], a[248:251], v[184:187], a[120:123]
v_exp_f32_e64 v220, v220
v_mfma_f32_16x16x32_bf16 a[28:31], a[252:255], v[160:163], a[28:31]
v_cvt_pk_bf16_f32 v216, v216, v217
v_cvt_pk_bf16_f32 v217, v218, v219
v_mfma_f32_16x16x32_bf16 a[60:63], a[252:255], v[168:171], a[60:63]
v_exp_f32_e64 v221, v221
v_mfma_f32_16x16x32_bf16 a[92:95], a[252:255], v[176:179], a[92:95]
v_mfma_f32_16x16x32_bf16 a[124:127], a[252:255], v[184:187], a[124:127]
v_exp_f32_e64 v222, v222
v_mfma_f32_16x16x32_bf16 v[124:127], v[76:79], v[184:187], v[124:127]
v_exp_f32_e64 v223, v223
s_add_u32 s12, s88, 0x6c0000
s_addc_u32 s13, s89, 0
s_mov_b32 s14, 0x240000
s_mov_b32 s15, 0x00020000
s_and_b32 s35, s0, 31
s_mul_i32 s35, s35, 9216
s_mul_i32 s34, s50, 294912
s_add_u32 s35, s35, s34
v_lshlrev_b32 v21, 7, v0
buffer_load_dword v10, v21, s[12:15], s35 offen
s_add_u32 s35, s35, 8192
v_min_u32 v12, 7, v0
v_lshlrev_b32 v12, 7, v12
buffer_load_dword v10, v12, s[12:15], s35 offen
s_waitcnt lgkmcnt(0)
v_mfma_f32_16x16x32_bf16 v[128:131], a[192:195], a[128:131], v[96:99]
v_exp_f32_e64 v224, v224
v_mfma_f32_16x16x32_bf16 v[128:131], a[196:199], a[132:135], v[128:131]
ds_read_b64_tr_b16 a[224:225], v68 offset:16384
v_mfma_f32_16x16x32_bf16 v[128:131], a[200:203], a[136:139], v[128:131]
v_cvt_pk_bf16_f32 v218, v220, v221
v_cvt_pk_bf16_f32 v219, v222, v223
v_mfma_f32_16x16x32_bf16 v[128:131], a[204:207], a[140:143], v[128:131]
ds_read_b64_tr_b16 a[226:227], v68 offset:20480
v_mfma_f32_16x16x32_bf16 v[132:135], a[208:211], a[128:131], v[96:99]
v_exp_f32_e64 v225, v225
v_mfma_f32_16x16x32_bf16 v[132:135], a[212:215], a[132:135], v[132:135]
ds_read_b64_tr_b16 a[228:229], v69 offset:16384
v_mfma_f32_16x16x32_bf16 v[132:135], a[216:219], a[136:139], v[132:135]
v_exp_f32_e64 v226, v226
v_mfma_f32_16x16x32_bf16 v[132:135], a[220:223], a[140:143], v[132:135]
ds_read_b64_tr_b16 a[230:231], v69 offset:20480
v_mfma_f32_16x16x32_bf16 v[136:139], a[192:195], a[144:147], v[100:103]
v_exp_f32_e64 v227, v227
v_mfma_f32_16x16x32_bf16 v[136:139], a[196:199], a[148:151], v[136:139]
ds_read_b64_tr_b16 a[232:233], v70 offset:16384
v_mfma_f32_16x16x32_bf16 v[136:139], a[200:203], a[152:155], v[136:139]
v_exp_f32_e64 v228, v228
v_mfma_f32_16x16x32_bf16 v[136:139], a[204:207], a[156:159], v[136:139]
ds_read_b64_tr_b16 a[234:235], v70 offset:20480
v_mfma_f32_16x16x32_bf16 v[140:143], a[208:211], a[144:147], v[100:103]
v_exp_f32_e64 v229, v229
v_mfma_f32_16x16x32_bf16 v[140:143], a[212:215], a[148:151], v[140:143]
ds_read_b64_tr_b16 a[236:237], v71 offset:16384
v_mfma_f32_16x16x32_bf16 v[140:143], a[216:219], a[152:155], v[140:143]
v_cvt_pk_bf16_f32 v224, v224, v225
v_cvt_pk_bf16_f32 v225, v226, v227
v_mfma_f32_16x16x32_bf16 v[140:143], a[220:223], a[156:159], v[140:143]
ds_read_b64_tr_b16 a[238:239], v71 offset:20480
v_mfma_f32_16x16x32_bf16 v[144:147], a[192:195], a[160:163], v[104:107]
v_exp_f32_e64 v230, v230
v_mfma_f32_16x16x32_bf16 v[144:147], a[196:199], a[164:167], v[144:147]
ds_read_b64_tr_b16 a[240:241], v72 offset:16384
v_mfma_f32_16x16x32_bf16 v[144:147], a[200:203], a[168:171], v[144:147]
v_exp_f32_e64 v231, v231
v_mfma_f32_16x16x32_bf16 v[144:147], a[204:207], a[172:175], v[144:147]
ds_read_b64_tr_b16 a[242:243], v72 offset:20480
v_mfma_f32_16x16x32_bf16 v[148:151], a[208:211], a[160:163], v[104:107]
v_exp_f32_e64 v232, v232
v_mfma_f32_16x16x32_bf16 v[148:151], a[212:215], a[164:167], v[148:151]
ds_read_b64_tr_b16 a[244:245], v73 offset:16384
v_mfma_f32_16x16x32_bf16 v[148:151], a[216:219], a[168:171], v[148:151]
v_exp_f32_e64 v233, v233
v_mfma_f32_16x16x32_bf16 v[148:151], a[220:223], a[172:175], v[148:151]
ds_read_b64_tr_b16 a[246:247], v73 offset:20480
v_mfma_f32_16x16x32_bf16 v[152:155], a[192:195], a[176:179], v[108:111]
v_cvt_pk_bf16_f32 v226, v228, v229
v_cvt_pk_bf16_f32 v227, v230, v231
v_mfma_f32_16x16x32_bf16 v[152:155], a[196:199], a[180:183], v[152:155]
ds_read_b64_tr_b16 a[248:249], v74 offset:16384
v_mfma_f32_16x16x32_bf16 v[152:155], a[200:203], a[184:187], v[152:155]
v_exp_f32_e64 v234, v234
v_mfma_f32_16x16x32_bf16 v[152:155], a[204:207], a[188:191], v[152:155]
ds_read_b64_tr_b16 a[250:251], v74 offset:20480
v_mfma_f32_16x16x32_bf16 v[156:159], a[208:211], a[176:179], v[108:111]
v_exp_f32_e64 v235, v235
v_mfma_f32_16x16x32_bf16 v[156:159], a[212:215], a[180:183], v[156:159]
ds_read_b64_tr_b16 a[252:253], v75 offset:16384
v_mfma_f32_16x16x32_bf16 v[156:159], a[216:219], a[184:187], v[156:159]
v_exp_f32_e64 v236, v236
v_mfma_f32_16x16x32_bf16 v[156:159], a[220:223], a[188:191], v[156:159]
ds_read_b64_tr_b16 a[254:255], v75 offset:20480
s_waitcnt lgkmcnt(8)
v_mfma_f32_16x16x32_bf16 a[0:3], a[224:227], v[192:195], a[0:3]
v_exp_f32_e64 v237, v237
v_mfma_f32_16x16x32_bf16 a[32:35], a[224:227], v[200:203], a[32:35]
v_cvt_pk_bf16_f32 v232, v232, v233
v_cvt_pk_bf16_f32 v233, v234, v235
v_mfma_f32_16x16x32_bf16 a[64:67], a[224:227], v[208:211], a[64:67]
ds_read_b128 a[192:195], v64 offset:40960
v_mfma_f32_16x16x32_bf16 a[96:99], a[224:227], v[216:219], a[96:99]
v_exp_f32_e64 v238, v238
v_mfma_f32_16x16x32_bf16 a[4:7], a[228:231], v[192:195], a[4:7]
ds_read_b128 a[196:199], v65 offset:40960
v_mfma_f32_16x16x32_bf16 a[36:39], a[228:231], v[200:203], a[36:39]
v_exp_f32_e64 v239, v239
v_mfma_f32_16x16x32_bf16 a[68:71], a[228:231], v[208:211], a[68:71]
v_exp_f32_e64 v240, v240
v_mfma_f32_16x16x32_bf16 a[100:103], a[228:231], v[216:219], a[100:103]
v_cvt_pk_bf16_f32 v234, v236, v237
v_cvt_pk_bf16_f32 v235, v238, v239
v_mfma_f32_16x16x32_bf16 v[112:115], v[76:79], v[192:195], v[112:115]
ds_read_b128 a[200:203], v66 offset:40960
v_mfma_f32_16x16x32_bf16 a[8:11], a[232:235], v[192:195], a[8:11]
v_exp_f32_e64 v241, v241
v_mfma_f32_16x16x32_bf16 a[40:43], a[232:235], v[200:203], a[40:43]
ds_read_b128 a[204:207], v67 offset:40960
v_mfma_f32_16x16x32_bf16 a[72:75], a[232:235], v[208:211], a[72:75]
v_exp_f32_e64 v242, v242
v_mfma_f32_16x16x32_bf16 a[104:107], a[232:235], v[216:219], a[104:107]
v_exp_f32_e64 v243, v243
v_mfma_f32_16x16x32_bf16 a[12:15], a[236:239], v[192:195], a[12:15]
v_mfma_f32_16x16x32_bf16 a[44:47], a[236:239], v[200:203], a[44:47]
v_exp_f32_e64 v244, v244
v_mfma_f32_16x16x32_bf16 a[76:79], a[236:239], v[208:211], a[76:79]
v_cvt_pk_bf16_f32 v240, v240, v241
v_cvt_pk_bf16_f32 v241, v242, v243
v_mfma_f32_16x16x32_bf16 a[108:111], a[236:239], v[216:219], a[108:111]
ds_read_b128 a[208:211], v64 offset:45056
v_mfma_f32_16x16x32_bf16 v[116:119], v[76:79], v[200:203], v[116:119]
v_exp_f32_e64 v245, v245
s_waitcnt lgkmcnt(5)
v_mfma_f32_16x16x32_bf16 a[16:19], a[240:243], v[192:195], a[16:19]
ds_read_b128 a[212:215], v65 offset:45056
v_mfma_f32_16x16x32_bf16 a[48:51], a[240:243], v[200:203], a[48:51]
v_exp_f32_e64 v246, v246
v_mfma_f32_16x16x32_bf16 a[80:83], a[240:243], v[208:211], a[80:83]
v_mfma_f32_16x16x32_bf16 a[112:115], a[240:243], v[216:219], a[112:115]
v_exp_f32_e64 v247, v247
v_mfma_f32_16x16x32_bf16 a[20:23], a[244:247], v[192:195], a[20:23]
v_exp_f32_e64 v248, v248
v_mfma_f32_16x16x32_bf16 a[52:55], a[244:247], v[200:203], a[52:55]
v_cvt_pk_bf16_f32 v242, v244, v245
v_cvt_pk_bf16_f32 v243, v246, v247
v_mfma_f32_16x16x32_bf16 a[84:87], a[244:247], v[208:211], a[84:87]
ds_read_b128 a[216:219], v66 offset:45056
v_mfma_f32_16x16x32_bf16 a[116:119], a[244:247], v[216:219], a[116:119]
v_exp_f32_e64 v249, v249
v_mfma_f32_16x16x32_bf16 v[120:123], v[76:79], v[208:211], v[120:123]
ds_read_b128 a[220:223], v67 offset:45056
v_mfma_f32_16x16x32_bf16 a[24:27], a[248:251], v[192:195], a[24:27]
v_exp_f32_e64 v250, v250
v_mfma_f32_16x16x32_bf16 a[56:59], a[248:251], v[200:203], a[56:59]
v_mfma_f32_16x16x32_bf16 a[88:91], a[248:251], v[208:211], a[88:91]
v_exp_f32_e64 v251, v251
v_mfma_f32_16x16x32_bf16 a[120:123], a[248:251], v[216:219], a[120:123]
v_exp_f32_e64 v252, v252
v_mfma_f32_16x16x32_bf16 a[28:31], a[252:255], v[192:195], a[28:31]
v_cvt_pk_bf16_f32 v248, v248, v249
v_cvt_pk_bf16_f32 v249, v250, v251
v_mfma_f32_16x16x32_bf16 a[60:63], a[252:255], v[200:203], a[60:63]
v_exp_f32_e64 v253, v253
v_mfma_f32_16x16x32_bf16 a[92:95], a[252:255], v[208:211], a[92:95]
v_mfma_f32_16x16x32_bf16 a[124:127], a[252:255], v[216:219], a[124:127]
v_exp_f32_e64 v254, v254
v_mfma_f32_16x16x32_bf16 v[124:127], v[76:79], v[216:219], v[124:127]
v_exp_f32_e64 v255, v255
s_waitcnt lgkmcnt(0)
v_mfma_f32_16x16x32_bf16 v[160:163], a[192:195], a[128:131], v[96:99]
v_exp_f32_e64 v128, v128
v_mfma_f32_16x16x32_bf16 v[160:163], a[196:199], a[132:135], v[160:163]
ds_read_b64_tr_b16 a[224:225], v68 offset:24576
v_mfma_f32_16x16x32_bf16 v[160:163], a[200:203], a[136:139], v[160:163]
v_cvt_pk_bf16_f32 v250, v252, v253
v_cvt_pk_bf16_f32 v251, v254, v255
v_mfma_f32_16x16x32_bf16 v[160:163], a[204:207], a[140:143], v[160:163]
ds_read_b64_tr_b16 a[226:227], v68 offset:28672
v_mfma_f32_16x16x32_bf16 v[164:167], a[208:211], a[128:131], v[96:99]
v_exp_f32_e64 v129, v129
v_mfma_f32_16x16x32_bf16 v[164:167], a[212:215], a[132:135], v[164:167]
ds_read_b64_tr_b16 a[228:229], v69 offset:24576
v_mfma_f32_16x16x32_bf16 v[164:167], a[216:219], a[136:139], v[164:167]
v_exp_f32_e64 v130, v130
v_mfma_f32_16x16x32_bf16 v[164:167], a[220:223], a[140:143], v[164:167]
ds_read_b64_tr_b16 a[230:231], v69 offset:28672
v_mfma_f32_16x16x32_bf16 v[168:171], a[192:195], a[144:147], v[100:103]
v_exp_f32_e64 v131, v131
v_mfma_f32_16x16x32_bf16 v[168:171], a[196:199], a[148:151], v[168:171]
ds_read_b64_tr_b16 a[232:233], v70 offset:24576
v_mfma_f32_16x16x32_bf16 v[168:171], a[200:203], a[152:155], v[168:171]
v_exp_f32_e64 v132, v132
v_mfma_f32_16x16x32_bf16 v[168:171], a[204:207], a[156:159], v[168:171]
ds_read_b64_tr_b16 a[234:235], v70 offset:28672
v_mfma_f32_16x16x32_bf16 v[172:175], a[208:211], a[144:147], v[100:103]
v_exp_f32_e64 v133, v133
v_mfma_f32_16x16x32_bf16 v[172:175], a[212:215], a[148:151], v[172:175]
ds_read_b64_tr_b16 a[236:237], v71 offset:24576
v_mfma_f32_16x16x32_bf16 v[172:175], a[216:219], a[152:155], v[172:175]
v_cvt_pk_bf16_f32 v128, v128, v129
v_cvt_pk_bf16_f32 v129, v130, v131
v_mfma_f32_16x16x32_bf16 v[172:175], a[220:223], a[156:159], v[172:175]
ds_read_b64_tr_b16 a[238:239], v71 offset:28672
v_mfma_f32_16x16x32_bf16 v[176:179], a[192:195], a[160:163], v[104:107]
v_exp_f32_e64 v134, v134
v_mfma_f32_16x16x32_bf16 v[176:179], a[196:199], a[164:167], v[176:179]
ds_read_b64_tr_b16 a[240:241], v72 offset:24576
v_mfma_f32_16x16x32_bf16 v[176:179], a[200:203], a[168:171], v[176:179]
v_exp_f32_e64 v135, v135
v_mfma_f32_16x16x32_bf16 v[176:179], a[204:207], a[172:175], v[176:179]
ds_read_b64_tr_b16 a[242:243], v72 offset:28672
v_mfma_f32_16x16x32_bf16 v[180:183], a[208:211], a[160:163], v[104:107]
v_exp_f32_e64 v136, v136
v_mfma_f32_16x16x32_bf16 v[180:183], a[212:215], a[164:167], v[180:183]
ds_read_b64_tr_b16 a[244:245], v73 offset:24576
v_mfma_f32_16x16x32_bf16 v[180:183], a[216:219], a[168:171], v[180:183]
v_exp_f32_e64 v137, v137
v_mfma_f32_16x16x32_bf16 v[180:183], a[220:223], a[172:175], v[180:183]
ds_read_b64_tr_b16 a[246:247], v73 offset:28672
v_mfma_f32_16x16x32_bf16 v[184:187], a[192:195], a[176:179], v[108:111]
v_cvt_pk_bf16_f32 v130, v132, v133
v_cvt_pk_bf16_f32 v131, v134, v135
v_mfma_f32_16x16x32_bf16 v[184:187], a[196:199], a[180:183], v[184:187]
ds_read_b64_tr_b16 a[248:249], v74 offset:24576
v_mfma_f32_16x16x32_bf16 v[184:187], a[200:203], a[184:187], v[184:187]
v_exp_f32_e64 v138, v138
v_mfma_f32_16x16x32_bf16 v[184:187], a[204:207], a[188:191], v[184:187]
ds_read_b64_tr_b16 a[250:251], v74 offset:28672
v_mfma_f32_16x16x32_bf16 v[188:191], a[208:211], a[176:179], v[108:111]
v_exp_f32_e64 v139, v139
v_mfma_f32_16x16x32_bf16 v[188:191], a[212:215], a[180:183], v[188:191]
ds_read_b64_tr_b16 a[252:253], v75 offset:24576
v_mfma_f32_16x16x32_bf16 v[188:191], a[216:219], a[184:187], v[188:191]
v_exp_f32_e64 v140, v140
v_mfma_f32_16x16x32_bf16 v[188:191], a[220:223], a[188:191], v[188:191]
ds_read_b64_tr_b16 a[254:255], v75 offset:28672
s_waitcnt vmcnt(8) lgkmcnt(8)
s_barrier
v_mfma_f32_16x16x32_bf16 a[0:3], a[224:227], v[224:227], a[0:3]
v_exp_f32_e64 v141, v141
v_mfma_f32_16x16x32_bf16 a[32:35], a[224:227], v[232:235], a[32:35]
v_cvt_pk_bf16_f32 v136, v136, v137
v_cvt_pk_bf16_f32 v137, v138, v139
v_mfma_f32_16x16x32_bf16 a[64:67], a[224:227], v[240:243], a[64:67]
ds_read_b128 a[192:195], v64 offset:49152
v_mfma_f32_16x16x32_bf16 a[96:99], a[224:227], v[248:251], a[96:99]
v_exp_f32_e64 v142, v142
v_mfma_f32_16x16x32_bf16 a[4:7], a[228:231], v[224:227], a[4:7]
ds_read_b128 a[196:199], v65 offset:49152
v_mfma_f32_16x16x32_bf16 a[36:39], a[228:231], v[232:235], a[36:39]
v_exp_f32_e64 v143, v143
v_mfma_f32_16x16x32_bf16 a[68:71], a[228:231], v[240:243], a[68:71]
v_exp_f32_e64 v144, v144
v_mfma_f32_16x16x32_bf16 a[100:103], a[228:231], v[248:251], a[100:103]
v_cvt_pk_bf16_f32 v138, v140, v141
v_cvt_pk_bf16_f32 v139, v142, v143
v_mfma_f32_16x16x32_bf16 v[112:115], v[76:79], v[224:227], v[112:115]
ds_read_b128 a[200:203], v66 offset:49152
v_mfma_f32_16x16x32_bf16 a[8:11], a[232:235], v[224:227], a[8:11]
v_exp_f32_e64 v145, v145
v_mfma_f32_16x16x32_bf16 a[40:43], a[232:235], v[232:235], a[40:43]
ds_read_b128 a[204:207], v67 offset:49152
v_mfma_f32_16x16x32_bf16 a[72:75], a[232:235], v[240:243], a[72:75]
v_exp_f32_e64 v146, v146
v_mfma_f32_16x16x32_bf16 a[104:107], a[232:235], v[248:251], a[104:107]
v_exp_f32_e64 v147, v147
v_mfma_f32_16x16x32_bf16 a[12:15], a[236:239], v[224:227], a[12:15]
v_mfma_f32_16x16x32_bf16 a[44:47], a[236:239], v[232:235], a[44:47]
v_exp_f32_e64 v148, v148
v_mfma_f32_16x16x32_bf16 a[76:79], a[236:239], v[240:243], a[76:79]
v_cvt_pk_bf16_f32 v144, v144, v145
v_cvt_pk_bf16_f32 v145, v146, v147
v_mfma_f32_16x16x32_bf16 a[108:111], a[236:239], v[248:251], a[108:111]
ds_read_b128 a[208:211], v64 offset:53248
v_mfma_f32_16x16x32_bf16 v[116:119], v[76:79], v[232:235], v[116:119]
v_exp_f32_e64 v149, v149
s_waitcnt lgkmcnt(5)
v_mfma_f32_16x16x32_bf16 a[16:19], a[240:243], v[224:227], a[16:19]
ds_read_b128 a[212:215], v65 offset:53248
v_mfma_f32_16x16x32_bf16 a[48:51], a[240:243], v[232:235], a[48:51]
v_exp_f32_e64 v150, v150
v_mfma_f32_16x16x32_bf16 a[80:83], a[240:243], v[240:243], a[80:83]
v_mfma_f32_16x16x32_bf16 a[112:115], a[240:243], v[248:251], a[112:115]
v_exp_f32_e64 v151, v151
v_mfma_f32_16x16x32_bf16 a[20:23], a[244:247], v[224:227], a[20:23]
v_exp_f32_e64 v152, v152
v_mfma_f32_16x16x32_bf16 a[52:55], a[244:247], v[232:235], a[52:55]
v_cvt_pk_bf16_f32 v146, v148, v149
v_cvt_pk_bf16_f32 v147, v150, v151
v_mfma_f32_16x16x32_bf16 a[84:87], a[244:247], v[240:243], a[84:87]
ds_read_b128 a[216:219], v66 offset:53248
v_mfma_f32_16x16x32_bf16 a[116:119], a[244:247], v[248:251], a[116:119]
v_exp_f32_e64 v153, v153
v_mfma_f32_16x16x32_bf16 v[120:123], v[76:79], v[240:243], v[120:123]
ds_read_b128 a[220:223], v67 offset:53248
v_mfma_f32_16x16x32_bf16 a[24:27], a[248:251], v[224:227], a[24:27]
v_exp_f32_e64 v154, v154
v_mfma_f32_16x16x32_bf16 a[56:59], a[248:251], v[232:235], a[56:59]
v_mfma_f32_16x16x32_bf16 a[88:91], a[248:251], v[240:243], a[88:91]
v_exp_f32_e64 v155, v155
v_mfma_f32_16x16x32_bf16 a[120:123], a[248:251], v[248:251], a[120:123]
v_exp_f32_e64 v156, v156
v_mfma_f32_16x16x32_bf16 a[28:31], a[252:255], v[224:227], a[28:31]
v_cvt_pk_bf16_f32 v152, v152, v153
v_cvt_pk_bf16_f32 v153, v154, v155
v_mfma_f32_16x16x32_bf16 a[60:63], a[252:255], v[232:235], a[60:63]
v_exp_f32_e64 v157, v157
v_mfma_f32_16x16x32_bf16 a[92:95], a[252:255], v[240:243], a[92:95]
v_mfma_f32_16x16x32_bf16 a[124:127], a[252:255], v[248:251], a[124:127]
v_exp_f32_e64 v158, v158
v_mfma_f32_16x16x32_bf16 v[124:127], v[76:79], v[248:251], v[124:127]
v_exp_f32_e64 v159, v159
s_mov_b32 s90, 238609295
s_mov_b32 s91, 9216
v_add_u32 v12, 0, v0
v_mul_hi_u32 v13, v12, s90
v_mul_u32_u24 v14, 18, v13
v_sub_u32 v14, v12, v14
v_mul_lo_u32 v13, v13, s91
v_lshl_add_u32 v52, v14, 4, v13
v_add_u32 v12, 64, v0
v_mul_hi_u32 v13, v12, s90
v_mul_u32_u24 v14, 18, v13
v_sub_u32 v14, v12, v14
v_mul_lo_u32 v13, v13, s91
v_lshl_add_u32 v53, v14, 4, v13
v_subrev_u32 v53, 1024, v53
v_add_u32 v12, 128, v0
v_mul_hi_u32 v13, v12, s90
v_mul_u32_u24 v14, 18, v13
v_sub_u32 v14, v12, v14
v_mul_lo_u32 v13, v13, s91
v_lshl_add_u32 v54, v14, 4, v13
v_subrev_u32 v54, 2048, v54
v_add_u32 v12, 192, v0
v_mul_hi_u32 v13, v12, s90
v_mul_u32_u24 v14, 18, v13
v_sub_u32 v14, v12, v14
v_mul_lo_u32 v13, v13, s91
v_lshl_add_u32 v55, v14, 4, v13
v_subrev_u32 v55, 3072, v55
v_add_u32 v12, 256, v0
v_mul_hi_u32 v13, v12, s90
v_mul_u32_u24 v14, 18, v13
v_sub_u32 v14, v12, v14
v_mul_lo_u32 v13, v13, s91
v_lshl_add_u32 v56, v14, 4, v13
v_add_u32 v12, 320, v0
v_mul_hi_u32 v13, v12, s90
v_mul_u32_u24 v14, 18, v13
v_sub_u32 v14, v12, v14
v_mul_lo_u32 v13, v13, s91
v_lshl_add_u32 v57, v14, 4, v13
v_subrev_u32 v57, 1024, v57
v_add_u32 v12, 384, v0
v_mul_hi_u32 v13, v12, s90
v_mul_u32_u24 v14, 18, v13
v_sub_u32 v14, v12, v14
v_mul_lo_u32 v13, v13, s91
v_lshl_add_u32 v58, v14, 4, v13
v_subrev_u32 v58, 2048, v58
v_add_u32 v12, 448, v0
v_mul_hi_u32 v13, v12, s90
v_mul_u32_u24 v14, 18, v13
v_sub_u32 v14, v12, v14
v_mul_lo_u32 v13, v13, s91
v_lshl_add_u32 v59, v14, 4, v13
v_subrev_u32 v59, 3072, v59
v_add_u32 v12, 512, v0
v_mul_hi_u32 v13, v12, s90
v_mul_u32_u24 v14, 18, v13
v_sub_u32 v14, v12, v14
v_mul_lo_u32 v13, v13, s91
v_lshl_add_u32 v60, v14, 4, v13
s_add_u32 s16, s88, 0x900000
s_addc_u32 s17, s89, 0
s_mov_b32 s18, 0x20000
s_mov_b32 s19, 0x00020000
s_lshl_b32 s62, s50, 4
s_lshl_b32 s34, s24, 2
s_add_u32 s62, s62, s34
s_mul_i32 s94, s62, 18432
s_lshl_b32 s91, s62, 10
s_mul_i32 s92, s24, 294912
s_mul_i32 s93, s24, 9216
v_and_b32 v27, 15, v0
v_lshlrev_b32 v27, 6, v27
v_and_b32 v21, 0x30, v0
v_add_u32 v27, v27, v21
s_mul_i32 s33, s51, 288
buffer_load_dwordx4 v[84:87], v27, s[16:19], s91 offen offset:0
buffer_load_dwordx4 v[88:91], v27, s[16:19], s91 offen offset:1024
buffer_load_dwordx4 v[92:95], v27, s[16:19], s91 offen offset:2048
buffer_load_dwordx4 v[28:31], v27, s[16:19], s91 offen offset:3072
s_add_u32 s16, s80, s33
s_addc_u32 s17, s81, 0
s_mov_b32 s18, 0x0
s_mov_b32 s19, 0x00020000
s_sub_u32 s18, 5308416, s33
s_waitcnt lgkmcnt(0)
v_mfma_f32_16x16x32_bf16 v[192:195], a[192:195], a[128:131], v[96:99]
v_exp_f32_e64 v160, v160
v_mfma_f32_16x16x32_bf16 v[192:195], a[196:199], a[132:135], v[192:195]
ds_read_b64_tr_b16 a[224:225], v68 offset:32768
v_mfma_f32_16x16x32_bf16 v[192:195], a[200:203], a[136:139], v[192:195]
v_cvt_pk_bf16_f32 v154, v156, v157
v_cvt_pk_bf16_f32 v155, v158, v159
v_mfma_f32_16x16x32_bf16 v[192:195], a[204:207], a[140:143], v[192:195]
ds_read_b64_tr_b16 a[226:227], v68 offset:36864
v_mfma_f32_16x16x32_bf16 v[196:199], a[208:211], a[128:131], v[96:99]
v_exp_f32_e64 v161, v161
v_mfma_f32_16x16x32_bf16 v[196:199], a[212:215], a[132:135], v[196:199]
ds_read_b64_tr_b16 a[228:229], v69 offset:32768
v_mfma_f32_16x16x32_bf16 v[196:199], a[216:219], a[136:139], v[196:199]
v_exp_f32_e64 v162, v162
v_mfma_f32_16x16x32_bf16 v[196:199], a[220:223], a[140:143], v[196:199]
ds_read_b64_tr_b16 a[230:231], v69 offset:36864
v_mfma_f32_16x16x32_bf16 v[200:203], a[192:195], a[144:147], v[100:103]
v_exp_f32_e64 v163, v163
v_mfma_f32_16x16x32_bf16 v[200:203], a[196:199], a[148:151], v[200:203]
ds_read_b64_tr_b16 a[232:233], v70 offset:32768
v_mfma_f32_16x16x32_bf16 v[200:203], a[200:203], a[152:155], v[200:203]
v_exp_f32_e64 v164, v164
v_mfma_f32_16x16x32_bf16 v[200:203], a[204:207], a[156:159], v[200:203]
ds_read_b64_tr_b16 a[234:235], v70 offset:36864
v_mfma_f32_16x16x32_bf16 v[204:207], a[208:211], a[144:147], v[100:103]
v_exp_f32_e64 v165, v165
v_mfma_f32_16x16x32_bf16 v[204:207], a[212:215], a[148:151], v[204:207]
ds_read_b64_tr_b16 a[236:237], v71 offset:32768
v_mfma_f32_16x16x32_bf16 v[204:207], a[216:219], a[152:155], v[204:207]
v_cvt_pk_bf16_f32 v160, v160, v161
v_cvt_pk_bf16_f32 v161, v162, v163
v_mfma_f32_16x16x32_bf16 v[204:207], a[220:223], a[156:159], v[204:207]
ds_read_b64_tr_b16 a[238:239], v71 offset:36864
v_mfma_f32_16x16x32_bf16 v[208:211], a[192:195], a[160:163], v[104:107]
v_exp_f32_e64 v166, v166
v_mfma_f32_16x16x32_bf16 v[208:211], a[196:199], a[164:167], v[208:211]
ds_read_b64_tr_b16 a[240:241], v72 offset:32768
v_mfma_f32_16x16x32_bf16 v[208:211], a[200:203], a[168:171], v[208:211]
v_exp_f32_e64 v167, v167
v_mfma_f32_16x16x32_bf16 v[208:211], a[204:207], a[172:175], v[208:211]
ds_read_b64_tr_b16 a[242:243], v72 offset:36864
v_mfma_f32_16x16x32_bf16 v[212:215], a[208:211], a[160:163], v[104:107]
v_exp_f32_e64 v168, v168
v_mfma_f32_16x16x32_bf16 v[212:215], a[212:215], a[164:167], v[212:215]
ds_read_b64_tr_b16 a[244:245], v73 offset:32768
v_mfma_f32_16x16x32_bf16 v[212:215], a[216:219], a[168:171], v[212:215]
v_exp_f32_e64 v169, v169
v_mfma_f32_16x16x32_bf16 v[212:215], a[220:223], a[172:175], v[212:215]
ds_read_b64_tr_b16 a[246:247], v73 offset:36864
v_mfma_f32_16x16x32_bf16 v[216:219], a[192:195], a[176:179], v[108:111]
v_cvt_pk_bf16_f32 v162, v164, v165
v_cvt_pk_bf16_f32 v163, v166, v167
v_mfma_f32_16x16x32_bf16 v[216:219], a[196:199], a[180:183], v[216:219]
ds_read_b64_tr_b16 a[248:249], v74 offset:32768
v_mfma_f32_16x16x32_bf16 v[216:219], a[200:203], a[184:187], v[216:219]
v_exp_f32_e64 v170, v170
v_mfma_f32_16x16x32_bf16 v[216:219], a[204:207], a[188:191], v[216:219]
ds_read_b64_tr_b16 a[250:251], v74 offset:36864
v_mfma_f32_16x16x32_bf16 v[220:223], a[208:211], a[176:179], v[108:111]
v_exp_f32_e64 v171, v171
v_mfma_f32_16x16x32_bf16 v[220:223], a[212:215], a[180:183], v[220:223]
ds_read_b64_tr_b16 a[252:253], v75 offset:32768
v_mfma_f32_16x16x32_bf16 v[220:223], a[216:219], a[184:187], v[220:223]
v_exp_f32_e64 v172, v172
v_mfma_f32_16x16x32_bf16 v[220:223], a[220:223], a[188:191], v[220:223]
ds_read_b64_tr_b16 a[254:255], v75 offset:36864
s_waitcnt lgkmcnt(8)
v_mfma_f32_16x16x32_bf16 a[0:3], a[224:227], v[128:131], a[0:3]
v_exp_f32_e64 v173, v173
v_mfma_f32_16x16x32_bf16 a[32:35], a[224:227], v[136:139], a[32:35]
v_cvt_pk_bf16_f32 v168, v168, v169
v_cvt_pk_bf16_f32 v169, v170, v171
v_mfma_f32_16x16x32_bf16 a[64:67], a[224:227], v[144:147], a[64:67]
ds_read_b128 a[192:195], v64 offset:57344
v_mfma_f32_16x16x32_bf16 a[96:99], a[224:227], v[152:155], a[96:99]
v_exp_f32_e64 v174, v174
v_mfma_f32_16x16x32_bf16 a[4:7], a[228:231], v[128:131], a[4:7]
ds_read_b128 a[196:199], v65 offset:57344
v_mfma_f32_16x16x32_bf16 a[36:39], a[228:231], v[136:139], a[36:39]
v_exp_f32_e64 v175, v175
v_mfma_f32_16x16x32_bf16 a[68:71], a[228:231], v[144:147], a[68:71]
v_exp_f32_e64 v176, v176
v_mfma_f32_16x16x32_bf16 a[100:103], a[228:231], v[152:155], a[100:103]
v_cvt_pk_bf16_f32 v170, v172, v173
v_cvt_pk_bf16_f32 v171, v174, v175
v_mfma_f32_16x16x32_bf16 v[112:115], v[76:79], v[128:131], v[112:115]
ds_read_b128 a[200:203], v66 offset:57344
v_mfma_f32_16x16x32_bf16 a[8:11], a[232:235], v[128:131], a[8:11]
v_exp_f32_e64 v177, v177
v_mfma_f32_16x16x32_bf16 a[40:43], a[232:235], v[136:139], a[40:43]
ds_read_b128 a[204:207], v67 offset:57344
v_mfma_f32_16x16x32_bf16 a[72:75], a[232:235], v[144:147], a[72:75]
v_exp_f32_e64 v178, v178
v_mfma_f32_16x16x32_bf16 a[104:107], a[232:235], v[152:155], a[104:107]
v_exp_f32_e64 v179, v179
v_mfma_f32_16x16x32_bf16 a[12:15], a[236:239], v[128:131], a[12:15]
v_mfma_f32_16x16x32_bf16 a[44:47], a[236:239], v[136:139], a[44:47]
v_exp_f32_e64 v180, v180
v_mfma_f32_16x16x32_bf16 a[76:79], a[236:239], v[144:147], a[76:79]
v_cvt_pk_bf16_f32 v176, v176, v177
v_cvt_pk_bf16_f32 v177, v178, v179
v_mfma_f32_16x16x32_bf16 a[108:111], a[236:239], v[152:155], a[108:111]
ds_read_b128 a[208:211], v64 offset:61440
v_mfma_f32_16x16x32_bf16 v[116:119], v[76:79], v[136:139], v[116:119]
v_exp_f32_e64 v181, v181
s_waitcnt lgkmcnt(5)
v_mfma_f32_16x16x32_bf16 a[16:19], a[240:243], v[128:131], a[16:19]
ds_read_b128 a[212:215], v65 offset:61440
v_mfma_f32_16x16x32_bf16 a[48:51], a[240:243], v[136:139], a[48:51]
v_exp_f32_e64 v182, v182
v_mfma_f32_16x16x32_bf16 a[80:83], a[240:243], v[144:147], a[80:83]
v_mfma_f32_16x16x32_bf16 a[112:115], a[240:243], v[152:155], a[112:115]
v_exp_f32_e64 v183, v183
v_mfma_f32_16x16x32_bf16 a[20:23], a[244:247], v[128:131], a[20:23]
v_exp_f32_e64 v184, v184
v_mfma_f32_16x16x32_bf16 a[52:55], a[244:247], v[136:139], a[52:55]
v_cvt_pk_bf16_f32 v178, v180, v181
v_cvt_pk_bf16_f32 v179, v182, v183
v_mfma_f32_16x16x32_bf16 a[84:87], a[244:247], v[144:147], a[84:87]
ds_read_b128 a[216:219], v66 offset:61440
v_mfma_f32_16x16x32_bf16 a[116:119], a[244:247], v[152:155], a[116:119]
v_exp_f32_e64 v185, v185
v_mfma_f32_16x16x32_bf16 v[120:123], v[76:79], v[144:147], v[120:123]
ds_read_b128 a[220:223], v67 offset:61440
v_mfma_f32_16x16x32_bf16 a[24:27], a[248:251], v[128:131], a[24:27]
v_exp_f32_e64 v186, v186
v_mfma_f32_16x16x32_bf16 a[56:59], a[248:251], v[136:139], a[56:59]
v_mfma_f32_16x16x32_bf16 a[88:91], a[248:251], v[144:147], a[88:91]
v_exp_f32_e64 v187, v187
v_mfma_f32_16x16x32_bf16 a[120:123], a[248:251], v[152:155], a[120:123]
v_exp_f32_e64 v188, v188
v_mfma_f32_16x16x32_bf16 a[28:31], a[252:255], v[128:131], a[28:31]
v_cvt_pk_bf16_f32 v184, v184, v185
v_cvt_pk_bf16_f32 v185, v186, v187
v_mfma_f32_16x16x32_bf16 a[60:63], a[252:255], v[136:139], a[60:63]
v_exp_f32_e64 v189, v189
v_mfma_f32_16x16x32_bf16 a[92:95], a[252:255], v[144:147], a[92:95]
v_mfma_f32_16x16x32_bf16 a[124:127], a[252:255], v[152:155], a[124:127]
v_exp_f32_e64 v190, v190
v_mfma_f32_16x16x32_bf16 v[124:127], v[76:79], v[152:155], v[124:127]
v_exp_f32_e64 v191, v191
s_waitcnt lgkmcnt(0)
v_mfma_f32_16x16x32_bf16 v[224:227], a[192:195], a[128:131], v[96:99]
v_exp_f32_e64 v192, v192
v_mfma_f32_16x16x32_bf16 v[224:227], a[196:199], a[132:135], v[224:227]
ds_read_b64_tr_b16 a[224:225], v68 offset:40960
v_mfma_f32_16x16x32_bf16 v[224:227], a[200:203], a[136:139], v[224:227]
v_cvt_pk_bf16_f32 v186, v188, v189
v_cvt_pk_bf16_f32 v187, v190, v191
v_mfma_f32_16x16x32_bf16 v[224:227], a[204:207], a[140:143], v[224:227]
ds_read_b64_tr_b16 a[226:227], v68 offset:45056
v_mfma_f32_16x16x32_bf16 v[228:231], a[208:211], a[128:131], v[96:99]
v_exp_f32_e64 v193, v193
v_mfma_f32_16x16x32_bf16 v[228:231], a[212:215], a[132:135], v[228:231]
ds_read_b64_tr_b16 a[228:229], v69 offset:40960
v_mfma_f32_16x16x32_bf16 v[228:231], a[216:219], a[136:139], v[228:231]
v_exp_f32_e64 v194, v194
v_mfma_f32_16x16x32_bf16 v[228:231], a[220:223], a[140:143], v[228:231]
ds_read_b64_tr_b16 a[230:231], v69 offset:45056
v_mfma_f32_16x16x32_bf16 v[232:235], a[192:195], a[144:147], v[100:103]
v_exp_f32_e64 v195, v195
v_mfma_f32_16x16x32_bf16 v[232:235], a[196:199], a[148:151], v[232:235]
ds_read_b64_tr_b16 a[232:233], v70 offset:40960
v_mfma_f32_16x16x32_bf16 v[232:235], a[200:203], a[152:155], v[232:235]
v_exp_f32_e64 v196, v196
v_mfma_f32_16x16x32_bf16 v[232:235], a[204:207], a[156:159], v[232:235]
ds_read_b64_tr_b16 a[234:235], v70 offset:45056
v_mfma_f32_16x16x32_bf16 v[236:239], a[208:211], a[144:147], v[100:103]
v_exp_f32_e64 v197, v197
v_mfma_f32_16x16x32_bf16 v[236:239], a[212:215], a[148:151], v[236:239]
ds_read_b64_tr_b16 a[236:237], v71 offset:40960
v_mfma_f32_16x16x32_bf16 v[236:239], a[216:219], a[152:155], v[236:239]
v_cvt_pk_bf16_f32 v192, v192, v193
v_cvt_pk_bf16_f32 v193, v194, v195
v_mfma_f32_16x16x32_bf16 v[236:239], a[220:223], a[156:159], v[236:239]
ds_read_b64_tr_b16 a[238:239], v71 offset:45056
v_mfma_f32_16x16x32_bf16 v[240:243], a[192:195], a[160:163], v[104:107]
v_exp_f32_e64 v198, v198
v_mfma_f32_16x16x32_bf16 v[240:243], a[196:199], a[164:167], v[240:243]
ds_read_b64_tr_b16 a[240:241], v72 offset:40960
v_mfma_f32_16x16x32_bf16 v[240:243], a[200:203], a[168:171], v[240:243]
v_exp_f32_e64 v199, v199
v_mfma_f32_16x16x32_bf16 v[240:243], a[204:207], a[172:175], v[240:243]
ds_read_b64_tr_b16 a[242:243], v72 offset:45056
v_mfma_f32_16x16x32_bf16 v[244:247], a[208:211], a[160:163], v[104:107]
v_exp_f32_e64 v200, v200
v_mfma_f32_16x16x32_bf16 v[244:247], a[212:215], a[164:167], v[244:247]
ds_read_b64_tr_b16 a[244:245], v73 offset:40960
v_mfma_f32_16x16x32_bf16 v[244:247], a[216:219], a[168:171], v[244:247]
v_exp_f32_e64 v201, v201
v_mfma_f32_16x16x32_bf16 v[244:247], a[220:223], a[172:175], v[244:247]
ds_read_b64_tr_b16 a[246:247], v73 offset:45056
v_mfma_f32_16x16x32_bf16 v[248:251], a[192:195], a[176:179], v[108:111]
v_cvt_pk_bf16_f32 v194, v196, v197
v_cvt_pk_bf16_f32 v195, v198, v199
v_mfma_f32_16x16x32_bf16 v[248:251], a[196:199], a[180:183], v[248:251]
ds_read_b64_tr_b16 a[248:249], v74 offset:40960
v_mfma_f32_16x16x32_bf16 v[248:251], a[200:203], a[184:187], v[248:251]
v_exp_f32_e64 v202, v202
v_mfma_f32_16x16x32_bf16 v[248:251], a[204:207], a[188:191], v[248:251]
ds_read_b64_tr_b16 a[250:251], v74 offset:45056
v_mfma_f32_16x16x32_bf16 v[252:255], a[208:211], a[176:179], v[108:111]
v_exp_f32_e64 v203, v203
v_mfma_f32_16x16x32_bf16 v[252:255], a[212:215], a[180:183], v[252:255]
ds_read_b64_tr_b16 a[252:253], v75 offset:40960
v_mfma_f32_16x16x32_bf16 v[252:255], a[216:219], a[184:187], v[252:255]
v_exp_f32_e64 v204, v204
v_mfma_f32_16x16x32_bf16 v[252:255], a[220:223], a[188:191], v[252:255]
ds_read_b64_tr_b16 a[254:255], v75 offset:45056
s_waitcnt vmcnt(6) lgkmcnt(8)
s_barrier
v_mfma_f32_16x16x32_bf16 a[0:3], a[224:227], v[160:163], a[0:3]
v_exp_f32_e64 v205, v205
v_mfma_f32_16x16x32_bf16 a[32:35], a[224:227], v[168:171], a[32:35]
v_cvt_pk_bf16_f32 v200, v200, v201
v_cvt_pk_bf16_f32 v201, v202, v203
v_mfma_f32_16x16x32_bf16 a[64:67], a[224:227], v[176:179], a[64:67]
s_add_u32 m0, s93, 0
s_add_u32 s3, s92, 0
buffer_load_dwordx4 v52, s[16:19], s3 offen offset:0 lds
v_mfma_f32_16x16x32_bf16 a[96:99], a[224:227], v[184:187], a[96:99]
v_exp_f32_e64 v206, v206
v_mfma_f32_16x16x32_bf16 a[4:7], a[228:231], v[160:163], a[4:7]
v_mfma_f32_16x16x32_bf16 a[36:39], a[228:231], v[168:171], a[36:39]
v_exp_f32_e64 v207, v207
v_mfma_f32_16x16x32_bf16 a[68:71], a[228:231], v[176:179], a[68:71]
v_exp_f32_e64 v208, v208
s_add_u32 m0, s93, 0
s_add_u32 s3, s92, 0
buffer_load_dwordx4 v53, s[16:19], s3 offen offset:1024 lds
v_mfma_f32_16x16x32_bf16 a[100:103], a[228:231], v[184:187], a[100:103]
v_cvt_pk_bf16_f32 v202, v204, v205
v_cvt_pk_bf16_f32 v203, v206, v207
v_mfma_f32_16x16x32_bf16 v[112:115], v[76:79], v[160:163], v[112:115]
v_mfma_f32_16x16x32_bf16 a[8:11], a[232:235], v[160:163], a[8:11]
v_exp_f32_e64 v209, v209
v_mfma_f32_16x16x32_bf16 a[40:43], a[232:235], v[168:171], a[40:43]
s_add_u32 m0, s93, 0
s_add_u32 s3, s92, 0
buffer_load_dwordx4 v54, s[16:19], s3 offen offset:2048 lds
v_mfma_f32_16x16x32_bf16 a[72:75], a[232:235], v[176:179], a[72:75]
v_exp_f32_e64 v210, v210
v_mfma_f32_16x16x32_bf16 a[104:107], a[232:235], v[184:187], a[104:107]
v_exp_f32_e64 v211, v211
v_mfma_f32_16x16x32_bf16 a[12:15], a[236:239], v[160:163], a[12:15]
s_add_u32 m0, s93, 0
s_add_u32 s3, s92, 0
buffer_load_dwordx4 v55, s[16:19], s3 offen offset:3072 lds
v_mfma_f32_16x16x32_bf16 a[44:47], a[236:239], v[168:171], a[44:47]
v_exp_f32_e64 v212, v212
v_mfma_f32_16x16x32_bf16 a[76:79], a[236:239], v[176:179], a[76:79]
v_cvt_pk_bf16_f32 v208, v208, v209
v_cvt_pk_bf16_f32 v209, v210, v211
v_mfma_f32_16x16x32_bf16 a[108:111], a[236:239], v[184:187], a[108:111]
s_add_u32 m0, s93, 4096
s_add_u32 s3, s92, 0
buffer_load_dwordx4 v56, s[16:19], s3 offen offset:0 lds
v_mfma_f32_16x16x32_bf16 v[116:119], v[76:79], v[168:171], v[116:119]
v_exp_f32_e64 v213, v213
s_waitcnt lgkmcnt(0)
v_mfma_f32_16x16x32_bf16 a[16:19], a[240:243], v[160:163], a[16:19]
v_mfma_f32_16x16x32_bf16 a[48:51], a[240:243], v[168:171], a[48:51]
v_exp_f32_e64 v214, v214
v_mfma_f32_16x16x32_bf16 a[80:83], a[240:243], v[176:179], a[80:83]
s_add_u32 m0, s93, 4096
s_add_u32 s3, s92, 0
buffer_load_dwordx4 v57, s[16:19], s3 offen offset:1024 lds
v_mfma_f32_16x16x32_bf16 a[112:115], a[240:243], v[184:187], a[112:115]
v_exp_f32_e64 v215, v215
v_mfma_f32_16x16x32_bf16 a[20:23], a[244:247], v[160:163], a[20:23]
v_exp_f32_e64 v216, v216
v_mfma_f32_16x16x32_bf16 a[52:55], a[244:247], v[168:171], a[52:55]
v_cvt_pk_bf16_f32 v210, v212, v213
v_cvt_pk_bf16_f32 v211, v214, v215
v_mfma_f32_16x16x32_bf16 a[84:87], a[244:247], v[176:179], a[84:87]
s_add_u32 m0, s93, 4096
s_add_u32 s3, s92, 0
buffer_load_dwordx4 v58, s[16:19], s3 offen offset:2048 lds
v_mfma_f32_16x16x32_bf16 a[116:119], a[244:247], v[184:187], a[116:119]
v_exp_f32_e64 v217, v217
v_mfma_f32_16x16x32_bf16 v[120:123], v[76:79], v[176:179], v[120:123]
v_mfma_f32_16x16x32_bf16 a[24:27], a[248:251], v[160:163], a[24:27]
v_exp_f32_e64 v218, v218
v_mfma_f32_16x16x32_bf16 a[56:59], a[248:251], v[168:171], a[56:59]
s_add_u32 m0, s93, 4096
s_add_u32 s3, s92, 0
buffer_load_dwordx4 v59, s[16:19], s3 offen offset:3072 lds
v_mfma_f32_16x16x32_bf16 a[88:91], a[248:251], v[176:179], a[88:91]
v_exp_f32_e64 v219, v219
v_mfma_f32_16x16x32_bf16 a[120:123], a[248:251], v[184:187], a[120:123]
v_exp_f32_e64 v220, v220
v_mfma_f32_16x16x32_bf16 a[28:31], a[252:255], v[160:163], a[28:31]
v_cvt_pk_bf16_f32 v216, v216, v217
v_cvt_pk_bf16_f32 v217, v218, v219
v_mfma_f32_16x16x32_bf16 a[60:63], a[252:255], v[168:171], a[60:63]
v_exp_f32_e64 v221, v221
v_mfma_f32_16x16x32_bf16 a[92:95], a[252:255], v[176:179], a[92:95]
s_add_u32 m0, s93, 8192
s_add_u32 s3, s92, 0
buffer_load_dwordx4 v60, s[16:19], s3 offen offset:0 lds
v_mfma_f32_16x16x32_bf16 a[124:127], a[252:255], v[184:187], a[124:127]
v_exp_f32_e64 v222, v222
v_mfma_f32_16x16x32_bf16 v[124:127], v[76:79], v[184:187], v[124:127]
v_exp_f32_e64 v223, v223
s_waitcnt lgkmcnt(0)
v_exp_f32_e64 v224, v224
ds_read_b64_tr_b16 a[224:225], v68 offset:49152
v_cvt_pk_bf16_f32 v218, v220, v221
v_cvt_pk_bf16_f32 v219, v222, v223
s_add_u32 s3, s94, 0
buffer_load_dwordx4 a[192:195], v11, s[12:15], s3 offen
ds_read_b64_tr_b16 a[226:227], v68 offset:53248
v_exp_f32_e64 v225, v225
ds_read_b64_tr_b16 a[228:229], v69 offset:49152
v_exp_f32_e64 v226, v226
ds_read_b64_tr_b16 a[230:231], v69 offset:53248
v_exp_f32_e64 v227, v227
s_add_u32 s3, s94, 18432
buffer_load_dwordx4 a[196:199], v11, s[12:15], s3 offen
ds_read_b64_tr_b16 a[232:233], v70 offset:49152
v_exp_f32_e64 v228, v228
ds_read_b64_tr_b16 a[234:235], v70 offset:53248
v_exp_f32_e64 v229, v229
ds_read_b64_tr_b16 a[236:237], v71 offset:49152
v_cvt_pk_bf16_f32 v224, v224, v225
v_cvt_pk_bf16_f32 v225, v226, v227
s_add_u32 s3, s94, 36864
buffer_load_dwordx4 a[200:203], v11, s[12:15], s3 offen
ds_read_b64_tr_b16 a[238:239], v71 offset:53248
v_exp_f32_e64 v230, v230
ds_read_b64_tr_b16 a[240:241], v72 offset:49152
v_exp_f32_e64 v231, v231
ds_read_b64_tr_b16 a[242:243], v72 offset:53248
v_exp_f32_e64 v232, v232
s_add_u32 s3, s94, 55296
buffer_load_dwordx4 a[204:207], v11, s[12:15], s3 offen
ds_read_b64_tr_b16 a[244:245], v73 offset:49152
v_exp_f32_e64 v233, v233
ds_read_b64_tr_b16 a[246:247], v73 offset:53248
v_cvt_pk_bf16_f32 v226, v228, v229
v_cvt_pk_bf16_f32 v227, v230, v231
ds_read_b64_tr_b16 a[248:249], v74 offset:49152
v_exp_f32_e64 v234, v234
s_add_u32 s3, s94, 1024
buffer_load_dwordx4 a[208:211], v11, s[12:15], s3 offen
ds_read_b64_tr_b16 a[250:251], v74 offset:53248
v_exp_f32_e64 v235, v235
ds_read_b64_tr_b16 a[252:253], v75 offset:49152
v_exp_f32_e64 v236, v236
ds_read_b64_tr_b16 a[254:255], v75 offset:53248
s_waitcnt lgkmcnt(8)
v_mfma_f32_16x16x32_bf16 a[0:3], a[224:227], v[192:195], a[0:3]
v_exp_f32_e64 v237, v237
v_mfma_f32_16x16x32_bf16 a[32:35], a[224:227], v[200:203], a[32:35]
v_cvt_pk_bf16_f32 v232, v232, v233
v_cvt_pk_bf16_f32 v233, v234, v235
v_mfma_f32_16x16x32_bf16 a[64:67], a[224:227], v[208:211], a[64:67]
s_add_u32 s3, s94, 19456
buffer_load_dwordx4 a[212:215], v11, s[12:15], s3 offen
v_mfma_f32_16x16x32_bf16 a[96:99], a[224:227], v[216:219], a[96:99]
v_exp_f32_e64 v238, v238
v_mfma_f32_16x16x32_bf16 a[4:7], a[228:231], v[192:195], a[4:7]
v_mfma_f32_16x16x32_bf16 a[36:39], a[228:231], v[200:203], a[36:39]
v_exp_f32_e64 v239, v239
v_mfma_f32_16x16x32_bf16 a[68:71], a[228:231], v[208:211], a[68:71]
v_exp_f32_e64 v240, v240
v_mfma_f32_16x16x32_bf16 a[100:103], a[228:231], v[216:219], a[100:103]
v_cvt_pk_bf16_f32 v234, v236, v237
v_cvt_pk_bf16_f32 v235, v238, v239
v_mfma_f32_16x16x32_bf16 v[112:115], v[76:79], v[192:195], v[112:115]
v_mfma_f32_16x16x32_bf16 a[8:11], a[232:235], v[192:195], a[8:11]
v_exp_f32_e64 v241, v241
v_mfma_f32_16x16x32_bf16 a[40:43], a[232:235], v[200:203], a[40:43]
s_add_u32 s3, s94, 37888
buffer_load_dwordx4 a[216:219], v11, s[12:15], s3 offen
v_mfma_f32_16x16x32_bf16 a[72:75], a[232:235], v[208:211], a[72:75]
v_exp_f32_e64 v242, v242
v_mfma_f32_16x16x32_bf16 a[104:107], a[232:235], v[216:219], a[104:107]
v_exp_f32_e64 v243, v243
v_mfma_f32_16x16x32_bf16 a[12:15], a[236:239], v[192:195], a[12:15]
v_mfma_f32_16x16x32_bf16 a[44:47], a[236:239], v[200:203], a[44:47]
v_exp_f32_e64 v244, v244
v_mfma_f32_16x16x32_bf16 a[76:79], a[236:239], v[208:211], a[76:79]
v_cvt_pk_bf16_f32 v240, v240, v241
v_cvt_pk_bf16_f32 v241, v242, v243
v_mfma_f32_16x16x32_bf16 a[108:111], a[236:239], v[216:219], a[108:111]
v_mfma_f32_16x16x32_bf16 v[116:119], v[76:79], v[200:203], v[116:119]
v_exp_f32_e64 v245, v245
s_waitcnt lgkmcnt(0)
v_mfma_f32_16x16x32_bf16 a[16:19], a[240:243], v[192:195], a[16:19]
s_add_u32 s3, s94, 56320
buffer_load_dwordx4 a[220:223], v11, s[12:15], s3 offen
v_mfma_f32_16x16x32_bf16 a[48:51], a[240:243], v[200:203], a[48:51]
v_exp_f32_e64 v246, v246
v_mfma_f32_16x16x32_bf16 a[80:83], a[240:243], v[208:211], a[80:83]
v_mfma_f32_16x16x32_bf16 a[112:115], a[240:243], v[216:219], a[112:115]
v_exp_f32_e64 v247, v247
v_mfma_f32_16x16x32_bf16 a[20:23], a[244:247], v[192:195], a[20:23]
v_exp_f32_e64 v248, v248
v_mfma_f32_16x16x32_bf16 a[52:55], a[244:247], v[200:203], a[52:55]
v_cvt_pk_bf16_f32 v242, v244, v245
v_cvt_pk_bf16_f32 v243, v246, v247
v_mfma_f32_16x16x32_bf16 a[84:87], a[244:247], v[208:211], a[84:87]
v_mfma_f32_16x16x32_bf16 a[116:119], a[244:247], v[216:219], a[116:119]
v_exp_f32_e64 v249, v249
v_mfma_f32_16x16x32_bf16 v[120:123], v[76:79], v[208:211], v[120:123]
v_mfma_f32_16x16x32_bf16 a[24:27], a[248:251], v[192:195], a[24:27]
v_exp_f32_e64 v250, v250
v_mfma_f32_16x16x32_bf16 a[56:59], a[248:251], v[200:203], a[56:59]
v_mfma_f32_16x16x32_bf16 a[88:91], a[248:251], v[208:211], a[88:91]
v_exp_f32_e64 v251, v251
v_mfma_f32_16x16x32_bf16 a[120:123], a[248:251], v[216:219], a[120:123]
v_exp_f32_e64 v252, v252
v_mfma_f32_16x16x32_bf16 a[28:31], a[252:255], v[192:195], a[28:31]
v_cvt_pk_bf16_f32 v248, v248, v249
v_cvt_pk_bf16_f32 v249, v250, v251
v_mfma_f32_16x16x32_bf16 a[60:63], a[252:255], v[200:203], a[60:63]
v_exp_f32_e64 v253, v253
v_mfma_f32_16x16x32_bf16 a[92:95], a[252:255], v[208:211], a[92:95]
v_mfma_f32_16x16x32_bf16 a[124:127], a[252:255], v[216:219], a[124:127]
v_exp_f32_e64 v254, v254
v_mfma_f32_16x16x32_bf16 v[124:127], v[76:79], v[216:219], v[124:127]
v_exp_f32_e64 v255, v255
v_cvt_pk_bf16_f32 v250, v252, v253
v_cvt_pk_bf16_f32 v251, v254, v255
ds_read_b64_tr_b16 a[224:225], v68 offset:57344
ds_read_b64_tr_b16 a[226:227], v68 offset:61440
ds_read_b64_tr_b16 a[228:229], v69 offset:57344
ds_read_b64_tr_b16 a[230:231], v69 offset:61440
ds_read_b64_tr_b16 a[232:233], v70 offset:57344
ds_read_b64_tr_b16 a[234:235], v70 offset:61440
ds_read_b64_tr_b16 a[236:237], v71 offset:57344
ds_read_b64_tr_b16 a[238:239], v71 offset:61440
ds_read_b64_tr_b16 a[240:241], v72 offset:57344
ds_read_b64_tr_b16 a[242:243], v72 offset:61440
ds_read_b64_tr_b16 a[244:245], v73 offset:57344
ds_read_b64_tr_b16 a[246:247], v73 offset:61440
ds_read_b64_tr_b16 a[248:249], v74 offset:57344
ds_read_b64_tr_b16 a[250:251], v74 offset:61440
ds_read_b64_tr_b16 a[252:253], v75 offset:57344
ds_read_b64_tr_b16 a[254:255], v75 offset:61440
s_mul_i32 s30, s24, 9216
v_subrev_u32 v49, s30, v49
v_add_u32 v50, 64512, v49
v_add_u32 v51, 129024, v49
s_waitcnt lgkmcnt(0)
v_mfma_f32_16x16x32_bf16 v[112:115], v[76:79], v[224:227], v[112:115]
v_mfma_f32_16x16x32_bf16 v[116:119], v[76:79], v[232:235], v[116:119]
v_mfma_f32_16x16x32_bf16 v[120:123], v[76:79], v[240:243], v[120:123]
v_mfma_f32_16x16x32_bf16 v[124:127], v[76:79], v[248:251], v[124:127]
v_mfma_f32_16x16x32_bf16 a[0:3], a[224:227], v[224:227], a[0:3]
v_mfma_f32_16x16x32_bf16 a[32:35], a[224:227], v[232:235], a[32:35]
v_mfma_f32_16x16x32_bf16 a[64:67], a[224:227], v[240:243], a[64:67]
v_mfma_f32_16x16x32_bf16 a[96:99], a[224:227], v[248:251], a[96:99]
v_mfma_f32_16x16x32_bf16 a[4:7], a[228:231], v[224:227], a[4:7]
v_mfma_f32_16x16x32_bf16 a[36:39], a[228:231], v[232:235], a[36:39]
v_mfma_f32_16x16x32_bf16 a[68:71], a[228:231], v[240:243], a[68:71]
v_mfma_f32_16x16x32_bf16 a[100:103], a[228:231], v[248:251], a[100:103]
v_mfma_f32_16x16x32_bf16 a[8:11], a[232:235], v[224:227], a[8:11]
v_mfma_f32_16x16x32_bf16 a[40:43], a[232:235], v[232:235], a[40:43]
v_mfma_f32_16x16x32_bf16 a[72:75], a[232:235], v[240:243], a[72:75]
v_mfma_f32_16x16x32_bf16 a[104:107], a[232:235], v[248:251], a[104:107]
v_mfma_f32_16x16x32_bf16 a[12:15], a[236:239], v[224:227], a[12:15]
v_mfma_f32_16x16x32_bf16 a[44:47], a[236:239], v[232:235], a[44:47]
v_mfma_f32_16x16x32_bf16 a[76:79], a[236:239], v[240:243], a[76:79]
v_mfma_f32_16x16x32_bf16 a[108:111], a[236:239], v[248:251], a[108:111]
v_mfma_f32_16x16x32_bf16 a[16:19], a[240:243], v[224:227], a[16:19]
v_mfma_f32_16x16x32_bf16 a[48:51], a[240:243], v[232:235], a[48:51]
v_mfma_f32_16x16x32_bf16 a[80:83], a[240:243], v[240:243], a[80:83]
v_mfma_f32_16x16x32_bf16 a[112:115], a[240:243], v[248:251], a[112:115]
v_mfma_f32_16x16x32_bf16 a[20:23], a[244:247], v[224:227], a[20:23]
v_mfma_f32_16x16x32_bf16 a[52:55], a[244:247], v[232:235], a[52:55]
v_mfma_f32_16x16x32_bf16 a[84:87], a[244:247], v[240:243], a[84:87]
v_mfma_f32_16x16x32_bf16 a[116:119], a[244:247], v[248:251], a[116:119]
v_mfma_f32_16x16x32_bf16 a[24:27], a[248:251], v[224:227], a[24:27]
v_mfma_f32_16x16x32_bf16 a[56:59], a[248:251], v[232:235], a[56:59]
v_mfma_f32_16x16x32_bf16 a[88:91], a[248:251], v[240:243], a[88:91]
v_mfma_f32_16x16x32_bf16 a[120:123], a[248:251], v[248:251], a[120:123]
v_mfma_f32_16x16x32_bf16 a[28:31], a[252:255], v[224:227], a[28:31]
v_mfma_f32_16x16x32_bf16 a[60:63], a[252:255], v[232:235], a[60:63]
v_mfma_f32_16x16x32_bf16 a[92:95], a[252:255], v[240:243], a[92:95]
v_mfma_f32_16x16x32_bf16 a[124:127], a[252:255], v[248:251], a[124:127]
s_waitcnt vmcnt(17)
s_mov_b32 s78, 0x3ae38e39
s_mov_b32 s79, 0x3c4ccccd
s_mov_b32 s82, 0x3c800000
s_mov_b32 s83, 0x42a00000
s_mov_b32 s63, 0x42800000
s_mov_b32 s91, 0x3727c5ac
v_add_f32 v12, v84, v86
v_mov_b32 v13, v12
s_nop 1
v_permlane16_swap_b32 v12, v13
s_nop 1
v_add_f32 v12, v12, v13
v_mov_b32 v13, v12
s_nop 1
v_permlane32_swap_b32 v12, v13
s_nop 1
v_add_f32 v12, v12, v13
v_mul_f32 v12, s78, v12
v_add_f32 v14, v85, v87
v_fma_f32 v16, v84, s79, -v12
v_mul_f32 v17, s83, v16
v_fmac_f32 v14, v17, v16
v_fma_f32 v16, v86, s82, -v12
v_mul_f32 v17, s63, v16
v_fmac_f32 v14, v17, v16
v_sub_f32 v40, 0, v12
v_mov_b32 v15, v14
s_nop 1
v_permlane16_swap_b32 v14, v15
s_nop 1
v_add_f32 v14, v14, v15
v_mov_b32 v15, v14
s_nop 1
v_permlane32_swap_b32 v14, v15
s_nop 1
v_add_f32 v14, v14, v15
v_mov_b32 v16, s91
v_fmac_f32 v16, s78, v14
v_rsq_f32 v44, v16
v_add_f32 v12, v88, v90
v_mov_b32 v13, v12
s_nop 1
v_permlane16_swap_b32 v12, v13
s_nop 1
v_add_f32 v12, v12, v13
v_mov_b32 v13, v12
s_nop 1
v_permlane32_swap_b32 v12, v13
s_nop 1
v_add_f32 v12, v12, v13
v_mul_f32 v12, s78, v12
v_add_f32 v14, v89, v91
v_fma_f32 v16, v88, s79, -v12
v_mul_f32 v17, s83, v16
v_fmac_f32 v14, v17, v16
v_fma_f32 v16, v90, s82, -v12
v_mul_f32 v17, s63, v16
v_fmac_f32 v14, v17, v16
v_sub_f32 v41, 0, v12
v_mov_b32 v15, v14
s_nop 1
v_permlane16_swap_b32 v14, v15
s_nop 1
v_add_f32 v14, v14, v15
v_mov_b32 v15, v14
s_nop 1
v_permlane32_swap_b32 v14, v15
s_nop 1
v_add_f32 v14, v14, v15
v_mov_b32 v16, s91
v_fmac_f32 v16, s78, v14
v_rsq_f32 v45, v16
v_add_f32 v12, v92, v94
v_mov_b32 v13, v12
s_nop 1
v_permlane16_swap_b32 v12, v13
s_nop 1
v_add_f32 v12, v12, v13
v_mov_b32 v13, v12
s_nop 1
v_permlane32_swap_b32 v12, v13
s_nop 1
v_add_f32 v12, v12, v13
v_mul_f32 v12, s78, v12
v_add_f32 v14, v93, v95
v_fma_f32 v16, v92, s79, -v12
v_mul_f32 v17, s83, v16
v_fmac_f32 v14, v17, v16
v_fma_f32 v16, v94, s82, -v12
v_mul_f32 v17, s63, v16
v_fmac_f32 v14, v17, v16
v_sub_f32 v42, 0, v12
v_mov_b32 v15, v14
s_nop 1
v_permlane16_swap_b32 v14, v15
s_nop 1
v_add_f32 v14, v14, v15
v_mov_b32 v15, v14
s_nop 1
v_permlane32_swap_b32 v14, v15
s_nop 1
v_add_f32 v14, v14, v15
v_mov_b32 v16, s91
v_fmac_f32 v16, s78, v14
v_rsq_f32 v46, v16
v_add_f32 v12, v28, v30
v_mov_b32 v13, v12
s_nop 1
v_permlane16_swap_b32 v12, v13
s_nop 1
v_add_f32 v12, v12, v13
v_mov_b32 v13, v12
s_nop 1
v_permlane32_swap_b32 v12, v13
s_nop 1
v_add_f32 v12, v12, v13
v_mul_f32 v12, s78, v12
v_add_f32 v14, v29, v31
v_fma_f32 v16, v28, s79, -v12
v_mul_f32 v17, s83, v16
v_fmac_f32 v14, v17, v16
v_fma_f32 v16, v30, s82, -v12
v_mul_f32 v17, s63, v16
v_fmac_f32 v14, v17, v16
v_sub_f32 v43, 0, v12
v_mov_b32 v15, v14
s_nop 1
v_permlane16_swap_b32 v14, v15
s_nop 1
v_add_f32 v14, v14, v15
v_mov_b32 v15, v14
s_nop 1
v_permlane32_swap_b32 v14, v15
s_nop 1
v_add_f32 v14, v14, v15
v_mov_b32 v16, s91
v_fmac_f32 v16, s78, v14
v_rsq_f32 v47, v16
s_mov_b32 s33, 0x4b800000
v_cmp_nle_f32 vcc, v112, s33
v_cmp_nle_f32 s[34:35], v116, s33
v_cmp_nle_f32 s[44:45], v120, s33
v_cmp_nle_f32 s[60:61], v124, s33
s_nop 1
s_or_b64 vcc, vcc, s[34:35]
s_or_b64 s[44:45], s[44:45], s[60:61]
s_or_b64 vcc, vcc, s[44:45]
s_cmp_lg_u64 vcc, 0
s_cselect_b32 s33, 1, 0
v_mov_b32 v12, s33
v_lshlrev_b32 v13, 2, v0
v_add_u32 v13, 159744, v13
s_lshl_b32 s34, s24, 8
v_add_u32 v17, s34, v13
ds_write_b32 v17, v12
s_waitcnt lgkmcnt(0)
s_barrier
ds_read_b32 v12, v13
ds_read_b32 v14, v13 offset:256
ds_read_b32 v15, v13 offset:512
ds_read_b32 v16, v13 offset:768
s_waitcnt lgkmcnt(0)
v_or3_b32 v12, v12, v14, v15
v_or_b32 v12, v12, v16
s_nop 0
v_readfirstlane_b32 s33, v12
s_nop 3
s_cmp_lg_u32 s33, 0
s_cbranch_scc1 L_fallback
L_att_epi:
s_mul_i32 s33, s51, 288
s_add_u32 s4, s80, s33
s_addc_u32 s5, s81, 0
s_mov_b32 s6, 0x0
s_mov_b32 s7, 0x00020000
s_add_u32 s8, s88, 0x6c0000
s_addc_u32 s9, s89, 0
s_mov_b32 s10, 0x240000
s_mov_b32 s11, 0x00020000
s_sub_u32 s6, 5308416, s33
s_mul_i32 s25, s24, 294912
s_sub_u32 s47, s30, 9216
s_cmp_eq_u32 s24, 0
s_cselect_b32 s47, 147456, s47
s_mul_i32 s26, s62, 18432
v_rcp_f32 v22, v112
v_rcp_f32 v23, v116
v_rcp_f32 v24, v120
v_rcp_f32 v25, v124
s_lshl_b32 s33, s46, 17
s_lshl_b32 s34, s31, 12
s_add_u32 s63, s33, s34
v_accvgpr_read_b32 v128, a0
s_add_u32 m0, s30, 36864
s_add_u32 s3, s25, 1179648
buffer_load_dwordx4 v52, s[4:7], s3 offen offset:0 lds
v_accvgpr_read_b32 v129, a1
v_accvgpr_read_b32 v130, a2
v_accvgpr_read_b32 v131, a3
v_accvgpr_read_b32 v132, a4
v_accvgpr_read_b32 v133, a5
v_accvgpr_read_b32 v134, a6
v_accvgpr_read_b32 v135, a7
v_pk_mul_f32 v[128:129], v[128:129], v[22:23] op_sel:[0,0] op_sel_hi:[1,0]
v_pk_mul_f32 v[130:131], v[130:131], v[22:23] op_sel:[0,0] op_sel_hi:[1,0]
v_pk_mul_f32 v[132:133], v[132:133], v[22:23] op_sel:[0,0] op_sel_hi:[1,0]
v_pk_mul_f32 v[134:135], v[134:135], v[22:23] op_sel:[0,0] op_sel_hi:[1,0]
v_cvt_pk_bf16_f32 v128, v128, v129
v_cvt_pk_bf16_f32 v129, v130, v131
v_cvt_pk_bf16_f32 v130, v132, v133
v_cvt_pk_bf16_f32 v131, v134, v135
buffer_store_dwordx4 v[128:131], v11, s[20:23], s63 offen offset:0 sc1
v_accvgpr_read_b32 v136, a8
v_accvgpr_read_b32 v137, a9
v_accvgpr_read_b32 v138, a10
v_accvgpr_read_b32 v139, a11
v_accvgpr_read_b32 v140, a12
v_accvgpr_read_b32 v141, a13
v_accvgpr_read_b32 v142, a14
v_accvgpr_read_b32 v143, a15
v_pk_mul_f32 v[136:137], v[136:137], v[22:23] op_sel:[0,0] op_sel_hi:[1,0]
v_pk_mul_f32 v[138:139], v[138:139], v[22:23] op_sel:[0,0] op_sel_hi:[1,0]
v_pk_mul_f32 v[140:141], v[140:141], v[22:23] op_sel:[0,0] op_sel_hi:[1,0]
v_pk_mul_f32 v[142:143], v[142:143], v[22:23] op_sel:[0,0] op_sel_hi:[1,0]
v_cvt_pk_bf16_f32 v136, v136, v137
v_cvt_pk_bf16_f32 v137, v138, v139
v_cvt_pk_bf16_f32 v138, v140, v141
v_cvt_pk_bf16_f32 v139, v142, v143
s_add_u32 m0, s30, 36864
s_add_u32 s3, s25, 1179648
buffer_load_dwordx4 v53, s[4:7], s3 offen offset:1024 lds
buffer_store_dwordx4 v[136:139], v11, s[20:23], s63 offen offset:1024 sc1
v_accvgpr_read_b32 v144, a16
v_accvgpr_read_b32 v145, a17
v_accvgpr_read_b32 v146, a18
v_accvgpr_read_b32 v147, a19
v_accvgpr_read_b32 v148, a20
v_accvgpr_read_b32 v149, a21
v_accvgpr_read_b32 v150, a22
v_accvgpr_read_b32 v151, a23
v_pk_mul_f32 v[144:145], v[144:145], v[22:23] op_sel:[0,0] op_sel_hi:[1,0]
v_pk_mul_f32 v[146:147], v[146:147], v[22:23] op_sel:[0,0] op_sel_hi:[1,0]
v_pk_mul_f32 v[148:149], v[148:149], v[22:23] op_sel:[0,0] op_sel_hi:[1,0]
v_pk_mul_f32 v[150:151], v[150:151], v[22:23] op_sel:[0,0] op_sel_hi:[1,0]
v_cvt_pk_bf16_f32 v144, v144, v145
v_cvt_pk_bf16_f32 v145, v146, v147
v_cvt_pk_bf16_f32 v146, v148, v149
v_cvt_pk_bf16_f32 v147, v150, v151
s_add_u32 m0, s30, 36864
s_add_u32 s3, s25, 1179648
buffer_load_dwordx4 v54, s[4:7], s3 offen offset:2048 lds
buffer_store_dwordx4 v[144:147], v11, s[20:23], s63 offen offset:2048 sc1
v_accvgpr_read_b32 v152, a24
v_accvgpr_read_b32 v153, a25
v_accvgpr_read_b32 v154, a26
v_accvgpr_read_b32 v155, a27
v_accvgpr_read_b32 v156, a28
v_accvgpr_read_b32 v157, a29
v_accvgpr_read_b32 v158, a30
v_accvgpr_read_b32 v159, a31
v_pk_mul_f32 v[152:153], v[152:153], v[22:23] op_sel:[0,0] op_sel_hi:[1,0]
v_pk_mul_f32 v[154:155], v[154:155], v[22:23] op_sel:[0,0] op_sel_hi:[1,0]
v_pk_mul_f32 v[156:157], v[156:157], v[22:23] op_sel:[0,0] op_sel_hi:[1,0]
v_pk_mul_f32 v[158:159], v[158:159], v[22:23] op_sel:[0,0] op_sel_hi:[1,0]
v_cvt_pk_bf16_f32 v152, v152, v153
v_cvt_pk_bf16_f32 v153, v154, v155
v_cvt_pk_bf16_f32 v154, v156, v157
v_cvt_pk_bf16_f32 v155, v158, v159
s_add_u32 m0, s30, 36864
s_add_u32 s3, s25, 1179648
buffer_load_dwordx4 v55, s[4:7], s3 offen offset:3072 lds
buffer_store_dwordx4 v[152:155], v11, s[20:23], s63 offen offset:3072 sc1
s_add_u32 s63, s63, 0x20000
v_accvgpr_read_b32 v160, a32
v_accvgpr_read_b32 v161, a33
v_accvgpr_read_b32 v162, a34
v_accvgpr_read_b32 v163, a35
v_accvgpr_read_b32 v164, a36
v_accvgpr_read_b32 v165, a37
v_accvgpr_read_b32 v166, a38
v_accvgpr_read_b32 v167, a39
v_pk_mul_f32 v[160:161], v[160:161], v[22:23] op_sel:[0,1] op_sel_hi:[1,1]
v_pk_mul_f32 v[162:163], v[162:163], v[22:23] op_sel:[0,1] op_sel_hi:[1,1]
v_pk_mul_f32 v[164:165], v[164:165], v[22:23] op_sel:[0,1] op_sel_hi:[1,1]
v_pk_mul_f32 v[166:167], v[166:167], v[22:23] op_sel:[0,1] op_sel_hi:[1,1]
v_cvt_pk_bf16_f32 v160, v160, v161
v_cvt_pk_bf16_f32 v161, v162, v163
v_cvt_pk_bf16_f32 v162, v164, v165
s_add_u32 m0, s30, 40960
s_add_u32 s3, s25, 1179648
buffer_load_dwordx4 v56, s[4:7], s3 offen offset:0 lds
v_cvt_pk_bf16_f32 v163, v166, v167
buffer_store_dwordx4 v[160:163], v11, s[20:23], s63 offen offset:0 sc1
v_accvgpr_read_b32 v168, a40
v_accvgpr_read_b32 v169, a41
v_accvgpr_read_b32 v170, a42
v_accvgpr_read_b32 v171, a43
v_accvgpr_read_b32 v172, a44
v_accvgpr_read_b32 v173, a45
v_accvgpr_read_b32 v174, a46
v_accvgpr_read_b32 v175, a47
v_pk_mul_f32 v[168:169], v[168:169], v[22:23] op_sel:[0,1] op_sel_hi:[1,1]
v_pk_mul_f32 v[170:171], v[170:171], v[22:23] op_sel:[0,1] op_sel_hi:[1,1]
v_pk_mul_f32 v[172:173], v[172:173], v[22:23] op_sel:[0,1] op_sel_hi:[1,1]
v_pk_mul_f32 v[174:175], v[174:175], v[22:23] op_sel:[0,1] op_sel_hi:[1,1]
v_cvt_pk_bf16_f32 v168, v168, v169
v_cvt_pk_bf16_f32 v169, v170, v171
v_cvt_pk_bf16_f32 v170, v172, v173
v_cvt_pk_bf16_f32 v171, v174, v175
s_add_u32 m0, s30, 40960
s_add_u32 s3, s25, 1179648
buffer_load_dwordx4 v57, s[4:7], s3 offen offset:1024 lds
buffer_store_dwordx4 v[168:171], v11, s[20:23], s63 offen offset:1024 sc1
v_accvgpr_read_b32 v176, a48
v_accvgpr_read_b32 v177, a49
v_accvgpr_read_b32 v178, a50
v_accvgpr_read_b32 v179, a51
v_accvgpr_read_b32 v180, a52
v_accvgpr_read_b32 v181, a53
v_accvgpr_read_b32 v182, a54
v_accvgpr_read_b32 v183, a55
v_pk_mul_f32 v[176:177], v[176:177], v[22:23] op_sel:[0,1] op_sel_hi:[1,1]
v_pk_mul_f32 v[178:179], v[178:179], v[22:23] op_sel:[0,1] op_sel_hi:[1,1]
v_pk_mul_f32 v[180:181], v[180:181], v[22:23] op_sel:[0,1] op_sel_hi:[1,1]
v_pk_mul_f32 v[182:183], v[182:183], v[22:23] op_sel:[0,1] op_sel_hi:[1,1]
v_cvt_pk_bf16_f32 v176, v176, v177
v_cvt_pk_bf16_f32 v177, v178, v179
v_cvt_pk_bf16_f32 v178, v180, v181
v_cvt_pk_bf16_f32 v179, v182, v183
s_add_u32 m0, s30, 40960
s_add_u32 s3, s25, 1179648
buffer_load_dwordx4 v58, s[4:7], s3 offen offset:2048 lds
buffer_store_dwordx4 v[176:179], v11, s[20:23], s63 offen offset:2048 sc1
v_accvgpr_read_b32 v184, a56
v_accvgpr_read_b32 v185, a57
v_accvgpr_read_b32 v186, a58
v_accvgpr_read_b32 v187, a59
v_accvgpr_read_b32 v188, a60
v_accvgpr_read_b32 v189, a61
v_accvgpr_read_b32 v190, a62
v_accvgpr_read_b32 v191, a63
v_pk_mul_f32 v[184:185], v[184:185], v[22:23] op_sel:[0,1] op_sel_hi:[1,1]
v_pk_mul_f32 v[186:187], v[186:187], v[22:23] op_sel:[0,1] op_sel_hi:[1,1]
v_pk_mul_f32 v[188:189], v[188:189], v[22:23] op_sel:[0,1] op_sel_hi:[1,1]
v_pk_mul_f32 v[190:191], v[190:191], v[22:23] op_sel:[0,1] op_sel_hi:[1,1]
v_cvt_pk_bf16_f32 v184, v184, v185
v_cvt_pk_bf16_f32 v185, v186, v187
v_cvt_pk_bf16_f32 v186, v188, v189
v_cvt_pk_bf16_f32 v187, v190, v191
s_add_u32 m0, s30, 40960
s_add_u32 s3, s25, 1179648
buffer_load_dwordx4 v59, s[4:7], s3 offen offset:3072 lds
buffer_store_dwordx4 v[184:187], v11, s[20:23], s63 offen offset:3072 sc1
s_add_u32 s63, s63, 0x20000
v_accvgpr_read_b32 v192, a64
v_accvgpr_read_b32 v193, a65
v_accvgpr_read_b32 v194, a66
v_accvgpr_read_b32 v195, a67
v_accvgpr_read_b32 v196, a68
v_accvgpr_read_b32 v197, a69
v_accvgpr_read_b32 v198, a70
v_accvgpr_read_b32 v199, a71
v_pk_mul_f32 v[192:193], v[192:193], v[24:25] op_sel:[0,0] op_sel_hi:[1,0]
v_pk_mul_f32 v[194:195], v[194:195], v[24:25] op_sel:[0,0] op_sel_hi:[1,0]
v_pk_mul_f32 v[196:197], v[196:197], v[24:25] op_sel:[0,0] op_sel_hi:[1,0]
v_pk_mul_f32 v[198:199], v[198:199], v[24:25] op_sel:[0,0] op_sel_hi:[1,0]
v_cvt_pk_bf16_f32 v192, v192, v193
v_cvt_pk_bf16_f32 v193, v194, v195
v_cvt_pk_bf16_f32 v194, v196, v197
s_add_u32 m0, s30, 45056
s_add_u32 s3, s25, 1179648
buffer_load_dwordx4 v60, s[4:7], s3 offen offset:0 lds
v_cvt_pk_bf16_f32 v195, v198, v199
buffer_store_dwordx4 v[192:195], v11, s[20:23], s63 offen offset:0 sc1
v_accvgpr_read_b32 v200, a72
v_accvgpr_read_b32 v201, a73
v_accvgpr_read_b32 v202, a74
v_accvgpr_read_b32 v203, a75
v_accvgpr_read_b32 v204, a76
v_accvgpr_read_b32 v205, a77
v_accvgpr_read_b32 v206, a78
v_accvgpr_read_b32 v207, a79
v_pk_mul_f32 v[200:201], v[200:201], v[24:25] op_sel:[0,0] op_sel_hi:[1,0]
v_pk_mul_f32 v[202:203], v[202:203], v[24:25] op_sel:[0,0] op_sel_hi:[1,0]
v_pk_mul_f32 v[204:205], v[204:205], v[24:25] op_sel:[0,0] op_sel_hi:[1,0]
v_pk_mul_f32 v[206:207], v[206:207], v[24:25] op_sel:[0,0] op_sel_hi:[1,0]
v_cvt_pk_bf16_f32 v200, v200, v201
v_cvt_pk_bf16_f32 v201, v202, v203
v_cvt_pk_bf16_f32 v202, v204, v205
v_cvt_pk_bf16_f32 v203, v206, v207
s_add_u32 s3, s26, 2048
buffer_load_dwordx4 a[128:131], v11, s[8:11], s3 offen
buffer_store_dwordx4 v[200:203], v11, s[20:23], s63 offen offset:1024 sc1
v_accvgpr_read_b32 v208, a80
v_accvgpr_read_b32 v209, a81
v_accvgpr_read_b32 v210, a82
v_accvgpr_read_b32 v211, a83
v_accvgpr_read_b32 v212, a84
v_accvgpr_read_b32 v213, a85
v_accvgpr_read_b32 v214, a86
v_accvgpr_read_b32 v215, a87
v_pk_mul_f32 v[208:209], v[208:209], v[24:25] op_sel:[0,0] op_sel_hi:[1,0]
v_pk_mul_f32 v[210:211], v[210:211], v[24:25] op_sel:[0,0] op_sel_hi:[1,0]
v_pk_mul_f32 v[212:213], v[212:213], v[24:25] op_sel:[0,0] op_sel_hi:[1,0]
v_pk_mul_f32 v[214:215], v[214:215], v[24:25] op_sel:[0,0] op_sel_hi:[1,0]
v_cvt_pk_bf16_f32 v208, v208, v209
v_cvt_pk_bf16_f32 v209, v210, v211
v_cvt_pk_bf16_f32 v210, v212, v213
v_cvt_pk_bf16_f32 v211, v214, v215
s_add_u32 s3, s26, 20480
buffer_load_dwordx4 a[132:135], v11, s[8:11], s3 offen
buffer_store_dwordx4 v[208:211], v11, s[20:23], s63 offen offset:2048 sc1
v_accvgpr_read_b32 v216, a88
v_accvgpr_read_b32 v217, a89
v_accvgpr_read_b32 v218, a90
v_accvgpr_read_b32 v219, a91
v_accvgpr_read_b32 v220, a92
v_accvgpr_read_b32 v221, a93
v_accvgpr_read_b32 v222, a94
v_accvgpr_read_b32 v223, a95
v_pk_mul_f32 v[216:217], v[216:217], v[24:25] op_sel:[0,0] op_sel_hi:[1,0]
v_pk_mul_f32 v[218:219], v[218:219], v[24:25] op_sel:[0,0] op_sel_hi:[1,0]
v_pk_mul_f32 v[220:221], v[220:221], v[24:25] op_sel:[0,0] op_sel_hi:[1,0]
v_pk_mul_f32 v[222:223], v[222:223], v[24:25] op_sel:[0,0] op_sel_hi:[1,0]
v_cvt_pk_bf16_f32 v216, v216, v217
v_cvt_pk_bf16_f32 v217, v218, v219
v_cvt_pk_bf16_f32 v218, v220, v221
v_cvt_pk_bf16_f32 v219, v222, v223
s_add_u32 s3, s26, 38912
buffer_load_dwordx4 a[136:139], v11, s[8:11], s3 offen
buffer_store_dwordx4 v[216:219], v11, s[20:23], s63 offen offset:3072 sc1
s_add_u32 s63, s63, 0x20000
v_accvgpr_read_b32 v224, a96
v_accvgpr_read_b32 v225, a97
v_accvgpr_read_b32 v226, a98
v_accvgpr_read_b32 v227, a99
v_accvgpr_read_b32 v228, a100
v_accvgpr_read_b32 v229, a101
v_accvgpr_read_b32 v230, a102
v_accvgpr_read_b32 v231, a103
v_pk_mul_f32 v[224:225], v[224:225], v[24:25] op_sel:[0,1] op_sel_hi:[1,1]
v_pk_mul_f32 v[226:227], v[226:227], v[24:25] op_sel:[0,1] op_sel_hi:[1,1]
v_pk_mul_f32 v[228:229], v[228:229], v[24:25] op_sel:[0,1] op_sel_hi:[1,1]
v_pk_mul_f32 v[230:231], v[230:231], v[24:25] op_sel:[0,1] op_sel_hi:[1,1]
v_cvt_pk_bf16_f32 v224, v224, v225
v_cvt_pk_bf16_f32 v225, v226, v227
v_cvt_pk_bf16_f32 v226, v228, v229
s_add_u32 s3, s26, 57344
buffer_load_dwordx4 a[140:143], v11, s[8:11], s3 offen
v_cvt_pk_bf16_f32 v227, v230, v231
buffer_store_dwordx4 v[224:227], v11, s[20:23], s63 offen offset:0 sc1
v_accvgpr_read_b32 v232, a104
v_accvgpr_read_b32 v233, a105
v_accvgpr_read_b32 v234, a106
v_accvgpr_read_b32 v235, a107
v_accvgpr_read_b32 v236, a108
v_accvgpr_read_b32 v237, a109
v_accvgpr_read_b32 v238, a110
v_accvgpr_read_b32 v239, a111
v_pk_mul_f32 v[232:233], v[232:233], v[24:25] op_sel:[0,1] op_sel_hi:[1,1]
v_pk_mul_f32 v[234:235], v[234:235], v[24:25] op_sel:[0,1] op_sel_hi:[1,1]
v_pk_mul_f32 v[236:237], v[236:237], v[24:25] op_sel:[0,1] op_sel_hi:[1,1]
v_pk_mul_f32 v[238:239], v[238:239], v[24:25] op_sel:[0,1] op_sel_hi:[1,1]
v_cvt_pk_bf16_f32 v232, v232, v233
v_cvt_pk_bf16_f32 v233, v234, v235
v_cvt_pk_bf16_f32 v234, v236, v237
v_cvt_pk_bf16_f32 v235, v238, v239
s_add_u32 s3, s26, 3072
buffer_load_dwordx4 a[144:147], v11, s[8:11], s3 offen
buffer_store_dwordx4 v[232:235], v11, s[20:23], s63 offen offset:1024 sc1
v_accvgpr_read_b32 v240, a112
v_accvgpr_read_b32 v241, a113
v_accvgpr_read_b32 v242, a114
v_accvgpr_read_b32 v243, a115
v_accvgpr_read_b32 v244, a116
v_accvgpr_read_b32 v245, a117
v_accvgpr_read_b32 v246, a118
v_accvgpr_read_b32 v247, a119
v_pk_mul_f32 v[240:241], v[240:241], v[24:25] op_sel:[0,1] op_sel_hi:[1,1]
v_pk_mul_f32 v[242:243], v[242:243], v[24:25] op_sel:[0,1] op_sel_hi:[1,1]
v_pk_mul_f32 v[244:245], v[244:245], v[24:25] op_sel:[0,1] op_sel_hi:[1,1]
v_pk_mul_f32 v[246:247], v[246:247], v[24:25] op_sel:[0,1] op_sel_hi:[1,1]
v_cvt_pk_bf16_f32 v240, v240, v241
v_cvt_pk_bf16_f32 v241, v242, v243
v_cvt_pk_bf16_f32 v242, v244, v245
v_cvt_pk_bf16_f32 v243, v246, v247
s_add_u32 s3, s26, 21504
buffer_load_dwordx4 a[148:151], v11, s[8:11], s3 offen
buffer_store_dwordx4 v[240:243], v11, s[20:23], s63 offen offset:2048 sc1
v_accvgpr_read_b32 v248, a120
v_accvgpr_read_b32 v249, a121
v_accvgpr_read_b32 v250, a122
v_accvgpr_read_b32 v251, a123
v_accvgpr_read_b32 v252, a124
v_accvgpr_read_b32 v253, a125
v_accvgpr_read_b32 v254, a126
v_accvgpr_read_b32 v255, a127
v_pk_mul_f32 v[248:249], v[248:249], v[24:25] op_sel:[0,1] op_sel_hi:[1,1]
v_pk_mul_f32 v[250:251], v[250:251], v[24:25] op_sel:[0,1] op_sel_hi:[1,1]
v_pk_mul_f32 v[252:253], v[252:253], v[24:25] op_sel:[0,1] op_sel_hi:[1,1]
v_pk_mul_f32 v[254:255], v[254:255], v[24:25] op_sel:[0,1] op_sel_hi:[1,1]
v_cvt_pk_bf16_f32 v248, v248, v249
v_cvt_pk_bf16_f32 v249, v250, v251
v_cvt_pk_bf16_f32 v250, v252, v253
v_cvt_pk_bf16_f32 v251, v254, v255
s_add_u32 s3, s26, 39936
buffer_load_dwordx4 a[152:155], v11, s[8:11], s3 offen
buffer_store_dwordx4 v[248:251], v11, s[20:23], s63 offen offset:3072 sc1
v_mov_b32 v72, 0x3f803f80
v_mov_b32 v73, 0x3f803f80
v_mov_b32 v74, 0x3f803f80
v_mov_b32 v75, 0x3f803f80
s_add_u32 s16, s88, 0x4000000
s_addc_u32 s17, s89, 0
s_mov_b32 s18, 0x990000
s_mov_b32 s19, 0x00020000
s_mul_i32 s78, s49, 144
s_mul_i32 s33, s54, 36
s_add_u32 s78, s78, s33
s_add_u32 s78, s78, s24
s_mul_i32 s78, s78, 9216
s_lshl_b32 s79, s49, 7
s_lshl_b32 s33, s54, 5
s_add_u32 s79, s79, s33
s_add_u32 s79, s79, s24
s_mul_i32 s79, s79, 9216
s_add_u32 s79, s79, 5308416
s_lshl_b32 s44, s52, 3
s_lshl_b32 s34, s24, 1
s_add_u32 s44, s44, s34
s_lshl_b32 s27, s44, 17
s_lshl_b32 s33, s54, 15
s_add_u32 s27, s27, s33
s_mul_i32 s28, s44, 147456
s_mul_i32 s33, s54, 36864
s_add_u32 s28, s28, s33
v_add_u32 v48, 131072, v11
s_add_u32 s3, s26, 58368
buffer_load_dwordx4 a[156:159], v11, s[8:11], s3 offen
s_and_b32 s77, s52, 7
s_lshl_b32 s33, s49, 1
s_add_u32 s77, s77, s33
s_mov_b32 s77, 0
s_waitcnt vmcnt(41)
s_barrier
ds_read_b64_tr_b16 a[0:1], v49 offset:0
ds_read_b64_tr_b16 a[2:3], v49 offset:4608
ds_read_b64_tr_b16 a[4:5], v49 offset:32
ds_read_b64_tr_b16 a[6:7], v49 offset:4640
ds_read_b64_tr_b16 a[8:9], v49 offset:64
ds_read_b64_tr_b16 a[10:11], v49 offset:4672
s_add_u32 m0, s30, 73728
s_add_u32 s3, s25, 2359296
buffer_load_dwordx4 v52, s[4:7], s3 offen offset:0 lds
ds_read_b64_tr_b16 a[12:13], v49 offset:96
ds_read_b64_tr_b16 a[14:15], v49 offset:4704
ds_read_b64_tr_b16 a[16:17], v49 offset:128
ds_read_b64_tr_b16 a[18:19], v49 offset:4736
ds_read_b64_tr_b16 a[20:21], v49 offset:160
ds_read_b64_tr_b16 a[22:23], v49 offset:4768
ds_read_b64_tr_b16 a[24:25], v49 offset:192
ds_read_b64_tr_b16 a[26:27], v49 offset:4800
ds_read_b64_tr_b16 a[28:29], v49 offset:224
ds_read_b64_tr_b16 a[30:31], v49 offset:4832
ds_read_b64_tr_b16 a[32:33], v49 offset:256
ds_read_b64_tr_b16 a[34:35], v49 offset:4864
s_waitcnt vmcnt(38) lgkmcnt(0)
v_mfma_f32_16x16x32_bf16 v[112:115], a[0:3], a[192:195], 0
ds_read_b64_tr_b16 a[36:37], v49 offset:9216
v_mfma_f32_16x16x32_bf16 v[148:151], a[0:3], a[196:199], 0
s_add_u32 m0, s30, 73728
s_add_u32 s3, s25, 2359296
buffer_load_dwordx4 v53, s[4:7], s3 offen offset:1024 lds
ds_read_b64_tr_b16 a[38:39], v49 offset:13824
v_mfma_f32_16x16x32_bf16 v[184:187], a[0:3], a[200:203], 0
v_mfma_f32_16x16x32_bf16 v[220:223], a[0:3], a[204:207], 0
ds_read_b64_tr_b16 a[40:41], v49 offset:9248
v_mfma_f32_16x16x32_bf16 v[116:119], a[4:7], a[192:195], 0
ds_read_b64_tr_b16 a[42:43], v49 offset:13856
v_mfma_f32_16x16x32_bf16 v[152:155], a[4:7], a[196:199], 0
s_add_u32 m0, s30, 73728
s_add_u32 s3, s25, 2359296
buffer_load_dwordx4 v54, s[4:7], s3 offen offset:2048 lds
v_mfma_f32_16x16x32_bf16 v[188:191], a[4:7], a[200:203], 0
ds_read_b64_tr_b16 a[44:45], v49 offset:9280
v_mfma_f32_16x16x32_bf16 v[224:227], a[4:7], a[204:207], 0
ds_read_b64_tr_b16 a[46:47], v49 offset:13888
v_mfma_f32_16x16x32_bf16 v[120:123], a[8:11], a[192:195], 0
v_mfma_f32_16x16x32_bf16 v[156:159], a[8:11], a[196:199], 0
s_add_u32 m0, s30, 73728
s_add_u32 s3, s25, 2359296
buffer_load_dwordx4 v55, s[4:7], s3 offen offset:3072 lds
ds_read_b64_tr_b16 a[48:49], v49 offset:9312
v_mfma_f32_16x16x32_bf16 v[192:195], a[8:11], a[200:203], 0
ds_read_b64_tr_b16 a[50:51], v49 offset:13920
v_mfma_f32_16x16x32_bf16 v[228:231], a[8:11], a[204:207], 0
v_mfma_f32_16x16x32_bf16 v[124:127], a[12:15], a[192:195], 0
ds_read_b64_tr_b16 a[52:53], v49 offset:9344
v_mfma_f32_16x16x32_bf16 v[160:163], a[12:15], a[196:199], 0
s_add_u32 m0, s30, 77824
s_add_u32 s3, s25, 2359296
buffer_load_dwordx4 v56, s[4:7], s3 offen offset:0 lds
ds_read_b64_tr_b16 a[54:55], v49 offset:13952
v_mfma_f32_16x16x32_bf16 v[196:199], a[12:15], a[200:203], 0
v_mfma_f32_16x16x32_bf16 v[232:235], a[12:15], a[204:207], 0
ds_read_b64_tr_b16 a[56:57], v49 offset:9376
v_mfma_f32_16x16x32_bf16 v[128:131], a[16:19], a[192:195], 0
ds_read_b64_tr_b16 a[58:59], v49 offset:13984
v_mfma_f32_16x16x32_bf16 v[164:167], a[16:19], a[196:199], 0
s_add_u32 m0, s30, 77824
s_add_u32 s3, s25, 2359296
buffer_load_dwordx4 v57, s[4:7], s3 offen offset:1024 lds
v_mfma_f32_16x16x32_bf16 v[200:203], a[16:19], a[200:203], 0
ds_read_b64_tr_b16 a[60:61], v49 offset:9408
v_mfma_f32_16x16x32_bf16 v[236:239], a[16:19], a[204:207], 0
ds_read_b64_tr_b16 a[62:63], v49 offset:14016
v_mfma_f32_16x16x32_bf16 v[132:135], a[20:23], a[192:195], 0
v_mfma_f32_16x16x32_bf16 v[168:171], a[20:23], a[196:199], 0
s_add_u32 m0, s30, 77824
s_add_u32 s3, s25, 2359296
buffer_load_dwordx4 v58, s[4:7], s3 offen offset:2048 lds
ds_read_b64_tr_b16 a[64:65], v49 offset:9440
v_mfma_f32_16x16x32_bf16 v[204:207], a[20:23], a[200:203], 0
ds_read_b64_tr_b16 a[66:67], v49 offset:14048
v_mfma_f32_16x16x32_bf16 v[240:243], a[20:23], a[204:207], 0
v_mfma_f32_16x16x32_bf16 v[136:139], a[24:27], a[192:195], 0
ds_read_b64_tr_b16 a[68:69], v49 offset:9472
v_mfma_f32_16x16x32_bf16 v[172:175], a[24:27], a[196:199], 0
s_add_u32 m0, s30, 77824
s_add_u32 s3, s25, 2359296
buffer_load_dwordx4 v59, s[4:7], s3 offen offset:3072 lds
ds_read_b64_tr_b16 a[70:71], v49 offset:14080
v_mfma_f32_16x16x32_bf16 v[208:211], a[24:27], a[200:203], 0
v_mfma_f32_16x16x32_bf16 v[244:247], a[24:27], a[204:207], 0
v_mfma_f32_16x16x32_bf16 v[140:143], a[28:31], a[192:195], 0
v_mfma_f32_16x16x32_bf16 v[176:179], a[28:31], a[196:199], 0
v_mfma_f32_16x16x32_bf16 v[212:215], a[28:31], a[200:203], 0
s_add_u32 m0, s30, 81920
s_add_u32 s3, s25, 2359296
buffer_load_dwordx4 v60, s[4:7], s3 offen offset:0 lds
v_mfma_f32_16x16x32_bf16 v[248:251], a[28:31], a[204:207], 0
v_mfma_f32_16x16x32_bf16 v[144:147], a[32:35], a[192:195], 0
v_mfma_f32_16x16x32_bf16 v[180:183], a[32:35], a[196:199], 0
v_mfma_f32_16x16x32_bf16 v[216:219], a[32:35], a[200:203], 0
v_mfma_f32_16x16x32_bf16 v[252:255], a[32:35], a[204:207], 0
s_add_u32 s3, s26, 4096
buffer_load_dwordx4 a[160:163], v11, s[8:11], s3 offen
s_cmp_gt_u32 s24, 1
s_cbranch_scc1 L_cs0_2
s_cmp_eq_u32 s24, 1
s_cbranch_scc1 L_cs0_1
v_mfma_f32_16x16x32_bf16 v[76:79], a[0:3], v[72:75], 0
v_mfma_f32_16x16x32_bf16 v[80:83], a[16:19], v[72:75], 0
v_mfma_f32_16x16x32_bf16 v[84:87], a[32:35], v[72:75], 0
s_branch L_cs0
L_cs0_1:
v_mfma_f32_16x16x32_bf16 v[76:79], a[4:7], v[72:75], 0
v_mfma_f32_16x16x32_bf16 v[80:83], a[20:23], v[72:75], 0
s_branch L_cs0
L_cs0_2:
s_cmp_eq_u32 s24, 3
s_cbranch_scc1 L_cs0_3
v_mfma_f32_16x16x32_bf16 v[76:79], a[8:11], v[72:75], 0
v_mfma_f32_16x16x32_bf16 v[80:83], a[24:27], v[72:75], 0
s_branch L_cs0
L_cs0_3:
v_mfma_f32_16x16x32_bf16 v[76:79], a[12:15], v[72:75], 0
v_mfma_f32_16x16x32_bf16 v[80:83], a[28:31], v[72:75], 0
L_cs0:
s_waitcnt vmcnt(11) lgkmcnt(0)
s_barrier
s_lshl_b32 s33, s32, 5
s_cmp_lg_u32 s24, 0
s_cbranch_scc1 L_sig7
v_mov_b32 v12, 0
v_mov_b32 v13, 0x1000000
s_mov_b64 exec, 1
buffer_atomic_add v13, v12, s[56:59], s33 offen
s_mov_b64 exec, -1
L_sig7:
v_mfma_f32_16x16x32_bf16 v[112:115], a[36:39], a[208:211], v[112:115]
ds_read_b64_tr_b16 a[0:1], v49 offset:18432
v_mfma_f32_16x16x32_bf16 v[148:151], a[36:39], a[212:215], v[148:151]
ds_read_b64_tr_b16 a[2:3], v49 offset:23040
v_mfma_f32_16x16x32_bf16 v[184:187], a[36:39], a[216:219], v[184:187]
v_mfma_f32_16x16x32_bf16 v[220:223], a[36:39], a[220:223], v[220:223]
s_add_u32 s3, s26, 22528
buffer_load_dwordx4 a[164:167], v11, s[8:11], s3 offen
ds_read_b64_tr_b16 a[4:5], v49 offset:18464
v_mfma_f32_16x16x32_bf16 v[116:119], a[40:43], a[208:211], v[116:119]
ds_read_b64_tr_b16 a[6:7], v49 offset:23072
v_mfma_f32_16x16x32_bf16 v[152:155], a[40:43], a[212:215], v[152:155]
v_mfma_f32_16x16x32_bf16 v[188:191], a[40:43], a[216:219], v[188:191]
ds_read_b64_tr_b16 a[8:9], v49 offset:18496
v_mfma_f32_16x16x32_bf16 v[224:227], a[40:43], a[220:223], v[224:227]
s_add_u32 s3, s26, 40960
buffer_load_dwordx4 a[168:171], v11, s[8:11], s3 offen
ds_read_b64_tr_b16 a[10:11], v49 offset:23104
v_mfma_f32_16x16x32_bf16 v[120:123], a[44:47], a[208:211], v[120:123]
v_mfma_f32_16x16x32_bf16 v[156:159], a[44:47], a[212:215], v[156:159]
ds_read_b64_tr_b16 a[12:13], v49 offset:18528
v_mfma_f32_16x16x32_bf16 v[192:195], a[44:47], a[216:219], v[192:195]
ds_read_b64_tr_b16 a[14:15], v49 offset:23136
v_mfma_f32_16x16x32_bf16 v[228:231], a[44:47], a[220:223], v[228:231]
s_add_u32 s3, s26, 59392
buffer_load_dwordx4 a[172:175], v11, s[8:11], s3 offen
v_mfma_f32_16x16x32_bf16 v[124:127], a[48:51], a[208:211], v[124:127]
ds_read_b64_tr_b16 a[16:17], v49 offset:18560
v_mfma_f32_16x16x32_bf16 v[160:163], a[48:51], a[212:215], v[160:163]
ds_read_b64_tr_b16 a[18:19], v49 offset:23168
v_mfma_f32_16x16x32_bf16 v[196:199], a[48:51], a[216:219], v[196:199]
v_mfma_f32_16x16x32_bf16 v[232:235], a[48:51], a[220:223], v[232:235]
s_add_u32 s3, s26, 5120
buffer_load_dwordx4 a[176:179], v11, s[8:11], s3 offen
ds_read_b64_tr_b16 a[20:21], v49 offset:18592
v_mfma_f32_16x16x32_bf16 v[128:131], a[52:55], a[208:211], v[128:131]
ds_read_b64_tr_b16 a[22:23], v49 offset:23200
v_mfma_f32_16x16x32_bf16 v[164:167], a[52:55], a[212:215], v[164:167]
v_mfma_f32_16x16x32_bf16 v[200:203], a[52:55], a[216:219], v[200:203]
ds_read_b64_tr_b16 a[24:25], v49 offset:18624
v_mfma_f32_16x16x32_bf16 v[236:239], a[52:55], a[220:223], v[236:239]
s_add_u32 s3, s26, 23552
buffer_load_dwordx4 a[180:183], v11, s[8:11], s3 offen
ds_read_b64_tr_b16 a[26:27], v49 offset:23232
v_mfma_f32_16x16x32_bf16 v[132:135], a[56:59], a[208:211], v[132:135]
v_mfma_f32_16x16x32_bf16 v[168:171], a[56:59], a[212:215], v[168:171]
ds_read_b64_tr_b16 a[28:29], v49 offset:18656
v_mfma_f32_16x16x32_bf16 v[204:207], a[56:59], a[216:219], v[204:207]
ds_read_b64_tr_b16 a[30:31], v49 offset:23264
v_mfma_f32_16x16x32_bf16 v[240:243], a[56:59], a[220:223], v[240:243]
s_add_u32 s3, s26, 41984
buffer_load_dwordx4 a[184:187], v11, s[8:11], s3 offen
v_mfma_f32_16x16x32_bf16 v[136:139], a[60:63], a[208:211], v[136:139]
ds_read_b64_tr_b16 a[32:33], v49 offset:18688
v_mfma_f32_16x16x32_bf16 v[172:175], a[60:63], a[212:215], v[172:175]
ds_read_b64_tr_b16 a[34:35], v49 offset:23296
v_mfma_f32_16x16x32_bf16 v[208:211], a[60:63], a[216:219], v[208:211]
v_mfma_f32_16x16x32_bf16 v[244:247], a[60:63], a[220:223], v[244:247]
s_add_u32 s3, s26, 60416
buffer_load_dwordx4 a[188:191], v11, s[8:11], s3 offen
v_mfma_f32_16x16x32_bf16 v[140:143], a[64:67], a[208:211], v[140:143]
v_mfma_f32_16x16x32_bf16 v[176:179], a[64:67], a[212:215], v[176:179]
v_mfma_f32_16x16x32_bf16 v[212:215], a[64:67], a[216:219], v[212:215]
v_mfma_f32_16x16x32_bf16 v[248:251], a[64:67], a[220:223], v[248:251]
v_mfma_f32_16x16x32_bf16 v[144:147], a[68:71], a[208:211], v[144:147]
s_add_u32 m0, s30, 110592
s_add_u32 s3, s25, 3538944
buffer_load_dwordx4 v52, s[4:7], s3 offen offset:0 lds
v_mfma_f32_16x16x32_bf16 v[180:183], a[68:71], a[212:215], v[180:183]
v_mfma_f32_16x16x32_bf16 v[216:219], a[68:71], a[216:219], v[216:219]
v_mfma_f32_16x16x32_bf16 v[252:255], a[68:71], a[220:223], v[252:255]
s_cmp_gt_u32 s24, 1
s_cbranch_scc1 L_cs1_2
s_cmp_eq_u32 s24, 1
s_cbranch_scc1 L_cs1_1
v_mfma_f32_16x16x32_bf16 v[76:79], a[36:39], v[72:75], v[76:79]
v_mfma_f32_16x16x32_bf16 v[80:83], a[52:55], v[72:75], v[80:83]
v_mfma_f32_16x16x32_bf16 v[84:87], a[68:71], v[72:75], v[84:87]
s_branch L_cs1
L_cs1_1:
v_mfma_f32_16x16x32_bf16 v[76:79], a[40:43], v[72:75], v[76:79]
v_mfma_f32_16x16x32_bf16 v[80:83], a[56:59], v[72:75], v[80:83]
s_branch L_cs1
L_cs1_2:
s_cmp_eq_u32 s24, 3
s_cbranch_scc1 L_cs1_3
v_mfma_f32_16x16x32_bf16 v[76:79], a[44:47], v[72:75], v[76:79]
v_mfma_f32_16x16x32_bf16 v[80:83], a[60:63], v[72:75], v[80:83]
s_branch L_cs1
L_cs1_3:
v_mfma_f32_16x16x32_bf16 v[76:79], a[48:51], v[72:75], v[76:79]
v_mfma_f32_16x16x32_bf16 v[80:83], a[64:67], v[72:75], v[80:83]
L_cs1:
s_waitcnt vmcnt(19) lgkmcnt(0)
v_mfma_f32_16x16x32_bf16 v[112:115], a[0:3], a[128:131], v[112:115]
s_add_u32 m0, s30, 110592
s_add_u32 s3, s25, 3538944
buffer_load_dwordx4 v53, s[4:7], s3 offen offset:1024 lds
ds_read_b64_tr_b16 a[36:37], v49 offset:27648
v_mfma_f32_16x16x32_bf16 v[148:151], a[0:3], a[132:135], v[148:151]
ds_read_b64_tr_b16 a[38:39], v49 offset:32256
v_mfma_f32_16x16x32_bf16 v[184:187], a[0:3], a[136:139], v[184:187]
v_mfma_f32_16x16x32_bf16 v[220:223], a[0:3], a[140:143], v[220:223]
ds_read_b64_tr_b16 a[40:41], v49 offset:27680
v_mfma_f32_16x16x32_bf16 v[116:119], a[4:7], a[128:131], v[116:119]
s_add_u32 m0, s30, 110592
s_add_u32 s3, s25, 3538944
buffer_load_dwordx4 v54, s[4:7], s3 offen offset:2048 lds
ds_read_b64_tr_b16 a[42:43], v49 offset:32288
v_mfma_f32_16x16x32_bf16 v[152:155], a[4:7], a[132:135], v[152:155]
v_mfma_f32_16x16x32_bf16 v[188:191], a[4:7], a[136:139], v[188:191]
ds_read_b64_tr_b16 a[44:45], v49 offset:27712
v_mfma_f32_16x16x32_bf16 v[224:227], a[4:7], a[140:143], v[224:227]
ds_read_b64_tr_b16 a[46:47], v49 offset:32320
v_mfma_f32_16x16x32_bf16 v[120:123], a[8:11], a[128:131], v[120:123]
s_add_u32 m0, s30, 110592
s_add_u32 s3, s25, 3538944
buffer_load_dwordx4 v55, s[4:7], s3 offen offset:3072 lds
v_mfma_f32_16x16x32_bf16 v[156:159], a[8:11], a[132:135], v[156:159]
ds_read_b64_tr_b16 a[48:49], v49 offset:27744
v_mfma_f32_16x16x32_bf16 v[192:195], a[8:11], a[136:139], v[192:195]
ds_read_b64_tr_b16 a[50:51], v49 offset:32352
v_mfma_f32_16x16x32_bf16 v[228:231], a[8:11], a[140:143], v[228:231]
v_mfma_f32_16x16x32_bf16 v[124:127], a[12:15], a[128:131], v[124:127]
s_add_u32 m0, s30, 114688
s_add_u32 s3, s25, 3538944
buffer_load_dwordx4 v56, s[4:7], s3 offen offset:0 lds
ds_read_b64_tr_b16 a[52:53], v49 offset:27776
v_mfma_f32_16x16x32_bf16 v[160:163], a[12:15], a[132:135], v[160:163]
ds_read_b64_tr_b16 a[54:55], v49 offset:32384
v_mfma_f32_16x16x32_bf16 v[196:199], a[12:15], a[136:139], v[196:199]
v_mfma_f32_16x16x32_bf16 v[232:235], a[12:15], a[140:143], v[232:235]
ds_read_b64_tr_b16 a[56:57], v49 offset:27808
v_mfma_f32_16x16x32_bf16 v[128:131], a[16:19], a[128:131], v[128:131]
s_add_u32 m0, s30, 114688
s_add_u32 s3, s25, 3538944
buffer_load_dwordx4 v57, s[4:7], s3 offen offset:1024 lds
ds_read_b64_tr_b16 a[58:59], v49 offset:32416
v_mfma_f32_16x16x32_bf16 v[164:167], a[16:19], a[132:135], v[164:167]
v_mfma_f32_16x16x32_bf16 v[200:203], a[16:19], a[136:139], v[200:203]
ds_read_b64_tr_b16 a[60:61], v49 offset:27840
v_mfma_f32_16x16x32_bf16 v[236:239], a[16:19], a[140:143], v[236:239]
ds_read_b64_tr_b16 a[62:63], v49 offset:32448
v_mfma_f32_16x16x32_bf16 v[132:135], a[20:23], a[128:131], v[132:135]
s_add_u32 m0, s30, 114688
s_add_u32 s3, s25, 3538944
buffer_load_dwordx4 v58, s[4:7], s3 offen offset:2048 lds
v_mfma_f32_16x16x32_bf16 v[168:171], a[20:23], a[132:135], v[168:171]
ds_read_b64_tr_b16 a[64:65], v49 offset:27872
v_mfma_f32_16x16x32_bf16 v[204:207], a[20:23], a[136:139], v[204:207]
ds_read_b64_tr_b16 a[66:67], v49 offset:32480
v_mfma_f32_16x16x32_bf16 v[240:243], a[20:23], a[140:143], v[240:243]
v_mfma_f32_16x16x32_bf16 v[136:139], a[24:27], a[128:131], v[136:139]
s_add_u32 m0, s30, 114688
s_add_u32 s3, s25, 3538944
buffer_load_dwordx4 v59, s[4:7], s3 offen offset:3072 lds
ds_read_b64_tr_b16 a[68:69], v49 offset:27904
v_mfma_f32_16x16x32_bf16 v[172:175], a[24:27], a[132:135], v[172:175]
ds_read_b64_tr_b16 a[70:71], v49 offset:32512
v_mfma_f32_16x16x32_bf16 v[208:211], a[24:27], a[136:139], v[208:211]
v_mfma_f32_16x16x32_bf16 v[244:247], a[24:27], a[140:143], v[244:247]
v_mfma_f32_16x16x32_bf16 v[140:143], a[28:31], a[128:131], v[140:143]
s_add_u32 m0, s30, 118784
s_add_u32 s3, s25, 3538944
buffer_load_dwordx4 v60, s[4:7], s3 offen offset:0 lds
v_mfma_f32_16x16x32_bf16 v[176:179], a[28:31], a[132:135], v[176:179]
v_mfma_f32_16x16x32_bf16 v[212:215], a[28:31], a[136:139], v[212:215]
v_mfma_f32_16x16x32_bf16 v[248:251], a[28:31], a[140:143], v[248:251]
v_mfma_f32_16x16x32_bf16 v[144:147], a[32:35], a[128:131], v[144:147]
v_mfma_f32_16x16x32_bf16 v[180:183], a[32:35], a[132:135], v[180:183]
s_add_u32 s3, s26, 6144
buffer_load_dwordx4 a[224:227], v11, s[8:11], s3 offen
v_mfma_f32_16x16x32_bf16 v[216:219], a[32:35], a[136:139], v[216:219]
v_mfma_f32_16x16x32_bf16 v[252:255], a[32:35], a[140:143], v[252:255]
s_cmp_gt_u32 s24, 1
s_cbranch_scc1 L_cs2_2
s_cmp_eq_u32 s24, 1
s_cbranch_scc1 L_cs2_1
v_mfma_f32_16x16x32_bf16 v[76:79], a[0:3], v[72:75], v[76:79]
v_mfma_f32_16x16x32_bf16 v[80:83], a[16:19], v[72:75], v[80:83]
v_mfma_f32_16x16x32_bf16 v[84:87], a[32:35], v[72:75], v[84:87]
s_branch L_cs2
L_cs2_1:
v_mfma_f32_16x16x32_bf16 v[76:79], a[4:7], v[72:75], v[76:79]
v_mfma_f32_16x16x32_bf16 v[80:83], a[20:23], v[72:75], v[80:83]
s_branch L_cs2
L_cs2_2:
s_cmp_eq_u32 s24, 3
s_cbranch_scc1 L_cs2_3
v_mfma_f32_16x16x32_bf16 v[76:79], a[8:11], v[72:75], v[76:79]
v_mfma_f32_16x16x32_bf16 v[80:83], a[24:27], v[72:75], v[80:83]
s_branch L_cs2
L_cs2_3:
v_mfma_f32_16x16x32_bf16 v[76:79], a[12:15], v[72:75], v[76:79]
v_mfma_f32_16x16x32_bf16 v[80:83], a[28:31], v[72:75], v[80:83]
L_cs2:
s_waitcnt vmcnt(27) lgkmcnt(0)
s_barrier
v_mfma_f32_16x16x32_bf16 v[112:115], a[36:39], a[144:147], v[112:115]
s_add_u32 s3, s26, 24576
buffer_load_dwordx4 a[228:231], v11, s[8:11], s3 offen
ds_read_b64_tr_b16 a[0:1], v49 offset:36864
v_mfma_f32_16x16x32_bf16 v[148:151], a[36:39], a[148:151], v[148:151]
ds_read_b64_tr_b16 a[2:3], v49 offset:41472
v_mfma_f32_16x16x32_bf16 v[184:187], a[36:39], a[152:155], v[184:187]
v_mfma_f32_16x16x32_bf16 v[220:223], a[36:39], a[156:159], v[220:223]
ds_read_b64_tr_b16 a[4:5], v49 offset:36896
v_mfma_f32_16x16x32_bf16 v[116:119], a[40:43], a[144:147], v[116:119]
s_add_u32 s3, s26, 43008
buffer_load_dwordx4 a[232:235], v11, s[8:11], s3 offen
ds_read_b64_tr_b16 a[6:7], v49 offset:41504
v_mfma_f32_16x16x32_bf16 v[152:155], a[40:43], a[148:151], v[152:155]
v_mfma_f32_16x16x32_bf16 v[188:191], a[40:43], a[152:155], v[188:191]
ds_read_b64_tr_b16 a[8:9], v49 offset:36928
v_mfma_f32_16x16x32_bf16 v[224:227], a[40:43], a[156:159], v[224:227]
ds_read_b64_tr_b16 a[10:11], v49 offset:41536
v_mfma_f32_16x16x32_bf16 v[120:123], a[44:47], a[144:147], v[120:123]
s_add_u32 s3, s26, 61440
buffer_load_dwordx4 a[236:239], v11, s[8:11], s3 offen
v_mfma_f32_16x16x32_bf16 v[156:159], a[44:47], a[148:151], v[156:159]
ds_read_b64_tr_b16 a[12:13], v49 offset:36960
v_mfma_f32_16x16x32_bf16 v[192:195], a[44:47], a[152:155], v[192:195]
ds_read_b64_tr_b16 a[14:15], v49 offset:41568
v_mfma_f32_16x16x32_bf16 v[228:231], a[44:47], a[156:159], v[228:231]
v_mfma_f32_16x16x32_bf16 v[124:127], a[48:51], a[144:147], v[124:127]
s_add_u32 s3, s26, 7168
buffer_load_dwordx4 a[240:243], v11, s[8:11], s3 offen
ds_read_b64_tr_b16 a[16:17], v49 offset:36992
v_mfma_f32_16x16x32_bf16 v[160:163], a[48:51], a[148:151], v[160:163]
ds_read_b64_tr_b16 a[18:19], v49 offset:41600
v_mfma_f32_16x16x32_bf16 v[196:199], a[48:51], a[152:155], v[196:199]
v_mfma_f32_16x16x32_bf16 v[232:235], a[48:51], a[156:159], v[232:235]
ds_read_b64_tr_b16 a[20:21], v49 offset:37024
v_mfma_f32_16x16x32_bf16 v[128:131], a[52:55], a[144:147], v[128:131]
s_add_u32 s3, s26, 25600
buffer_load_dwordx4 a[244:247], v11, s[8:11], s3 offen
ds_read_b64_tr_b16 a[22:23], v49 offset:41632
v_mfma_f32_16x16x32_bf16 v[164:167], a[52:55], a[148:151], v[164:167]
v_mfma_f32_16x16x32_bf16 v[200:203], a[52:55], a[152:155], v[200:203]
ds_read_b64_tr_b16 a[24:25], v49 offset:37056
v_mfma_f32_16x16x32_bf16 v[236:239], a[52:55], a[156:159], v[236:239]
ds_read_b64_tr_b16 a[26:27], v49 offset:41664
v_mfma_f32_16x16x32_bf16 v[132:135], a[56:59], a[144:147], v[132:135]
s_add_u32 s3, s26, 44032
buffer_load_dwordx4 a[248:251], v11, s[8:11], s3 offen
v_mfma_f32_16x16x32_bf16 v[168:171], a[56:59], a[148:151], v[168:171]
ds_read_b64_tr_b16 a[28:29], v49 offset:37088
v_mfma_f32_16x16x32_bf16 v[204:207], a[56:59], a[152:155], v[204:207]
ds_read_b64_tr_b16 a[30:31], v49 offset:41696
v_mfma_f32_16x16x32_bf16 v[240:243], a[56:59], a[156:159], v[240:243]
v_mfma_f32_16x16x32_bf16 v[136:139], a[60:63], a[144:147], v[136:139]
s_add_u32 s3, s26, 62464
buffer_load_dwordx4 a[252:255], v11, s[8:11], s3 offen
ds_read_b64_tr_b16 a[32:33], v49 offset:37120
v_mfma_f32_16x16x32_bf16 v[172:175], a[60:63], a[148:151], v[172:175]
ds_read_b64_tr_b16 a[34:35], v49 offset:41728
v_mfma_f32_16x16x32_bf16 v[208:211], a[60:63], a[152:155], v[208:211]
v_mfma_f32_16x16x32_bf16 v[244:247], a[60:63], a[156:159], v[244:247]
v_mfma_f32_16x16x32_bf16 v[140:143], a[64:67], a[144:147], v[140:143]
s_add_u32 s3, s26, 8192
buffer_load_dwordx4 a[72:75], v11, s[8:11], s3 offen
v_mfma_f32_16x16x32_bf16 v[176:179], a[64:67], a[148:151], v[176:179]
v_mfma_f32_16x16x32_bf16 v[212:215], a[64:67], a[152:155], v[212:215]
v_mfma_f32_16x16x32_bf16 v[248:251], a[64:67], a[156:159], v[248:251]
v_mfma_f32_16x16x32_bf16 v[144:147], a[68:71], a[144:147], v[144:147]
v_mfma_f32_16x16x32_bf16 v[180:183], a[68:71], a[148:151], v[180:183]
s_add_u32 s3, s26, 26624
buffer_load_dwordx4 a[76:79], v11, s[8:11], s3 offen
v_mfma_f32_16x16x32_bf16 v[216:219], a[68:71], a[152:155], v[216:219]
v_mfma_f32_16x16x32_bf16 v[252:255], a[68:71], a[156:159], v[252:255]
s_cmp_gt_u32 s24, 1
s_cbranch_scc1 L_cs3_2
s_cmp_eq_u32 s24, 1
s_cbranch_scc1 L_cs3_1
v_mfma_f32_16x16x32_bf16 v[76:79], a[36:39], v[72:75], v[76:79]
v_mfma_f32_16x16x32_bf16 v[80:83], a[52:55], v[72:75], v[80:83]
v_mfma_f32_16x16x32_bf16 v[84:87], a[68:71], v[72:75], v[84:87]
s_branch L_cs3
L_cs3_1:
v_mfma_f32_16x16x32_bf16 v[76:79], a[40:43], v[72:75], v[76:79]
v_mfma_f32_16x16x32_bf16 v[80:83], a[56:59], v[72:75], v[80:83]
s_branch L_cs3
L_cs3_2:
s_cmp_eq_u32 s24, 3
s_cbranch_scc1 L_cs3_3
v_mfma_f32_16x16x32_bf16 v[76:79], a[44:47], v[72:75], v[76:79]
v_mfma_f32_16x16x32_bf16 v[80:83], a[60:63], v[72:75], v[80:83]
s_branch L_cs3
L_cs3_3:
v_mfma_f32_16x16x32_bf16 v[76:79], a[48:51], v[72:75], v[76:79]
v_mfma_f32_16x16x32_bf16 v[80:83], a[64:67], v[72:75], v[80:83]
L_cs3:
s_waitcnt vmcnt(23) lgkmcnt(0)
v_mfma_f32_16x16x32_bf16 v[112:115], a[0:3], a[160:163], v[112:115]
s_add_u32 s3, s26, 45056
buffer_load_dwordx4 a[80:83], v11, s[8:11], s3 offen
ds_read_b64_tr_b16 a[36:37], v49 offset:46080
v_mfma_f32_16x16x32_bf16 v[148:151], a[0:3], a[164:167], v[148:151]
ds_read_b64_tr_b16 a[38:39], v49 offset:50688
v_mfma_f32_16x16x32_bf16 v[184:187], a[0:3], a[168:171], v[184:187]
v_mfma_f32_16x16x32_bf16 v[220:223], a[0:3], a[172:175], v[220:223]
ds_read_b64_tr_b16 a[40:41], v49 offset:46112
v_mfma_f32_16x16x32_bf16 v[116:119], a[4:7], a[160:163], v[116:119]
s_add_u32 s3, s26, 63488
buffer_load_dwordx4 a[84:87], v11, s[8:11], s3 offen
ds_read_b64_tr_b16 a[42:43], v49 offset:50720
v_mfma_f32_16x16x32_bf16 v[152:155], a[4:7], a[164:167], v[152:155]
v_mfma_f32_16x16x32_bf16 v[188:191], a[4:7], a[168:171], v[188:191]
ds_read_b64_tr_b16 a[44:45], v49 offset:46144
v_mfma_f32_16x16x32_bf16 v[224:227], a[4:7], a[172:175], v[224:227]
ds_read_b64_tr_b16 a[46:47], v49 offset:50752
v_mfma_f32_16x16x32_bf16 v[120:123], a[8:11], a[160:163], v[120:123]
s_add_u32 s3, s26, 9216
buffer_load_dwordx4 a[88:91], v11, s[8:11], s3 offen
v_mfma_f32_16x16x32_bf16 v[156:159], a[8:11], a[164:167], v[156:159]
ds_read_b64_tr_b16 a[48:49], v49 offset:46176
v_mfma_f32_16x16x32_bf16 v[192:195], a[8:11], a[168:171], v[192:195]
ds_read_b64_tr_b16 a[50:51], v49 offset:50784
v_mfma_f32_16x16x32_bf16 v[228:231], a[8:11], a[172:175], v[228:231]
v_mfma_f32_16x16x32_bf16 v[124:127], a[12:15], a[160:163], v[124:127]
s_add_u32 s3, s26, 27648
buffer_load_dwordx4 a[92:95], v11, s[8:11], s3 offen
ds_read_b64_tr_b16 a[52:53], v49 offset:46208
v_mfma_f32_16x16x32_bf16 v[160:163], a[12:15], a[164:167], v[160:163]
ds_read_b64_tr_b16 a[54:55], v49 offset:50816
v_mfma_f32_16x16x32_bf16 v[196:199], a[12:15], a[168:171], v[196:199]
v_mfma_f32_16x16x32_bf16 v[232:235], a[12:15], a[172:175], v[232:235]
ds_read_b64_tr_b16 a[56:57], v49 offset:46240
v_mfma_f32_16x16x32_bf16 v[128:131], a[16:19], a[160:163], v[128:131]
s_add_u32 s3, s26, 46080
buffer_load_dwordx4 a[96:99], v11, s[8:11], s3 offen
ds_read_b64_tr_b16 a[58:59], v49 offset:50848
v_mfma_f32_16x16x32_bf16 v[164:167], a[16:19], a[164:167], v[164:167]
v_mfma_f32_16x16x32_bf16 v[200:203], a[16:19], a[168:171], v[200:203]
ds_read_b64_tr_b16 a[60:61], v49 offset:46272
v_mfma_f32_16x16x32_bf16 v[236:239], a[16:19], a[172:175], v[236:239]
ds_read_b64_tr_b16 a[62:63], v49 offset:50880
v_mfma_f32_16x16x32_bf16 v[132:135], a[20:23], a[160:163], v[132:135]
s_add_u32 s3, s26, 64512
buffer_load_dwordx4 a[100:103], v11, s[8:11], s3 offen
v_mfma_f32_16x16x32_bf16 v[168:171], a[20:23], a[164:167], v[168:171]
ds_read_b64_tr_b16 a[64:65], v49 offset:46304
v_mfma_f32_16x16x32_bf16 v[204:207], a[20:23], a[168:171], v[204:207]
ds_read_b64_tr_b16 a[66:67], v49 offset:50912
v_mfma_f32_16x16x32_bf16 v[240:243], a[20:23], a[172:175], v[240:243]
v_mfma_f32_16x16x32_bf16 v[136:139], a[24:27], a[160:163], v[136:139]
s_add_u32 s3, s26, 10240
buffer_load_dwordx4 a[104:107], v11, s[8:11], s3 offen
ds_read_b64_tr_b16 a[68:69], v49 offset:46336
v_mfma_f32_16x16x32_bf16 v[172:175], a[24:27], a[164:167], v[172:175]
ds_read_b64_tr_b16 a[70:71], v49 offset:50944
v_mfma_f32_16x16x32_bf16 v[208:211], a[24:27], a[168:171], v[208:211]
v_mfma_f32_16x16x32_bf16 v[244:247], a[24:27], a[172:175], v[244:247]
v_mfma_f32_16x16x32_bf16 v[140:143], a[28:31], a[160:163], v[140:143]
s_add_u32 s3, s26, 28672
buffer_load_dwordx4 a[108:111], v11, s[8:11], s3 offen
v_mfma_f32_16x16x32_bf16 v[176:179], a[28:31], a[164:167], v[176:179]
v_mfma_f32_16x16x32_bf16 v[212:215], a[28:31], a[168:171], v[212:215]
v_mfma_f32_16x16x32_bf16 v[248:251], a[28:31], a[172:175], v[248:251]
v_mfma_f32_16x16x32_bf16 v[144:147], a[32:35], a[160:163], v[144:147]
v_mfma_f32_16x16x32_bf16 v[180:183], a[32:35], a[164:167], v[180:183]
s_add_u32 s3, s26, 47104
buffer_load_dwordx4 a[112:115], v11, s[8:11], s3 offen
v_mfma_f32_16x16x32_bf16 v[216:219], a[32:35], a[168:171], v[216:219]
v_mfma_f32_16x16x32_bf16 v[252:255], a[32:35], a[172:175], v[252:255]
s_cmp_gt_u32 s24, 1
s_cbranch_scc1 L_cs4_2
s_cmp_eq_u32 s24, 1
s_cbranch_scc1 L_cs4_1
v_mfma_f32_16x16x32_bf16 v[76:79], a[0:3], v[72:75], v[76:79]
v_mfma_f32_16x16x32_bf16 v[80:83], a[16:19], v[72:75], v[80:83]
v_mfma_f32_16x16x32_bf16 v[84:87], a[32:35], v[72:75], v[84:87]
s_branch L_cs4
L_cs4_1:
v_mfma_f32_16x16x32_bf16 v[76:79], a[4:7], v[72:75], v[76:79]
v_mfma_f32_16x16x32_bf16 v[80:83], a[20:23], v[72:75], v[80:83]
s_branch L_cs4
L_cs4_2:
s_cmp_eq_u32 s24, 3
s_cbranch_scc1 L_cs4_3
v_mfma_f32_16x16x32_bf16 v[76:79], a[8:11], v[72:75], v[76:79]
v_mfma_f32_16x16x32_bf16 v[80:83], a[24:27], v[72:75], v[80:83]
s_branch L_cs4
L_cs4_3:
v_mfma_f32_16x16x32_bf16 v[76:79], a[12:15], v[72:75], v[76:79]
v_mfma_f32_16x16x32_bf16 v[80:83], a[28:31], v[72:75], v[80:83]
L_cs4:
s_waitcnt vmcnt(28) lgkmcnt(0)
v_mfma_f32_16x16x32_bf16 v[112:115], a[36:39], a[176:179], v[112:115]
s_add_u32 s3, s26, 65536
buffer_load_dwordx4 a[116:119], v11, s[8:11], s3 offen
ds_read_b64_tr_b16 a[0:1], v49 offset:55296
v_mfma_f32_16x16x32_bf16 v[148:151], a[36:39], a[180:183], v[148:151]
ds_read_b64_tr_b16 a[2:3], v49 offset:59904
v_mfma_f32_16x16x32_bf16 v[184:187], a[36:39], a[184:187], v[184:187]
v_mfma_f32_16x16x32_bf16 v[220:223], a[36:39], a[188:191], v[220:223]
ds_read_b64_tr_b16 a[4:5], v49 offset:55328
v_mfma_f32_16x16x32_bf16 v[116:119], a[40:43], a[176:179], v[116:119]
s_add_u32 s3, s26, 11264
buffer_load_dwordx4 a[192:195], v11, s[8:11], s3 offen
ds_read_b64_tr_b16 a[6:7], v49 offset:59936
v_mfma_f32_16x16x32_bf16 v[152:155], a[40:43], a[180:183], v[152:155]
v_mfma_f32_16x16x32_bf16 v[188:191], a[40:43], a[184:187], v[188:191]
ds_read_b64_tr_b16 a[8:9], v49 offset:55360
v_mfma_f32_16x16x32_bf16 v[224:227], a[40:43], a[188:191], v[224:227]
ds_read_b64_tr_b16 a[10:11], v49 offset:59968
v_mfma_f32_16x16x32_bf16 v[120:123], a[44:47], a[176:179], v[120:123]
s_add_u32 s3, s26, 29696
buffer_load_dwordx4 a[196:199], v11, s[8:11], s3 offen
v_mfma_f32_16x16x32_bf16 v[156:159], a[44:47], a[180:183], v[156:159]
ds_read_b64_tr_b16 a[12:13], v49 offset:55392
v_mfma_f32_16x16x32_bf16 v[192:195], a[44:47], a[184:187], v[192:195]
ds_read_b64_tr_b16 a[14:15], v49 offset:60000
v_mfma_f32_16x16x32_bf16 v[228:231], a[44:47], a[188:191], v[228:231]
v_mfma_f32_16x16x32_bf16 v[124:127], a[48:51], a[176:179], v[124:127]
s_add_u32 s3, s26, 48128
buffer_load_dwordx4 a[200:203], v11, s[8:11], s3 offen
ds_read_b64_tr_b16 a[16:17], v49 offset:55424
v_mfma_f32_16x16x32_bf16 v[160:163], a[48:51], a[180:183], v[160:163]
ds_read_b64_tr_b16 a[18:19], v49 offset:60032
v_mfma_f32_16x16x32_bf16 v[196:199], a[48:51], a[184:187], v[196:199]
v_mfma_f32_16x16x32_bf16 v[232:235], a[48:51], a[188:191], v[232:235]
ds_read_b64_tr_b16 a[20:21], v49 offset:55456
v_mfma_f32_16x16x32_bf16 v[128:131], a[52:55], a[176:179], v[128:131]
s_add_u32 s3, s26, 66560
buffer_load_dwordx4 a[204:207], v11, s[8:11], s3 offen
ds_read_b64_tr_b16 a[22:23], v49 offset:60064
v_mfma_f32_16x16x32_bf16 v[164:167], a[52:55], a[180:183], v[164:167]
v_mfma_f32_16x16x32_bf16 v[200:203], a[52:55], a[184:187], v[200:203]
ds_read_b64_tr_b16 a[24:25], v49 offset:55488
v_mfma_f32_16x16x32_bf16 v[236:239], a[52:55], a[188:191], v[236:239]
ds_read_b64_tr_b16 a[26:27], v49 offset:60096
v_mfma_f32_16x16x32_bf16 v[132:135], a[56:59], a[176:179], v[132:135]
s_add_u32 s3, s26, 12288
buffer_load_dwordx4 a[208:211], v11, s[8:11], s3 offen
v_mfma_f32_16x16x32_bf16 v[168:171], a[56:59], a[180:183], v[168:171]
ds_read_b64_tr_b16 a[28:29], v49 offset:55520
v_mfma_f32_16x16x32_bf16 v[204:207], a[56:59], a[184:187], v[204:207]
ds_read_b64_tr_b16 a[30:31], v49 offset:60128
v_mfma_f32_16x16x32_bf16 v[240:243], a[56:59], a[188:191], v[240:243]
v_mfma_f32_16x16x32_bf16 v[136:139], a[60:63], a[176:179], v[136:139]
s_add_u32 s3, s26, 30720
buffer_load_dwordx4 a[212:215], v11, s[8:11], s3 offen
ds_read_b64_tr_b16 a[32:33], v49 offset:55552
v_mfma_f32_16x16x32_bf16 v[172:175], a[60:63], a[180:183], v[172:175]
ds_read_b64_tr_b16 a[34:35], v49 offset:60160
v_mfma_f32_16x16x32_bf16 v[208:211], a[60:63], a[184:187], v[208:211]
v_mfma_f32_16x16x32_bf16 v[244:247], a[60:63], a[188:191], v[244:247]
v_mfma_f32_16x16x32_bf16 v[140:143], a[64:67], a[176:179], v[140:143]
s_add_u32 s3, s26, 49152
buffer_load_dwordx4 a[216:219], v11, s[8:11], s3 offen
v_mfma_f32_16x16x32_bf16 v[176:179], a[64:67], a[180:183], v[176:179]
v_mfma_f32_16x16x32_bf16 v[212:215], a[64:67], a[184:187], v[212:215]
v_mfma_f32_16x16x32_bf16 v[248:251], a[64:67], a[188:191], v[248:251]
v_mfma_f32_16x16x32_bf16 v[144:147], a[68:71], a[176:179], v[144:147]
v_mfma_f32_16x16x32_bf16 v[180:183], a[68:71], a[180:183], v[180:183]
s_add_u32 s3, s26, 67584
buffer_load_dwordx4 a[220:223], v11, s[8:11], s3 offen
v_mfma_f32_16x16x32_bf16 v[216:219], a[68:71], a[184:187], v[216:219]
v_mfma_f32_16x16x32_bf16 v[252:255], a[68:71], a[188:191], v[252:255]
s_cmp_gt_u32 s24, 1
s_cbranch_scc1 L_cs5_2
s_cmp_eq_u32 s24, 1
s_cbranch_scc1 L_cs5_1
v_mfma_f32_16x16x32_bf16 v[76:79], a[36:39], v[72:75], v[76:79]
v_mfma_f32_16x16x32_bf16 v[80:83], a[52:55], v[72:75], v[80:83]
v_mfma_f32_16x16x32_bf16 v[84:87], a[68:71], v[72:75], v[84:87]
s_branch L_cs5
L_cs5_1:
v_mfma_f32_16x16x32_bf16 v[76:79], a[40:43], v[72:75], v[76:79]
v_mfma_f32_16x16x32_bf16 v[80:83], a[56:59], v[72:75], v[80:83]
s_branch L_cs5
L_cs5_2:
s_cmp_eq_u32 s24, 3
s_cbranch_scc1 L_cs5_3
v_mfma_f32_16x16x32_bf16 v[76:79], a[44:47], v[72:75], v[76:79]
v_mfma_f32_16x16x32_bf16 v[80:83], a[60:63], v[72:75], v[80:83]
s_branch L_cs5
L_cs5_3:
v_mfma_f32_16x16x32_bf16 v[76:79], a[48:51], v[72:75], v[76:79]
v_mfma_f32_16x16x32_bf16 v[80:83], a[64:67], v[72:75], v[80:83]
L_cs5:
s_waitcnt vmcnt(24) lgkmcnt(0)
v_mfma_f32_16x16x32_bf16 v[112:115], a[0:3], a[224:227], v[112:115]
s_add_u32 s3, s26, 13312
buffer_load_dwordx4 a[128:131], v11, s[8:11], s3 offen
ds_read_b64_tr_b16 a[36:37], v50 offset:0
v_mfma_f32_16x16x32_bf16 v[148:151], a[0:3], a[228:231], v[148:151]
ds_read_b64_tr_b16 a[38:39], v50 offset:4608
v_mfma_f32_16x16x32_bf16 v[184:187], a[0:3], a[232:235], v[184:187]
v_mfma_f32_16x16x32_bf16 v[220:223], a[0:3], a[236:239], v[220:223]
ds_read_b64_tr_b16 a[40:41], v50 offset:32
v_mfma_f32_16x16x32_bf16 v[116:119], a[4:7], a[224:227], v[116:119]
s_add_u32 s3, s26, 31744
buffer_load_dwordx4 a[132:135], v11, s[8:11], s3 offen
ds_read_b64_tr_b16 a[42:43], v50 offset:4640
v_mfma_f32_16x16x32_bf16 v[152:155], a[4:7], a[228:231], v[152:155]
v_mfma_f32_16x16x32_bf16 v[188:191], a[4:7], a[232:235], v[188:191]
ds_read_b64_tr_b16 a[44:45], v50 offset:64
v_mfma_f32_16x16x32_bf16 v[224:227], a[4:7], a[236:239], v[224:227]
ds_read_b64_tr_b16 a[46:47], v50 offset:4672
v_mfma_f32_16x16x32_bf16 v[120:123], a[8:11], a[224:227], v[120:123]
s_add_u32 s3, s26, 50176
buffer_load_dwordx4 a[136:139], v11, s[8:11], s3 offen
v_mfma_f32_16x16x32_bf16 v[156:159], a[8:11], a[228:231], v[156:159]
ds_read_b64_tr_b16 a[48:49], v50 offset:96
v_mfma_f32_16x16x32_bf16 v[192:195], a[8:11], a[232:235], v[192:195]
ds_read_b64_tr_b16 a[50:51], v50 offset:4704
v_mfma_f32_16x16x32_bf16 v[228:231], a[8:11], a[236:239], v[228:231]
v_mfma_f32_16x16x32_bf16 v[124:127], a[12:15], a[224:227], v[124:127]
s_add_u32 s3, s26, 68608
buffer_load_dwordx4 a[140:143], v11, s[8:11], s3 offen
ds_read_b64_tr_b16 a[52:53], v50 offset:128
v_mfma_f32_16x16x32_bf16 v[160:163], a[12:15], a[228:231], v[160:163]
ds_read_b64_tr_b16 a[54:55], v50 offset:4736
v_mfma_f32_16x16x32_bf16 v[196:199], a[12:15], a[232:235], v[196:199]
v_mfma_f32_16x16x32_bf16 v[232:235], a[12:15], a[236:239], v[232:235]
ds_read_b64_tr_b16 a[56:57], v50 offset:160
v_mfma_f32_16x16x32_bf16 v[128:131], a[16:19], a[224:227], v[128:131]
s_add_u32 m0, s47, 0
s_add_u32 s3, s25, 4718592
buffer_load_dwordx4 v52, s[4:7], s3 offen offset:0 lds
ds_read_b64_tr_b16 a[58:59], v50 offset:4768
v_mfma_f32_16x16x32_bf16 v[164:167], a[16:19], a[228:231], v[164:167]
v_mfma_f32_16x16x32_bf16 v[200:203], a[16:19], a[232:235], v[200:203]
ds_read_b64_tr_b16 a[60:61], v50 offset:192
v_mfma_f32_16x16x32_bf16 v[236:239], a[16:19], a[236:239], v[236:239]
ds_read_b64_tr_b16 a[62:63], v50 offset:4800
v_mfma_f32_16x16x32_bf16 v[132:135], a[20:23], a[224:227], v[132:135]
s_add_u32 m0, s47, 0
s_add_u32 s3, s25, 4718592
buffer_load_dwordx4 v53, s[4:7], s3 offen offset:1024 lds
v_mfma_f32_16x16x32_bf16 v[168:171], a[20:23], a[228:231], v[168:171]
ds_read_b64_tr_b16 a[64:65], v50 offset:224
v_mfma_f32_16x16x32_bf16 v[204:207], a[20:23], a[232:235], v[204:207]
ds_read_b64_tr_b16 a[66:67], v50 offset:4832
v_mfma_f32_16x16x32_bf16 v[240:243], a[20:23], a[236:239], v[240:243]
v_mfma_f32_16x16x32_bf16 v[136:139], a[24:27], a[224:227], v[136:139]
s_add_u32 m0, s47, 0
s_add_u32 s3, s25, 4718592
buffer_load_dwordx4 v54, s[4:7], s3 offen offset:2048 lds
ds_read_b64_tr_b16 a[68:69], v50 offset:256
v_mfma_f32_16x16x32_bf16 v[172:175], a[24:27], a[228:231], v[172:175]
ds_read_b64_tr_b16 a[70:71], v50 offset:4864
v_mfma_f32_16x16x32_bf16 v[208:211], a[24:27], a[232:235], v[208:211]
v_mfma_f32_16x16x32_bf16 v[244:247], a[24:27], a[236:239], v[244:247]
v_mfma_f32_16x16x32_bf16 v[140:143], a[28:31], a[224:227], v[140:143]
s_add_u32 m0, s47, 0
s_add_u32 s3, s25, 4718592
buffer_load_dwordx4 v55, s[4:7], s3 offen offset:3072 lds
v_mfma_f32_16x16x32_bf16 v[176:179], a[28:31], a[228:231], v[176:179]
v_mfma_f32_16x16x32_bf16 v[212:215], a[28:31], a[232:235], v[212:215]
v_mfma_f32_16x16x32_bf16 v[248:251], a[28:31], a[236:239], v[248:251]
v_mfma_f32_16x16x32_bf16 v[144:147], a[32:35], a[224:227], v[144:147]
v_mfma_f32_16x16x32_bf16 v[180:183], a[32:35], a[228:231], v[180:183]
s_add_u32 m0, s47, 4096
s_add_u32 s3, s25, 4718592
buffer_load_dwordx4 v56, s[4:7], s3 offen offset:0 lds
v_mfma_f32_16x16x32_bf16 v[216:219], a[32:35], a[232:235], v[216:219]
v_mfma_f32_16x16x32_bf16 v[252:255], a[32:35], a[236:239], v[252:255]
s_cmp_gt_u32 s24, 1
s_cbranch_scc1 L_cs6_2
s_cmp_eq_u32 s24, 1
s_cbranch_scc1 L_cs6_1
v_mfma_f32_16x16x32_bf16 v[76:79], a[0:3], v[72:75], v[76:79]
v_mfma_f32_16x16x32_bf16 v[80:83], a[16:19], v[72:75], v[80:83]
v_mfma_f32_16x16x32_bf16 v[84:87], a[32:35], v[72:75], v[84:87]
s_branch L_cs6
L_cs6_1:
v_mfma_f32_16x16x32_bf16 v[76:79], a[4:7], v[72:75], v[76:79]
v_mfma_f32_16x16x32_bf16 v[80:83], a[20:23], v[72:75], v[80:83]
s_branch L_cs6
L_cs6_2:
s_cmp_eq_u32 s24, 3
s_cbranch_scc1 L_cs6_3
v_mfma_f32_16x16x32_bf16 v[76:79], a[8:11], v[72:75], v[76:79]
v_mfma_f32_16x16x32_bf16 v[80:83], a[24:27], v[72:75], v[80:83]
s_branch L_cs6
L_cs6_3:
v_mfma_f32_16x16x32_bf16 v[76:79], a[12:15], v[72:75], v[76:79]
v_mfma_f32_16x16x32_bf16 v[80:83], a[28:31], v[72:75], v[80:83]
L_cs6:
s_waitcnt vmcnt(29) lgkmcnt(0)
s_barrier
v_mfma_f32_16x16x32_bf16 v[112:115], a[36:39], a[240:243], v[112:115]
s_add_u32 m0, s47, 4096
s_add_u32 s3, s25, 4718592
buffer_load_dwordx4 v57, s[4:7], s3 offen offset:1024 lds
ds_read_b64_tr_b16 a[0:1], v50 offset:9216
v_mfma_f32_16x16x32_bf16 v[148:151], a[36:39], a[244:247], v[148:151]
ds_read_b64_tr_b16 a[2:3], v50 offset:13824
v_mfma_f32_16x16x32_bf16 v[184:187], a[36:39], a[248:251], v[184:187]
v_mfma_f32_16x16x32_bf16 v[220:223], a[36:39], a[252:255], v[220:223]
ds_read_b64_tr_b16 a[4:5], v50 offset:9248
v_mfma_f32_16x16x32_bf16 v[116:119], a[40:43], a[240:243], v[116:119]
s_add_u32 m0, s47, 4096
s_add_u32 s3, s25, 4718592
buffer_load_dwordx4 v58, s[4:7], s3 offen offset:2048 lds
ds_read_b64_tr_b16 a[6:7], v50 offset:13856
v_mfma_f32_16x16x32_bf16 v[152:155], a[40:43], a[244:247], v[152:155]
v_mfma_f32_16x16x32_bf16 v[188:191], a[40:43], a[248:251], v[188:191]
ds_read_b64_tr_b16 a[8:9], v50 offset:9280
v_mfma_f32_16x16x32_bf16 v[224:227], a[40:43], a[252:255], v[224:227]
ds_read_b64_tr_b16 a[10:11], v50 offset:13888
v_mfma_f32_16x16x32_bf16 v[120:123], a[44:47], a[240:243], v[120:123]
s_add_u32 m0, s47, 4096
s_add_u32 s3, s25, 4718592
buffer_load_dwordx4 v59, s[4:7], s3 offen offset:3072 lds
v_mfma_f32_16x16x32_bf16 v[156:159], a[44:47], a[244:247], v[156:159]
ds_read_b64_tr_b16 a[12:13], v50 offset:9312
v_mfma_f32_16x16x32_bf16 v[192:195], a[44:47], a[248:251], v[192:195]
ds_read_b64_tr_b16 a[14:15], v50 offset:13920
v_mfma_f32_16x16x32_bf16 v[228:231], a[44:47], a[252:255], v[228:231]
v_mfma_f32_16x16x32_bf16 v[124:127], a[48:51], a[240:243], v[124:127]
s_add_u32 m0, s47, 8192
s_add_u32 s3, s25, 4718592
buffer_load_dwordx4 v60, s[4:7], s3 offen offset:0 lds
ds_read_b64_tr_b16 a[16:17], v50 offset:9344
v_mfma_f32_16x16x32_bf16 v[160:163], a[48:51], a[244:247], v[160:163]
ds_read_b64_tr_b16 a[18:19], v50 offset:13952
v_mfma_f32_16x16x32_bf16 v[196:199], a[48:51], a[248:251], v[196:199]
v_mfma_f32_16x16x32_bf16 v[232:235], a[48:51], a[252:255], v[232:235]
ds_read_b64_tr_b16 a[20:21], v50 offset:9376
v_mfma_f32_16x16x32_bf16 v[128:131], a[52:55], a[240:243], v[128:131]
s_add_u32 s3, s26, 14336
buffer_load_dwordx4 a[144:147], v11, s[8:11], s3 offen
ds_read_b64_tr_b16 a[22:23], v50 offset:13984
v_mfma_f32_16x16x32_bf16 v[164:167], a[52:55], a[244:247], v[164:167]
v_mfma_f32_16x16x32_bf16 v[200:203], a[52:55], a[248:251], v[200:203]
ds_read_b64_tr_b16 a[24:25], v50 offset:9408
v_mfma_f32_16x16x32_bf16 v[236:239], a[52:55], a[252:255], v[236:239]
ds_read_b64_tr_b16 a[26:27], v50 offset:14016
v_mfma_f32_16x16x32_bf16 v[132:135], a[56:59], a[240:243], v[132:135]
s_add_u32 s3, s26, 32768
buffer_load_dwordx4 a[148:151], v11, s[8:11], s3 offen
v_mfma_f32_16x16x32_bf16 v[168:171], a[56:59], a[244:247], v[168:171]
ds_read_b64_tr_b16 a[28:29], v50 offset:9440
v_mfma_f32_16x16x32_bf16 v[204:207], a[56:59], a[248:251], v[204:207]
ds_read_b64_tr_b16 a[30:31], v50 offset:14048
v_mfma_f32_16x16x32_bf16 v[240:243], a[56:59], a[252:255], v[240:243]
v_mfma_f32_16x16x32_bf16 v[136:139], a[60:63], a[240:243], v[136:139]
s_add_u32 s3, s26, 51200
buffer_load_dwordx4 a[152:155], v11, s[8:11], s3 offen
ds_read_b64_tr_b16 a[32:33], v50 offset:9472
v_mfma_f32_16x16x32_bf16 v[172:175], a[60:63], a[244:247], v[172:175]
ds_read_b64_tr_b16 a[34:35], v50 offset:14080
v_mfma_f32_16x16x32_bf16 v[208:211], a[60:63], a[248:251], v[208:211]
v_mfma_f32_16x16x32_bf16 v[244:247], a[60:63], a[252:255], v[244:247]
v_mfma_f32_16x16x32_bf16 v[140:143], a[64:67], a[240:243], v[140:143]
s_add_u32 s3, s26, 69632
buffer_load_dwordx4 a[156:159], v11, s[8:11], s3 offen
v_mfma_f32_16x16x32_bf16 v[176:179], a[64:67], a[244:247], v[176:179]
v_mfma_f32_16x16x32_bf16 v[212:215], a[64:67], a[248:251], v[212:215]
v_mfma_f32_16x16x32_bf16 v[248:251], a[64:67], a[252:255], v[248:251]
v_mfma_f32_16x16x32_bf16 v[144:147], a[68:71], a[240:243], v[144:147]
v_mfma_f32_16x16x32_bf16 v[180:183], a[68:71], a[244:247], v[180:183]
s_add_u32 s3, s26, 15360
buffer_load_dwordx4 a[160:163], v11, s[8:11], s3 offen
v_mfma_f32_16x16x32_bf16 v[216:219], a[68:71], a[248:251], v[216:219]
v_mfma_f32_16x16x32_bf16 v[252:255], a[68:71], a[252:255], v[252:255]
s_cmp_gt_u32 s24, 1
s_cbranch_scc1 L_cs7_2
s_cmp_eq_u32 s24, 1
s_cbranch_scc1 L_cs7_1
v_mfma_f32_16x16x32_bf16 v[76:79], a[36:39], v[72:75], v[76:79]
v_mfma_f32_16x16x32_bf16 v[80:83], a[52:55], v[72:75], v[80:83]
v_mfma_f32_16x16x32_bf16 v[84:87], a[68:71], v[72:75], v[84:87]
s_branch L_cs7
L_cs7_1:
v_mfma_f32_16x16x32_bf16 v[76:79], a[40:43], v[72:75], v[76:79]
v_mfma_f32_16x16x32_bf16 v[80:83], a[56:59], v[72:75], v[80:83]
s_branch L_cs7
L_cs7_2:
s_cmp_eq_u32 s24, 3
s_cbranch_scc1 L_cs7_3
v_mfma_f32_16x16x32_bf16 v[76:79], a[44:47], v[72:75], v[76:79]
v_mfma_f32_16x16x32_bf16 v[80:83], a[60:63], v[72:75], v[80:83]
s_branch L_cs7
L_cs7_3:
v_mfma_f32_16x16x32_bf16 v[76:79], a[48:51], v[72:75], v[76:79]
v_mfma_f32_16x16x32_bf16 v[80:83], a[64:67], v[72:75], v[80:83]
L_cs7:
s_waitcnt vmcnt(34) lgkmcnt(0)
v_and_b32 v14, 7, v0
v_cmp_eq_u32 vcc, 0, v14
s_nop 1
s_mov_b64 s[42:43], vcc
s_cmp_eq_u32 s24, 0
s_cselect_b64 vcc, s[42:43], 0
v_mov_b32 v12, 0x7fff0000
v_lshlrev_b32 v13, 2, v0
v_cndmask_b32 v62, v12, v13, vcc
v_mfma_f32_16x16x32_bf16 v[112:115], a[0:3], a[72:75], v[112:115]
buffer_load_dword v61, v62, s[56:59], 0 offen sc1
ds_read_b64_tr_b16 a[36:37], v50 offset:18432
v_mfma_f32_16x16x32_bf16 v[148:151], a[0:3], a[76:79], v[148:151]
ds_read_b64_tr_b16 a[38:39], v50 offset:23040
v_mfma_f32_16x16x32_bf16 v[184:187], a[0:3], a[80:83], v[184:187]
v_mfma_f32_16x16x32_bf16 v[220:223], a[0:3], a[84:87], v[220:223]
ds_read_b64_tr_b16 a[40:41], v50 offset:18464
v_mfma_f32_16x16x32_bf16 v[116:119], a[4:7], a[72:75], v[116:119]
s_add_u32 s3, s26, 33792
buffer_load_dwordx4 a[164:167], v11, s[8:11], s3 offen
ds_read_b64_tr_b16 a[42:43], v50 offset:23072
v_mfma_f32_16x16x32_bf16 v[152:155], a[4:7], a[76:79], v[152:155]
v_mfma_f32_16x16x32_bf16 v[188:191], a[4:7], a[80:83], v[188:191]
ds_read_b64_tr_b16 a[44:45], v50 offset:18496
v_mfma_f32_16x16x32_bf16 v[224:227], a[4:7], a[84:87], v[224:227]
ds_read_b64_tr_b16 a[46:47], v50 offset:23104
v_mfma_f32_16x16x32_bf16 v[120:123], a[8:11], a[72:75], v[120:123]
s_add_u32 s3, s26, 52224
buffer_load_dwordx4 a[168:171], v11, s[8:11], s3 offen
v_mfma_f32_16x16x32_bf16 v[156:159], a[8:11], a[76:79], v[156:159]
ds_read_b64_tr_b16 a[48:49], v50 offset:18528
v_mfma_f32_16x16x32_bf16 v[192:195], a[8:11], a[80:83], v[192:195]
ds_read_b64_tr_b16 a[50:51], v50 offset:23136
v_mfma_f32_16x16x32_bf16 v[228:231], a[8:11], a[84:87], v[228:231]
v_mfma_f32_16x16x32_bf16 v[124:127], a[12:15], a[72:75], v[124:127]
s_add_u32 s3, s26, 70656
buffer_load_dwordx4 a[172:175], v11, s[8:11], s3 offen
ds_read_b64_tr_b16 a[52:53], v50 offset:18560
v_mfma_f32_16x16x32_bf16 v[160:163], a[12:15], a[76:79], v[160:163]
ds_read_b64_tr_b16 a[54:55], v50 offset:23168
v_mfma_f32_16x16x32_bf16 v[196:199], a[12:15], a[80:83], v[196:199]
v_mfma_f32_16x16x32_bf16 v[232:235], a[12:15], a[84:87], v[232:235]
ds_read_b64_tr_b16 a[56:57], v50 offset:18592
v_mfma_f32_16x16x32_bf16 v[128:131], a[16:19], a[72:75], v[128:131]
s_add_u32 s3, s26, 16384
buffer_load_dwordx4 a[176:179], v11, s[8:11], s3 offen
ds_read_b64_tr_b16 a[58:59], v50 offset:23200
v_mfma_f32_16x16x32_bf16 v[164:167], a[16:19], a[76:79], v[164:167]
v_mfma_f32_16x16x32_bf16 v[200:203], a[16:19], a[80:83], v[200:203]
ds_read_b64_tr_b16 a[60:61], v50 offset:18624
v_mfma_f32_16x16x32_bf16 v[236:239], a[16:19], a[84:87], v[236:239]
ds_read_b64_tr_b16 a[62:63], v50 offset:23232
v_mfma_f32_16x16x32_bf16 v[132:135], a[20:23], a[72:75], v[132:135]
s_add_u32 s3, s26, 34816
buffer_load_dwordx4 a[180:183], v11, s[8:11], s3 offen
v_mfma_f32_16x16x32_bf16 v[168:171], a[20:23], a[76:79], v[168:171]
ds_read_b64_tr_b16 a[64:65], v50 offset:18656
v_mfma_f32_16x16x32_bf16 v[204:207], a[20:23], a[80:83], v[204:207]
ds_read_b64_tr_b16 a[66:67], v50 offset:23264
v_mfma_f32_16x16x32_bf16 v[240:243], a[20:23], a[84:87], v[240:243]
v_mfma_f32_16x16x32_bf16 v[136:139], a[24:27], a[72:75], v[136:139]
s_add_u32 s3, s26, 53248
buffer_load_dwordx4 a[184:187], v11, s[8:11], s3 offen
ds_read_b64_tr_b16 a[68:69], v50 offset:18688
v_mfma_f32_16x16x32_bf16 v[172:175], a[24:27], a[76:79], v[172:175]
ds_read_b64_tr_b16 a[70:71], v50 offset:23296
v_mfma_f32_16x16x32_bf16 v[208:211], a[24:27], a[80:83], v[208:211]
v_mfma_f32_16x16x32_bf16 v[244:247], a[24:27], a[84:87], v[244:247]
v_mfma_f32_16x16x32_bf16 v[140:143], a[28:31], a[72:75], v[140:143]
s_add_u32 s3, s26, 71680
buffer_load_dwordx4 a[188:191], v11, s[8:11], s3 offen
v_mfma_f32_16x16x32_bf16 v[176:179], a[28:31], a[76:79], v[176:179]
v_mfma_f32_16x16x32_bf16 v[212:215], a[28:31], a[80:83], v[212:215]
v_mfma_f32_16x16x32_bf16 v[248:251], a[28:31], a[84:87], v[248:251]
v_mfma_f32_16x16x32_bf16 v[144:147], a[32:35], a[72:75], v[144:147]
v_mfma_f32_16x16x32_bf16 v[180:183], a[32:35], a[76:79], v[180:183]
s_add_u32 s3, s26, 17408
buffer_load_dwordx4 a[224:227], v11, s[8:11], s3 offen
v_mfma_f32_16x16x32_bf16 v[216:219], a[32:35], a[80:83], v[216:219]
v_mfma_f32_16x16x32_bf16 v[252:255], a[32:35], a[84:87], v[252:255]
s_cmp_gt_u32 s24, 1
s_cbranch_scc1 L_cs8_2
s_cmp_eq_u32 s24, 1
s_cbranch_scc1 L_cs8_1
v_mfma_f32_16x16x32_bf16 v[76:79], a[0:3], v[72:75], v[76:79]
v_mfma_f32_16x16x32_bf16 v[80:83], a[16:19], v[72:75], v[80:83]
v_mfma_f32_16x16x32_bf16 v[84:87], a[32:35], v[72:75], v[84:87]
s_branch L_cs8
L_cs8_1:
v_mfma_f32_16x16x32_bf16 v[76:79], a[4:7], v[72:75], v[76:79]
v_mfma_f32_16x16x32_bf16 v[80:83], a[20:23], v[72:75], v[80:83]
s_branch L_cs8
L_cs8_2:
s_cmp_eq_u32 s24, 3
s_cbranch_scc1 L_cs8_3
v_mfma_f32_16x16x32_bf16 v[76:79], a[8:11], v[72:75], v[76:79]
v_mfma_f32_16x16x32_bf16 v[80:83], a[24:27], v[72:75], v[80:83]
s_branch L_cs8
L_cs8_3:
v_mfma_f32_16x16x32_bf16 v[76:79], a[12:15], v[72:75], v[76:79]
v_mfma_f32_16x16x32_bf16 v[80:83], a[28:31], v[72:75], v[80:83]
L_cs8:
s_waitcnt vmcnt(39) lgkmcnt(0)
v_mfma_f32_16x16x32_bf16 v[112:115], a[36:39], a[88:91], v[112:115]
s_add_u32 s3, s26, 35840
buffer_load_dwordx4 a[228:231], v11, s[8:11], s3 offen
ds_read_b64_tr_b16 a[0:1], v50 offset:27648
v_mfma_f32_16x16x32_bf16 v[148:151], a[36:39], a[92:95], v[148:151]
ds_read_b64_tr_b16 a[2:3], v50 offset:32256
v_mfma_f32_16x16x32_bf16 v[184:187], a[36:39], a[96:99], v[184:187]
v_mfma_f32_16x16x32_bf16 v[220:223], a[36:39], a[100:103], v[220:223]
ds_read_b64_tr_b16 a[4:5], v50 offset:27680
v_mfma_f32_16x16x32_bf16 v[116:119], a[40:43], a[88:91], v[116:119]
s_add_u32 s3, s26, 54272
buffer_load_dwordx4 a[232:235], v11, s[8:11], s3 offen
ds_read_b64_tr_b16 a[6:7], v50 offset:32288
v_mfma_f32_16x16x32_bf16 v[152:155], a[40:43], a[92:95], v[152:155]
v_mfma_f32_16x16x32_bf16 v[188:191], a[40:43], a[96:99], v[188:191]
ds_read_b64_tr_b16 a[8:9], v50 offset:27712
v_mfma_f32_16x16x32_bf16 v[224:227], a[40:43], a[100:103], v[224:227]
ds_read_b64_tr_b16 a[10:11], v50 offset:32320
v_mfma_f32_16x16x32_bf16 v[120:123], a[44:47], a[88:91], v[120:123]
s_add_u32 s3, s26, 72704
buffer_load_dwordx4 a[236:239], v11, s[8:11], s3 offen
v_mfma_f32_16x16x32_bf16 v[156:159], a[44:47], a[92:95], v[156:159]
ds_read_b64_tr_b16 a[12:13], v50 offset:27744
v_mfma_f32_16x16x32_bf16 v[192:195], a[44:47], a[96:99], v[192:195]
ds_read_b64_tr_b16 a[14:15], v50 offset:32352
v_mfma_f32_16x16x32_bf16 v[228:231], a[44:47], a[100:103], v[228:231]
v_mfma_f32_16x16x32_bf16 v[124:127], a[48:51], a[88:91], v[124:127]
ds_read_b64_tr_b16 a[16:17], v50 offset:27776
v_mfma_f32_16x16x32_bf16 v[160:163], a[48:51], a[92:95], v[160:163]
ds_read_b64_tr_b16 a[18:19], v50 offset:32384
v_mfma_f32_16x16x32_bf16 v[196:199], a[48:51], a[96:99], v[196:199]
v_mfma_f32_16x16x32_bf16 v[232:235], a[48:51], a[100:103], v[232:235]
ds_read_b64_tr_b16 a[20:21], v50 offset:27808
v_mfma_f32_16x16x32_bf16 v[128:131], a[52:55], a[88:91], v[128:131]
ds_read_b64_tr_b16 a[22:23], v50 offset:32416
v_mfma_f32_16x16x32_bf16 v[164:167], a[52:55], a[92:95], v[164:167]
v_mfma_f32_16x16x32_bf16 v[200:203], a[52:55], a[96:99], v[200:203]
ds_read_b64_tr_b16 a[24:25], v50 offset:27840
v_mfma_f32_16x16x32_bf16 v[236:239], a[52:55], a[100:103], v[236:239]
ds_read_b64_tr_b16 a[26:27], v50 offset:32448
v_mfma_f32_16x16x32_bf16 v[132:135], a[56:59], a[88:91], v[132:135]
v_mfma_f32_16x16x32_bf16 v[168:171], a[56:59], a[92:95], v[168:171]
ds_read_b64_tr_b16 a[28:29], v50 offset:27872
v_mfma_f32_16x16x32_bf16 v[204:207], a[56:59], a[96:99], v[204:207]
ds_read_b64_tr_b16 a[30:31], v50 offset:32480
v_mfma_f32_16x16x32_bf16 v[240:243], a[56:59], a[100:103], v[240:243]
v_mfma_f32_16x16x32_bf16 v[136:139], a[60:63], a[88:91], v[136:139]
ds_read_b64_tr_b16 a[32:33], v50 offset:27904
v_mfma_f32_16x16x32_bf16 v[172:175], a[60:63], a[92:95], v[172:175]
ds_read_b64_tr_b16 a[34:35], v50 offset:32512
v_mfma_f32_16x16x32_bf16 v[208:211], a[60:63], a[96:99], v[208:211]
v_mfma_f32_16x16x32_bf16 v[244:247], a[60:63], a[100:103], v[244:247]
v_mfma_f32_16x16x32_bf16 v[140:143], a[64:67], a[88:91], v[140:143]
v_mfma_f32_16x16x32_bf16 v[176:179], a[64:67], a[92:95], v[176:179]
v_mfma_f32_16x16x32_bf16 v[212:215], a[64:67], a[96:99], v[212:215]
v_mfma_f32_16x16x32_bf16 v[248:251], a[64:67], a[100:103], v[248:251]
v_mfma_f32_16x16x32_bf16 v[144:147], a[68:71], a[88:91], v[144:147]
v_mfma_f32_16x16x32_bf16 v[180:183], a[68:71], a[92:95], v[180:183]
v_mfma_f32_16x16x32_bf16 v[216:219], a[68:71], a[96:99], v[216:219]
v_mfma_f32_16x16x32_bf16 v[252:255], a[68:71], a[100:103], v[252:255]
s_cmp_gt_u32 s24, 1
s_cbranch_scc1 L_cs9_2
s_cmp_eq_u32 s24, 1
s_cbranch_scc1 L_cs9_1
v_mfma_f32_16x16x32_bf16 v[76:79], a[36:39], v[72:75], v[76:79]
v_mfma_f32_16x16x32_bf16 v[80:83], a[52:55], v[72:75], v[80:83]
v_mfma_f32_16x16x32_bf16 v[84:87], a[68:71], v[72:75], v[84:87]
s_branch L_cs9
L_cs9_1:
v_mfma_f32_16x16x32_bf16 v[76:79], a[40:43], v[72:75], v[76:79]
v_mfma_f32_16x16x32_bf16 v[80:83], a[56:59], v[72:75], v[80:83]
s_branch L_cs9
L_cs9_2:
s_cmp_eq_u32 s24, 3
s_cbranch_scc1 L_cs9_3
v_mfma_f32_16x16x32_bf16 v[76:79], a[44:47], v[72:75], v[76:79]
v_mfma_f32_16x16x32_bf16 v[80:83], a[60:63], v[72:75], v[80:83]
s_branch L_cs9
L_cs9_3:
v_mfma_f32_16x16x32_bf16 v[76:79], a[48:51], v[72:75], v[76:79]
v_mfma_f32_16x16x32_bf16 v[80:83], a[64:67], v[72:75], v[80:83]
L_cs9:
s_waitcnt vmcnt(38) lgkmcnt(0)
s_cmp_lg_u32 s24, 0
s_cbranch_scc1 L_poll8_ok
s_waitcnt vmcnt(11)
s_mov_b32 s35, 400000
L_poll8:
v_bfe_u32 v12, v61, 24, 8
v_cmp_gt_u32 vcc, 32, v12
s_nop 1
s_and_b64 vcc, vcc, s[42:43]
s_cmp_eq_u64 vcc, 0
s_cbranch_scc1 L_poll8_ok
s_sleep 2
buffer_load_dword v61, v62, s[56:59], 0 offen sc1
s_waitcnt vmcnt(0)
s_sub_u32 s35, s35, 1
s_cmp_lg_u32 s35, 0
s_cbranch_scc1 L_poll8
L_poll8_ok:
v_mfma_f32_16x16x32_bf16 v[112:115], a[0:3], a[104:107], v[112:115]
ds_read_b64_tr_b16 a[36:37], v50 offset:36864
v_mfma_f32_16x16x32_bf16 v[148:151], a[0:3], a[108:111], v[148:151]
ds_read_b64_tr_b16 a[38:39], v50 offset:41472
v_mfma_f32_16x16x32_bf16 v[184:187], a[0:3], a[112:115], v[184:187]
v_mfma_f32_16x16x32_bf16 v[220:223], a[0:3], a[116:119], v[220:223]
ds_read_b64_tr_b16 a[40:41], v50 offset:36896
v_mfma_f32_16x16x32_bf16 v[116:119], a[4:7], a[104:107], v[116:119]
ds_read_b64_tr_b16 a[42:43], v50 offset:41504
v_mfma_f32_16x16x32_bf16 v[152:155], a[4:7], a[108:111], v[152:155]
v_mfma_f32_16x16x32_bf16 v[188:191], a[4:7], a[112:115], v[188:191]
ds_read_b64_tr_b16 a[44:45], v50 offset:36928
v_mfma_f32_16x16x32_bf16 v[224:227], a[4:7], a[116:119], v[224:227]
ds_read_b64_tr_b16 a[46:47], v50 offset:41536
v_mfma_f32_16x16x32_bf16 v[120:123], a[8:11], a[104:107], v[120:123]
v_mfma_f32_16x16x32_bf16 v[156:159], a[8:11], a[108:111], v[156:159]
ds_read_b64_tr_b16 a[48:49], v50 offset:36960
v_mfma_f32_16x16x32_bf16 v[192:195], a[8:11], a[112:115], v[192:195]
ds_read_b64_tr_b16 a[50:51], v50 offset:41568
v_mfma_f32_16x16x32_bf16 v[228:231], a[8:11], a[116:119], v[228:231]
v_mfma_f32_16x16x32_bf16 v[124:127], a[12:15], a[104:107], v[124:127]
ds_read_b64_tr_b16 a[52:53], v50 offset:36992
v_mfma_f32_16x16x32_bf16 v[160:163], a[12:15], a[108:111], v[160:163]
ds_read_b64_tr_b16 a[54:55], v50 offset:41600
v_mfma_f32_16x16x32_bf16 v[196:199], a[12:15], a[112:115], v[196:199]
v_mfma_f32_16x16x32_bf16 v[232:235], a[12:15], a[116:119], v[232:235]
ds_read_b64_tr_b16 a[56:57], v50 offset:37024
v_mfma_f32_16x16x32_bf16 v[128:131], a[16:19], a[104:107], v[128:131]
ds_read_b64_tr_b16 a[58:59], v50 offset:41632
v_mfma_f32_16x16x32_bf16 v[164:167], a[16:19], a[108:111], v[164:167]
v_mfma_f32_16x16x32_bf16 v[200:203], a[16:19], a[112:115], v[200:203]
ds_read_b64_tr_b16 a[60:61], v50 offset:37056
v_mfma_f32_16x16x32_bf16 v[236:239], a[16:19], a[116:119], v[236:239]
ds_read_b64_tr_b16 a[62:63], v50 offset:41664
v_mfma_f32_16x16x32_bf16 v[132:135], a[20:23], a[104:107], v[132:135]
v_mfma_f32_16x16x32_bf16 v[168:171], a[20:23], a[108:111], v[168:171]
ds_read_b64_tr_b16 a[64:65], v50 offset:37088
v_mfma_f32_16x16x32_bf16 v[204:207], a[20:23], a[112:115], v[204:207]
ds_read_b64_tr_b16 a[66:67], v50 offset:41696
v_mfma_f32_16x16x32_bf16 v[240:243], a[20:23], a[116:119], v[240:243]
v_mfma_f32_16x16x32_bf16 v[136:139], a[24:27], a[104:107], v[136:139]
ds_read_b64_tr_b16 a[68:69], v50 offset:37120
v_mfma_f32_16x16x32_bf16 v[172:175], a[24:27], a[108:111], v[172:175]
ds_read_b64_tr_b16 a[70:71], v50 offset:41728
v_mfma_f32_16x16x32_bf16 v[208:211], a[24:27], a[112:115], v[208:211]
v_mfma_f32_16x16x32_bf16 v[244:247], a[24:27], a[116:119], v[244:247]
v_mfma_f32_16x16x32_bf16 v[140:143], a[28:31], a[104:107], v[140:143]
v_mfma_f32_16x16x32_bf16 v[176:179], a[28:31], a[108:111], v[176:179]
v_mfma_f32_16x16x32_bf16 v[212:215], a[28:31], a[112:115], v[212:215]
v_mfma_f32_16x16x32_bf16 v[248:251], a[28:31], a[116:119], v[248:251]
v_mfma_f32_16x16x32_bf16 v[144:147], a[32:35], a[104:107], v[144:147]
v_mfma_f32_16x16x32_bf16 v[180:183], a[32:35], a[108:111], v[180:183]
v_mfma_f32_16x16x32_bf16 v[216:219], a[32:35], a[112:115], v[216:219]
v_mfma_f32_16x16x32_bf16 v[252:255], a[32:35], a[116:119], v[252:255]
s_cmp_gt_u32 s24, 1
s_cbranch_scc1 L_cs10_2
s_cmp_eq_u32 s24, 1
s_cbranch_scc1 L_cs10_1
v_mfma_f32_16x16x32_bf16 v[76:79], a[0:3], v[72:75], v[76:79]
v_mfma_f32_16x16x32_bf16 v[80:83], a[16:19], v[72:75], v[80:83]
v_mfma_f32_16x16x32_bf16 v[84:87], a[32:35], v[72:75], v[84:87]
s_branch L_cs10
L_cs10_1:
v_mfma_f32_16x16x32_bf16 v[76:79], a[4:7], v[72:75], v[76:79]
v_mfma_f32_16x16x32_bf16 v[80:83], a[20:23], v[72:75], v[80:83]
s_branch L_cs10
L_cs10_2:
s_cmp_eq_u32 s24, 3
s_cbranch_scc1 L_cs10_3
v_mfma_f32_16x16x32_bf16 v[76:79], a[8:11], v[72:75], v[76:79]
v_mfma_f32_16x16x32_bf16 v[80:83], a[24:27], v[72:75], v[80:83]
s_branch L_cs10
L_cs10_3:
v_mfma_f32_16x16x32_bf16 v[76:79], a[12:15], v[72:75], v[76:79]
v_mfma_f32_16x16x32_bf16 v[80:83], a[28:31], v[72:75], v[80:83]
L_cs10:
s_waitcnt vmcnt(11) lgkmcnt(0)
s_barrier
s_add_u32 s66, s77, 0
s_and_b32 s66, s66, 7
s_mul_i32 s66, s66, 36864
s_add_u32 s66, s66, s79
s_add_u32 s70, s77, 0
s_and_b32 s70, s70, 7
s_lshl_b32 s70, s70, 12
s_add_u32 s70, s70, s27
s_add_u32 s67, s77, 1
s_and_b32 s67, s67, 7
s_mul_i32 s67, s67, 36864
s_add_u32 s67, s67, s79
s_add_u32 s71, s77, 1
s_and_b32 s71, s71, 7
s_lshl_b32 s71, s71, 12
s_add_u32 s71, s71, s27
v_mfma_f32_16x16x32_bf16 v[112:115], a[36:39], a[192:195], v[112:115]
s_add_u32 m0, s30, 36864
s_add_u32 s83, s66, 0
buffer_load_dwordx4 v11, s[16:19], s83 offen offset:0 lds
ds_read_b64_tr_b16 a[0:1], v50 offset:46080
v_mfma_f32_16x16x32_bf16 v[148:151], a[36:39], a[196:199], v[148:151]
ds_read_b64_tr_b16 a[2:3], v50 offset:50688
v_mfma_f32_16x16x32_bf16 v[184:187], a[36:39], a[200:203], v[184:187]
v_mfma_f32_16x16x32_bf16 v[220:223], a[36:39], a[204:207], v[220:223]
ds_read_b64_tr_b16 a[4:5], v50 offset:46112
v_mfma_f32_16x16x32_bf16 v[116:119], a[40:43], a[192:195], v[116:119]
buffer_load_dwordx4 v11, s[16:19], s83 offen offset:1024 lds
ds_read_b64_tr_b16 a[6:7], v50 offset:50720
v_mfma_f32_16x16x32_bf16 v[152:155], a[40:43], a[196:199], v[152:155]
v_mfma_f32_16x16x32_bf16 v[188:191], a[40:43], a[200:203], v[188:191]
ds_read_b64_tr_b16 a[8:9], v50 offset:46144
v_mfma_f32_16x16x32_bf16 v[224:227], a[40:43], a[204:207], v[224:227]
ds_read_b64_tr_b16 a[10:11], v50 offset:50752
v_mfma_f32_16x16x32_bf16 v[120:123], a[44:47], a[192:195], v[120:123]
buffer_load_dwordx4 v11, s[16:19], s83 offen offset:2048 lds
v_mfma_f32_16x16x32_bf16 v[156:159], a[44:47], a[196:199], v[156:159]
ds_read_b64_tr_b16 a[12:13], v50 offset:46176
v_mfma_f32_16x16x32_bf16 v[192:195], a[44:47], a[200:203], v[192:195]
ds_read_b64_tr_b16 a[14:15], v50 offset:50784
v_mfma_f32_16x16x32_bf16 v[228:231], a[44:47], a[204:207], v[228:231]
v_mfma_f32_16x16x32_bf16 v[124:127], a[48:51], a[192:195], v[124:127]
buffer_load_dwordx4 v11, s[16:19], s83 offen offset:3072 lds
ds_read_b64_tr_b16 a[16:17], v50 offset:46208
v_mfma_f32_16x16x32_bf16 v[160:163], a[48:51], a[196:199], v[160:163]
ds_read_b64_tr_b16 a[18:19], v50 offset:50816
v_mfma_f32_16x16x32_bf16 v[196:199], a[48:51], a[200:203], v[196:199]
v_mfma_f32_16x16x32_bf16 v[232:235], a[48:51], a[204:207], v[232:235]
ds_read_b64_tr_b16 a[20:21], v50 offset:46240
v_mfma_f32_16x16x32_bf16 v[128:131], a[52:55], a[192:195], v[128:131]
s_add_u32 m0, s30, 40960
s_add_u32 s83, s66, 4096
buffer_load_dwordx4 v11, s[16:19], s83 offen offset:0 lds
ds_read_b64_tr_b16 a[22:23], v50 offset:50848
v_mfma_f32_16x16x32_bf16 v[164:167], a[52:55], a[196:199], v[164:167]
v_mfma_f32_16x16x32_bf16 v[200:203], a[52:55], a[200:203], v[200:203]
ds_read_b64_tr_b16 a[24:25], v50 offset:46272
v_mfma_f32_16x16x32_bf16 v[236:239], a[52:55], a[204:207], v[236:239]
ds_read_b64_tr_b16 a[26:27], v50 offset:50880
v_mfma_f32_16x16x32_bf16 v[132:135], a[56:59], a[192:195], v[132:135]
buffer_load_dwordx4 v11, s[16:19], s83 offen offset:1024 lds
v_mfma_f32_16x16x32_bf16 v[168:171], a[56:59], a[196:199], v[168:171]
ds_read_b64_tr_b16 a[28:29], v50 offset:46304
v_mfma_f32_16x16x32_bf16 v[204:207], a[56:59], a[200:203], v[204:207]
ds_read_b64_tr_b16 a[30:31], v50 offset:50912
v_mfma_f32_16x16x32_bf16 v[240:243], a[56:59], a[204:207], v[240:243]
v_mfma_f32_16x16x32_bf16 v[136:139], a[60:63], a[192:195], v[136:139]
buffer_load_dwordx4 v11, s[16:19], s83 offen offset:2048 lds
ds_read_b64_tr_b16 a[32:33], v50 offset:46336
v_mfma_f32_16x16x32_bf16 v[172:175], a[60:63], a[196:199], v[172:175]
ds_read_b64_tr_b16 a[34:35], v50 offset:50944
v_mfma_f32_16x16x32_bf16 v[208:211], a[60:63], a[200:203], v[208:211]
v_mfma_f32_16x16x32_bf16 v[244:247], a[60:63], a[204:207], v[244:247]
v_mfma_f32_16x16x32_bf16 v[140:143], a[64:67], a[192:195], v[140:143]
buffer_load_dwordx4 v11, s[16:19], s83 offen offset:3072 lds
v_mfma_f32_16x16x32_bf16 v[176:179], a[64:67], a[196:199], v[176:179]
v_mfma_f32_16x16x32_bf16 v[212:215], a[64:67], a[200:203], v[212:215]
v_mfma_f32_16x16x32_bf16 v[248:251], a[64:67], a[204:207], v[248:251]
v_mfma_f32_16x16x32_bf16 v[144:147], a[68:71], a[192:195], v[144:147]
v_mfma_f32_16x16x32_bf16 v[180:183], a[68:71], a[196:199], v[180:183]
s_add_u32 m0, s30, 45056
s_add_u32 s83, s66, 8192
buffer_load_dwordx4 v11, s[16:19], s83 offen offset:0 lds
v_mfma_f32_16x16x32_bf16 v[216:219], a[68:71], a[200:203], v[216:219]
v_mfma_f32_16x16x32_bf16 v[252:255], a[68:71], a[204:207], v[252:255]
s_cmp_gt_u32 s24, 1
s_cbranch_scc1 L_cs11_2
s_cmp_eq_u32 s24, 1
s_cbranch_scc1 L_cs11_1
v_mfma_f32_16x16x32_bf16 v[76:79], a[36:39], v[72:75], v[76:79]
v_mfma_f32_16x16x32_bf16 v[80:83], a[52:55], v[72:75], v[80:83]
v_mfma_f32_16x16x32_bf16 v[84:87], a[68:71], v[72:75], v[84:87]
s_branch L_cs11
L_cs11_1:
v_mfma_f32_16x16x32_bf16 v[76:79], a[40:43], v[72:75], v[76:79]
v_mfma_f32_16x16x32_bf16 v[80:83], a[56:59], v[72:75], v[80:83]
s_branch L_cs11
L_cs11_2:
s_cmp_eq_u32 s24, 3
s_cbranch_scc1 L_cs11_3
v_mfma_f32_16x16x32_bf16 v[76:79], a[44:47], v[72:75], v[76:79]
v_mfma_f32_16x16x32_bf16 v[80:83], a[60:63], v[72:75], v[80:83]
s_branch L_cs11
L_cs11_3:
v_mfma_f32_16x16x32_bf16 v[76:79], a[48:51], v[72:75], v[76:79]
v_mfma_f32_16x16x32_bf16 v[80:83], a[64:67], v[72:75], v[80:83]
L_cs11:
s_waitcnt vmcnt(20) lgkmcnt(0)
v_mfma_f32_16x16x32_bf16 v[112:115], a[0:3], a[208:211], v[112:115]
buffer_load_dwordx4 a[72:75], v11, s[20:23], s70 offen offset:0
ds_read_b64_tr_b16 a[36:37], v50 offset:55296
v_mfma_f32_16x16x32_bf16 v[148:151], a[0:3], a[212:215], v[148:151]
ds_read_b64_tr_b16 a[38:39], v50 offset:59904
v_mfma_f32_16x16x32_bf16 v[184:187], a[0:3], a[216:219], v[184:187]
v_mfma_f32_16x16x32_bf16 v[220:223], a[0:3], a[220:223], v[220:223]
ds_read_b64_tr_b16 a[40:41], v50 offset:55328
v_mfma_f32_16x16x32_bf16 v[116:119], a[4:7], a[208:211], v[116:119]
buffer_load_dwordx4 a[76:79], v48, s[20:23], s70 offen offset:0
ds_read_b64_tr_b16 a[42:43], v50 offset:59936
v_mfma_f32_16x16x32_bf16 v[152:155], a[4:7], a[212:215], v[152:155]
v_mfma_f32_16x16x32_bf16 v[188:191], a[4:7], a[216:219], v[188:191]
ds_read_b64_tr_b16 a[44:45], v50 offset:55360
v_mfma_f32_16x16x32_bf16 v[224:227], a[4:7], a[220:223], v[224:227]
ds_read_b64_tr_b16 a[46:47], v50 offset:59968
v_mfma_f32_16x16x32_bf16 v[120:123], a[8:11], a[208:211], v[120:123]
buffer_load_dwordx4 a[80:83], v11, s[20:23], s70 offen offset:1024
v_mfma_f32_16x16x32_bf16 v[156:159], a[8:11], a[212:215], v[156:159]
ds_read_b64_tr_b16 a[48:49], v50 offset:55392
v_mfma_f32_16x16x32_bf16 v[192:195], a[8:11], a[216:219], v[192:195]
ds_read_b64_tr_b16 a[50:51], v50 offset:60000
v_mfma_f32_16x16x32_bf16 v[228:231], a[8:11], a[220:223], v[228:231]
v_mfma_f32_16x16x32_bf16 v[124:127], a[12:15], a[208:211], v[124:127]
buffer_load_dwordx4 a[84:87], v48, s[20:23], s70 offen offset:1024
ds_read_b64_tr_b16 a[52:53], v50 offset:55424
v_mfma_f32_16x16x32_bf16 v[160:163], a[12:15], a[212:215], v[160:163]
ds_read_b64_tr_b16 a[54:55], v50 offset:60032
v_mfma_f32_16x16x32_bf16 v[196:199], a[12:15], a[216:219], v[196:199]
v_mfma_f32_16x16x32_bf16 v[232:235], a[12:15], a[220:223], v[232:235]
ds_read_b64_tr_b16 a[56:57], v50 offset:55456
v_mfma_f32_16x16x32_bf16 v[128:131], a[16:19], a[208:211], v[128:131]
buffer_load_dwordx4 a[88:91], v11, s[20:23], s70 offen offset:2048
ds_read_b64_tr_b16 a[58:59], v50 offset:60064
v_mfma_f32_16x16x32_bf16 v[164:167], a[16:19], a[212:215], v[164:167]
v_mfma_f32_16x16x32_bf16 v[200:203], a[16:19], a[216:219], v[200:203]
ds_read_b64_tr_b16 a[60:61], v50 offset:55488
v_mfma_f32_16x16x32_bf16 v[236:239], a[16:19], a[220:223], v[236:239]
ds_read_b64_tr_b16 a[62:63], v50 offset:60096
v_mfma_f32_16x16x32_bf16 v[132:135], a[20:23], a[208:211], v[132:135]
buffer_load_dwordx4 a[92:95], v48, s[20:23], s70 offen offset:2048
v_mfma_f32_16x16x32_bf16 v[168:171], a[20:23], a[212:215], v[168:171]
ds_read_b64_tr_b16 a[64:65], v50 offset:55520
v_mfma_f32_16x16x32_bf16 v[204:207], a[20:23], a[216:219], v[204:207]
ds_read_b64_tr_b16 a[66:67], v50 offset:60128
v_mfma_f32_16x16x32_bf16 v[240:243], a[20:23], a[220:223], v[240:243]
v_mfma_f32_16x16x32_bf16 v[136:139], a[24:27], a[208:211], v[136:139]
buffer_load_dwordx4 a[96:99], v11, s[20:23], s70 offen offset:3072
ds_read_b64_tr_b16 a[68:69], v50 offset:55552
v_mfma_f32_16x16x32_bf16 v[172:175], a[24:27], a[212:215], v[172:175]
ds_read_b64_tr_b16 a[70:71], v50 offset:60160
v_mfma_f32_16x16x32_bf16 v[208:211], a[24:27], a[216:219], v[208:211]
v_mfma_f32_16x16x32_bf16 v[244:247], a[24:27], a[220:223], v[244:247]
v_mfma_f32_16x16x32_bf16 v[140:143], a[28:31], a[208:211], v[140:143]
buffer_load_dwordx4 a[100:103], v48, s[20:23], s70 offen offset:3072
v_mfma_f32_16x16x32_bf16 v[176:179], a[28:31], a[212:215], v[176:179]
v_mfma_f32_16x16x32_bf16 v[212:215], a[28:31], a[216:219], v[212:215]
v_mfma_f32_16x16x32_bf16 v[248:251], a[28:31], a[220:223], v[248:251]
v_mfma_f32_16x16x32_bf16 v[144:147], a[32:35], a[208:211], v[144:147]
v_mfma_f32_16x16x32_bf16 v[180:183], a[32:35], a[212:215], v[180:183]
s_add_u32 m0, s30, 73728
s_add_u32 s83, s67, 0
buffer_load_dwordx4 v11, s[16:19], s83 offen offset:0 lds
v_mfma_f32_16x16x32_bf16 v[216:219], a[32:35], a[216:219], v[216:219]
v_mfma_f32_16x16x32_bf16 v[252:255], a[32:35], a[220:223], v[252:255]
s_cmp_gt_u32 s24, 1
s_cbranch_scc1 L_cs12_2
s_cmp_eq_u32 s24, 1
s_cbranch_scc1 L_cs12_1
v_mfma_f32_16x16x32_bf16 v[76:79], a[0:3], v[72:75], v[76:79]
v_mfma_f32_16x16x32_bf16 v[80:83], a[16:19], v[72:75], v[80:83]
v_mfma_f32_16x16x32_bf16 v[84:87], a[32:35], v[72:75], v[84:87]
s_branch L_cs12
L_cs12_1:
v_mfma_f32_16x16x32_bf16 v[76:79], a[4:7], v[72:75], v[76:79]
v_mfma_f32_16x16x32_bf16 v[80:83], a[20:23], v[72:75], v[80:83]
s_branch L_cs12
L_cs12_2:
s_cmp_eq_u32 s24, 3
s_cbranch_scc1 L_cs12_3
v_mfma_f32_16x16x32_bf16 v[76:79], a[8:11], v[72:75], v[76:79]
v_mfma_f32_16x16x32_bf16 v[80:83], a[24:27], v[72:75], v[80:83]
s_branch L_cs12
L_cs12_3:
v_mfma_f32_16x16x32_bf16 v[76:79], a[12:15], v[72:75], v[76:79]
v_mfma_f32_16x16x32_bf16 v[80:83], a[28:31], v[72:75], v[80:83]
L_cs12:
s_waitcnt vmcnt(29) lgkmcnt(0)
v_mfma_f32_16x16x32_bf16 v[112:115], a[36:39], a[128:131], v[112:115]
buffer_load_dwordx4 v11, s[16:19], s83 offen offset:1024 lds
ds_read_b64_tr_b16 a[0:1], v51 offset:0
v_mfma_f32_16x16x32_bf16 v[148:151], a[36:39], a[132:135], v[148:151]
ds_read_b64_tr_b16 a[2:3], v51 offset:4608
v_mfma_f32_16x16x32_bf16 v[184:187], a[36:39], a[136:139], v[184:187]
v_mfma_f32_16x16x32_bf16 v[220:223], a[36:39], a[140:143], v[220:223]
ds_read_b64_tr_b16 a[4:5], v51 offset:32
v_mfma_f32_16x16x32_bf16 v[116:119], a[40:43], a[128:131], v[116:119]
buffer_load_dwordx4 v11, s[16:19], s83 offen offset:2048 lds
ds_read_b64_tr_b16 a[6:7], v51 offset:4640
v_mfma_f32_16x16x32_bf16 v[152:155], a[40:43], a[132:135], v[152:155]
v_mfma_f32_16x16x32_bf16 v[188:191], a[40:43], a[136:139], v[188:191]
ds_read_b64_tr_b16 a[8:9], v51 offset:64
v_mfma_f32_16x16x32_bf16 v[224:227], a[40:43], a[140:143], v[224:227]
ds_read_b64_tr_b16 a[10:11], v51 offset:4672
v_mfma_f32_16x16x32_bf16 v[120:123], a[44:47], a[128:131], v[120:123]
buffer_load_dwordx4 v11, s[16:19], s83 offen offset:3072 lds
v_mfma_f32_16x16x32_bf16 v[156:159], a[44:47], a[132:135], v[156:159]
ds_read_b64_tr_b16 a[12:13], v51 offset:96
v_mfma_f32_16x16x32_bf16 v[192:195], a[44:47], a[136:139], v[192:195]
ds_read_b64_tr_b16 a[14:15], v51 offset:4704
v_mfma_f32_16x16x32_bf16 v[228:231], a[44:47], a[140:143], v[228:231]
v_mfma_f32_16x16x32_bf16 v[124:127], a[48:51], a[128:131], v[124:127]
s_add_u32 m0, s30, 77824
s_add_u32 s83, s67, 4096
buffer_load_dwordx4 v11, s[16:19], s83 offen offset:0 lds
ds_read_b64_tr_b16 a[16:17], v51 offset:128
v_mfma_f32_16x16x32_bf16 v[160:163], a[48:51], a[132:135], v[160:163]
ds_read_b64_tr_b16 a[18:19], v51 offset:4736
v_mfma_f32_16x16x32_bf16 v[196:199], a[48:51], a[136:139], v[196:199]
v_mfma_f32_16x16x32_bf16 v[232:235], a[48:51], a[140:143], v[232:235]
ds_read_b64_tr_b16 a[20:21], v51 offset:160
v_mfma_f32_16x16x32_bf16 v[128:131], a[52:55], a[128:131], v[128:131]
buffer_load_dwordx4 v11, s[16:19], s83 offen offset:1024 lds
ds_read_b64_tr_b16 a[22:23], v51 offset:4768
v_mfma_f32_16x16x32_bf16 v[164:167], a[52:55], a[132:135], v[164:167]
v_mfma_f32_16x16x32_bf16 v[200:203], a[52:55], a[136:139], v[200:203]
ds_read_b64_tr_b16 a[24:25], v51 offset:192
v_mfma_f32_16x16x32_bf16 v[236:239], a[52:55], a[140:143], v[236:239]
ds_read_b64_tr_b16 a[26:27], v51 offset:4800
v_mfma_f32_16x16x32_bf16 v[132:135], a[56:59], a[128:131], v[132:135]
buffer_load_dwordx4 v11, s[16:19], s83 offen offset:2048 lds
v_mfma_f32_16x16x32_bf16 v[168:171], a[56:59], a[132:135], v[168:171]
ds_read_b64_tr_b16 a[28:29], v51 offset:224
v_mfma_f32_16x16x32_bf16 v[204:207], a[56:59], a[136:139], v[204:207]
ds_read_b64_tr_b16 a[30:31], v51 offset:4832
v_mfma_f32_16x16x32_bf16 v[240:243], a[56:59], a[140:143], v[240:243]
v_mfma_f32_16x16x32_bf16 v[136:139], a[60:63], a[128:131], v[136:139]
buffer_load_dwordx4 v11, s[16:19], s83 offen offset:3072 lds
ds_read_b64_tr_b16 a[32:33], v51 offset:256
v_mfma_f32_16x16x32_bf16 v[172:175], a[60:63], a[132:135], v[172:175]
ds_read_b64_tr_b16 a[34:35], v51 offset:4864
v_mfma_f32_16x16x32_bf16 v[208:211], a[60:63], a[136:139], v[208:211]
v_mfma_f32_16x16x32_bf16 v[244:247], a[60:63], a[140:143], v[244:247]
v_mfma_f32_16x16x32_bf16 v[140:143], a[64:67], a[128:131], v[140:143]
s_add_u32 m0, s30, 81920
s_add_u32 s83, s67, 8192
buffer_load_dwordx4 v11, s[16:19], s83 offen offset:0 lds
v_mfma_f32_16x16x32_bf16 v[176:179], a[64:67], a[132:135], v[176:179]
v_mfma_f32_16x16x32_bf16 v[212:215], a[64:67], a[136:139], v[212:215]
v_mfma_f32_16x16x32_bf16 v[248:251], a[64:67], a[140:143], v[248:251]
v_mfma_f32_16x16x32_bf16 v[144:147], a[68:71], a[128:131], v[144:147]
v_mfma_f32_16x16x32_bf16 v[180:183], a[68:71], a[132:135], v[180:183]
buffer_load_dwordx4 a[104:107], v11, s[20:23], s71 offen offset:0
v_mfma_f32_16x16x32_bf16 v[216:219], a[68:71], a[136:139], v[216:219]
v_mfma_f32_16x16x32_bf16 v[252:255], a[68:71], a[140:143], v[252:255]
s_cmp_gt_u32 s24, 1
s_cbranch_scc1 L_cs13_2
s_cmp_eq_u32 s24, 1
s_cbranch_scc1 L_cs13_1
v_mfma_f32_16x16x32_bf16 v[76:79], a[36:39], v[72:75], v[76:79]
v_mfma_f32_16x16x32_bf16 v[80:83], a[52:55], v[72:75], v[80:83]
v_mfma_f32_16x16x32_bf16 v[84:87], a[68:71], v[72:75], v[84:87]
s_branch L_cs13
L_cs13_1:
v_mfma_f32_16x16x32_bf16 v[76:79], a[40:43], v[72:75], v[76:79]
v_mfma_f32_16x16x32_bf16 v[80:83], a[56:59], v[72:75], v[80:83]
s_branch L_cs13
L_cs13_2:
s_cmp_eq_u32 s24, 3
s_cbranch_scc1 L_cs13_3
v_mfma_f32_16x16x32_bf16 v[76:79], a[44:47], v[72:75], v[76:79]
v_mfma_f32_16x16x32_bf16 v[80:83], a[60:63], v[72:75], v[80:83]
s_branch L_cs13
L_cs13_3:
v_mfma_f32_16x16x32_bf16 v[76:79], a[48:51], v[72:75], v[76:79]
v_mfma_f32_16x16x32_bf16 v[80:83], a[64:67], v[72:75], v[80:83]
L_cs13:
s_waitcnt vmcnt(38) lgkmcnt(0)
s_add_u32 s72, s77, 2
s_and_b32 s72, s72, 7
s_lshl_b32 s72, s72, 12
s_add_u32 s72, s72, s27
s_add_u32 s73, s77, 3
s_and_b32 s73, s73, 7
s_lshl_b32 s73, s73, 12
s_add_u32 s73, s73, s27
v_mfma_f32_16x16x32_bf16 v[112:115], a[0:3], a[144:147], v[112:115]
buffer_load_dwordx4 a[108:111], v48, s[20:23], s71 offen offset:0
ds_read_b64_tr_b16 a[36:37], v51 offset:9216
v_mfma_f32_16x16x32_bf16 v[148:151], a[0:3], a[148:151], v[148:151]
ds_read_b64_tr_b16 a[38:39], v51 offset:13824
v_mfma_f32_16x16x32_bf16 v[184:187], a[0:3], a[152:155], v[184:187]
v_mfma_f32_16x16x32_bf16 v[220:223], a[0:3], a[156:159], v[220:223]
ds_read_b64_tr_b16 a[40:41], v51 offset:9248
v_mfma_f32_16x16x32_bf16 v[116:119], a[4:7], a[144:147], v[116:119]
buffer_load_dwordx4 a[112:115], v11, s[20:23], s71 offen offset:1024
ds_read_b64_tr_b16 a[42:43], v51 offset:13856
v_mfma_f32_16x16x32_bf16 v[152:155], a[4:7], a[148:151], v[152:155]
v_mfma_f32_16x16x32_bf16 v[188:191], a[4:7], a[152:155], v[188:191]
ds_read_b64_tr_b16 a[44:45], v51 offset:9280
v_mfma_f32_16x16x32_bf16 v[224:227], a[4:7], a[156:159], v[224:227]
ds_read_b64_tr_b16 a[46:47], v51 offset:13888
v_mfma_f32_16x16x32_bf16 v[120:123], a[8:11], a[144:147], v[120:123]
buffer_load_dwordx4 a[116:119], v48, s[20:23], s71 offen offset:1024
v_mfma_f32_16x16x32_bf16 v[156:159], a[8:11], a[148:151], v[156:159]
ds_read_b64_tr_b16 a[48:49], v51 offset:9312
v_mfma_f32_16x16x32_bf16 v[192:195], a[8:11], a[152:155], v[192:195]
ds_read_b64_tr_b16 a[50:51], v51 offset:13920
v_mfma_f32_16x16x32_bf16 v[228:231], a[8:11], a[156:159], v[228:231]
v_mfma_f32_16x16x32_bf16 v[124:127], a[12:15], a[144:147], v[124:127]
buffer_load_dwordx4 a[120:123], v11, s[20:23], s71 offen offset:2048
ds_read_b64_tr_b16 a[52:53], v51 offset:9344
v_mfma_f32_16x16x32_bf16 v[160:163], a[12:15], a[148:151], v[160:163]
ds_read_b64_tr_b16 a[54:55], v51 offset:13952
v_mfma_f32_16x16x32_bf16 v[196:199], a[12:15], a[152:155], v[196:199]
v_mfma_f32_16x16x32_bf16 v[232:235], a[12:15], a[156:159], v[232:235]
ds_read_b64_tr_b16 a[56:57], v51 offset:9376
v_mfma_f32_16x16x32_bf16 v[128:131], a[16:19], a[144:147], v[128:131]
buffer_load_dwordx4 a[124:127], v48, s[20:23], s71 offen offset:2048
ds_read_b64_tr_b16 a[58:59], v51 offset:13984
v_mfma_f32_16x16x32_bf16 v[164:167], a[16:19], a[148:151], v[164:167]
v_mfma_f32_16x16x32_bf16 v[200:203], a[16:19], a[152:155], v[200:203]
ds_read_b64_tr_b16 a[60:61], v51 offset:9408
v_mfma_f32_16x16x32_bf16 v[236:239], a[16:19], a[156:159], v[236:239]
ds_read_b64_tr_b16 a[62:63], v51 offset:14016
v_mfma_f32_16x16x32_bf16 v[132:135], a[20:23], a[144:147], v[132:135]
buffer_load_dwordx4 a[192:195], v11, s[20:23], s71 offen offset:3072
v_mfma_f32_16x16x32_bf16 v[168:171], a[20:23], a[148:151], v[168:171]
ds_read_b64_tr_b16 a[64:65], v51 offset:9440
v_mfma_f32_16x16x32_bf16 v[204:207], a[20:23], a[152:155], v[204:207]
ds_read_b64_tr_b16 a[66:67], v51 offset:14048
v_mfma_f32_16x16x32_bf16 v[240:243], a[20:23], a[156:159], v[240:243]
v_mfma_f32_16x16x32_bf16 v[136:139], a[24:27], a[144:147], v[136:139]
buffer_load_dwordx4 a[196:199], v48, s[20:23], s71 offen offset:3072
ds_read_b64_tr_b16 a[68:69], v51 offset:9472
v_mfma_f32_16x16x32_bf16 v[172:175], a[24:27], a[148:151], v[172:175]
ds_read_b64_tr_b16 a[70:71], v51 offset:14080
v_mfma_f32_16x16x32_bf16 v[208:211], a[24:27], a[152:155], v[208:211]
v_mfma_f32_16x16x32_bf16 v[244:247], a[24:27], a[156:159], v[244:247]
v_mfma_f32_16x16x32_bf16 v[140:143], a[28:31], a[144:147], v[140:143]
buffer_load_dwordx4 a[200:203], v11, s[20:23], s72 offen offset:0
v_mfma_f32_16x16x32_bf16 v[176:179], a[28:31], a[148:151], v[176:179]
v_mfma_f32_16x16x32_bf16 v[212:215], a[28:31], a[152:155], v[212:215]
v_mfma_f32_16x16x32_bf16 v[248:251], a[28:31], a[156:159], v[248:251]
v_mfma_f32_16x16x32_bf16 v[144:147], a[32:35], a[144:147], v[144:147]
v_mfma_f32_16x16x32_bf16 v[180:183], a[32:35], a[148:151], v[180:183]
buffer_load_dwordx4 a[204:207], v48, s[20:23], s72 offen offset:0
v_mfma_f32_16x16x32_bf16 v[216:219], a[32:35], a[152:155], v[216:219]
v_mfma_f32_16x16x32_bf16 v[252:255], a[32:35], a[156:159], v[252:255]
s_cmp_gt_u32 s24, 1
s_cbranch_scc1 L_cs14_2
s_cmp_eq_u32 s24, 1
s_cbranch_scc1 L_cs14_1
v_mfma_f32_16x16x32_bf16 v[76:79], a[0:3], v[72:75], v[76:79]
v_mfma_f32_16x16x32_bf16 v[80:83], a[16:19], v[72:75], v[80:83]
v_mfma_f32_16x16x32_bf16 v[84:87], a[32:35], v[72:75], v[84:87]
s_branch L_cs14
L_cs14_1:
v_mfma_f32_16x16x32_bf16 v[76:79], a[4:7], v[72:75], v[76:79]
v_mfma_f32_16x16x32_bf16 v[80:83], a[20:23], v[72:75], v[80:83]
s_branch L_cs14
L_cs14_2:
s_cmp_eq_u32 s24, 3
s_cbranch_scc1 L_cs14_3
v_mfma_f32_16x16x32_bf16 v[76:79], a[8:11], v[72:75], v[76:79]
v_mfma_f32_16x16x32_bf16 v[80:83], a[24:27], v[72:75], v[80:83]
s_branch L_cs14
L_cs14_3:
v_mfma_f32_16x16x32_bf16 v[76:79], a[12:15], v[72:75], v[76:79]
v_mfma_f32_16x16x32_bf16 v[80:83], a[28:31], v[72:75], v[80:83]
L_cs14:
s_waitcnt vmcnt(44) lgkmcnt(0)
s_barrier
s_add_u32 s68, s77, 2
s_and_b32 s68, s68, 7
s_mul_i32 s68, s68, 36864
s_add_u32 s68, s68, s79
v_mfma_f32_16x16x32_bf16 v[112:115], a[36:39], a[160:163], v[112:115]
buffer_load_dwordx4 a[208:211], v11, s[20:23], s72 offen offset:1024
ds_read_b64_tr_b16 a[0:1], v51 offset:18432
v_mfma_f32_16x16x32_bf16 v[148:151], a[36:39], a[164:167], v[148:151]
ds_read_b64_tr_b16 a[2:3], v51 offset:23040
v_mfma_f32_16x16x32_bf16 v[184:187], a[36:39], a[168:171], v[184:187]
v_mfma_f32_16x16x32_bf16 v[220:223], a[36:39], a[172:175], v[220:223]
ds_read_b64_tr_b16 a[4:5], v51 offset:18464
v_mfma_f32_16x16x32_bf16 v[116:119], a[40:43], a[160:163], v[116:119]
buffer_load_dwordx4 a[212:215], v48, s[20:23], s72 offen offset:1024
ds_read_b64_tr_b16 a[6:7], v51 offset:23072
v_mfma_f32_16x16x32_bf16 v[152:155], a[40:43], a[164:167], v[152:155]
v_mfma_f32_16x16x32_bf16 v[188:191], a[40:43], a[168:171], v[188:191]
ds_read_b64_tr_b16 a[8:9], v51 offset:18496
v_mfma_f32_16x16x32_bf16 v[224:227], a[40:43], a[172:175], v[224:227]
ds_read_b64_tr_b16 a[10:11], v51 offset:23104
v_mfma_f32_16x16x32_bf16 v[120:123], a[44:47], a[160:163], v[120:123]
buffer_load_dwordx4 a[216:219], v11, s[20:23], s72 offen offset:2048
v_mfma_f32_16x16x32_bf16 v[156:159], a[44:47], a[164:167], v[156:159]
ds_read_b64_tr_b16 a[12:13], v51 offset:18528
v_mfma_f32_16x16x32_bf16 v[192:195], a[44:47], a[168:171], v[192:195]
ds_read_b64_tr_b16 a[14:15], v51 offset:23136
v_mfma_f32_16x16x32_bf16 v[228:231], a[44:47], a[172:175], v[228:231]
v_mfma_f32_16x16x32_bf16 v[124:127], a[48:51], a[160:163], v[124:127]
buffer_load_dwordx4 a[220:223], v48, s[20:23], s72 offen offset:2048
ds_read_b64_tr_b16 a[16:17], v51 offset:18560
v_mfma_f32_16x16x32_bf16 v[160:163], a[48:51], a[164:167], v[160:163]
ds_read_b64_tr_b16 a[18:19], v51 offset:23168
v_mfma_f32_16x16x32_bf16 v[196:199], a[48:51], a[168:171], v[196:199]
v_mfma_f32_16x16x32_bf16 v[232:235], a[48:51], a[172:175], v[232:235]
ds_read_b64_tr_b16 a[20:21], v51 offset:18592
v_mfma_f32_16x16x32_bf16 v[128:131], a[52:55], a[160:163], v[128:131]
buffer_load_dwordx4 a[128:131], v11, s[20:23], s72 offen offset:3072
ds_read_b64_tr_b16 a[22:23], v51 offset:23200
v_mfma_f32_16x16x32_bf16 v[164:167], a[52:55], a[164:167], v[164:167]
v_mfma_f32_16x16x32_bf16 v[200:203], a[52:55], a[168:171], v[200:203]
ds_read_b64_tr_b16 a[24:25], v51 offset:18624
v_mfma_f32_16x16x32_bf16 v[236:239], a[52:55], a[172:175], v[236:239]
ds_read_b64_tr_b16 a[26:27], v51 offset:23232
v_mfma_f32_16x16x32_bf16 v[132:135], a[56:59], a[160:163], v[132:135]
buffer_load_dwordx4 a[132:135], v48, s[20:23], s72 offen offset:3072
v_mfma_f32_16x16x32_bf16 v[168:171], a[56:59], a[164:167], v[168:171]
ds_read_b64_tr_b16 a[28:29], v51 offset:18656
v_mfma_f32_16x16x32_bf16 v[204:207], a[56:59], a[168:171], v[204:207]
ds_read_b64_tr_b16 a[30:31], v51 offset:23264
v_mfma_f32_16x16x32_bf16 v[240:243], a[56:59], a[172:175], v[240:243]
v_mfma_f32_16x16x32_bf16 v[136:139], a[60:63], a[160:163], v[136:139]
buffer_load_dwordx4 a[136:139], v11, s[20:23], s73 offen offset:0
ds_read_b64_tr_b16 a[32:33], v51 offset:18688
v_mfma_f32_16x16x32_bf16 v[172:175], a[60:63], a[164:167], v[172:175]
ds_read_b64_tr_b16 a[34:35], v51 offset:23296
v_mfma_f32_16x16x32_bf16 v[208:211], a[60:63], a[168:171], v[208:211]
v_mfma_f32_16x16x32_bf16 v[244:247], a[60:63], a[172:175], v[244:247]
v_mfma_f32_16x16x32_bf16 v[140:143], a[64:67], a[160:163], v[140:143]
buffer_load_dwordx4 a[140:143], v48, s[20:23], s73 offen offset:0
v_mfma_f32_16x16x32_bf16 v[176:179], a[64:67], a[164:167], v[176:179]
v_mfma_f32_16x16x32_bf16 v[212:215], a[64:67], a[168:171], v[212:215]
v_mfma_f32_16x16x32_bf16 v[248:251], a[64:67], a[172:175], v[248:251]
v_mfma_f32_16x16x32_bf16 v[144:147], a[68:71], a[160:163], v[144:147]
v_mfma_f32_16x16x32_bf16 v[180:183], a[68:71], a[164:167], v[180:183]
s_add_u32 m0, s30, 110592
s_add_u32 s83, s68, 0
buffer_load_dwordx4 v11, s[16:19], s83 offen offset:0 lds
v_mfma_f32_16x16x32_bf16 v[216:219], a[68:71], a[168:171], v[216:219]
v_mfma_f32_16x16x32_bf16 v[252:255], a[68:71], a[172:175], v[252:255]
s_cmp_gt_u32 s24, 1
s_cbranch_scc1 L_cs15_2
s_cmp_eq_u32 s24, 1
s_cbranch_scc1 L_cs15_1
v_mfma_f32_16x16x32_bf16 v[76:79], a[36:39], v[72:75], v[76:79]
v_mfma_f32_16x16x32_bf16 v[80:83], a[52:55], v[72:75], v[80:83]
v_mfma_f32_16x16x32_bf16 v[84:87], a[68:71], v[72:75], v[84:87]
s_branch L_cs15
L_cs15_1:
v_mfma_f32_16x16x32_bf16 v[76:79], a[40:43], v[72:75], v[76:79]
v_mfma_f32_16x16x32_bf16 v[80:83], a[56:59], v[72:75], v[80:83]
s_branch L_cs15
L_cs15_2:
s_cmp_eq_u32 s24, 3
s_cbranch_scc1 L_cs15_3
v_mfma_f32_16x16x32_bf16 v[76:79], a[44:47], v[72:75], v[76:79]
v_mfma_f32_16x16x32_bf16 v[80:83], a[60:63], v[72:75], v[80:83]
s_branch L_cs15
L_cs15_3:
v_mfma_f32_16x16x32_bf16 v[76:79], a[48:51], v[72:75], v[76:79]
v_mfma_f32_16x16x32_bf16 v[80:83], a[64:67], v[72:75], v[80:83]
L_cs15:
s_waitcnt vmcnt(49) lgkmcnt(0)
v_mfma_f32_16x16x32_bf16 v[112:115], a[0:3], a[176:179], v[112:115]
buffer_load_dwordx4 v11, s[16:19], s83 offen offset:1024 lds
ds_read_b64_tr_b16 a[36:37], v49 offset:0
v_mfma_f32_16x16x32_bf16 v[148:151], a[0:3], a[180:183], v[148:151]
ds_read_b64_tr_b16 a[38:39], v49 offset:4608
v_mfma_f32_16x16x32_bf16 v[184:187], a[0:3], a[184:187], v[184:187]
v_mfma_f32_16x16x32_bf16 v[220:223], a[0:3], a[188:191], v[220:223]
ds_read_b64_tr_b16 a[40:41], v49 offset:32
v_mfma_f32_16x16x32_bf16 v[116:119], a[4:7], a[176:179], v[116:119]
buffer_load_dwordx4 v11, s[16:19], s83 offen offset:2048 lds
ds_read_b64_tr_b16 a[42:43], v49 offset:4640
v_mfma_f32_16x16x32_bf16 v[152:155], a[4:7], a[180:183], v[152:155]
v_mfma_f32_16x16x32_bf16 v[188:191], a[4:7], a[184:187], v[188:191]
ds_read_b64_tr_b16 a[44:45], v49 offset:64
v_mfma_f32_16x16x32_bf16 v[224:227], a[4:7], a[188:191], v[224:227]
ds_read_b64_tr_b16 a[46:47], v49 offset:4672
v_mfma_f32_16x16x32_bf16 v[120:123], a[8:11], a[176:179], v[120:123]
buffer_load_dwordx4 v11, s[16:19], s83 offen offset:3072 lds
v_mfma_f32_16x16x32_bf16 v[156:159], a[8:11], a[180:183], v[156:159]
ds_read_b64_tr_b16 a[48:49], v49 offset:96
v_mfma_f32_16x16x32_bf16 v[192:195], a[8:11], a[184:187], v[192:195]
ds_read_b64_tr_b16 a[50:51], v49 offset:4704
v_mfma_f32_16x16x32_bf16 v[228:231], a[8:11], a[188:191], v[228:231]
v_mfma_f32_16x16x32_bf16 v[124:127], a[12:15], a[176:179], v[124:127]
s_add_u32 m0, s30, 114688
s_add_u32 s83, s68, 4096
buffer_load_dwordx4 v11, s[16:19], s83 offen offset:0 lds
ds_read_b64_tr_b16 a[52:53], v49 offset:128
v_mfma_f32_16x16x32_bf16 v[160:163], a[12:15], a[180:183], v[160:163]
ds_read_b64_tr_b16 a[54:55], v49 offset:4736
v_mfma_f32_16x16x32_bf16 v[196:199], a[12:15], a[184:187], v[196:199]
v_mfma_f32_16x16x32_bf16 v[232:235], a[12:15], a[188:191], v[232:235]
ds_read_b64_tr_b16 a[56:57], v49 offset:160
v_mfma_f32_16x16x32_bf16 v[128:131], a[16:19], a[176:179], v[128:131]
buffer_load_dwordx4 v11, s[16:19], s83 offen offset:1024 lds
ds_read_b64_tr_b16 a[58:59], v49 offset:4768
v_mfma_f32_16x16x32_bf16 v[164:167], a[16:19], a[180:183], v[164:167]
v_mfma_f32_16x16x32_bf16 v[200:203], a[16:19], a[184:187], v[200:203]
ds_read_b64_tr_b16 a[60:61], v49 offset:192
v_mfma_f32_16x16x32_bf16 v[236:239], a[16:19], a[188:191], v[236:239]
ds_read_b64_tr_b16 a[62:63], v49 offset:4800
v_mfma_f32_16x16x32_bf16 v[132:135], a[20:23], a[176:179], v[132:135]
buffer_load_dwordx4 v11, s[16:19], s83 offen offset:2048 lds
v_mfma_f32_16x16x32_bf16 v[168:171], a[20:23], a[180:183], v[168:171]
ds_read_b64_tr_b16 a[64:65], v49 offset:224
v_mfma_f32_16x16x32_bf16 v[204:207], a[20:23], a[184:187], v[204:207]
ds_read_b64_tr_b16 a[66:67], v49 offset:4832
v_mfma_f32_16x16x32_bf16 v[240:243], a[20:23], a[188:191], v[240:243]
v_mfma_f32_16x16x32_bf16 v[136:139], a[24:27], a[176:179], v[136:139]
buffer_load_dwordx4 v11, s[16:19], s83 offen offset:3072 lds
ds_read_b64_tr_b16 a[68:69], v49 offset:256
v_mfma_f32_16x16x32_bf16 v[172:175], a[24:27], a[180:183], v[172:175]
ds_read_b64_tr_b16 a[70:71], v49 offset:4864
v_mfma_f32_16x16x32_bf16 v[208:211], a[24:27], a[184:187], v[208:211]
v_mfma_f32_16x16x32_bf16 v[244:247], a[24:27], a[188:191], v[244:247]
v_mfma_f32_16x16x32_bf16 v[140:143], a[28:31], a[176:179], v[140:143]
s_add_u32 m0, s30, 118784
s_add_u32 s83, s68, 8192
buffer_load_dwordx4 v11, s[16:19], s83 offen offset:0 lds
v_mfma_f32_16x16x32_bf16 v[176:179], a[28:31], a[180:183], v[176:179]
v_mfma_f32_16x16x32_bf16 v[212:215], a[28:31], a[184:187], v[212:215]
v_mfma_f32_16x16x32_bf16 v[248:251], a[28:31], a[188:191], v[248:251]
v_mfma_f32_16x16x32_bf16 v[144:147], a[32:35], a[176:179], v[144:147]
v_mfma_f32_16x16x32_bf16 v[180:183], a[32:35], a[180:183], v[180:183]
v_mfma_f32_16x16x32_bf16 v[216:219], a[32:35], a[184:187], v[216:219]
v_mfma_f32_16x16x32_bf16 v[252:255], a[32:35], a[188:191], v[252:255]
s_cmp_gt_u32 s24, 1
s_cbranch_scc1 L_cs16_2
s_cmp_eq_u32 s24, 1
s_cbranch_scc1 L_cs16_1
v_mfma_f32_16x16x32_bf16 v[76:79], a[0:3], v[72:75], v[76:79]
v_mfma_f32_16x16x32_bf16 v[80:83], a[16:19], v[72:75], v[80:83]
v_mfma_f32_16x16x32_bf16 v[84:87], a[32:35], v[72:75], v[84:87]
s_branch L_cs16
L_cs16_1:
v_mfma_f32_16x16x32_bf16 v[76:79], a[4:7], v[72:75], v[76:79]
v_mfma_f32_16x16x32_bf16 v[80:83], a[20:23], v[72:75], v[80:83]
s_branch L_cs16
L_cs16_2:
s_cmp_eq_u32 s24, 3
s_cbranch_scc1 L_cs16_3
v_mfma_f32_16x16x32_bf16 v[76:79], a[8:11], v[72:75], v[76:79]
v_mfma_f32_16x16x32_bf16 v[80:83], a[24:27], v[72:75], v[80:83]
s_branch L_cs16
L_cs16_3:
v_mfma_f32_16x16x32_bf16 v[76:79], a[12:15], v[72:75], v[76:79]
v_mfma_f32_16x16x32_bf16 v[80:83], a[28:31], v[72:75], v[80:83]
L_cs16:
s_waitcnt vmcnt(53) lgkmcnt(0)
v_mfma_f32_16x16x32_bf16 v[112:115], a[36:39], a[224:227], v[112:115]
v_mfma_f32_16x16x32_bf16 v[148:151], a[36:39], a[228:231], v[148:151]
v_mfma_f32_16x16x32_bf16 v[184:187], a[36:39], a[232:235], v[184:187]
v_mfma_f32_16x16x32_bf16 v[220:223], a[36:39], a[236:239], v[220:223]
v_mfma_f32_16x16x32_bf16 v[116:119], a[40:43], a[224:227], v[116:119]
v_mfma_f32_16x16x32_bf16 v[152:155], a[40:43], a[228:231], v[152:155]
v_mfma_f32_16x16x32_bf16 v[188:191], a[40:43], a[232:235], v[188:191]
v_mfma_f32_16x16x32_bf16 v[224:227], a[40:43], a[236:239], v[224:227]
v_mfma_f32_16x16x32_bf16 v[120:123], a[44:47], a[224:227], v[120:123]
v_mfma_f32_16x16x32_bf16 v[156:159], a[44:47], a[228:231], v[156:159]
v_mfma_f32_16x16x32_bf16 v[192:195], a[44:47], a[232:235], v[192:195]
v_mfma_f32_16x16x32_bf16 v[228:231], a[44:47], a[236:239], v[228:231]
v_mfma_f32_16x16x32_bf16 v[124:127], a[48:51], a[224:227], v[124:127]
v_mfma_f32_16x16x32_bf16 v[160:163], a[48:51], a[228:231], v[160:163]
v_mfma_f32_16x16x32_bf16 v[196:199], a[48:51], a[232:235], v[196:199]
v_mfma_f32_16x16x32_bf16 v[232:235], a[48:51], a[236:239], v[232:235]
v_mfma_f32_16x16x32_bf16 v[128:131], a[52:55], a[224:227], v[128:131]
v_mfma_f32_16x16x32_bf16 v[164:167], a[52:55], a[228:231], v[164:167]
v_mfma_f32_16x16x32_bf16 v[200:203], a[52:55], a[232:235], v[200:203]
v_mfma_f32_16x16x32_bf16 v[236:239], a[52:55], a[236:239], v[236:239]
v_mfma_f32_16x16x32_bf16 v[132:135], a[56:59], a[224:227], v[132:135]
v_mfma_f32_16x16x32_bf16 v[168:171], a[56:59], a[228:231], v[168:171]
v_mfma_f32_16x16x32_bf16 v[204:207], a[56:59], a[232:235], v[204:207]
v_mfma_f32_16x16x32_bf16 v[240:243], a[56:59], a[236:239], v[240:243]
v_mfma_f32_16x16x32_bf16 v[136:139], a[60:63], a[224:227], v[136:139]
v_mfma_f32_16x16x32_bf16 v[172:175], a[60:63], a[228:231], v[172:175]
v_mfma_f32_16x16x32_bf16 v[208:211], a[60:63], a[232:235], v[208:211]
v_mfma_f32_16x16x32_bf16 v[244:247], a[60:63], a[236:239], v[244:247]
v_mfma_f32_16x16x32_bf16 v[140:143], a[64:67], a[224:227], v[140:143]
v_mfma_f32_16x16x32_bf16 v[176:179], a[64:67], a[228:231], v[176:179]
v_mfma_f32_16x16x32_bf16 v[212:215], a[64:67], a[232:235], v[212:215]
v_mfma_f32_16x16x32_bf16 v[248:251], a[64:67], a[236:239], v[248:251]
v_mfma_f32_16x16x32_bf16 v[144:147], a[68:71], a[224:227], v[144:147]
v_mfma_f32_16x16x32_bf16 v[180:183], a[68:71], a[228:231], v[180:183]
v_mfma_f32_16x16x32_bf16 v[216:219], a[68:71], a[232:235], v[216:219]
v_mfma_f32_16x16x32_bf16 v[252:255], a[68:71], a[236:239], v[252:255]
s_cmp_gt_u32 s24, 1
s_cbranch_scc1 L_cs17_2
s_cmp_eq_u32 s24, 1
s_cbranch_scc1 L_cs17_1
v_mfma_f32_16x16x32_bf16 v[76:79], a[36:39], v[72:75], v[76:79]
v_mfma_f32_16x16x32_bf16 v[80:83], a[52:55], v[72:75], v[80:83]
v_mfma_f32_16x16x32_bf16 v[84:87], a[68:71], v[72:75], v[84:87]
s_branch L_cs17
L_cs17_1:
v_mfma_f32_16x16x32_bf16 v[76:79], a[40:43], v[72:75], v[76:79]
v_mfma_f32_16x16x32_bf16 v[80:83], a[56:59], v[72:75], v[80:83]
s_branch L_cs17
L_cs17_2:
s_cmp_eq_u32 s24, 3
s_cbranch_scc1 L_cs17_3
v_mfma_f32_16x16x32_bf16 v[76:79], a[44:47], v[72:75], v[76:79]
v_mfma_f32_16x16x32_bf16 v[80:83], a[60:63], v[72:75], v[80:83]
s_branch L_cs17
L_cs17_3:
v_mfma_f32_16x16x32_bf16 v[76:79], a[48:51], v[72:75], v[76:79]
v_mfma_f32_16x16x32_bf16 v[80:83], a[64:67], v[72:75], v[80:83]
L_cs17:
s_nop 7
s_barrier
v_lshrrev_b32 v18, 4, v0
v_lshlrev_b32 v18, 4, v18
v_add_u32 v18, 159744, v18
s_lshl_b32 s33, s24, 6
v_add_u32 v13, s33, v18
ds_write_b128 v13, v[76:79] offset:0
ds_write_b128 v13, v[80:83] offset:256
ds_write_b128 v13, v[84:87] offset:512
s_waitcnt lgkmcnt(0)
s_barrier
s_add_u32 s4, s88, 0x4000000
s_addc_u32 s5, s89, 0
s_mov_b32 s6, 0x990000
s_mov_b32 s7, 0x00020000
s_add_u32 s8, s88, 0x2400000
s_addc_u32 s9, s89, 0
s_mov_b32 s10, 0x1000000
s_mov_b32 s11, 0x00020000
s_add_u32 s69, s77, 3
s_and_b32 s69, s69, 7
s_mul_i32 s69, s69, 36864
s_add_u32 s69, s69, s79
ds_read_b128 v[76:79], v18 offset:0
s_add_u32 m0, s30, 0
s_add_u32 s83, s69, 0
buffer_load_dwordx4 v11, s[4:7], s83 offen offset:0 lds
ds_read_b128 v[80:83], v18 offset:64
ds_read_b128 v[84:87], v18 offset:128
ds_read_b128 v[88:91], v18 offset:192
ds_read_b128 v[92:95], v18 offset:256
ds_read_b128 v[96:99], v18 offset:320
ds_read_b128 v[100:103], v18 offset:384
ds_read_b128 v[104:107], v18 offset:448
ds_read_b128 v[108:111], v18 offset:512
s_add_u32 s16, s88, 0x1000000
s_addc_u32 s17, s89, 0
s_mov_b32 s18, 0x1200000
s_mov_b32 s19, 0x00020000
s_add_u32 s12, s88, 0x1000000
s_addc_u32 s13, s89, 0
s_mov_b32 s14, 0x1200000
s_mov_b32 s15, 0x00020000
s_mov_b32 s92, 0xbdd2d3e8
s_mov_b32 s93, 0xbdd2d3e8
v_mov_b32 v16, 0xc0135761
buffer_load_dwordx4 v11, s[4:7], s83 offen offset:1024 lds
v_mov_b32 v17, 0xc0135761
s_waitcnt lgkmcnt(0)
s_mul_i32 s60, s51, 9
s_lshr_b32 s33, s60, 1
s_lshl_b32 s33, s33, 10
s_mul_i32 s47, s62, 147456
s_add_u32 s47, s47, s33
v_add_u32 v22, 0x1000, v11
s_bitcmp1_b32 s51, 0
s_cbranch_scc1 L_t4odd
v_mov_b32 v18, v40
v_mov_b32 v20, v44
v_pk_fma_f32 v[112:113], v[76:77], v[18:19], v[112:113] op_sel_hi:[1,0,1]
v_pk_fma_f32 v[114:115], v[78:79], v[18:19], v[114:115] op_sel_hi:[1,0,1]
v_pk_mul_f32 v[112:113], v[112:113], v[20:21] op_sel_hi:[1,0]
v_pk_mul_f32 v[114:115], v[114:115], v[20:21] op_sel_hi:[1,0]
buffer_load_dwordx4 v11, s[4:7], s83 offen offset:2048 lds
v_pk_mul_f32 v[24:25], v[112:113], v[112:113]
v_pk_mul_f32 v[26:27], v[114:115], v[114:115]
v_pk_fma_f32 v[24:25], v[24:25], s[92:93], v[16:17]
v_pk_fma_f32 v[26:27], v[26:27], s[92:93], v[16:17]
v_pk_mul_f32 v[24:25], v[24:25], v[112:113]
v_pk_mul_f32 v[26:27], v[26:27], v[114:115]
v_exp_f32 v24, v24
v_exp_f32 v25, v25
v_exp_f32 v26, v26
v_exp_f32 v27, v27
v_pk_add_f32 v[24:25], v[24:25], 1.0 op_sel_hi:[1,0]
buffer_load_dwordx4 v11, s[4:7], s83 offen offset:3072 lds
v_pk_add_f32 v[26:27], v[26:27], 1.0 op_sel_hi:[1,0]
v_rcp_f32 v24, v24
v_rcp_f32 v25, v25
v_rcp_f32 v26, v26
v_rcp_f32 v27, v27
s_nop 0
v_pk_mul_f32 v[112:113], v[112:113], v[24:25]
v_pk_mul_f32 v[114:115], v[114:115], v[26:27]
v_cvt_pk_bf16_f32 v112, v112, v113
v_cvt_pk_bf16_f32 v113, v114, v115
v_pk_fma_f32 v[116:117], v[80:81], v[18:19], v[116:117] op_sel_hi:[1,0,1]
v_pk_fma_f32 v[118:119], v[82:83], v[18:19], v[118:119] op_sel_hi:[1,0,1]
s_add_u32 m0, s30, 4096
s_add_u32 s83, s69, 4096
buffer_load_dwordx4 v11, s[4:7], s83 offen offset:0 lds
v_pk_mul_f32 v[116:117], v[116:117], v[20:21] op_sel_hi:[1,0]
v_pk_mul_f32 v[118:119], v[118:119], v[20:21] op_sel_hi:[1,0]
v_pk_mul_f32 v[24:25], v[116:117], v[116:117]
v_pk_mul_f32 v[26:27], v[118:119], v[118:119]
v_pk_fma_f32 v[24:25], v[24:25], s[92:93], v[16:17]
v_pk_fma_f32 v[26:27], v[26:27], s[92:93], v[16:17]
v_pk_mul_f32 v[24:25], v[24:25], v[116:117]
v_pk_mul_f32 v[26:27], v[26:27], v[118:119]
v_exp_f32 v24, v24
v_exp_f32 v25, v25
v_exp_f32 v26, v26
buffer_load_dwordx4 v11, s[4:7], s83 offen offset:1024 lds
v_exp_f32 v27, v27
v_pk_add_f32 v[24:25], v[24:25], 1.0 op_sel_hi:[1,0]
v_pk_add_f32 v[26:27], v[26:27], 1.0 op_sel_hi:[1,0]
v_rcp_f32 v24, v24
v_rcp_f32 v25, v25
v_rcp_f32 v26, v26
v_rcp_f32 v27, v27
s_nop 0
v_pk_mul_f32 v[116:117], v[116:117], v[24:25]
v_pk_mul_f32 v[118:119], v[118:119], v[26:27]
v_cvt_pk_bf16_f32 v114, v116, v117
buffer_load_dwordx4 v11, s[4:7], s83 offen offset:2048 lds
v_cvt_pk_bf16_f32 v115, v118, v119
buffer_store_dwordx4 v[112:115], v11, s[16:19], s47 offen offset:0 sc1
v_pk_fma_f32 v[120:121], v[84:85], v[18:19], v[120:121] op_sel_hi:[1,0,1]
v_pk_fma_f32 v[122:123], v[86:87], v[18:19], v[122:123] op_sel_hi:[1,0,1]
v_pk_mul_f32 v[120:121], v[120:121], v[20:21] op_sel_hi:[1,0]
v_pk_mul_f32 v[122:123], v[122:123], v[20:21] op_sel_hi:[1,0]
v_pk_mul_f32 v[24:25], v[120:121], v[120:121]
v_pk_mul_f32 v[26:27], v[122:123], v[122:123]
v_pk_fma_f32 v[24:25], v[24:25], s[92:93], v[16:17]
v_pk_fma_f32 v[26:27], v[26:27], s[92:93], v[16:17]
v_pk_mul_f32 v[24:25], v[24:25], v[120:121]
v_pk_mul_f32 v[26:27], v[26:27], v[122:123]
v_exp_f32 v24, v24
v_exp_f32 v25, v25
buffer_load_dwordx4 v11, s[4:7], s83 offen offset:3072 lds
v_exp_f32 v26, v26
v_exp_f32 v27, v27
v_pk_add_f32 v[24:25], v[24:25], 1.0 op_sel_hi:[1,0]
v_pk_add_f32 v[26:27], v[26:27], 1.0 op_sel_hi:[1,0]
v_rcp_f32 v24, v24
v_rcp_f32 v25, v25
v_rcp_f32 v26, v26
v_rcp_f32 v27, v27
s_nop 0
v_pk_mul_f32 v[120:121], v[120:121], v[24:25]
v_pk_mul_f32 v[122:123], v[122:123], v[26:27]
s_add_u32 m0, s30, 8192
s_add_u32 s83, s69, 8192
buffer_load_dwordx4 v11, s[4:7], s83 offen offset:0 lds
v_cvt_pk_bf16_f32 v120, v120, v121
v_cvt_pk_bf16_f32 v121, v122, v123
v_pk_fma_f32 v[124:125], v[88:89], v[18:19], v[124:125] op_sel_hi:[1,0,1]
v_pk_fma_f32 v[126:127], v[90:91], v[18:19], v[126:127] op_sel_hi:[1,0,1]
v_pk_mul_f32 v[124:125], v[124:125], v[20:21] op_sel_hi:[1,0]
v_pk_mul_f32 v[126:127], v[126:127], v[20:21] op_sel_hi:[1,0]
v_pk_mul_f32 v[24:25], v[124:125], v[124:125]
v_pk_mul_f32 v[26:27], v[126:127], v[126:127]
v_pk_fma_f32 v[24:25], v[24:25], s[92:93], v[16:17]
v_pk_fma_f32 v[26:27], v[26:27], s[92:93], v[16:17]
v_pk_mul_f32 v[24:25], v[24:25], v[124:125]
v_pk_mul_f32 v[26:27], v[26:27], v[126:127]
v_exp_f32 v24, v24
v_exp_f32 v25, v25
v_exp_f32 v26, v26
v_exp_f32 v27, v27
v_pk_add_f32 v[24:25], v[24:25], 1.0 op_sel_hi:[1,0]
v_pk_add_f32 v[26:27], v[26:27], 1.0 op_sel_hi:[1,0]
v_rcp_f32 v24, v24
v_rcp_f32 v25, v25
v_rcp_f32 v26, v26
v_rcp_f32 v27, v27
s_nop 0
v_pk_mul_f32 v[124:125], v[124:125], v[24:25]
v_pk_mul_f32 v[126:127], v[126:127], v[26:27]
v_cvt_pk_bf16_f32 v122, v124, v125
v_cvt_pk_bf16_f32 v123, v126, v127
buffer_store_dwordx4 v[120:123], v11, s[16:19], s47 offen offset:1024 sc1
v_pk_fma_f32 v[128:129], v[92:93], v[18:19], v[128:129] op_sel_hi:[1,0,1]
v_pk_fma_f32 v[130:131], v[94:95], v[18:19], v[130:131] op_sel_hi:[1,0,1]
v_pk_mul_f32 v[128:129], v[128:129], v[20:21] op_sel_hi:[1,0]
v_pk_mul_f32 v[130:131], v[130:131], v[20:21] op_sel_hi:[1,0]
v_pk_mul_f32 v[24:25], v[128:129], v[128:129]
v_pk_mul_f32 v[26:27], v[130:131], v[130:131]
v_pk_fma_f32 v[24:25], v[24:25], s[92:93], v[16:17]
v_pk_fma_f32 v[26:27], v[26:27], s[92:93], v[16:17]
v_pk_mul_f32 v[24:25], v[24:25], v[128:129]
v_pk_mul_f32 v[26:27], v[26:27], v[130:131]
v_exp_f32 v24, v24
v_exp_f32 v25, v25
v_exp_f32 v26, v26
v_exp_f32 v27, v27
v_pk_add_f32 v[24:25], v[24:25], 1.0 op_sel_hi:[1,0]
v_pk_add_f32 v[26:27], v[26:27], 1.0 op_sel_hi:[1,0]
v_rcp_f32 v24, v24
v_rcp_f32 v25, v25
v_rcp_f32 v26, v26
v_rcp_f32 v27, v27
s_nop 0
v_pk_mul_f32 v[128:129], v[128:129], v[24:25]
v_pk_mul_f32 v[130:131], v[130:131], v[26:27]
v_cvt_pk_bf16_f32 v128, v128, v129
v_cvt_pk_bf16_f32 v129, v130, v131
v_pk_fma_f32 v[132:133], v[96:97], v[18:19], v[132:133] op_sel_hi:[1,0,1]
v_pk_fma_f32 v[134:135], v[98:99], v[18:19], v[134:135] op_sel_hi:[1,0,1]
v_pk_mul_f32 v[132:133], v[132:133], v[20:21] op_sel_hi:[1,0]
v_pk_mul_f32 v[134:135], v[134:135], v[20:21] op_sel_hi:[1,0]
v_pk_mul_f32 v[24:25], v[132:133], v[132:133]
v_pk_mul_f32 v[26:27], v[134:135], v[134:135]
v_pk_fma_f32 v[24:25], v[24:25], s[92:93], v[16:17]
v_pk_fma_f32 v[26:27], v[26:27], s[92:93], v[16:17]
v_pk_mul_f32 v[24:25], v[24:25], v[132:133]
v_pk_mul_f32 v[26:27], v[26:27], v[134:135]
v_exp_f32 v24, v24
v_exp_f32 v25, v25
v_exp_f32 v26, v26
v_exp_f32 v27, v27
v_pk_add_f32 v[24:25], v[24:25], 1.0 op_sel_hi:[1,0]
v_pk_add_f32 v[26:27], v[26:27], 1.0 op_sel_hi:[1,0]
v_rcp_f32 v24, v24
v_rcp_f32 v25, v25
v_rcp_f32 v26, v26
v_rcp_f32 v27, v27
s_nop 0
v_pk_mul_f32 v[132:133], v[132:133], v[24:25]
v_pk_mul_f32 v[134:135], v[134:135], v[26:27]
v_cvt_pk_bf16_f32 v130, v132, v133
v_cvt_pk_bf16_f32 v131, v134, v135
buffer_store_dwordx4 v[128:131], v11, s[16:19], s47 offen offset:2048 sc1
v_pk_fma_f32 v[136:137], v[100:101], v[18:19], v[136:137] op_sel_hi:[1,0,1]
v_pk_fma_f32 v[138:139], v[102:103], v[18:19], v[138:139] op_sel_hi:[1,0,1]
v_pk_mul_f32 v[136:137], v[136:137], v[20:21] op_sel_hi:[1,0]
v_pk_mul_f32 v[138:139], v[138:139], v[20:21] op_sel_hi:[1,0]
v_pk_mul_f32 v[24:25], v[136:137], v[136:137]
v_pk_mul_f32 v[26:27], v[138:139], v[138:139]
v_pk_fma_f32 v[24:25], v[24:25], s[92:93], v[16:17]
v_pk_fma_f32 v[26:27], v[26:27], s[92:93], v[16:17]
v_pk_mul_f32 v[24:25], v[24:25], v[136:137]
v_pk_mul_f32 v[26:27], v[26:27], v[138:139]
v_exp_f32 v24, v24
v_exp_f32 v25, v25
v_exp_f32 v26, v26
v_exp_f32 v27, v27
v_pk_add_f32 v[24:25], v[24:25], 1.0 op_sel_hi:[1,0]
v_pk_add_f32 v[26:27], v[26:27], 1.0 op_sel_hi:[1,0]
v_rcp_f32 v24, v24
v_rcp_f32 v25, v25
v_rcp_f32 v26, v26
v_rcp_f32 v27, v27
s_nop 0
v_pk_mul_f32 v[136:137], v[136:137], v[24:25]
v_pk_mul_f32 v[138:139], v[138:139], v[26:27]
v_cvt_pk_bf16_f32 v136, v136, v137
v_cvt_pk_bf16_f32 v137, v138, v139
v_pk_fma_f32 v[140:141], v[104:105], v[18:19], v[140:141] op_sel_hi:[1,0,1]
v_pk_fma_f32 v[142:143], v[106:107], v[18:19], v[142:143] op_sel_hi:[1,0,1]
v_pk_mul_f32 v[140:141], v[140:141], v[20:21] op_sel_hi:[1,0]
v_pk_mul_f32 v[142:143], v[142:143], v[20:21] op_sel_hi:[1,0]
v_pk_mul_f32 v[24:25], v[140:141], v[140:141]
v_pk_mul_f32 v[26:27], v[142:143], v[142:143]
v_pk_fma_f32 v[24:25], v[24:25], s[92:93], v[16:17]
v_pk_fma_f32 v[26:27], v[26:27], s[92:93], v[16:17]
v_pk_mul_f32 v[24:25], v[24:25], v[140:141]
v_pk_mul_f32 v[26:27], v[26:27], v[142:143]
v_exp_f32 v24, v24
v_exp_f32 v25, v25
v_exp_f32 v26, v26
v_exp_f32 v27, v27
v_pk_add_f32 v[24:25], v[24:25], 1.0 op_sel_hi:[1,0]
v_pk_add_f32 v[26:27], v[26:27], 1.0 op_sel_hi:[1,0]
v_rcp_f32 v24, v24
v_rcp_f32 v25, v25
v_rcp_f32 v26, v26
v_rcp_f32 v27, v27
s_nop 0
v_pk_mul_f32 v[140:141], v[140:141], v[24:25]
v_pk_mul_f32 v[142:143], v[142:143], v[26:27]
v_cvt_pk_bf16_f32 v138, v140, v141
v_cvt_pk_bf16_f32 v139, v142, v143
buffer_store_dwordx4 v[136:139], v11, s[16:19], s47 offen offset:3072 sc1
v_pk_fma_f32 v[144:145], v[108:109], v[18:19], v[144:145] op_sel_hi:[1,0,1]
v_pk_fma_f32 v[146:147], v[110:111], v[18:19], v[146:147] op_sel_hi:[1,0,1]
v_pk_mul_f32 v[144:145], v[144:145], v[20:21] op_sel_hi:[1,0]
v_pk_mul_f32 v[146:147], v[146:147], v[20:21] op_sel_hi:[1,0]
v_pk_mul_f32 v[24:25], v[144:145], v[144:145]
v_pk_mul_f32 v[26:27], v[146:147], v[146:147]
v_pk_fma_f32 v[24:25], v[24:25], s[92:93], v[16:17]
v_pk_fma_f32 v[26:27], v[26:27], s[92:93], v[16:17]
v_pk_mul_f32 v[24:25], v[24:25], v[144:145]
v_pk_mul_f32 v[26:27], v[26:27], v[146:147]
v_exp_f32 v24, v24
v_exp_f32 v25, v25
v_exp_f32 v26, v26
v_exp_f32 v27, v27
v_pk_add_f32 v[24:25], v[24:25], 1.0 op_sel_hi:[1,0]
v_pk_add_f32 v[26:27], v[26:27], 1.0 op_sel_hi:[1,0]
v_rcp_f32 v24, v24
v_rcp_f32 v25, v25
v_rcp_f32 v26, v26
v_rcp_f32 v27, v27
s_nop 0
v_pk_mul_f32 v[144:145], v[144:145], v[24:25]
v_pk_mul_f32 v[146:147], v[146:147], v[26:27]
v_cvt_pk_bf16_f32 v144, v144, v145
v_cvt_pk_bf16_f32 v145, v146, v147
buffer_store_dwordx2 v[144:145], v22, s[16:19], s47 offen offset:0 sc1
s_add_u32 s47, s47, 147456
v_mov_b32 v18, v41
v_mov_b32 v20, v45
v_pk_fma_f32 v[148:149], v[76:77], v[18:19], v[148:149] op_sel_hi:[1,0,1]
v_pk_fma_f32 v[150:151], v[78:79], v[18:19], v[150:151] op_sel_hi:[1,0,1]
v_pk_mul_f32 v[148:149], v[148:149], v[20:21] op_sel_hi:[1,0]
v_pk_mul_f32 v[150:151], v[150:151], v[20:21] op_sel_hi:[1,0]
v_pk_mul_f32 v[24:25], v[148:149], v[148:149]
v_pk_mul_f32 v[26:27], v[150:151], v[150:151]
v_pk_fma_f32 v[24:25], v[24:25], s[92:93], v[16:17]
v_pk_fma_f32 v[26:27], v[26:27], s[92:93], v[16:17]
v_pk_mul_f32 v[24:25], v[24:25], v[148:149]
v_pk_mul_f32 v[26:27], v[26:27], v[150:151]
v_exp_f32 v24, v24
v_exp_f32 v25, v25
v_exp_f32 v26, v26
v_exp_f32 v27, v27
v_pk_add_f32 v[24:25], v[24:25], 1.0 op_sel_hi:[1,0]
v_pk_add_f32 v[26:27], v[26:27], 1.0 op_sel_hi:[1,0]
v_rcp_f32 v24, v24
v_rcp_f32 v25, v25
v_rcp_f32 v26, v26
v_rcp_f32 v27, v27
s_nop 0
v_pk_mul_f32 v[148:149], v[148:149], v[24:25]
v_pk_mul_f32 v[150:151], v[150:151], v[26:27]
v_cvt_pk_bf16_f32 v148, v148, v149
v_cvt_pk_bf16_f32 v149, v150, v151
v_pk_fma_f32 v[152:153], v[80:81], v[18:19], v[152:153] op_sel_hi:[1,0,1]
v_pk_fma_f32 v[154:155], v[82:83], v[18:19], v[154:155] op_sel_hi:[1,0,1]
v_pk_mul_f32 v[152:153], v[152:153], v[20:21] op_sel_hi:[1,0]
v_pk_mul_f32 v[154:155], v[154:155], v[20:21] op_sel_hi:[1,0]
v_pk_mul_f32 v[24:25], v[152:153], v[152:153]
v_pk_mul_f32 v[26:27], v[154:155], v[154:155]
v_pk_fma_f32 v[24:25], v[24:25], s[92:93], v[16:17]
v_pk_fma_f32 v[26:27], v[26:27], s[92:93], v[16:17]
v_pk_mul_f32 v[24:25], v[24:25], v[152:153]
v_pk_mul_f32 v[26:27], v[26:27], v[154:155]
v_exp_f32 v24, v24
v_exp_f32 v25, v25
v_exp_f32 v26, v26
v_exp_f32 v27, v27
v_pk_add_f32 v[24:25], v[24:25], 1.0 op_sel_hi:[1,0]
v_pk_add_f32 v[26:27], v[26:27], 1.0 op_sel_hi:[1,0]
v_rcp_f32 v24, v24
v_rcp_f32 v25, v25
v_rcp_f32 v26, v26
v_rcp_f32 v27, v27
s_nop 0
v_pk_mul_f32 v[152:153], v[152:153], v[24:25]
v_pk_mul_f32 v[154:155], v[154:155], v[26:27]
v_cvt_pk_bf16_f32 v150, v152, v153
v_cvt_pk_bf16_f32 v151, v154, v155
buffer_store_dwordx4 v[148:151], v11, s[16:19], s47 offen offset:0 sc1
v_pk_fma_f32 v[156:157], v[84:85], v[18:19], v[156:157] op_sel_hi:[1,0,1]
v_pk_fma_f32 v[158:159], v[86:87], v[18:19], v[158:159] op_sel_hi:[1,0,1]
v_pk_mul_f32 v[156:157], v[156:157], v[20:21] op_sel_hi:[1,0]
v_pk_mul_f32 v[158:159], v[158:159], v[20:21] op_sel_hi:[1,0]
v_pk_mul_f32 v[24:25], v[156:157], v[156:157]
v_pk_mul_f32 v[26:27], v[158:159], v[158:159]
v_pk_fma_f32 v[24:25], v[24:25], s[92:93], v[16:17]
v_pk_fma_f32 v[26:27], v[26:27], s[92:93], v[16:17]
v_pk_mul_f32 v[24:25], v[24:25], v[156:157]
v_pk_mul_f32 v[26:27], v[26:27], v[158:159]
v_exp_f32 v24, v24
v_exp_f32 v25, v25
v_exp_f32 v26, v26
v_exp_f32 v27, v27
v_pk_add_f32 v[24:25], v[24:25], 1.0 op_sel_hi:[1,0]
v_pk_add_f32 v[26:27], v[26:27], 1.0 op_sel_hi:[1,0]
v_rcp_f32 v24, v24
v_rcp_f32 v25, v25
v_rcp_f32 v26, v26
v_rcp_f32 v27, v27
s_nop 0
v_pk_mul_f32 v[156:157], v[156:157], v[24:25]
v_pk_mul_f32 v[158:159], v[158:159], v[26:27]
v_cvt_pk_bf16_f32 v156, v156, v157
v_cvt_pk_bf16_f32 v157, v158, v159
v_pk_fma_f32 v[160:161], v[88:89], v[18:19], v[160:161] op_sel_hi:[1,0,1]
v_pk_fma_f32 v[162:163], v[90:91], v[18:19], v[162:163] op_sel_hi:[1,0,1]
v_pk_mul_f32 v[160:161], v[160:161], v[20:21] op_sel_hi:[1,0]
v_pk_mul_f32 v[162:163], v[162:163], v[20:21] op_sel_hi:[1,0]
v_pk_mul_f32 v[24:25], v[160:161], v[160:161]
v_pk_mul_f32 v[26:27], v[162:163], v[162:163]
v_pk_fma_f32 v[24:25], v[24:25], s[92:93], v[16:17]
v_pk_fma_f32 v[26:27], v[26:27], s[92:93], v[16:17]
v_pk_mul_f32 v[24:25], v[24:25], v[160:161]
v_pk_mul_f32 v[26:27], v[26:27], v[162:163]
v_exp_f32 v24, v24
v_exp_f32 v25, v25
v_exp_f32 v26, v26
v_exp_f32 v27, v27
v_pk_add_f32 v[24:25], v[24:25], 1.0 op_sel_hi:[1,0]
v_pk_add_f32 v[26:27], v[26:27], 1.0 op_sel_hi:[1,0]
v_rcp_f32 v24, v24
v_rcp_f32 v25, v25
v_rcp_f32 v26, v26
v_rcp_f32 v27, v27
s_nop 0
v_pk_mul_f32 v[160:161], v[160:161], v[24:25]
v_pk_mul_f32 v[162:163], v[162:163], v[26:27]
v_cvt_pk_bf16_f32 v158, v160, v161
v_cvt_pk_bf16_f32 v159, v162, v163
buffer_store_dwordx4 v[156:159], v11, s[16:19], s47 offen offset:1024 sc1
v_pk_fma_f32 v[164:165], v[92:93], v[18:19], v[164:165] op_sel_hi:[1,0,1]
v_pk_fma_f32 v[166:167], v[94:95], v[18:19], v[166:167] op_sel_hi:[1,0,1]
v_pk_mul_f32 v[164:165], v[164:165], v[20:21] op_sel_hi:[1,0]
v_pk_mul_f32 v[166:167], v[166:167], v[20:21] op_sel_hi:[1,0]
v_pk_mul_f32 v[24:25], v[164:165], v[164:165]
v_pk_mul_f32 v[26:27], v[166:167], v[166:167]
v_pk_fma_f32 v[24:25], v[24:25], s[92:93], v[16:17]
v_pk_fma_f32 v[26:27], v[26:27], s[92:93], v[16:17]
v_pk_mul_f32 v[24:25], v[24:25], v[164:165]
v_pk_mul_f32 v[26:27], v[26:27], v[166:167]
v_exp_f32 v24, v24
v_exp_f32 v25, v25
v_exp_f32 v26, v26
v_exp_f32 v27, v27
v_pk_add_f32 v[24:25], v[24:25], 1.0 op_sel_hi:[1,0]
v_pk_add_f32 v[26:27], v[26:27], 1.0 op_sel_hi:[1,0]
v_rcp_f32 v24, v24
v_rcp_f32 v25, v25
v_rcp_f32 v26, v26
v_rcp_f32 v27, v27
s_nop 0
v_pk_mul_f32 v[164:165], v[164:165], v[24:25]
v_pk_mul_f32 v[166:167], v[166:167], v[26:27]
v_cvt_pk_bf16_f32 v164, v164, v165
v_cvt_pk_bf16_f32 v165, v166, v167
v_pk_fma_f32 v[168:169], v[96:97], v[18:19], v[168:169] op_sel_hi:[1,0,1]
v_pk_fma_f32 v[170:171], v[98:99], v[18:19], v[170:171] op_sel_hi:[1,0,1]
v_pk_mul_f32 v[168:169], v[168:169], v[20:21] op_sel_hi:[1,0]
v_pk_mul_f32 v[170:171], v[170:171], v[20:21] op_sel_hi:[1,0]
v_pk_mul_f32 v[24:25], v[168:169], v[168:169]
v_pk_mul_f32 v[26:27], v[170:171], v[170:171]
v_pk_fma_f32 v[24:25], v[24:25], s[92:93], v[16:17]
v_pk_fma_f32 v[26:27], v[26:27], s[92:93], v[16:17]
v_pk_mul_f32 v[24:25], v[24:25], v[168:169]
v_pk_mul_f32 v[26:27], v[26:27], v[170:171]
v_exp_f32 v24, v24
v_exp_f32 v25, v25
v_exp_f32 v26, v26
v_exp_f32 v27, v27
v_pk_add_f32 v[24:25], v[24:25], 1.0 op_sel_hi:[1,0]
v_pk_add_f32 v[26:27], v[26:27], 1.0 op_sel_hi:[1,0]
v_rcp_f32 v24, v24
v_rcp_f32 v25, v25
v_rcp_f32 v26, v26
v_rcp_f32 v27, v27
s_nop 0
v_pk_mul_f32 v[168:169], v[168:169], v[24:25]
v_pk_mul_f32 v[170:171], v[170:171], v[26:27]
v_cvt_pk_bf16_f32 v166, v168, v169
v_cvt_pk_bf16_f32 v167, v170, v171
buffer_store_dwordx4 v[164:167], v11, s[16:19], s47 offen offset:2048 sc1
v_pk_fma_f32 v[172:173], v[100:101], v[18:19], v[172:173] op_sel_hi:[1,0,1]
v_pk_fma_f32 v[174:175], v[102:103], v[18:19], v[174:175] op_sel_hi:[1,0,1]
v_pk_mul_f32 v[172:173], v[172:173], v[20:21] op_sel_hi:[1,0]
v_pk_mul_f32 v[174:175], v[174:175], v[20:21] op_sel_hi:[1,0]
v_pk_mul_f32 v[24:25], v[172:173], v[172:173]
v_pk_mul_f32 v[26:27], v[174:175], v[174:175]
v_pk_fma_f32 v[24:25], v[24:25], s[92:93], v[16:17]
v_pk_fma_f32 v[26:27], v[26:27], s[92:93], v[16:17]
v_pk_mul_f32 v[24:25], v[24:25], v[172:173]
v_pk_mul_f32 v[26:27], v[26:27], v[174:175]
v_exp_f32 v24, v24
v_exp_f32 v25, v25
v_exp_f32 v26, v26
v_exp_f32 v27, v27
v_pk_add_f32 v[24:25], v[24:25], 1.0 op_sel_hi:[1,0]
v_pk_add_f32 v[26:27], v[26:27], 1.0 op_sel_hi:[1,0]
v_rcp_f32 v24, v24
v_rcp_f32 v25, v25
v_rcp_f32 v26, v26
v_rcp_f32 v27, v27
s_nop 0
v_pk_mul_f32 v[172:173], v[172:173], v[24:25]
v_pk_mul_f32 v[174:175], v[174:175], v[26:27]
v_cvt_pk_bf16_f32 v172, v172, v173
v_cvt_pk_bf16_f32 v173, v174, v175
v_pk_fma_f32 v[176:177], v[104:105], v[18:19], v[176:177] op_sel_hi:[1,0,1]
v_pk_fma_f32 v[178:179], v[106:107], v[18:19], v[178:179] op_sel_hi:[1,0,1]
v_pk_mul_f32 v[176:177], v[176:177], v[20:21] op_sel_hi:[1,0]
v_pk_mul_f32 v[178:179], v[178:179], v[20:21] op_sel_hi:[1,0]
v_pk_mul_f32 v[24:25], v[176:177], v[176:177]
v_pk_mul_f32 v[26:27], v[178:179], v[178:179]
v_pk_fma_f32 v[24:25], v[24:25], s[92:93], v[16:17]
v_pk_fma_f32 v[26:27], v[26:27], s[92:93], v[16:17]
v_pk_mul_f32 v[24:25], v[24:25], v[176:177]
v_pk_mul_f32 v[26:27], v[26:27], v[178:179]
v_exp_f32 v24, v24
v_exp_f32 v25, v25
v_exp_f32 v26, v26
v_exp_f32 v27, v27
v_pk_add_f32 v[24:25], v[24:25], 1.0 op_sel_hi:[1,0]
v_pk_add_f32 v[26:27], v[26:27], 1.0 op_sel_hi:[1,0]
v_rcp_f32 v24, v24
v_rcp_f32 v25, v25
v_rcp_f32 v26, v26
v_rcp_f32 v27, v27
s_nop 0
v_pk_mul_f32 v[176:177], v[176:177], v[24:25]
v_pk_mul_f32 v[178:179], v[178:179], v[26:27]
v_cvt_pk_bf16_f32 v174, v176, v177
v_cvt_pk_bf16_f32 v175, v178, v179
buffer_store_dwordx4 v[172:175], v11, s[16:19], s47 offen offset:3072 sc1
v_pk_fma_f32 v[180:181], v[108:109], v[18:19], v[180:181] op_sel_hi:[1,0,1]
v_pk_fma_f32 v[182:183], v[110:111], v[18:19], v[182:183] op_sel_hi:[1,0,1]
v_pk_mul_f32 v[180:181], v[180:181], v[20:21] op_sel_hi:[1,0]
v_pk_mul_f32 v[182:183], v[182:183], v[20:21] op_sel_hi:[1,0]
v_pk_mul_f32 v[24:25], v[180:181], v[180:181]
v_pk_mul_f32 v[26:27], v[182:183], v[182:183]
v_pk_fma_f32 v[24:25], v[24:25], s[92:93], v[16:17]
v_pk_fma_f32 v[26:27], v[26:27], s[92:93], v[16:17]
v_pk_mul_f32 v[24:25], v[24:25], v[180:181]
v_pk_mul_f32 v[26:27], v[26:27], v[182:183]
v_exp_f32 v24, v24
v_exp_f32 v25, v25
v_exp_f32 v26, v26
v_exp_f32 v27, v27
v_pk_add_f32 v[24:25], v[24:25], 1.0 op_sel_hi:[1,0]
v_pk_add_f32 v[26:27], v[26:27], 1.0 op_sel_hi:[1,0]
v_rcp_f32 v24, v24
v_rcp_f32 v25, v25
v_rcp_f32 v26, v26
v_rcp_f32 v27, v27
s_nop 0
v_pk_mul_f32 v[180:181], v[180:181], v[24:25]
v_pk_mul_f32 v[182:183], v[182:183], v[26:27]
v_cvt_pk_bf16_f32 v180, v180, v181
v_cvt_pk_bf16_f32 v181, v182, v183
buffer_store_dwordx2 v[180:181], v22, s[16:19], s47 offen offset:0 sc1
s_add_u32 s47, s47, 147456
v_mov_b32 v18, v42
v_mov_b32 v20, v46
v_pk_fma_f32 v[184:185], v[76:77], v[18:19], v[184:185] op_sel_hi:[1,0,1]
v_pk_fma_f32 v[186:187], v[78:79], v[18:19], v[186:187] op_sel_hi:[1,0,1]
v_pk_mul_f32 v[184:185], v[184:185], v[20:21] op_sel_hi:[1,0]
v_pk_mul_f32 v[186:187], v[186:187], v[20:21] op_sel_hi:[1,0]
v_pk_mul_f32 v[24:25], v[184:185], v[184:185]
v_pk_mul_f32 v[26:27], v[186:187], v[186:187]
v_pk_fma_f32 v[24:25], v[24:25], s[92:93], v[16:17]
v_pk_fma_f32 v[26:27], v[26:27], s[92:93], v[16:17]
v_pk_mul_f32 v[24:25], v[24:25], v[184:185]
v_pk_mul_f32 v[26:27], v[26:27], v[186:187]
v_exp_f32 v24, v24
v_exp_f32 v25, v25
v_exp_f32 v26, v26
v_exp_f32 v27, v27
v_pk_add_f32 v[24:25], v[24:25], 1.0 op_sel_hi:[1,0]
v_pk_add_f32 v[26:27], v[26:27], 1.0 op_sel_hi:[1,0]
v_rcp_f32 v24, v24
v_rcp_f32 v25, v25
v_rcp_f32 v26, v26
v_rcp_f32 v27, v27
s_nop 0
v_pk_mul_f32 v[184:185], v[184:185], v[24:25]
v_pk_mul_f32 v[186:187], v[186:187], v[26:27]
v_cvt_pk_bf16_f32 v184, v184, v185
v_cvt_pk_bf16_f32 v185, v186, v187
v_pk_fma_f32 v[188:189], v[80:81], v[18:19], v[188:189] op_sel_hi:[1,0,1]
v_pk_fma_f32 v[190:191], v[82:83], v[18:19], v[190:191] op_sel_hi:[1,0,1]
v_pk_mul_f32 v[188:189], v[188:189], v[20:21] op_sel_hi:[1,0]
v_pk_mul_f32 v[190:191], v[190:191], v[20:21] op_sel_hi:[1,0]
v_pk_mul_f32 v[24:25], v[188:189], v[188:189]
v_pk_mul_f32 v[26:27], v[190:191], v[190:191]
v_pk_fma_f32 v[24:25], v[24:25], s[92:93], v[16:17]
v_pk_fma_f32 v[26:27], v[26:27], s[92:93], v[16:17]
v_pk_mul_f32 v[24:25], v[24:25], v[188:189]
v_pk_mul_f32 v[26:27], v[26:27], v[190:191]
v_exp_f32 v24, v24
v_exp_f32 v25, v25
v_exp_f32 v26, v26
v_exp_f32 v27, v27
v_pk_add_f32 v[24:25], v[24:25], 1.0 op_sel_hi:[1,0]
v_pk_add_f32 v[26:27], v[26:27], 1.0 op_sel_hi:[1,0]
v_rcp_f32 v24, v24
v_rcp_f32 v25, v25
v_rcp_f32 v26, v26
v_rcp_f32 v27, v27
s_nop 0
v_pk_mul_f32 v[188:189], v[188:189], v[24:25]
v_pk_mul_f32 v[190:191], v[190:191], v[26:27]
v_cvt_pk_bf16_f32 v186, v188, v189
v_cvt_pk_bf16_f32 v187, v190, v191
buffer_store_dwordx4 v[184:187], v11, s[16:19], s47 offen offset:0 sc1
v_pk_fma_f32 v[192:193], v[84:85], v[18:19], v[192:193] op_sel_hi:[1,0,1]
v_pk_fma_f32 v[194:195], v[86:87], v[18:19], v[194:195] op_sel_hi:[1,0,1]
v_pk_mul_f32 v[192:193], v[192:193], v[20:21] op_sel_hi:[1,0]
v_pk_mul_f32 v[194:195], v[194:195], v[20:21] op_sel_hi:[1,0]
v_pk_mul_f32 v[24:25], v[192:193], v[192:193]
v_pk_mul_f32 v[26:27], v[194:195], v[194:195]
v_pk_fma_f32 v[24:25], v[24:25], s[92:93], v[16:17]
v_pk_fma_f32 v[26:27], v[26:27], s[92:93], v[16:17]
v_pk_mul_f32 v[24:25], v[24:25], v[192:193]
v_pk_mul_f32 v[26:27], v[26:27], v[194:195]
v_exp_f32 v24, v24
v_exp_f32 v25, v25
v_exp_f32 v26, v26
v_exp_f32 v27, v27
v_pk_add_f32 v[24:25], v[24:25], 1.0 op_sel_hi:[1,0]
v_pk_add_f32 v[26:27], v[26:27], 1.0 op_sel_hi:[1,0]
v_rcp_f32 v24, v24
v_rcp_f32 v25, v25
v_rcp_f32 v26, v26
v_rcp_f32 v27, v27
s_nop 0
v_pk_mul_f32 v[192:193], v[192:193], v[24:25]
v_pk_mul_f32 v[194:195], v[194:195], v[26:27]
v_cvt_pk_bf16_f32 v192, v192, v193
v_cvt_pk_bf16_f32 v193, v194, v195
v_pk_fma_f32 v[196:197], v[88:89], v[18:19], v[196:197] op_sel_hi:[1,0,1]
v_pk_fma_f32 v[198:199], v[90:91], v[18:19], v[198:199] op_sel_hi:[1,0,1]
v_pk_mul_f32 v[196:197], v[196:197], v[20:21] op_sel_hi:[1,0]
v_pk_mul_f32 v[198:199], v[198:199], v[20:21] op_sel_hi:[1,0]
v_pk_mul_f32 v[24:25], v[196:197], v[196:197]
v_pk_mul_f32 v[26:27], v[198:199], v[198:199]
v_pk_fma_f32 v[24:25], v[24:25], s[92:93], v[16:17]
v_pk_fma_f32 v[26:27], v[26:27], s[92:93], v[16:17]
v_pk_mul_f32 v[24:25], v[24:25], v[196:197]
v_pk_mul_f32 v[26:27], v[26:27], v[198:199]
v_exp_f32 v24, v24
v_exp_f32 v25, v25
v_exp_f32 v26, v26
v_exp_f32 v27, v27
v_pk_add_f32 v[24:25], v[24:25], 1.0 op_sel_hi:[1,0]
v_pk_add_f32 v[26:27], v[26:27], 1.0 op_sel_hi:[1,0]
v_rcp_f32 v24, v24
v_rcp_f32 v25, v25
v_rcp_f32 v26, v26
v_rcp_f32 v27, v27
s_nop 0
v_pk_mul_f32 v[196:197], v[196:197], v[24:25]
v_pk_mul_f32 v[198:199], v[198:199], v[26:27]
v_cvt_pk_bf16_f32 v194, v196, v197
v_cvt_pk_bf16_f32 v195, v198, v199
buffer_store_dwordx4 v[192:195], v11, s[16:19], s47 offen offset:1024 sc1
v_pk_fma_f32 v[200:201], v[92:93], v[18:19], v[200:201] op_sel_hi:[1,0,1]
v_pk_fma_f32 v[202:203], v[94:95], v[18:19], v[202:203] op_sel_hi:[1,0,1]
v_pk_mul_f32 v[200:201], v[200:201], v[20:21] op_sel_hi:[1,0]
v_pk_mul_f32 v[202:203], v[202:203], v[20:21] op_sel_hi:[1,0]
v_pk_mul_f32 v[24:25], v[200:201], v[200:201]
v_pk_mul_f32 v[26:27], v[202:203], v[202:203]
v_pk_fma_f32 v[24:25], v[24:25], s[92:93], v[16:17]
v_pk_fma_f32 v[26:27], v[26:27], s[92:93], v[16:17]
v_pk_mul_f32 v[24:25], v[24:25], v[200:201]
v_pk_mul_f32 v[26:27], v[26:27], v[202:203]
v_exp_f32 v24, v24
v_exp_f32 v25, v25
v_exp_f32 v26, v26
v_exp_f32 v27, v27
v_pk_add_f32 v[24:25], v[24:25], 1.0 op_sel_hi:[1,0]
v_pk_add_f32 v[26:27], v[26:27], 1.0 op_sel_hi:[1,0]
v_rcp_f32 v24, v24
v_rcp_f32 v25, v25
v_rcp_f32 v26, v26
v_rcp_f32 v27, v27
s_nop 0
v_pk_mul_f32 v[200:201], v[200:201], v[24:25]
v_pk_mul_f32 v[202:203], v[202:203], v[26:27]
v_cvt_pk_bf16_f32 v200, v200, v201
v_cvt_pk_bf16_f32 v201, v202, v203
v_pk_fma_f32 v[204:205], v[96:97], v[18:19], v[204:205] op_sel_hi:[1,0,1]
v_pk_fma_f32 v[206:207], v[98:99], v[18:19], v[206:207] op_sel_hi:[1,0,1]
v_pk_mul_f32 v[204:205], v[204:205], v[20:21] op_sel_hi:[1,0]
v_pk_mul_f32 v[206:207], v[206:207], v[20:21] op_sel_hi:[1,0]
v_pk_mul_f32 v[24:25], v[204:205], v[204:205]
v_pk_mul_f32 v[26:27], v[206:207], v[206:207]
v_pk_fma_f32 v[24:25], v[24:25], s[92:93], v[16:17]
v_pk_fma_f32 v[26:27], v[26:27], s[92:93], v[16:17]
v_pk_mul_f32 v[24:25], v[24:25], v[204:205]
v_pk_mul_f32 v[26:27], v[26:27], v[206:207]
v_exp_f32 v24, v24
v_exp_f32 v25, v25
v_exp_f32 v26, v26
v_exp_f32 v27, v27
v_pk_add_f32 v[24:25], v[24:25], 1.0 op_sel_hi:[1,0]
v_pk_add_f32 v[26:27], v[26:27], 1.0 op_sel_hi:[1,0]
v_rcp_f32 v24, v24
v_rcp_f32 v25, v25
v_rcp_f32 v26, v26
v_rcp_f32 v27, v27
s_nop 0
v_pk_mul_f32 v[204:205], v[204:205], v[24:25]
v_pk_mul_f32 v[206:207], v[206:207], v[26:27]
v_cvt_pk_bf16_f32 v202, v204, v205
v_cvt_pk_bf16_f32 v203, v206, v207
buffer_store_dwordx4 v[200:203], v11, s[16:19], s47 offen offset:2048 sc1
v_pk_fma_f32 v[208:209], v[100:101], v[18:19], v[208:209] op_sel_hi:[1,0,1]
v_pk_fma_f32 v[210:211], v[102:103], v[18:19], v[210:211] op_sel_hi:[1,0,1]
v_pk_mul_f32 v[208:209], v[208:209], v[20:21] op_sel_hi:[1,0]
v_pk_mul_f32 v[210:211], v[210:211], v[20:21] op_sel_hi:[1,0]
v_pk_mul_f32 v[24:25], v[208:209], v[208:209]
v_pk_mul_f32 v[26:27], v[210:211], v[210:211]
v_pk_fma_f32 v[24:25], v[24:25], s[92:93], v[16:17]
v_pk_fma_f32 v[26:27], v[26:27], s[92:93], v[16:17]
v_pk_mul_f32 v[24:25], v[24:25], v[208:209]
v_pk_mul_f32 v[26:27], v[26:27], v[210:211]
v_exp_f32 v24, v24
v_exp_f32 v25, v25
v_exp_f32 v26, v26
v_exp_f32 v27, v27
v_pk_add_f32 v[24:25], v[24:25], 1.0 op_sel_hi:[1,0]
v_pk_add_f32 v[26:27], v[26:27], 1.0 op_sel_hi:[1,0]
v_rcp_f32 v24, v24
v_rcp_f32 v25, v25
v_rcp_f32 v26, v26
v_rcp_f32 v27, v27
s_nop 0
v_pk_mul_f32 v[208:209], v[208:209], v[24:25]
v_pk_mul_f32 v[210:211], v[210:211], v[26:27]
v_cvt_pk_bf16_f32 v208, v208, v209
v_cvt_pk_bf16_f32 v209, v210, v211
v_pk_fma_f32 v[212:213], v[104:105], v[18:19], v[212:213] op_sel_hi:[1,0,1]
v_pk_fma_f32 v[214:215], v[106:107], v[18:19], v[214:215] op_sel_hi:[1,0,1]
v_pk_mul_f32 v[212:213], v[212:213], v[20:21] op_sel_hi:[1,0]
v_pk_mul_f32 v[214:215], v[214:215], v[20:21] op_sel_hi:[1,0]
v_pk_mul_f32 v[24:25], v[212:213], v[212:213]
v_pk_mul_f32 v[26:27], v[214:215], v[214:215]
v_pk_fma_f32 v[24:25], v[24:25], s[92:93], v[16:17]
v_pk_fma_f32 v[26:27], v[26:27], s[92:93], v[16:17]
v_pk_mul_f32 v[24:25], v[24:25], v[212:213]
v_pk_mul_f32 v[26:27], v[26:27], v[214:215]
v_exp_f32 v24, v24
v_exp_f32 v25, v25
v_exp_f32 v26, v26
v_exp_f32 v27, v27
v_pk_add_f32 v[24:25], v[24:25], 1.0 op_sel_hi:[1,0]
v_pk_add_f32 v[26:27], v[26:27], 1.0 op_sel_hi:[1,0]
v_rcp_f32 v24, v24
v_rcp_f32 v25, v25
v_rcp_f32 v26, v26
v_rcp_f32 v27, v27
s_nop 0
v_pk_mul_f32 v[212:213], v[212:213], v[24:25]
v_pk_mul_f32 v[214:215], v[214:215], v[26:27]
v_cvt_pk_bf16_f32 v210, v212, v213
v_cvt_pk_bf16_f32 v211, v214, v215
buffer_store_dwordx4 v[208:211], v11, s[16:19], s47 offen offset:3072 sc1
v_pk_fma_f32 v[216:217], v[108:109], v[18:19], v[216:217] op_sel_hi:[1,0,1]
v_pk_fma_f32 v[218:219], v[110:111], v[18:19], v[218:219] op_sel_hi:[1,0,1]
v_pk_mul_f32 v[216:217], v[216:217], v[20:21] op_sel_hi:[1,0]
v_pk_mul_f32 v[218:219], v[218:219], v[20:21] op_sel_hi:[1,0]
v_pk_mul_f32 v[24:25], v[216:217], v[216:217]
v_pk_mul_f32 v[26:27], v[218:219], v[218:219]
v_pk_fma_f32 v[24:25], v[24:25], s[92:93], v[16:17]
v_pk_fma_f32 v[26:27], v[26:27], s[92:93], v[16:17]
v_pk_mul_f32 v[24:25], v[24:25], v[216:217]
v_pk_mul_f32 v[26:27], v[26:27], v[218:219]
v_exp_f32 v24, v24
v_exp_f32 v25, v25
v_exp_f32 v26, v26
v_exp_f32 v27, v27
v_pk_add_f32 v[24:25], v[24:25], 1.0 op_sel_hi:[1,0]
v_pk_add_f32 v[26:27], v[26:27], 1.0 op_sel_hi:[1,0]
v_rcp_f32 v24, v24
v_rcp_f32 v25, v25
v_rcp_f32 v26, v26
v_rcp_f32 v27, v27
s_nop 0
v_pk_mul_f32 v[216:217], v[216:217], v[24:25]
v_pk_mul_f32 v[218:219], v[218:219], v[26:27]
v_cvt_pk_bf16_f32 v216, v216, v217
v_cvt_pk_bf16_f32 v217, v218, v219
buffer_store_dwordx2 v[216:217], v22, s[16:19], s47 offen offset:0 sc1
s_add_u32 s47, s47, 147456
v_mov_b32 v18, v43
v_mov_b32 v20, v47
v_pk_fma_f32 v[220:221], v[76:77], v[18:19], v[220:221] op_sel_hi:[1,0,1]
v_pk_fma_f32 v[222:223], v[78:79], v[18:19], v[222:223] op_sel_hi:[1,0,1]
v_pk_mul_f32 v[220:221], v[220:221], v[20:21] op_sel_hi:[1,0]
v_pk_mul_f32 v[222:223], v[222:223], v[20:21] op_sel_hi:[1,0]
v_pk_mul_f32 v[24:25], v[220:221], v[220:221]
v_pk_mul_f32 v[26:27], v[222:223], v[222:223]
v_pk_fma_f32 v[24:25], v[24:25], s[92:93], v[16:17]
v_pk_fma_f32 v[26:27], v[26:27], s[92:93], v[16:17]
v_pk_mul_f32 v[24:25], v[24:25], v[220:221]
v_pk_mul_f32 v[26:27], v[26:27], v[222:223]
v_exp_f32 v24, v24
v_exp_f32 v25, v25
v_exp_f32 v26, v26
v_exp_f32 v27, v27
v_pk_add_f32 v[24:25], v[24:25], 1.0 op_sel_hi:[1,0]
v_pk_add_f32 v[26:27], v[26:27], 1.0 op_sel_hi:[1,0]
v_rcp_f32 v24, v24
v_rcp_f32 v25, v25
v_rcp_f32 v26, v26
v_rcp_f32 v27, v27
s_nop 0
v_pk_mul_f32 v[220:221], v[220:221], v[24:25]
v_pk_mul_f32 v[222:223], v[222:223], v[26:27]
v_cvt_pk_bf16_f32 v220, v220, v221
v_cvt_pk_bf16_f32 v221, v222, v223
v_pk_fma_f32 v[224:225], v[80:81], v[18:19], v[224:225] op_sel_hi:[1,0,1]
v_pk_fma_f32 v[226:227], v[82:83], v[18:19], v[226:227] op_sel_hi:[1,0,1]
v_pk_mul_f32 v[224:225], v[224:225], v[20:21] op_sel_hi:[1,0]
v_pk_mul_f32 v[226:227], v[226:227], v[20:21] op_sel_hi:[1,0]
v_pk_mul_f32 v[24:25], v[224:225], v[224:225]
v_pk_mul_f32 v[26:27], v[226:227], v[226:227]
v_pk_fma_f32 v[24:25], v[24:25], s[92:93], v[16:17]
v_pk_fma_f32 v[26:27], v[26:27], s[92:93], v[16:17]
v_pk_mul_f32 v[24:25], v[24:25], v[224:225]
v_pk_mul_f32 v[26:27], v[26:27], v[226:227]
v_exp_f32 v24, v24
v_exp_f32 v25, v25
v_exp_f32 v26, v26
v_exp_f32 v27, v27
v_pk_add_f32 v[24:25], v[24:25], 1.0 op_sel_hi:[1,0]
v_pk_add_f32 v[26:27], v[26:27], 1.0 op_sel_hi:[1,0]
v_rcp_f32 v24, v24
v_rcp_f32 v25, v25
v_rcp_f32 v26, v26
v_rcp_f32 v27, v27
s_nop 0
v_pk_mul_f32 v[224:225], v[224:225], v[24:25]
v_pk_mul_f32 v[226:227], v[226:227], v[26:27]
v_cvt_pk_bf16_f32 v222, v224, v225
v_cvt_pk_bf16_f32 v223, v226, v227
buffer_store_dwordx4 v[220:223], v11, s[16:19], s47 offen offset:0 sc1
v_pk_fma_f32 v[228:229], v[84:85], v[18:19], v[228:229] op_sel_hi:[1,0,1]
v_pk_fma_f32 v[230:231], v[86:87], v[18:19], v[230:231] op_sel_hi:[1,0,1]
v_pk_mul_f32 v[228:229], v[228:229], v[20:21] op_sel_hi:[1,0]
v_pk_mul_f32 v[230:231], v[230:231], v[20:21] op_sel_hi:[1,0]
v_pk_mul_f32 v[24:25], v[228:229], v[228:229]
v_pk_mul_f32 v[26:27], v[230:231], v[230:231]
v_pk_fma_f32 v[24:25], v[24:25], s[92:93], v[16:17]
v_pk_fma_f32 v[26:27], v[26:27], s[92:93], v[16:17]
v_pk_mul_f32 v[24:25], v[24:25], v[228:229]
v_pk_mul_f32 v[26:27], v[26:27], v[230:231]
v_exp_f32 v24, v24
v_exp_f32 v25, v25
v_exp_f32 v26, v26
v_exp_f32 v27, v27
v_pk_add_f32 v[24:25], v[24:25], 1.0 op_sel_hi:[1,0]
v_pk_add_f32 v[26:27], v[26:27], 1.0 op_sel_hi:[1,0]
v_rcp_f32 v24, v24
v_rcp_f32 v25, v25
v_rcp_f32 v26, v26
v_rcp_f32 v27, v27
s_nop 0
v_pk_mul_f32 v[228:229], v[228:229], v[24:25]
v_pk_mul_f32 v[230:231], v[230:231], v[26:27]
v_cvt_pk_bf16_f32 v228, v228, v229
v_cvt_pk_bf16_f32 v229, v230, v231
v_pk_fma_f32 v[232:233], v[88:89], v[18:19], v[232:233] op_sel_hi:[1,0,1]
v_pk_fma_f32 v[234:235], v[90:91], v[18:19], v[234:235] op_sel_hi:[1,0,1]
v_pk_mul_f32 v[232:233], v[232:233], v[20:21] op_sel_hi:[1,0]
v_pk_mul_f32 v[234:235], v[234:235], v[20:21] op_sel_hi:[1,0]
v_pk_mul_f32 v[24:25], v[232:233], v[232:233]
v_pk_mul_f32 v[26:27], v[234:235], v[234:235]
v_pk_fma_f32 v[24:25], v[24:25], s[92:93], v[16:17]
v_pk_fma_f32 v[26:27], v[26:27], s[92:93], v[16:17]
v_pk_mul_f32 v[24:25], v[24:25], v[232:233]
v_pk_mul_f32 v[26:27], v[26:27], v[234:235]
v_exp_f32 v24, v24
v_exp_f32 v25, v25
v_exp_f32 v26, v26
v_exp_f32 v27, v27
v_pk_add_f32 v[24:25], v[24:25], 1.0 op_sel_hi:[1,0]
v_pk_add_f32 v[26:27], v[26:27], 1.0 op_sel_hi:[1,0]
v_rcp_f32 v24, v24
v_rcp_f32 v25, v25
v_rcp_f32 v26, v26
v_rcp_f32 v27, v27
s_nop 0
v_pk_mul_f32 v[232:233], v[232:233], v[24:25]
v_pk_mul_f32 v[234:235], v[234:235], v[26:27]
v_cvt_pk_bf16_f32 v230, v232, v233
v_cvt_pk_bf16_f32 v231, v234, v235
buffer_store_dwordx4 v[228:231], v11, s[16:19], s47 offen offset:1024 sc1
v_pk_fma_f32 v[236:237], v[92:93], v[18:19], v[236:237] op_sel_hi:[1,0,1]
v_pk_fma_f32 v[238:239], v[94:95], v[18:19], v[238:239] op_sel_hi:[1,0,1]
v_pk_mul_f32 v[236:237], v[236:237], v[20:21] op_sel_hi:[1,0]
v_pk_mul_f32 v[238:239], v[238:239], v[20:21] op_sel_hi:[1,0]
v_pk_mul_f32 v[24:25], v[236:237], v[236:237]
v_pk_mul_f32 v[26:27], v[238:239], v[238:239]
v_pk_fma_f32 v[24:25], v[24:25], s[92:93], v[16:17]
v_pk_fma_f32 v[26:27], v[26:27], s[92:93], v[16:17]
v_pk_mul_f32 v[24:25], v[24:25], v[236:237]
v_pk_mul_f32 v[26:27], v[26:27], v[238:239]
v_exp_f32 v24, v24
v_exp_f32 v25, v25
v_exp_f32 v26, v26
v_exp_f32 v27, v27
v_pk_add_f32 v[24:25], v[24:25], 1.0 op_sel_hi:[1,0]
v_pk_add_f32 v[26:27], v[26:27], 1.0 op_sel_hi:[1,0]
v_rcp_f32 v24, v24
v_rcp_f32 v25, v25
v_rcp_f32 v26, v26
v_rcp_f32 v27, v27
s_nop 0
v_pk_mul_f32 v[236:237], v[236:237], v[24:25]
v_pk_mul_f32 v[238:239], v[238:239], v[26:27]
v_cvt_pk_bf16_f32 v236, v236, v237
v_cvt_pk_bf16_f32 v237, v238, v239
v_pk_fma_f32 v[240:241], v[96:97], v[18:19], v[240:241] op_sel_hi:[1,0,1]
v_pk_fma_f32 v[242:243], v[98:99], v[18:19], v[242:243] op_sel_hi:[1,0,1]
v_pk_mul_f32 v[240:241], v[240:241], v[20:21] op_sel_hi:[1,0]
v_pk_mul_f32 v[242:243], v[242:243], v[20:21] op_sel_hi:[1,0]
v_pk_mul_f32 v[24:25], v[240:241], v[240:241]
v_pk_mul_f32 v[26:27], v[242:243], v[242:243]
v_pk_fma_f32 v[24:25], v[24:25], s[92:93], v[16:17]
v_pk_fma_f32 v[26:27], v[26:27], s[92:93], v[16:17]
v_pk_mul_f32 v[24:25], v[24:25], v[240:241]
v_pk_mul_f32 v[26:27], v[26:27], v[242:243]
v_exp_f32 v24, v24
v_exp_f32 v25, v25
v_exp_f32 v26, v26
v_exp_f32 v27, v27
v_pk_add_f32 v[24:25], v[24:25], 1.0 op_sel_hi:[1,0]
v_pk_add_f32 v[26:27], v[26:27], 1.0 op_sel_hi:[1,0]
v_rcp_f32 v24, v24
v_rcp_f32 v25, v25
v_rcp_f32 v26, v26
v_rcp_f32 v27, v27
s_nop 0
v_pk_mul_f32 v[240:241], v[240:241], v[24:25]
v_pk_mul_f32 v[242:243], v[242:243], v[26:27]
v_cvt_pk_bf16_f32 v238, v240, v241
v_cvt_pk_bf16_f32 v239, v242, v243
buffer_store_dwordx4 v[236:239], v11, s[16:19], s47 offen offset:2048 sc1
v_pk_fma_f32 v[244:245], v[100:101], v[18:19], v[244:245] op_sel_hi:[1,0,1]
v_pk_fma_f32 v[246:247], v[102:103], v[18:19], v[246:247] op_sel_hi:[1,0,1]
v_pk_mul_f32 v[244:245], v[244:245], v[20:21] op_sel_hi:[1,0]
v_pk_mul_f32 v[246:247], v[246:247], v[20:21] op_sel_hi:[1,0]
v_pk_mul_f32 v[24:25], v[244:245], v[244:245]
v_pk_mul_f32 v[26:27], v[246:247], v[246:247]
v_pk_fma_f32 v[24:25], v[24:25], s[92:93], v[16:17]
v_pk_fma_f32 v[26:27], v[26:27], s[92:93], v[16:17]
v_pk_mul_f32 v[24:25], v[24:25], v[244:245]
v_pk_mul_f32 v[26:27], v[26:27], v[246:247]
v_exp_f32 v24, v24
v_exp_f32 v25, v25
v_exp_f32 v26, v26
v_exp_f32 v27, v27
v_pk_add_f32 v[24:25], v[24:25], 1.0 op_sel_hi:[1,0]
v_pk_add_f32 v[26:27], v[26:27], 1.0 op_sel_hi:[1,0]
v_rcp_f32 v24, v24
v_rcp_f32 v25, v25
v_rcp_f32 v26, v26
v_rcp_f32 v27, v27
s_nop 0
v_pk_mul_f32 v[244:245], v[244:245], v[24:25]
v_pk_mul_f32 v[246:247], v[246:247], v[26:27]
v_cvt_pk_bf16_f32 v244, v244, v245
v_cvt_pk_bf16_f32 v245, v246, v247
v_pk_fma_f32 v[248:249], v[104:105], v[18:19], v[248:249] op_sel_hi:[1,0,1]
v_pk_fma_f32 v[250:251], v[106:107], v[18:19], v[250:251] op_sel_hi:[1,0,1]
v_pk_mul_f32 v[248:249], v[248:249], v[20:21] op_sel_hi:[1,0]
v_pk_mul_f32 v[250:251], v[250:251], v[20:21] op_sel_hi:[1,0]
v_pk_mul_f32 v[24:25], v[248:249], v[248:249]
v_pk_mul_f32 v[26:27], v[250:251], v[250:251]
v_pk_fma_f32 v[24:25], v[24:25], s[92:93], v[16:17]
v_pk_fma_f32 v[26:27], v[26:27], s[92:93], v[16:17]
v_pk_mul_f32 v[24:25], v[24:25], v[248:249]
v_pk_mul_f32 v[26:27], v[26:27], v[250:251]
v_exp_f32 v24, v24
v_exp_f32 v25, v25
v_exp_f32 v26, v26
v_exp_f32 v27, v27
v_pk_add_f32 v[24:25], v[24:25], 1.0 op_sel_hi:[1,0]
v_pk_add_f32 v[26:27], v[26:27], 1.0 op_sel_hi:[1,0]
v_rcp_f32 v24, v24
v_rcp_f32 v25, v25
v_rcp_f32 v26, v26
v_rcp_f32 v27, v27
s_nop 0
v_pk_mul_f32 v[248:249], v[248:249], v[24:25]
v_pk_mul_f32 v[250:251], v[250:251], v[26:27]
v_cvt_pk_bf16_f32 v246, v248, v249
v_cvt_pk_bf16_f32 v247, v250, v251
buffer_store_dwordx4 v[244:247], v11, s[16:19], s47 offen offset:3072 sc1
v_pk_fma_f32 v[252:253], v[108:109], v[18:19], v[252:253] op_sel_hi:[1,0,1]
v_pk_fma_f32 v[254:255], v[110:111], v[18:19], v[254:255] op_sel_hi:[1,0,1]
v_pk_mul_f32 v[252:253], v[252:253], v[20:21] op_sel_hi:[1,0]
v_pk_mul_f32 v[254:255], v[254:255], v[20:21] op_sel_hi:[1,0]
v_pk_mul_f32 v[24:25], v[252:253], v[252:253]
v_pk_mul_f32 v[26:27], v[254:255], v[254:255]
v_pk_fma_f32 v[24:25], v[24:25], s[92:93], v[16:17]
v_pk_fma_f32 v[26:27], v[26:27], s[92:93], v[16:17]
v_pk_mul_f32 v[24:25], v[24:25], v[252:253]
v_pk_mul_f32 v[26:27], v[26:27], v[254:255]
v_exp_f32 v24, v24
v_exp_f32 v25, v25
v_exp_f32 v26, v26
v_exp_f32 v27, v27
v_pk_add_f32 v[24:25], v[24:25], 1.0 op_sel_hi:[1,0]
v_pk_add_f32 v[26:27], v[26:27], 1.0 op_sel_hi:[1,0]
v_rcp_f32 v24, v24
v_rcp_f32 v25, v25
v_rcp_f32 v26, v26
v_rcp_f32 v27, v27
s_nop 0
v_pk_mul_f32 v[252:253], v[252:253], v[24:25]
v_pk_mul_f32 v[254:255], v[254:255], v[26:27]
v_cvt_pk_bf16_f32 v252, v252, v253
v_cvt_pk_bf16_f32 v253, v254, v255
buffer_store_dwordx2 v[252:253], v22, s[16:19], s47 offen offset:0 sc1
buffer_load_dword v10, v11, s[4:7], 0 offen
s_branch L_t4done
L_t4odd:
v_mov_b32 v18, v40
v_mov_b32 v20, v44
v_pk_fma_f32 v[112:113], v[76:77], v[18:19], v[112:113] op_sel_hi:[1,0,1]
v_pk_fma_f32 v[114:115], v[78:79], v[18:19], v[114:115] op_sel_hi:[1,0,1]
v_pk_mul_f32 v[112:113], v[112:113], v[20:21] op_sel_hi:[1,0]
v_pk_mul_f32 v[114:115], v[114:115], v[20:21] op_sel_hi:[1,0]
buffer_load_dwordx4 v11, s[4:7], s83 offen offset:2048 lds
v_pk_mul_f32 v[24:25], v[112:113], v[112:113]
v_pk_mul_f32 v[26:27], v[114:115], v[114:115]
v_pk_fma_f32 v[24:25], v[24:25], s[92:93], v[16:17]
v_pk_fma_f32 v[26:27], v[26:27], s[92:93], v[16:17]
v_pk_mul_f32 v[24:25], v[24:25], v[112:113]
v_pk_mul_f32 v[26:27], v[26:27], v[114:115]
v_exp_f32 v24, v24
v_exp_f32 v25, v25
v_exp_f32 v26, v26
v_exp_f32 v27, v27
v_pk_add_f32 v[24:25], v[24:25], 1.0 op_sel_hi:[1,0]
buffer_load_dwordx4 v11, s[4:7], s83 offen offset:3072 lds
v_pk_add_f32 v[26:27], v[26:27], 1.0 op_sel_hi:[1,0]
v_rcp_f32 v24, v24
v_rcp_f32 v25, v25
v_rcp_f32 v26, v26
v_rcp_f32 v27, v27
s_nop 0
v_pk_mul_f32 v[112:113], v[112:113], v[24:25]
v_pk_mul_f32 v[114:115], v[114:115], v[26:27]
v_cvt_pk_bf16_f32 v112, v112, v113
v_cvt_pk_bf16_f32 v113, v114, v115
buffer_store_dwordx2 v[112:113], v11, s[16:19], s47 offen offset:8 sc1
v_pk_fma_f32 v[116:117], v[80:81], v[18:19], v[116:117] op_sel_hi:[1,0,1]
v_pk_fma_f32 v[118:119], v[82:83], v[18:19], v[118:119] op_sel_hi:[1,0,1]
v_pk_mul_f32 v[116:117], v[116:117], v[20:21] op_sel_hi:[1,0]
v_pk_mul_f32 v[118:119], v[118:119], v[20:21] op_sel_hi:[1,0]
v_pk_mul_f32 v[24:25], v[116:117], v[116:117]
v_pk_mul_f32 v[26:27], v[118:119], v[118:119]
v_pk_fma_f32 v[24:25], v[24:25], s[92:93], v[16:17]
v_pk_fma_f32 v[26:27], v[26:27], s[92:93], v[16:17]
v_pk_mul_f32 v[24:25], v[24:25], v[116:117]
v_pk_mul_f32 v[26:27], v[26:27], v[118:119]
v_exp_f32 v24, v24
v_exp_f32 v25, v25
s_add_u32 m0, s30, 4096
s_add_u32 s83, s69, 4096
buffer_load_dwordx4 v11, s[4:7], s83 offen offset:0 lds
v_exp_f32 v26, v26
v_exp_f32 v27, v27
v_pk_add_f32 v[24:25], v[24:25], 1.0 op_sel_hi:[1,0]
v_pk_add_f32 v[26:27], v[26:27], 1.0 op_sel_hi:[1,0]
v_rcp_f32 v24, v24
v_rcp_f32 v25, v25
v_rcp_f32 v26, v26
v_rcp_f32 v27, v27
s_nop 0
v_pk_mul_f32 v[116:117], v[116:117], v[24:25]
v_pk_mul_f32 v[118:119], v[118:119], v[26:27]
buffer_load_dwordx4 v11, s[4:7], s83 offen offset:1024 lds
v_cvt_pk_bf16_f32 v116, v116, v117
v_cvt_pk_bf16_f32 v117, v118, v119
v_pk_fma_f32 v[120:121], v[84:85], v[18:19], v[120:121] op_sel_hi:[1,0,1]
v_pk_fma_f32 v[122:123], v[86:87], v[18:19], v[122:123] op_sel_hi:[1,0,1]
v_pk_mul_f32 v[120:121], v[120:121], v[20:21] op_sel_hi:[1,0]
v_pk_mul_f32 v[122:123], v[122:123], v[20:21] op_sel_hi:[1,0]
v_pk_mul_f32 v[24:25], v[120:121], v[120:121]
v_pk_mul_f32 v[26:27], v[122:123], v[122:123]
v_pk_fma_f32 v[24:25], v[24:25], s[92:93], v[16:17]
v_pk_fma_f32 v[26:27], v[26:27], s[92:93], v[16:17]
v_pk_mul_f32 v[24:25], v[24:25], v[120:121]
v_pk_mul_f32 v[26:27], v[26:27], v[122:123]
v_exp_f32 v24, v24
buffer_load_dwordx4 v11, s[4:7], s83 offen offset:2048 lds
v_exp_f32 v25, v25
v_exp_f32 v26, v26
v_exp_f32 v27, v27
v_pk_add_f32 v[24:25], v[24:25], 1.0 op_sel_hi:[1,0]
v_pk_add_f32 v[26:27], v[26:27], 1.0 op_sel_hi:[1,0]
v_rcp_f32 v24, v24
v_rcp_f32 v25, v25
v_rcp_f32 v26, v26
v_rcp_f32 v27, v27
s_nop 0
v_pk_mul_f32 v[120:121], v[120:121], v[24:25]
buffer_load_dwordx4 v11, s[4:7], s83 offen offset:3072 lds
v_pk_mul_f32 v[122:123], v[122:123], v[26:27]
v_cvt_pk_bf16_f32 v118, v120, v121
v_cvt_pk_bf16_f32 v119, v122, v123
buffer_store_dwordx4 v[116:119], v11, s[16:19], s47 offen offset:1024 sc1
v_pk_fma_f32 v[124:125], v[88:89], v[18:19], v[124:125] op_sel_hi:[1,0,1]
v_pk_fma_f32 v[126:127], v[90:91], v[18:19], v[126:127] op_sel_hi:[1,0,1]
v_pk_mul_f32 v[124:125], v[124:125], v[20:21] op_sel_hi:[1,0]
v_pk_mul_f32 v[126:127], v[126:127], v[20:21] op_sel_hi:[1,0]
v_pk_mul_f32 v[24:25], v[124:125], v[124:125]
v_pk_mul_f32 v[26:27], v[126:127], v[126:127]
v_pk_fma_f32 v[24:25], v[24:25], s[92:93], v[16:17]
v_pk_fma_f32 v[26:27], v[26:27], s[92:93], v[16:17]
v_pk_mul_f32 v[24:25], v[24:25], v[124:125]
v_pk_mul_f32 v[26:27], v[26:27], v[126:127]
v_exp_f32 v24, v24
v_exp_f32 v25, v25
s_add_u32 m0, s30, 8192
s_add_u32 s83, s69, 8192
buffer_load_dwordx4 v11, s[4:7], s83 offen offset:0 lds
v_exp_f32 v26, v26
v_exp_f32 v27, v27
v_pk_add_f32 v[24:25], v[24:25], 1.0 op_sel_hi:[1,0]
v_pk_add_f32 v[26:27], v[26:27], 1.0 op_sel_hi:[1,0]
v_rcp_f32 v24, v24
v_rcp_f32 v25, v25
v_rcp_f32 v26, v26
v_rcp_f32 v27, v27
s_nop 0
v_pk_mul_f32 v[124:125], v[124:125], v[24:25]
v_pk_mul_f32 v[126:127], v[126:127], v[26:27]
v_cvt_pk_bf16_f32 v124, v124, v125
v_cvt_pk_bf16_f32 v125, v126, v127
v_pk_fma_f32 v[128:129], v[92:93], v[18:19], v[128:129] op_sel_hi:[1,0,1]
v_pk_fma_f32 v[130:131], v[94:95], v[18:19], v[130:131] op_sel_hi:[1,0,1]
v_pk_mul_f32 v[128:129], v[128:129], v[20:21] op_sel_hi:[1,0]
v_pk_mul_f32 v[130:131], v[130:131], v[20:21] op_sel_hi:[1,0]
v_pk_mul_f32 v[24:25], v[128:129], v[128:129]
v_pk_mul_f32 v[26:27], v[130:131], v[130:131]
v_pk_fma_f32 v[24:25], v[24:25], s[92:93], v[16:17]
v_pk_fma_f32 v[26:27], v[26:27], s[92:93], v[16:17]
v_pk_mul_f32 v[24:25], v[24:25], v[128:129]
v_pk_mul_f32 v[26:27], v[26:27], v[130:131]
v_exp_f32 v24, v24
v_exp_f32 v25, v25
v_exp_f32 v26, v26
v_exp_f32 v27, v27
v_pk_add_f32 v[24:25], v[24:25], 1.0 op_sel_hi:[1,0]
v_pk_add_f32 v[26:27], v[26:27], 1.0 op_sel_hi:[1,0]
v_rcp_f32 v24, v24
v_rcp_f32 v25, v25
v_rcp_f32 v26, v26
v_rcp_f32 v27, v27
s_nop 0
v_pk_mul_f32 v[128:129], v[128:129], v[24:25]
v_pk_mul_f32 v[130:131], v[130:131], v[26:27]
v_cvt_pk_bf16_f32 v126, v128, v129
v_cvt_pk_bf16_f32 v127, v130, v131
buffer_store_dwordx4 v[124:127], v11, s[16:19], s47 offen offset:2048 sc1
v_pk_fma_f32 v[132:133], v[96:97], v[18:19], v[132:133] op_sel_hi:[1,0,1]
v_pk_fma_f32 v[134:135], v[98:99], v[18:19], v[134:135] op_sel_hi:[1,0,1]
v_pk_mul_f32 v[132:133], v[132:133], v[20:21] op_sel_hi:[1,0]
v_pk_mul_f32 v[134:135], v[134:135], v[20:21] op_sel_hi:[1,0]
v_pk_mul_f32 v[24:25], v[132:133], v[132:133]
v_pk_mul_f32 v[26:27], v[134:135], v[134:135]
v_pk_fma_f32 v[24:25], v[24:25], s[92:93], v[16:17]
v_pk_fma_f32 v[26:27], v[26:27], s[92:93], v[16:17]
v_pk_mul_f32 v[24:25], v[24:25], v[132:133]
v_pk_mul_f32 v[26:27], v[26:27], v[134:135]
v_exp_f32 v24, v24
v_exp_f32 v25, v25
v_exp_f32 v26, v26
v_exp_f32 v27, v27
v_pk_add_f32 v[24:25], v[24:25], 1.0 op_sel_hi:[1,0]
v_pk_add_f32 v[26:27], v[26:27], 1.0 op_sel_hi:[1,0]
v_rcp_f32 v24, v24
v_rcp_f32 v25, v25
v_rcp_f32 v26, v26
v_rcp_f32 v27, v27
s_nop 0
v_pk_mul_f32 v[132:133], v[132:133], v[24:25]
v_pk_mul_f32 v[134:135], v[134:135], v[26:27]
v_cvt_pk_bf16_f32 v132, v132, v133
v_cvt_pk_bf16_f32 v133, v134, v135
v_pk_fma_f32 v[136:137], v[100:101], v[18:19], v[136:137] op_sel_hi:[1,0,1]
v_pk_fma_f32 v[138:139], v[102:103], v[18:19], v[138:139] op_sel_hi:[1,0,1]
v_pk_mul_f32 v[136:137], v[136:137], v[20:21] op_sel_hi:[1,0]
v_pk_mul_f32 v[138:139], v[138:139], v[20:21] op_sel_hi:[1,0]
v_pk_mul_f32 v[24:25], v[136:137], v[136:137]
v_pk_mul_f32 v[26:27], v[138:139], v[138:139]
v_pk_fma_f32 v[24:25], v[24:25], s[92:93], v[16:17]
v_pk_fma_f32 v[26:27], v[26:27], s[92:93], v[16:17]
v_pk_mul_f32 v[24:25], v[24:25], v[136:137]
v_pk_mul_f32 v[26:27], v[26:27], v[138:139]
v_exp_f32 v24, v24
v_exp_f32 v25, v25
v_exp_f32 v26, v26
v_exp_f32 v27, v27
v_pk_add_f32 v[24:25], v[24:25], 1.0 op_sel_hi:[1,0]
v_pk_add_f32 v[26:27], v[26:27], 1.0 op_sel_hi:[1,0]
v_rcp_f32 v24, v24
v_rcp_f32 v25, v25
v_rcp_f32 v26, v26
v_rcp_f32 v27, v27
s_nop 0
v_pk_mul_f32 v[136:137], v[136:137], v[24:25]
v_pk_mul_f32 v[138:139], v[138:139], v[26:27]
v_cvt_pk_bf16_f32 v134, v136, v137
v_cvt_pk_bf16_f32 v135, v138, v139
buffer_store_dwordx4 v[132:135], v11, s[16:19], s47 offen offset:3072 sc1
v_pk_fma_f32 v[140:141], v[104:105], v[18:19], v[140:141] op_sel_hi:[1,0,1]
v_pk_fma_f32 v[142:143], v[106:107], v[18:19], v[142:143] op_sel_hi:[1,0,1]
v_pk_mul_f32 v[140:141], v[140:141], v[20:21] op_sel_hi:[1,0]
v_pk_mul_f32 v[142:143], v[142:143], v[20:21] op_sel_hi:[1,0]
v_pk_mul_f32 v[24:25], v[140:141], v[140:141]
v_pk_mul_f32 v[26:27], v[142:143], v[142:143]
v_pk_fma_f32 v[24:25], v[24:25], s[92:93], v[16:17]
v_pk_fma_f32 v[26:27], v[26:27], s[92:93], v[16:17]
v_pk_mul_f32 v[24:25], v[24:25], v[140:141]
v_pk_mul_f32 v[26:27], v[26:27], v[142:143]
v_exp_f32 v24, v24
v_exp_f32 v25, v25
v_exp_f32 v26, v26
v_exp_f32 v27, v27
v_pk_add_f32 v[24:25], v[24:25], 1.0 op_sel_hi:[1,0]
v_pk_add_f32 v[26:27], v[26:27], 1.0 op_sel_hi:[1,0]
v_rcp_f32 v24, v24
v_rcp_f32 v25, v25
v_rcp_f32 v26, v26
v_rcp_f32 v27, v27
s_nop 0
v_pk_mul_f32 v[140:141], v[140:141], v[24:25]
v_pk_mul_f32 v[142:143], v[142:143], v[26:27]
v_cvt_pk_bf16_f32 v140, v140, v141
v_cvt_pk_bf16_f32 v141, v142, v143
v_pk_fma_f32 v[144:145], v[108:109], v[18:19], v[144:145] op_sel_hi:[1,0,1]
v_pk_fma_f32 v[146:147], v[110:111], v[18:19], v[146:147] op_sel_hi:[1,0,1]
v_pk_mul_f32 v[144:145], v[144:145], v[20:21] op_sel_hi:[1,0]
v_pk_mul_f32 v[146:147], v[146:147], v[20:21] op_sel_hi:[1,0]
v_pk_mul_f32 v[24:25], v[144:145], v[144:145]
v_pk_mul_f32 v[26:27], v[146:147], v[146:147]
v_pk_fma_f32 v[24:25], v[24:25], s[92:93], v[16:17]
v_pk_fma_f32 v[26:27], v[26:27], s[92:93], v[16:17]
v_pk_mul_f32 v[24:25], v[24:25], v[144:145]
v_pk_mul_f32 v[26:27], v[26:27], v[146:147]
v_exp_f32 v24, v24
v_exp_f32 v25, v25
v_exp_f32 v26, v26
v_exp_f32 v27, v27
v_pk_add_f32 v[24:25], v[24:25], 1.0 op_sel_hi:[1,0]
v_pk_add_f32 v[26:27], v[26:27], 1.0 op_sel_hi:[1,0]
v_rcp_f32 v24, v24
v_rcp_f32 v25, v25
v_rcp_f32 v26, v26
v_rcp_f32 v27, v27
s_nop 0
v_pk_mul_f32 v[144:145], v[144:145], v[24:25]
v_pk_mul_f32 v[146:147], v[146:147], v[26:27]
v_cvt_pk_bf16_f32 v142, v144, v145
v_cvt_pk_bf16_f32 v143, v146, v147
buffer_store_dwordx4 v[140:143], v22, s[16:19], s47 offen offset:0 sc1
s_add_u32 s47, s47, 147456
v_mov_b32 v18, v41
v_mov_b32 v20, v45
v_pk_fma_f32 v[148:149], v[76:77], v[18:19], v[148:149] op_sel_hi:[1,0,1]
v_pk_fma_f32 v[150:151], v[78:79], v[18:19], v[150:151] op_sel_hi:[1,0,1]
v_pk_mul_f32 v[148:149], v[148:149], v[20:21] op_sel_hi:[1,0]
v_pk_mul_f32 v[150:151], v[150:151], v[20:21] op_sel_hi:[1,0]
v_pk_mul_f32 v[24:25], v[148:149], v[148:149]
v_pk_mul_f32 v[26:27], v[150:151], v[150:151]
v_pk_fma_f32 v[24:25], v[24:25], s[92:93], v[16:17]
v_pk_fma_f32 v[26:27], v[26:27], s[92:93], v[16:17]
v_pk_mul_f32 v[24:25], v[24:25], v[148:149]
v_pk_mul_f32 v[26:27], v[26:27], v[150:151]
v_exp_f32 v24, v24
v_exp_f32 v25, v25
v_exp_f32 v26, v26
v_exp_f32 v27, v27
v_pk_add_f32 v[24:25], v[24:25], 1.0 op_sel_hi:[1,0]
v_pk_add_f32 v[26:27], v[26:27], 1.0 op_sel_hi:[1,0]
v_rcp_f32 v24, v24
v_rcp_f32 v25, v25
v_rcp_f32 v26, v26
v_rcp_f32 v27, v27
s_nop 0
v_pk_mul_f32 v[148:149], v[148:149], v[24:25]
v_pk_mul_f32 v[150:151], v[150:151], v[26:27]
v_cvt_pk_bf16_f32 v148, v148, v149
v_cvt_pk_bf16_f32 v149, v150, v151
buffer_store_dwordx2 v[148:149], v11, s[16:19], s47 offen offset:8 sc1
v_pk_fma_f32 v[152:153], v[80:81], v[18:19], v[152:153] op_sel_hi:[1,0,1]
v_pk_fma_f32 v[154:155], v[82:83], v[18:19], v[154:155] op_sel_hi:[1,0,1]
v_pk_mul_f32 v[152:153], v[152:153], v[20:21] op_sel_hi:[1,0]
v_pk_mul_f32 v[154:155], v[154:155], v[20:21] op_sel_hi:[1,0]
v_pk_mul_f32 v[24:25], v[152:153], v[152:153]
v_pk_mul_f32 v[26:27], v[154:155], v[154:155]
v_pk_fma_f32 v[24:25], v[24:25], s[92:93], v[16:17]
v_pk_fma_f32 v[26:27], v[26:27], s[92:93], v[16:17]
v_pk_mul_f32 v[24:25], v[24:25], v[152:153]
v_pk_mul_f32 v[26:27], v[26:27], v[154:155]
v_exp_f32 v24, v24
v_exp_f32 v25, v25
v_exp_f32 v26, v26
v_exp_f32 v27, v27
v_pk_add_f32 v[24:25], v[24:25], 1.0 op_sel_hi:[1,0]
v_pk_add_f32 v[26:27], v[26:27], 1.0 op_sel_hi:[1,0]
v_rcp_f32 v24, v24
v_rcp_f32 v25, v25
v_rcp_f32 v26, v26
v_rcp_f32 v27, v27
s_nop 0
v_pk_mul_f32 v[152:153], v[152:153], v[24:25]
v_pk_mul_f32 v[154:155], v[154:155], v[26:27]
v_cvt_pk_bf16_f32 v152, v152, v153
v_cvt_pk_bf16_f32 v153, v154, v155
v_pk_fma_f32 v[156:157], v[84:85], v[18:19], v[156:157] op_sel_hi:[1,0,1]
v_pk_fma_f32 v[158:159], v[86:87], v[18:19], v[158:159] op_sel_hi:[1,0,1]
v_pk_mul_f32 v[156:157], v[156:157], v[20:21] op_sel_hi:[1,0]
v_pk_mul_f32 v[158:159], v[158:159], v[20:21] op_sel_hi:[1,0]
v_pk_mul_f32 v[24:25], v[156:157], v[156:157]
v_pk_mul_f32 v[26:27], v[158:159], v[158:159]
v_pk_fma_f32 v[24:25], v[24:25], s[92:93], v[16:17]
v_pk_fma_f32 v[26:27], v[26:27], s[92:93], v[16:17]
v_pk_mul_f32 v[24:25], v[24:25], v[156:157]
v_pk_mul_f32 v[26:27], v[26:27], v[158:159]
v_exp_f32 v24, v24
v_exp_f32 v25, v25
v_exp_f32 v26, v26
v_exp_f32 v27, v27
v_pk_add_f32 v[24:25], v[24:25], 1.0 op_sel_hi:[1,0]
v_pk_add_f32 v[26:27], v[26:27], 1.0 op_sel_hi:[1,0]
v_rcp_f32 v24, v24
v_rcp_f32 v25, v25
v_rcp_f32 v26, v26
v_rcp_f32 v27, v27
s_nop 0
v_pk_mul_f32 v[156:157], v[156:157], v[24:25]
v_pk_mul_f32 v[158:159], v[158:159], v[26:27]
v_cvt_pk_bf16_f32 v154, v156, v157
v_cvt_pk_bf16_f32 v155, v158, v159
buffer_store_dwordx4 v[152:155], v11, s[16:19], s47 offen offset:1024 sc1
v_pk_fma_f32 v[160:161], v[88:89], v[18:19], v[160:161] op_sel_hi:[1,0,1]
v_pk_fma_f32 v[162:163], v[90:91], v[18:19], v[162:163] op_sel_hi:[1,0,1]
v_pk_mul_f32 v[160:161], v[160:161], v[20:21] op_sel_hi:[1,0]
v_pk_mul_f32 v[162:163], v[162:163], v[20:21] op_sel_hi:[1,0]
v_pk_mul_f32 v[24:25], v[160:161], v[160:161]
v_pk_mul_f32 v[26:27], v[162:163], v[162:163]
v_pk_fma_f32 v[24:25], v[24:25], s[92:93], v[16:17]
v_pk_fma_f32 v[26:27], v[26:27], s[92:93], v[16:17]
v_pk_mul_f32 v[24:25], v[24:25], v[160:161]
v_pk_mul_f32 v[26:27], v[26:27], v[162:163]
v_exp_f32 v24, v24
v_exp_f32 v25, v25
v_exp_f32 v26, v26
v_exp_f32 v27, v27
v_pk_add_f32 v[24:25], v[24:25], 1.0 op_sel_hi:[1,0]
v_pk_add_f32 v[26:27], v[26:27], 1.0 op_sel_hi:[1,0]
v_rcp_f32 v24, v24
v_rcp_f32 v25, v25
v_rcp_f32 v26, v26
v_rcp_f32 v27, v27
s_nop 0
v_pk_mul_f32 v[160:161], v[160:161], v[24:25]
v_pk_mul_f32 v[162:163], v[162:163], v[26:27]
v_cvt_pk_bf16_f32 v160, v160, v161
v_cvt_pk_bf16_f32 v161, v162, v163
v_pk_fma_f32 v[164:165], v[92:93], v[18:19], v[164:165] op_sel_hi:[1,0,1]
v_pk_fma_f32 v[166:167], v[94:95], v[18:19], v[166:167] op_sel_hi:[1,0,1]
v_pk_mul_f32 v[164:165], v[164:165], v[20:21] op_sel_hi:[1,0]
v_pk_mul_f32 v[166:167], v[166:167], v[20:21] op_sel_hi:[1,0]
v_pk_mul_f32 v[24:25], v[164:165], v[164:165]
v_pk_mul_f32 v[26:27], v[166:167], v[166:167]
v_pk_fma_f32 v[24:25], v[24:25], s[92:93], v[16:17]
v_pk_fma_f32 v[26:27], v[26:27], s[92:93], v[16:17]
v_pk_mul_f32 v[24:25], v[24:25], v[164:165]
v_pk_mul_f32 v[26:27], v[26:27], v[166:167]
v_exp_f32 v24, v24
v_exp_f32 v25, v25
v_exp_f32 v26, v26
v_exp_f32 v27, v27
v_pk_add_f32 v[24:25], v[24:25], 1.0 op_sel_hi:[1,0]
v_pk_add_f32 v[26:27], v[26:27], 1.0 op_sel_hi:[1,0]
v_rcp_f32 v24, v24
v_rcp_f32 v25, v25
v_rcp_f32 v26, v26
v_rcp_f32 v27, v27
s_nop 0
v_pk_mul_f32 v[164:165], v[164:165], v[24:25]
v_pk_mul_f32 v[166:167], v[166:167], v[26:27]
v_cvt_pk_bf16_f32 v162, v164, v165
v_cvt_pk_bf16_f32 v163, v166, v167
buffer_store_dwordx4 v[160:163], v11, s[16:19], s47 offen offset:2048 sc1
v_pk_fma_f32 v[168:169], v[96:97], v[18:19], v[168:169] op_sel_hi:[1,0,1]
v_pk_fma_f32 v[170:171], v[98:99], v[18:19], v[170:171] op_sel_hi:[1,0,1]
v_pk_mul_f32 v[168:169], v[168:169], v[20:21] op_sel_hi:[1,0]
v_pk_mul_f32 v[170:171], v[170:171], v[20:21] op_sel_hi:[1,0]
v_pk_mul_f32 v[24:25], v[168:169], v[168:169]
v_pk_mul_f32 v[26:27], v[170:171], v[170:171]
v_pk_fma_f32 v[24:25], v[24:25], s[92:93], v[16:17]
v_pk_fma_f32 v[26:27], v[26:27], s[92:93], v[16:17]
v_pk_mul_f32 v[24:25], v[24:25], v[168:169]
v_pk_mul_f32 v[26:27], v[26:27], v[170:171]
v_exp_f32 v24, v24
v_exp_f32 v25, v25
v_exp_f32 v26, v26
v_exp_f32 v27, v27
v_pk_add_f32 v[24:25], v[24:25], 1.0 op_sel_hi:[1,0]
v_pk_add_f32 v[26:27], v[26:27], 1.0 op_sel_hi:[1,0]
v_rcp_f32 v24, v24
v_rcp_f32 v25, v25
v_rcp_f32 v26, v26
v_rcp_f32 v27, v27
s_nop 0
v_pk_mul_f32 v[168:169], v[168:169], v[24:25]
v_pk_mul_f32 v[170:171], v[170:171], v[26:27]
v_cvt_pk_bf16_f32 v168, v168, v169
v_cvt_pk_bf16_f32 v169, v170, v171
v_pk_fma_f32 v[172:173], v[100:101], v[18:19], v[172:173] op_sel_hi:[1,0,1]
v_pk_fma_f32 v[174:175], v[102:103], v[18:19], v[174:175] op_sel_hi:[1,0,1]
v_pk_mul_f32 v[172:173], v[172:173], v[20:21] op_sel_hi:[1,0]
v_pk_mul_f32 v[174:175], v[174:175], v[20:21] op_sel_hi:[1,0]
v_pk_mul_f32 v[24:25], v[172:173], v[172:173]
v_pk_mul_f32 v[26:27], v[174:175], v[174:175]
v_pk_fma_f32 v[24:25], v[24:25], s[92:93], v[16:17]
v_pk_fma_f32 v[26:27], v[26:27], s[92:93], v[16:17]
v_pk_mul_f32 v[24:25], v[24:25], v[172:173]
v_pk_mul_f32 v[26:27], v[26:27], v[174:175]
v_exp_f32 v24, v24
v_exp_f32 v25, v25
v_exp_f32 v26, v26
v_exp_f32 v27, v27
v_pk_add_f32 v[24:25], v[24:25], 1.0 op_sel_hi:[1,0]
v_pk_add_f32 v[26:27], v[26:27], 1.0 op_sel_hi:[1,0]
v_rcp_f32 v24, v24
v_rcp_f32 v25, v25
v_rcp_f32 v26, v26
v_rcp_f32 v27, v27
s_nop 0
v_pk_mul_f32 v[172:173], v[172:173], v[24:25]
v_pk_mul_f32 v[174:175], v[174:175], v[26:27]
v_cvt_pk_bf16_f32 v170, v172, v173
v_cvt_pk_bf16_f32 v171, v174, v175
buffer_store_dwordx4 v[168:171], v11, s[16:19], s47 offen offset:3072 sc1
v_pk_fma_f32 v[176:177], v[104:105], v[18:19], v[176:177] op_sel_hi:[1,0,1]
v_pk_fma_f32 v[178:179], v[106:107], v[18:19], v[178:179] op_sel_hi:[1,0,1]
v_pk_mul_f32 v[176:177], v[176:177], v[20:21] op_sel_hi:[1,0]
v_pk_mul_f32 v[178:179], v[178:179], v[20:21] op_sel_hi:[1,0]
v_pk_mul_f32 v[24:25], v[176:177], v[176:177]
v_pk_mul_f32 v[26:27], v[178:179], v[178:179]
v_pk_fma_f32 v[24:25], v[24:25], s[92:93], v[16:17]
v_pk_fma_f32 v[26:27], v[26:27], s[92:93], v[16:17]
v_pk_mul_f32 v[24:25], v[24:25], v[176:177]
v_pk_mul_f32 v[26:27], v[26:27], v[178:179]
v_exp_f32 v24, v24
v_exp_f32 v25, v25
v_exp_f32 v26, v26
v_exp_f32 v27, v27
v_pk_add_f32 v[24:25], v[24:25], 1.0 op_sel_hi:[1,0]
v_pk_add_f32 v[26:27], v[26:27], 1.0 op_sel_hi:[1,0]
v_rcp_f32 v24, v24
v_rcp_f32 v25, v25
v_rcp_f32 v26, v26
v_rcp_f32 v27, v27
s_nop 0
v_pk_mul_f32 v[176:177], v[176:177], v[24:25]
v_pk_mul_f32 v[178:179], v[178:179], v[26:27]
v_cvt_pk_bf16_f32 v176, v176, v177
v_cvt_pk_bf16_f32 v177, v178, v179
v_pk_fma_f32 v[180:181], v[108:109], v[18:19], v[180:181] op_sel_hi:[1,0,1]
v_pk_fma_f32 v[182:183], v[110:111], v[18:19], v[182:183] op_sel_hi:[1,0,1]
v_pk_mul_f32 v[180:181], v[180:181], v[20:21] op_sel_hi:[1,0]
v_pk_mul_f32 v[182:183], v[182:183], v[20:21] op_sel_hi:[1,0]
v_pk_mul_f32 v[24:25], v[180:181], v[180:181]
v_pk_mul_f32 v[26:27], v[182:183], v[182:183]
v_pk_fma_f32 v[24:25], v[24:25], s[92:93], v[16:17]
v_pk_fma_f32 v[26:27], v[26:27], s[92:93], v[16:17]
v_pk_mul_f32 v[24:25], v[24:25], v[180:181]
v_pk_mul_f32 v[26:27], v[26:27], v[182:183]
v_exp_f32 v24, v24
v_exp_f32 v25, v25
v_exp_f32 v26, v26
v_exp_f32 v27, v27
v_pk_add_f32 v[24:25], v[24:25], 1.0 op_sel_hi:[1,0]
v_pk_add_f32 v[26:27], v[26:27], 1.0 op_sel_hi:[1,0]
v_rcp_f32 v24, v24
v_rcp_f32 v25, v25
v_rcp_f32 v26, v26
v_rcp_f32 v27, v27
s_nop 0
v_pk_mul_f32 v[180:181], v[180:181], v[24:25]
v_pk_mul_f32 v[182:183], v[182:183], v[26:27]
v_cvt_pk_bf16_f32 v178, v180, v181
v_cvt_pk_bf16_f32 v179, v182, v183
buffer_store_dwordx4 v[176:179], v22, s[16:19], s47 offen offset:0 sc1
s_add_u32 s47, s47, 147456
v_mov_b32 v18, v42
v_mov_b32 v20, v46
v_pk_fma_f32 v[184:185], v[76:77], v[18:19], v[184:185] op_sel_hi:[1,0,1]
v_pk_fma_f32 v[186:187], v[78:79], v[18:19], v[186:187] op_sel_hi:[1,0,1]
v_pk_mul_f32 v[184:185], v[184:185], v[20:21] op_sel_hi:[1,0]
v_pk_mul_f32 v[186:187], v[186:187], v[20:21] op_sel_hi:[1,0]
v_pk_mul_f32 v[24:25], v[184:185], v[184:185]
v_pk_mul_f32 v[26:27], v[186:187], v[186:187]
v_pk_fma_f32 v[24:25], v[24:25], s[92:93], v[16:17]
v_pk_fma_f32 v[26:27], v[26:27], s[92:93], v[16:17]
v_pk_mul_f32 v[24:25], v[24:25], v[184:185]
v_pk_mul_f32 v[26:27], v[26:27], v[186:187]
v_exp_f32 v24, v24
v_exp_f32 v25, v25
v_exp_f32 v26, v26
v_exp_f32 v27, v27
v_pk_add_f32 v[24:25], v[24:25], 1.0 op_sel_hi:[1,0]
v_pk_add_f32 v[26:27], v[26:27], 1.0 op_sel_hi:[1,0]
v_rcp_f32 v24, v24
v_rcp_f32 v25, v25
v_rcp_f32 v26, v26
v_rcp_f32 v27, v27
s_nop 0
v_pk_mul_f32 v[184:185], v[184:185], v[24:25]
v_pk_mul_f32 v[186:187], v[186:187], v[26:27]
v_cvt_pk_bf16_f32 v184, v184, v185
v_cvt_pk_bf16_f32 v185, v186, v187
buffer_store_dwordx2 v[184:185], v11, s[16:19], s47 offen offset:8 sc1
v_pk_fma_f32 v[188:189], v[80:81], v[18:19], v[188:189] op_sel_hi:[1,0,1]
v_pk_fma_f32 v[190:191], v[82:83], v[18:19], v[190:191] op_sel_hi:[1,0,1]
v_pk_mul_f32 v[188:189], v[188:189], v[20:21] op_sel_hi:[1,0]
v_pk_mul_f32 v[190:191], v[190:191], v[20:21] op_sel_hi:[1,0]
v_pk_mul_f32 v[24:25], v[188:189], v[188:189]
v_pk_mul_f32 v[26:27], v[190:191], v[190:191]
v_pk_fma_f32 v[24:25], v[24:25], s[92:93], v[16:17]
v_pk_fma_f32 v[26:27], v[26:27], s[92:93], v[16:17]
v_pk_mul_f32 v[24:25], v[24:25], v[188:189]
v_pk_mul_f32 v[26:27], v[26:27], v[190:191]
v_exp_f32 v24, v24
v_exp_f32 v25, v25
v_exp_f32 v26, v26
v_exp_f32 v27, v27
v_pk_add_f32 v[24:25], v[24:25], 1.0 op_sel_hi:[1,0]
v_pk_add_f32 v[26:27], v[26:27], 1.0 op_sel_hi:[1,0]
v_rcp_f32 v24, v24
v_rcp_f32 v25, v25
v_rcp_f32 v26, v26
v_rcp_f32 v27, v27
s_nop 0
v_pk_mul_f32 v[188:189], v[188:189], v[24:25]
v_pk_mul_f32 v[190:191], v[190:191], v[26:27]
v_cvt_pk_bf16_f32 v188, v188, v189
v_cvt_pk_bf16_f32 v189, v190, v191
v_pk_fma_f32 v[192:193], v[84:85], v[18:19], v[192:193] op_sel_hi:[1,0,1]
v_pk_fma_f32 v[194:195], v[86:87], v[18:19], v[194:195] op_sel_hi:[1,0,1]
v_pk_mul_f32 v[192:193], v[192:193], v[20:21] op_sel_hi:[1,0]
v_pk_mul_f32 v[194:195], v[194:195], v[20:21] op_sel_hi:[1,0]
v_pk_mul_f32 v[24:25], v[192:193], v[192:193]
v_pk_mul_f32 v[26:27], v[194:195], v[194:195]
v_pk_fma_f32 v[24:25], v[24:25], s[92:93], v[16:17]
v_pk_fma_f32 v[26:27], v[26:27], s[92:93], v[16:17]
v_pk_mul_f32 v[24:25], v[24:25], v[192:193]
v_pk_mul_f32 v[26:27], v[26:27], v[194:195]
v_exp_f32 v24, v24
v_exp_f32 v25, v25
v_exp_f32 v26, v26
v_exp_f32 v27, v27
v_pk_add_f32 v[24:25], v[24:25], 1.0 op_sel_hi:[1,0]
v_pk_add_f32 v[26:27], v[26:27], 1.0 op_sel_hi:[1,0]
v_rcp_f32 v24, v24
v_rcp_f32 v25, v25
v_rcp_f32 v26, v26
v_rcp_f32 v27, v27
s_nop 0
v_pk_mul_f32 v[192:193], v[192:193], v[24:25]
v_pk_mul_f32 v[194:195], v[194:195], v[26:27]
v_cvt_pk_bf16_f32 v190, v192, v193
v_cvt_pk_bf16_f32 v191, v194, v195
buffer_store_dwordx4 v[188:191], v11, s[16:19], s47 offen offset:1024 sc1
v_pk_fma_f32 v[196:197], v[88:89], v[18:19], v[196:197] op_sel_hi:[1,0,1]
v_pk_fma_f32 v[198:199], v[90:91], v[18:19], v[198:199] op_sel_hi:[1,0,1]
v_pk_mul_f32 v[196:197], v[196:197], v[20:21] op_sel_hi:[1,0]
v_pk_mul_f32 v[198:199], v[198:199], v[20:21] op_sel_hi:[1,0]
v_pk_mul_f32 v[24:25], v[196:197], v[196:197]
v_pk_mul_f32 v[26:27], v[198:199], v[198:199]
v_pk_fma_f32 v[24:25], v[24:25], s[92:93], v[16:17]
v_pk_fma_f32 v[26:27], v[26:27], s[92:93], v[16:17]
v_pk_mul_f32 v[24:25], v[24:25], v[196:197]
v_pk_mul_f32 v[26:27], v[26:27], v[198:199]
v_exp_f32 v24, v24
v_exp_f32 v25, v25
v_exp_f32 v26, v26
v_exp_f32 v27, v27
v_pk_add_f32 v[24:25], v[24:25], 1.0 op_sel_hi:[1,0]
v_pk_add_f32 v[26:27], v[26:27], 1.0 op_sel_hi:[1,0]
v_rcp_f32 v24, v24
v_rcp_f32 v25, v25
v_rcp_f32 v26, v26
v_rcp_f32 v27, v27
s_nop 0
v_pk_mul_f32 v[196:197], v[196:197], v[24:25]
v_pk_mul_f32 v[198:199], v[198:199], v[26:27]
v_cvt_pk_bf16_f32 v196, v196, v197
v_cvt_pk_bf16_f32 v197, v198, v199
v_pk_fma_f32 v[200:201], v[92:93], v[18:19], v[200:201] op_sel_hi:[1,0,1]
v_pk_fma_f32 v[202:203], v[94:95], v[18:19], v[202:203] op_sel_hi:[1,0,1]
v_pk_mul_f32 v[200:201], v[200:201], v[20:21] op_sel_hi:[1,0]
v_pk_mul_f32 v[202:203], v[202:203], v[20:21] op_sel_hi:[1,0]
v_pk_mul_f32 v[24:25], v[200:201], v[200:201]
v_pk_mul_f32 v[26:27], v[202:203], v[202:203]
v_pk_fma_f32 v[24:25], v[24:25], s[92:93], v[16:17]
v_pk_fma_f32 v[26:27], v[26:27], s[92:93], v[16:17]
v_pk_mul_f32 v[24:25], v[24:25], v[200:201]
v_pk_mul_f32 v[26:27], v[26:27], v[202:203]
v_exp_f32 v24, v24
v_exp_f32 v25, v25
v_exp_f32 v26, v26
v_exp_f32 v27, v27
v_pk_add_f32 v[24:25], v[24:25], 1.0 op_sel_hi:[1,0]
v_pk_add_f32 v[26:27], v[26:27], 1.0 op_sel_hi:[1,0]
v_rcp_f32 v24, v24
v_rcp_f32 v25, v25
v_rcp_f32 v26, v26
v_rcp_f32 v27, v27
s_nop 0
v_pk_mul_f32 v[200:201], v[200:201], v[24:25]
v_pk_mul_f32 v[202:203], v[202:203], v[26:27]
v_cvt_pk_bf16_f32 v198, v200, v201
v_cvt_pk_bf16_f32 v199, v202, v203
buffer_store_dwordx4 v[196:199], v11, s[16:19], s47 offen offset:2048 sc1
v_pk_fma_f32 v[204:205], v[96:97], v[18:19], v[204:205] op_sel_hi:[1,0,1]
v_pk_fma_f32 v[206:207], v[98:99], v[18:19], v[206:207] op_sel_hi:[1,0,1]
v_pk_mul_f32 v[204:205], v[204:205], v[20:21] op_sel_hi:[1,0]
v_pk_mul_f32 v[206:207], v[206:207], v[20:21] op_sel_hi:[1,0]
v_pk_mul_f32 v[24:25], v[204:205], v[204:205]
v_pk_mul_f32 v[26:27], v[206:207], v[206:207]
v_pk_fma_f32 v[24:25], v[24:25], s[92:93], v[16:17]
v_pk_fma_f32 v[26:27], v[26:27], s[92:93], v[16:17]
v_pk_mul_f32 v[24:25], v[24:25], v[204:205]
v_pk_mul_f32 v[26:27], v[26:27], v[206:207]
v_exp_f32 v24, v24
v_exp_f32 v25, v25
v_exp_f32 v26, v26
v_exp_f32 v27, v27
v_pk_add_f32 v[24:25], v[24:25], 1.0 op_sel_hi:[1,0]
v_pk_add_f32 v[26:27], v[26:27], 1.0 op_sel_hi:[1,0]
v_rcp_f32 v24, v24
v_rcp_f32 v25, v25
v_rcp_f32 v26, v26
v_rcp_f32 v27, v27
s_nop 0
v_pk_mul_f32 v[204:205], v[204:205], v[24:25]
v_pk_mul_f32 v[206:207], v[206:207], v[26:27]
v_cvt_pk_bf16_f32 v204, v204, v205
v_cvt_pk_bf16_f32 v205, v206, v207
v_pk_fma_f32 v[208:209], v[100:101], v[18:19], v[208:209] op_sel_hi:[1,0,1]
v_pk_fma_f32 v[210:211], v[102:103], v[18:19], v[210:211] op_sel_hi:[1,0,1]
v_pk_mul_f32 v[208:209], v[208:209], v[20:21] op_sel_hi:[1,0]
v_pk_mul_f32 v[210:211], v[210:211], v[20:21] op_sel_hi:[1,0]
v_pk_mul_f32 v[24:25], v[208:209], v[208:209]
v_pk_mul_f32 v[26:27], v[210:211], v[210:211]
v_pk_fma_f32 v[24:25], v[24:25], s[92:93], v[16:17]
v_pk_fma_f32 v[26:27], v[26:27], s[92:93], v[16:17]
v_pk_mul_f32 v[24:25], v[24:25], v[208:209]
v_pk_mul_f32 v[26:27], v[26:27], v[210:211]
v_exp_f32 v24, v24
v_exp_f32 v25, v25
v_exp_f32 v26, v26
v_exp_f32 v27, v27
v_pk_add_f32 v[24:25], v[24:25], 1.0 op_sel_hi:[1,0]
v_pk_add_f32 v[26:27], v[26:27], 1.0 op_sel_hi:[1,0]
v_rcp_f32 v24, v24
v_rcp_f32 v25, v25
v_rcp_f32 v26, v26
v_rcp_f32 v27, v27
s_nop 0
v_pk_mul_f32 v[208:209], v[208:209], v[24:25]
v_pk_mul_f32 v[210:211], v[210:211], v[26:27]
v_cvt_pk_bf16_f32 v206, v208, v209
v_cvt_pk_bf16_f32 v207, v210, v211
buffer_store_dwordx4 v[204:207], v11, s[16:19], s47 offen offset:3072 sc1
v_pk_fma_f32 v[212:213], v[104:105], v[18:19], v[212:213] op_sel_hi:[1,0,1]
v_pk_fma_f32 v[214:215], v[106:107], v[18:19], v[214:215] op_sel_hi:[1,0,1]
v_pk_mul_f32 v[212:213], v[212:213], v[20:21] op_sel_hi:[1,0]
v_pk_mul_f32 v[214:215], v[214:215], v[20:21] op_sel_hi:[1,0]
v_pk_mul_f32 v[24:25], v[212:213], v[212:213]
v_pk_mul_f32 v[26:27], v[214:215], v[214:215]
v_pk_fma_f32 v[24:25], v[24:25], s[92:93], v[16:17]
v_pk_fma_f32 v[26:27], v[26:27], s[92:93], v[16:17]
v_pk_mul_f32 v[24:25], v[24:25], v[212:213]
v_pk_mul_f32 v[26:27], v[26:27], v[214:215]
v_exp_f32 v24, v24
v_exp_f32 v25, v25
v_exp_f32 v26, v26
v_exp_f32 v27, v27
v_pk_add_f32 v[24:25], v[24:25], 1.0 op_sel_hi:[1,0]
v_pk_add_f32 v[26:27], v[26:27], 1.0 op_sel_hi:[1,0]
v_rcp_f32 v24, v24
v_rcp_f32 v25, v25
v_rcp_f32 v26, v26
v_rcp_f32 v27, v27
s_nop 0
v_pk_mul_f32 v[212:213], v[212:213], v[24:25]
v_pk_mul_f32 v[214:215], v[214:215], v[26:27]
v_cvt_pk_bf16_f32 v212, v212, v213
v_cvt_pk_bf16_f32 v213, v214, v215
v_pk_fma_f32 v[216:217], v[108:109], v[18:19], v[216:217] op_sel_hi:[1,0,1]
v_pk_fma_f32 v[218:219], v[110:111], v[18:19], v[218:219] op_sel_hi:[1,0,1]
v_pk_mul_f32 v[216:217], v[216:217], v[20:21] op_sel_hi:[1,0]
v_pk_mul_f32 v[218:219], v[218:219], v[20:21] op_sel_hi:[1,0]
v_pk_mul_f32 v[24:25], v[216:217], v[216:217]
v_pk_mul_f32 v[26:27], v[218:219], v[218:219]
v_pk_fma_f32 v[24:25], v[24:25], s[92:93], v[16:17]
v_pk_fma_f32 v[26:27], v[26:27], s[92:93], v[16:17]
v_pk_mul_f32 v[24:25], v[24:25], v[216:217]
v_pk_mul_f32 v[26:27], v[26:27], v[218:219]
v_exp_f32 v24, v24
v_exp_f32 v25, v25
v_exp_f32 v26, v26
v_exp_f32 v27, v27
v_pk_add_f32 v[24:25], v[24:25], 1.0 op_sel_hi:[1,0]
v_pk_add_f32 v[26:27], v[26:27], 1.0 op_sel_hi:[1,0]
v_rcp_f32 v24, v24
v_rcp_f32 v25, v25
v_rcp_f32 v26, v26
v_rcp_f32 v27, v27
s_nop 0
v_pk_mul_f32 v[216:217], v[216:217], v[24:25]
v_pk_mul_f32 v[218:219], v[218:219], v[26:27]
v_cvt_pk_bf16_f32 v214, v216, v217
v_cvt_pk_bf16_f32 v215, v218, v219
buffer_store_dwordx4 v[212:215], v22, s[16:19], s47 offen offset:0 sc1
s_add_u32 s47, s47, 147456
v_mov_b32 v18, v43
v_mov_b32 v20, v47
v_pk_fma_f32 v[220:221], v[76:77], v[18:19], v[220:221] op_sel_hi:[1,0,1]
v_pk_fma_f32 v[222:223], v[78:79], v[18:19], v[222:223] op_sel_hi:[1,0,1]
v_pk_mul_f32 v[220:221], v[220:221], v[20:21] op_sel_hi:[1,0]
v_pk_mul_f32 v[222:223], v[222:223], v[20:21] op_sel_hi:[1,0]
v_pk_mul_f32 v[24:25], v[220:221], v[220:221]
v_pk_mul_f32 v[26:27], v[222:223], v[222:223]
v_pk_fma_f32 v[24:25], v[24:25], s[92:93], v[16:17]
v_pk_fma_f32 v[26:27], v[26:27], s[92:93], v[16:17]
v_pk_mul_f32 v[24:25], v[24:25], v[220:221]
v_pk_mul_f32 v[26:27], v[26:27], v[222:223]
v_exp_f32 v24, v24
v_exp_f32 v25, v25
v_exp_f32 v26, v26
v_exp_f32 v27, v27
v_pk_add_f32 v[24:25], v[24:25], 1.0 op_sel_hi:[1,0]
v_pk_add_f32 v[26:27], v[26:27], 1.0 op_sel_hi:[1,0]
v_rcp_f32 v24, v24
v_rcp_f32 v25, v25
v_rcp_f32 v26, v26
v_rcp_f32 v27, v27
s_nop 0
v_pk_mul_f32 v[220:221], v[220:221], v[24:25]
v_pk_mul_f32 v[222:223], v[222:223], v[26:27]
v_cvt_pk_bf16_f32 v220, v220, v221
v_cvt_pk_bf16_f32 v221, v222, v223
buffer_store_dwordx2 v[220:221], v11, s[16:19], s47 offen offset:8 sc1
v_pk_fma_f32 v[224:225], v[80:81], v[18:19], v[224:225] op_sel_hi:[1,0,1]
v_pk_fma_f32 v[226:227], v[82:83], v[18:19], v[226:227] op_sel_hi:[1,0,1]
v_pk_mul_f32 v[224:225], v[224:225], v[20:21] op_sel_hi:[1,0]
v_pk_mul_f32 v[226:227], v[226:227], v[20:21] op_sel_hi:[1,0]
v_pk_mul_f32 v[24:25], v[224:225], v[224:225]
v_pk_mul_f32 v[26:27], v[226:227], v[226:227]
v_pk_fma_f32 v[24:25], v[24:25], s[92:93], v[16:17]
v_pk_fma_f32 v[26:27], v[26:27], s[92:93], v[16:17]
v_pk_mul_f32 v[24:25], v[24:25], v[224:225]
v_pk_mul_f32 v[26:27], v[26:27], v[226:227]
v_exp_f32 v24, v24
v_exp_f32 v25, v25
v_exp_f32 v26, v26
v_exp_f32 v27, v27
v_pk_add_f32 v[24:25], v[24:25], 1.0 op_sel_hi:[1,0]
v_pk_add_f32 v[26:27], v[26:27], 1.0 op_sel_hi:[1,0]
v_rcp_f32 v24, v24
v_rcp_f32 v25, v25
v_rcp_f32 v26, v26
v_rcp_f32 v27, v27
s_nop 0
v_pk_mul_f32 v[224:225], v[224:225], v[24:25]
v_pk_mul_f32 v[226:227], v[226:227], v[26:27]
v_cvt_pk_bf16_f32 v224, v224, v225
v_cvt_pk_bf16_f32 v225, v226, v227
v_pk_fma_f32 v[228:229], v[84:85], v[18:19], v[228:229] op_sel_hi:[1,0,1]
v_pk_fma_f32 v[230:231], v[86:87], v[18:19], v[230:231] op_sel_hi:[1,0,1]
v_pk_mul_f32 v[228:229], v[228:229], v[20:21] op_sel_hi:[1,0]
v_pk_mul_f32 v[230:231], v[230:231], v[20:21] op_sel_hi:[1,0]
v_pk_mul_f32 v[24:25], v[228:229], v[228:229]
v_pk_mul_f32 v[26:27], v[230:231], v[230:231]
v_pk_fma_f32 v[24:25], v[24:25], s[92:93], v[16:17]
v_pk_fma_f32 v[26:27], v[26:27], s[92:93], v[16:17]
v_pk_mul_f32 v[24:25], v[24:25], v[228:229]
v_pk_mul_f32 v[26:27], v[26:27], v[230:231]
v_exp_f32 v24, v24
v_exp_f32 v25, v25
v_exp_f32 v26, v26
v_exp_f32 v27, v27
v_pk_add_f32 v[24:25], v[24:25], 1.0 op_sel_hi:[1,0]
v_pk_add_f32 v[26:27], v[26:27], 1.0 op_sel_hi:[1,0]
v_rcp_f32 v24, v24
v_rcp_f32 v25, v25
v_rcp_f32 v26, v26
v_rcp_f32 v27, v27
s_nop 0
v_pk_mul_f32 v[228:229], v[228:229], v[24:25]
v_pk_mul_f32 v[230:231], v[230:231], v[26:27]
v_cvt_pk_bf16_f32 v226, v228, v229
v_cvt_pk_bf16_f32 v227, v230, v231
buffer_store_dwordx4 v[224:227], v11, s[16:19], s47 offen offset:1024 sc1
v_pk_fma_f32 v[232:233], v[88:89], v[18:19], v[232:233] op_sel_hi:[1,0,1]
v_pk_fma_f32 v[234:235], v[90:91], v[18:19], v[234:235] op_sel_hi:[1,0,1]
v_pk_mul_f32 v[232:233], v[232:233], v[20:21] op_sel_hi:[1,0]
v_pk_mul_f32 v[234:235], v[234:235], v[20:21] op_sel_hi:[1,0]
v_pk_mul_f32 v[24:25], v[232:233], v[232:233]
v_pk_mul_f32 v[26:27], v[234:235], v[234:235]
v_pk_fma_f32 v[24:25], v[24:25], s[92:93], v[16:17]
v_pk_fma_f32 v[26:27], v[26:27], s[92:93], v[16:17]
v_pk_mul_f32 v[24:25], v[24:25], v[232:233]
v_pk_mul_f32 v[26:27], v[26:27], v[234:235]
v_exp_f32 v24, v24
v_exp_f32 v25, v25
v_exp_f32 v26, v26
v_exp_f32 v27, v27
v_pk_add_f32 v[24:25], v[24:25], 1.0 op_sel_hi:[1,0]
v_pk_add_f32 v[26:27], v[26:27], 1.0 op_sel_hi:[1,0]
v_rcp_f32 v24, v24
v_rcp_f32 v25, v25
v_rcp_f32 v26, v26
v_rcp_f32 v27, v27
s_nop 0
v_pk_mul_f32 v[232:233], v[232:233], v[24:25]
v_pk_mul_f32 v[234:235], v[234:235], v[26:27]
v_cvt_pk_bf16_f32 v232, v232, v233
v_cvt_pk_bf16_f32 v233, v234, v235
v_pk_fma_f32 v[236:237], v[92:93], v[18:19], v[236:237] op_sel_hi:[1,0,1]
v_pk_fma_f32 v[238:239], v[94:95], v[18:19], v[238:239] op_sel_hi:[1,0,1]
v_pk_mul_f32 v[236:237], v[236:237], v[20:21] op_sel_hi:[1,0]
v_pk_mul_f32 v[238:239], v[238:239], v[20:21] op_sel_hi:[1,0]
v_pk_mul_f32 v[24:25], v[236:237], v[236:237]
v_pk_mul_f32 v[26:27], v[238:239], v[238:239]
v_pk_fma_f32 v[24:25], v[24:25], s[92:93], v[16:17]
v_pk_fma_f32 v[26:27], v[26:27], s[92:93], v[16:17]
v_pk_mul_f32 v[24:25], v[24:25], v[236:237]
v_pk_mul_f32 v[26:27], v[26:27], v[238:239]
v_exp_f32 v24, v24
v_exp_f32 v25, v25
v_exp_f32 v26, v26
v_exp_f32 v27, v27
v_pk_add_f32 v[24:25], v[24:25], 1.0 op_sel_hi:[1,0]
v_pk_add_f32 v[26:27], v[26:27], 1.0 op_sel_hi:[1,0]
v_rcp_f32 v24, v24
v_rcp_f32 v25, v25
v_rcp_f32 v26, v26
v_rcp_f32 v27, v27
s_nop 0
v_pk_mul_f32 v[236:237], v[236:237], v[24:25]
v_pk_mul_f32 v[238:239], v[238:239], v[26:27]
v_cvt_pk_bf16_f32 v234, v236, v237
v_cvt_pk_bf16_f32 v235, v238, v239
buffer_store_dwordx4 v[232:235], v11, s[16:19], s47 offen offset:2048 sc1
v_pk_fma_f32 v[240:241], v[96:97], v[18:19], v[240:241] op_sel_hi:[1,0,1]
v_pk_fma_f32 v[242:243], v[98:99], v[18:19], v[242:243] op_sel_hi:[1,0,1]
v_pk_mul_f32 v[240:241], v[240:241], v[20:21] op_sel_hi:[1,0]
v_pk_mul_f32 v[242:243], v[242:243], v[20:21] op_sel_hi:[1,0]
v_pk_mul_f32 v[24:25], v[240:241], v[240:241]
v_pk_mul_f32 v[26:27], v[242:243], v[242:243]
v_pk_fma_f32 v[24:25], v[24:25], s[92:93], v[16:17]
v_pk_fma_f32 v[26:27], v[26:27], s[92:93], v[16:17]
v_pk_mul_f32 v[24:25], v[24:25], v[240:241]
v_pk_mul_f32 v[26:27], v[26:27], v[242:243]
v_exp_f32 v24, v24
v_exp_f32 v25, v25
v_exp_f32 v26, v26
v_exp_f32 v27, v27
v_pk_add_f32 v[24:25], v[24:25], 1.0 op_sel_hi:[1,0]
v_pk_add_f32 v[26:27], v[26:27], 1.0 op_sel_hi:[1,0]
v_rcp_f32 v24, v24
v_rcp_f32 v25, v25
v_rcp_f32 v26, v26
v_rcp_f32 v27, v27
s_nop 0
v_pk_mul_f32 v[240:241], v[240:241], v[24:25]
v_pk_mul_f32 v[242:243], v[242:243], v[26:27]
v_cvt_pk_bf16_f32 v240, v240, v241
v_cvt_pk_bf16_f32 v241, v242, v243
v_pk_fma_f32 v[244:245], v[100:101], v[18:19], v[244:245] op_sel_hi:[1,0,1]
v_pk_fma_f32 v[246:247], v[102:103], v[18:19], v[246:247] op_sel_hi:[1,0,1]
v_pk_mul_f32 v[244:245], v[244:245], v[20:21] op_sel_hi:[1,0]
v_pk_mul_f32 v[246:247], v[246:247], v[20:21] op_sel_hi:[1,0]
v_pk_mul_f32 v[24:25], v[244:245], v[244:245]
v_pk_mul_f32 v[26:27], v[246:247], v[246:247]
v_pk_fma_f32 v[24:25], v[24:25], s[92:93], v[16:17]
v_pk_fma_f32 v[26:27], v[26:27], s[92:93], v[16:17]
v_pk_mul_f32 v[24:25], v[24:25], v[244:245]
v_pk_mul_f32 v[26:27], v[26:27], v[246:247]
v_exp_f32 v24, v24
v_exp_f32 v25, v25
v_exp_f32 v26, v26
v_exp_f32 v27, v27
v_pk_add_f32 v[24:25], v[24:25], 1.0 op_sel_hi:[1,0]
v_pk_add_f32 v[26:27], v[26:27], 1.0 op_sel_hi:[1,0]
v_rcp_f32 v24, v24
v_rcp_f32 v25, v25
v_rcp_f32 v26, v26
v_rcp_f32 v27, v27
s_nop 0
v_pk_mul_f32 v[244:245], v[244:245], v[24:25]
v_pk_mul_f32 v[246:247], v[246:247], v[26:27]
v_cvt_pk_bf16_f32 v242, v244, v245
v_cvt_pk_bf16_f32 v243, v246, v247
buffer_store_dwordx4 v[240:243], v11, s[16:19], s47 offen offset:3072 sc1
v_pk_fma_f32 v[248:249], v[104:105], v[18:19], v[248:249] op_sel_hi:[1,0,1]
v_pk_fma_f32 v[250:251], v[106:107], v[18:19], v[250:251] op_sel_hi:[1,0,1]
v_pk_mul_f32 v[248:249], v[248:249], v[20:21] op_sel_hi:[1,0]
v_pk_mul_f32 v[250:251], v[250:251], v[20:21] op_sel_hi:[1,0]
v_pk_mul_f32 v[24:25], v[248:249], v[248:249]
v_pk_mul_f32 v[26:27], v[250:251], v[250:251]
v_pk_fma_f32 v[24:25], v[24:25], s[92:93], v[16:17]
v_pk_fma_f32 v[26:27], v[26:27], s[92:93], v[16:17]
v_pk_mul_f32 v[24:25], v[24:25], v[248:249]
v_pk_mul_f32 v[26:27], v[26:27], v[250:251]
v_exp_f32 v24, v24
v_exp_f32 v25, v25
v_exp_f32 v26, v26
v_exp_f32 v27, v27
v_pk_add_f32 v[24:25], v[24:25], 1.0 op_sel_hi:[1,0]
v_pk_add_f32 v[26:27], v[26:27], 1.0 op_sel_hi:[1,0]
v_rcp_f32 v24, v24
v_rcp_f32 v25, v25
v_rcp_f32 v26, v26
v_rcp_f32 v27, v27
s_nop 0
v_pk_mul_f32 v[248:249], v[248:249], v[24:25]
v_pk_mul_f32 v[250:251], v[250:251], v[26:27]
v_cvt_pk_bf16_f32 v248, v248, v249
v_cvt_pk_bf16_f32 v249, v250, v251
v_pk_fma_f32 v[252:253], v[108:109], v[18:19], v[252:253] op_sel_hi:[1,0,1]
v_pk_fma_f32 v[254:255], v[110:111], v[18:19], v[254:255] op_sel_hi:[1,0,1]
v_pk_mul_f32 v[252:253], v[252:253], v[20:21] op_sel_hi:[1,0]
v_pk_mul_f32 v[254:255], v[254:255], v[20:21] op_sel_hi:[1,0]
v_pk_mul_f32 v[24:25], v[252:253], v[252:253]
v_pk_mul_f32 v[26:27], v[254:255], v[254:255]
v_pk_fma_f32 v[24:25], v[24:25], s[92:93], v[16:17]
v_pk_fma_f32 v[26:27], v[26:27], s[92:93], v[16:17]
v_pk_mul_f32 v[24:25], v[24:25], v[252:253]
v_pk_mul_f32 v[26:27], v[26:27], v[254:255]
v_exp_f32 v24, v24
v_exp_f32 v25, v25
v_exp_f32 v26, v26
v_exp_f32 v27, v27
v_pk_add_f32 v[24:25], v[24:25], 1.0 op_sel_hi:[1,0]
v_pk_add_f32 v[26:27], v[26:27], 1.0 op_sel_hi:[1,0]
v_rcp_f32 v24, v24
v_rcp_f32 v25, v25
v_rcp_f32 v26, v26
v_rcp_f32 v27, v27
s_nop 0
v_pk_mul_f32 v[252:253], v[252:253], v[24:25]
v_pk_mul_f32 v[254:255], v[254:255], v[26:27]
v_cvt_pk_bf16_f32 v250, v252, v253
v_cvt_pk_bf16_f32 v251, v254, v255
buffer_store_dwordx4 v[248:251], v22, s[16:19], s47 offen offset:0 sc1
buffer_load_dword v10, v11, s[4:7], 0 offen
L_t4done:
s_add_u32 s16, s88, 0x5000000
s_addc_u32 s17, s89, 0
s_mov_b32 s18, 0x2800000
s_mov_b32 s19, 0x00020000
s_mov_b32 s20, s64
s_mov_b32 s21, s65
s_mov_b32 s22, 0x240000
s_mov_b32 s23, 0x00020000
s_lshl_b32 s47, s52, 2
s_add_u32 s47, s47, s49
s_lshl_b32 s93, s47, 2
s_add_u32 s93, s93, s24
s_lshl_b32 s93, s93, 2
s_add_u32 s93, s93, s54
s_mul_i32 s93, s93, 10240
s_lshl_b32 s92, s47, 8
s_cmp_ge_u32 s24, 2
s_cselect_b32 s34, 5, 0
s_mul_i32 s60, s49, 9
s_add_u32 s60, s60, s34
s_lshl_b32 s44, s52, 3
s_lshl_b32 s33, s54, 1
s_add_u32 s44, s44, s33
s_and_b32 s61, s24, 1
s_add_u32 s44, s44, s61
s_mul_i32 s45, s44, 18432
s_lshl_b32 s34, s60, 5
s_add_u32 s45, s45, s34
s_mul_i32 s34, s44, 18432
v_add_u32 v22, s34, v11
s_lshl_b32 s94, s47, 2
s_add_u32 s94, s94, s54
s_mul_i32 s94, s94, 40960
s_mul_i32 s33, s61, 5120
s_add_u32 s94, s94, s33
s_add_u32 s91, s94, 3072
s_cmp_ge_u32 s24, 2
s_cselect_b32 s94, s91, s94
s_add_u32 s91, s94, 2048
s_cmp_ge_u32 s24, 2
s_cselect_b32 s91, 0x7fff0000, s91
v_add_u32 v26, 147456, v11
v_mov_b32 v49, v11
v_add_u32 v50, 64512, v11
v_add_u32 v51, 129024, v11
s_waitcnt vmcnt(54)
s_barrier
ds_read_b128 a[0:3], v49 offset:36864
ds_read_b128 a[4:7], v49 offset:37888
ds_read_b128 a[8:11], v49 offset:38912
ds_read_b128 a[12:15], v49 offset:39936
ds_read_b128 a[16:19], v49 offset:40960
ds_read_b128 a[20:23], v49 offset:41984
ds_read_b128 a[24:27], v49 offset:43008
ds_read_b128 a[28:31], v49 offset:44032
ds_read_b128 a[32:35], v49 offset:45056
s_waitcnt vmcnt(52) lgkmcnt(0)
v_mfma_f32_16x16x32_bf16 v[184:187], a[0:3], a[72:75], 0
ds_read_b128 a[36:39], v49 offset:46080
v_mfma_f32_16x16x32_bf16 v[220:223], a[0:3], a[76:79], 0
ds_read_b128 a[40:43], v49 offset:47104
v_mfma_f32_16x16x32_bf16 v[188:191], a[4:7], a[72:75], 0
ds_read_b128 a[44:47], v49 offset:48128
v_mfma_f32_16x16x32_bf16 v[224:227], a[4:7], a[76:79], 0
ds_read_b128 a[48:51], v49 offset:49152
v_mfma_f32_16x16x32_bf16 v[192:195], a[8:11], a[72:75], 0
ds_read_b128 a[52:55], v49 offset:50176
v_mfma_f32_16x16x32_bf16 v[228:231], a[8:11], a[76:79], 0
v_mfma_f32_16x16x32_bf16 v[196:199], a[12:15], a[72:75], 0
ds_read_b128 a[56:59], v49 offset:51200
v_mfma_f32_16x16x32_bf16 v[232:235], a[12:15], a[76:79], 0
v_mfma_f32_16x16x32_bf16 v[200:203], a[16:19], a[72:75], 0
ds_read_b128 a[60:63], v49 offset:52224
v_mfma_f32_16x16x32_bf16 v[236:239], a[16:19], a[76:79], 0
v_mfma_f32_16x16x32_bf16 v[204:207], a[20:23], a[72:75], 0
ds_read_b128 a[64:67], v49 offset:53248
v_mfma_f32_16x16x32_bf16 v[240:243], a[20:23], a[76:79], 0
v_mfma_f32_16x16x32_bf16 v[208:211], a[24:27], a[72:75], 0
ds_read_b128 a[68:71], v49 offset:54272
v_mfma_f32_16x16x32_bf16 v[244:247], a[24:27], a[76:79], 0
v_mfma_f32_16x16x32_bf16 v[212:215], a[28:31], a[72:75], 0
v_mfma_f32_16x16x32_bf16 v[248:251], a[28:31], a[76:79], 0
v_mfma_f32_16x16x32_bf16 v[216:219], a[32:35], a[72:75], 0
v_mfma_f32_16x16x32_bf16 v[252:255], a[32:35], a[76:79], 0
s_waitcnt vmcnt(50) lgkmcnt(0)
v_mfma_f32_16x16x32_bf16 v[184:187], a[36:39], a[80:83], v[184:187]
ds_read_b128 a[0:3], v49 offset:55296
v_mfma_f32_16x16x32_bf16 v[220:223], a[36:39], a[84:87], v[220:223]
buffer_load_dwordx4 a[72:75], v11, s[8:11], s73 offen offset:1024
ds_read_b128 a[4:7], v49 offset:56320
v_mfma_f32_16x16x32_bf16 v[188:191], a[40:43], a[80:83], v[188:191]
ds_read_b128 a[8:11], v49 offset:57344
v_mfma_f32_16x16x32_bf16 v[224:227], a[40:43], a[84:87], v[224:227]
ds_read_b128 a[12:15], v49 offset:58368
v_mfma_f32_16x16x32_bf16 v[192:195], a[44:47], a[80:83], v[192:195]
ds_read_b128 a[16:19], v49 offset:59392
v_mfma_f32_16x16x32_bf16 v[228:231], a[44:47], a[84:87], v[228:231]
buffer_load_dwordx4 a[76:79], v48, s[8:11], s73 offen offset:1024
v_mfma_f32_16x16x32_bf16 v[196:199], a[48:51], a[80:83], v[196:199]
ds_read_b128 a[20:23], v49 offset:60416
v_mfma_f32_16x16x32_bf16 v[232:235], a[48:51], a[84:87], v[232:235]
v_mfma_f32_16x16x32_bf16 v[200:203], a[52:55], a[80:83], v[200:203]
ds_read_b128 a[24:27], v49 offset:61440
v_mfma_f32_16x16x32_bf16 v[236:239], a[52:55], a[84:87], v[236:239]
v_mfma_f32_16x16x32_bf16 v[204:207], a[56:59], a[80:83], v[204:207]
ds_read_b128 a[28:31], v49 offset:62464
v_mfma_f32_16x16x32_bf16 v[240:243], a[56:59], a[84:87], v[240:243]
v_mfma_f32_16x16x32_bf16 v[208:211], a[60:63], a[80:83], v[208:211]
ds_read_b128 a[32:35], v49 offset:63488
v_mfma_f32_16x16x32_bf16 v[244:247], a[60:63], a[84:87], v[244:247]
v_mfma_f32_16x16x32_bf16 v[212:215], a[64:67], a[80:83], v[212:215]
v_mfma_f32_16x16x32_bf16 v[248:251], a[64:67], a[84:87], v[248:251]
v_mfma_f32_16x16x32_bf16 v[216:219], a[68:71], a[80:83], v[216:219]
v_mfma_f32_16x16x32_bf16 v[252:255], a[68:71], a[84:87], v[252:255]
s_waitcnt vmcnt(50) lgkmcnt(0)
v_mfma_f32_16x16x32_bf16 v[184:187], a[0:3], a[88:91], v[184:187]
ds_read_b128 a[36:39], v50 offset:0
v_mfma_f32_16x16x32_bf16 v[220:223], a[0:3], a[92:95], v[220:223]
buffer_load_dwordx4 a[80:83], v11, s[8:11], s73 offen offset:2048
ds_read_b128 a[40:43], v50 offset:1024
v_mfma_f32_16x16x32_bf16 v[188:191], a[4:7], a[88:91], v[188:191]
ds_read_b128 a[44:47], v50 offset:2048
v_mfma_f32_16x16x32_bf16 v[224:227], a[4:7], a[92:95], v[224:227]
ds_read_b128 a[48:51], v50 offset:3072
v_mfma_f32_16x16x32_bf16 v[192:195], a[8:11], a[88:91], v[192:195]
ds_read_b128 a[52:55], v50 offset:4096
v_mfma_f32_16x16x32_bf16 v[228:231], a[8:11], a[92:95], v[228:231]
buffer_load_dwordx4 a[84:87], v48, s[8:11], s73 offen offset:2048
v_mfma_f32_16x16x32_bf16 v[196:199], a[12:15], a[88:91], v[196:199]
ds_read_b128 a[56:59], v50 offset:5120
v_mfma_f32_16x16x32_bf16 v[232:235], a[12:15], a[92:95], v[232:235]
v_mfma_f32_16x16x32_bf16 v[200:203], a[16:19], a[88:91], v[200:203]
ds_read_b128 a[60:63], v50 offset:6144
v_mfma_f32_16x16x32_bf16 v[236:239], a[16:19], a[92:95], v[236:239]
v_mfma_f32_16x16x32_bf16 v[204:207], a[20:23], a[88:91], v[204:207]
ds_read_b128 a[64:67], v50 offset:7168
v_mfma_f32_16x16x32_bf16 v[240:243], a[20:23], a[92:95], v[240:243]
v_mfma_f32_16x16x32_bf16 v[208:211], a[24:27], a[88:91], v[208:211]
ds_read_b128 a[68:71], v50 offset:8192
v_mfma_f32_16x16x32_bf16 v[244:247], a[24:27], a[92:95], v[244:247]
v_mfma_f32_16x16x32_bf16 v[212:215], a[28:31], a[88:91], v[212:215]
v_mfma_f32_16x16x32_bf16 v[248:251], a[28:31], a[92:95], v[248:251]
v_mfma_f32_16x16x32_bf16 v[216:219], a[32:35], a[88:91], v[216:219]
v_mfma_f32_16x16x32_bf16 v[252:255], a[32:35], a[92:95], v[252:255]
s_waitcnt vmcnt(41) lgkmcnt(0)
s_barrier
s_add_u32 s66, s77, 4
s_and_b32 s66, s66, 7
s_mul_i32 s66, s66, 36864
s_add_u32 s66, s66, s79
v_mfma_f32_16x16x32_bf16 v[184:187], a[36:39], a[96:99], v[184:187]
ds_read_b128 a[0:3], v50 offset:9216
v_mfma_f32_16x16x32_bf16 v[220:223], a[36:39], a[100:103], v[220:223]
buffer_load_dwordx4 a[88:91], v11, s[8:11], s73 offen offset:3072
ds_read_b128 a[4:7], v50 offset:10240
v_mfma_f32_16x16x32_bf16 v[188:191], a[40:43], a[96:99], v[188:191]
ds_read_b128 a[8:11], v50 offset:11264
v_mfma_f32_16x16x32_bf16 v[224:227], a[40:43], a[100:103], v[224:227]
ds_read_b128 a[12:15], v50 offset:12288
v_mfma_f32_16x16x32_bf16 v[192:195], a[44:47], a[96:99], v[192:195]
ds_read_b128 a[16:19], v50 offset:13312
v_mfma_f32_16x16x32_bf16 v[228:231], a[44:47], a[100:103], v[228:231]
buffer_load_dwordx4 a[92:95], v48, s[8:11], s73 offen offset:3072
v_mfma_f32_16x16x32_bf16 v[196:199], a[48:51], a[96:99], v[196:199]
ds_read_b128 a[20:23], v50 offset:14336
v_mfma_f32_16x16x32_bf16 v[232:235], a[48:51], a[100:103], v[232:235]
v_mfma_f32_16x16x32_bf16 v[200:203], a[52:55], a[96:99], v[200:203]
ds_read_b128 a[24:27], v50 offset:15360
v_mfma_f32_16x16x32_bf16 v[236:239], a[52:55], a[100:103], v[236:239]
s_add_u32 m0, s30, 36864
s_add_u32 s83, s66, 0
buffer_load_dwordx4 v11, s[4:7], s83 offen offset:0 lds
v_mfma_f32_16x16x32_bf16 v[204:207], a[56:59], a[96:99], v[204:207]
ds_read_b128 a[28:31], v50 offset:16384
v_mfma_f32_16x16x32_bf16 v[240:243], a[56:59], a[100:103], v[240:243]
v_mfma_f32_16x16x32_bf16 v[208:211], a[60:63], a[96:99], v[208:211]
ds_read_b128 a[32:35], v50 offset:17408
v_mfma_f32_16x16x32_bf16 v[244:247], a[60:63], a[100:103], v[244:247]
buffer_load_dwordx4 v11, s[4:7], s83 offen offset:1024 lds
v_mfma_f32_16x16x32_bf16 v[212:215], a[64:67], a[96:99], v[212:215]
v_mfma_f32_16x16x32_bf16 v[248:251], a[64:67], a[100:103], v[248:251]
v_mfma_f32_16x16x32_bf16 v[216:219], a[68:71], a[96:99], v[216:219]
v_mfma_f32_16x16x32_bf16 v[252:255], a[68:71], a[100:103], v[252:255]
buffer_load_dwordx4 v11, s[4:7], s83 offen offset:2048 lds
s_add_u32 s76, s77, 4
s_and_b32 s76, s76, 7
s_lshl_b32 s76, s76, 12
s_add_u32 s76, s76, s27
s_waitcnt vmcnt(44) lgkmcnt(0)
v_mfma_f32_16x16x32_bf16 v[184:187], a[0:3], a[104:107], v[184:187]
ds_read_b128 a[36:39], v50 offset:18432
v_mfma_f32_16x16x32_bf16 v[220:223], a[0:3], a[108:111], v[220:223]
buffer_load_dwordx4 a[96:99], v11, s[8:11], s76 offen offset:0
ds_read_b128 a[40:43], v50 offset:19456
v_mfma_f32_16x16x32_bf16 v[188:191], a[4:7], a[104:107], v[188:191]
ds_read_b128 a[44:47], v50 offset:20480
v_mfma_f32_16x16x32_bf16 v[224:227], a[4:7], a[108:111], v[224:227]
ds_read_b128 a[48:51], v50 offset:21504
v_mfma_f32_16x16x32_bf16 v[192:195], a[8:11], a[104:107], v[192:195]
ds_read_b128 a[52:55], v50 offset:22528
v_mfma_f32_16x16x32_bf16 v[228:231], a[8:11], a[108:111], v[228:231]
buffer_load_dwordx4 a[100:103], v48, s[8:11], s76 offen offset:0
v_mfma_f32_16x16x32_bf16 v[196:199], a[12:15], a[104:107], v[196:199]
ds_read_b128 a[56:59], v50 offset:23552
v_mfma_f32_16x16x32_bf16 v[232:235], a[12:15], a[108:111], v[232:235]
v_mfma_f32_16x16x32_bf16 v[200:203], a[16:19], a[104:107], v[200:203]
ds_read_b128 a[60:63], v50 offset:24576
v_mfma_f32_16x16x32_bf16 v[236:239], a[16:19], a[108:111], v[236:239]
buffer_load_dwordx4 v11, s[4:7], s83 offen offset:3072 lds
v_mfma_f32_16x16x32_bf16 v[204:207], a[20:23], a[104:107], v[204:207]
ds_read_b128 a[64:67], v50 offset:25600
v_mfma_f32_16x16x32_bf16 v[240:243], a[20:23], a[108:111], v[240:243]
v_mfma_f32_16x16x32_bf16 v[208:211], a[24:27], a[104:107], v[208:211]
ds_read_b128 a[68:71], v50 offset:26624
v_mfma_f32_16x16x32_bf16 v[244:247], a[24:27], a[108:111], v[244:247]
s_add_u32 m0, s30, 40960
s_add_u32 s83, s66, 4096
buffer_load_dwordx4 v11, s[4:7], s83 offen offset:0 lds
v_mfma_f32_16x16x32_bf16 v[212:215], a[28:31], a[104:107], v[212:215]
v_mfma_f32_16x16x32_bf16 v[248:251], a[28:31], a[108:111], v[248:251]
v_mfma_f32_16x16x32_bf16 v[216:219], a[32:35], a[104:107], v[216:219]
v_mfma_f32_16x16x32_bf16 v[252:255], a[32:35], a[108:111], v[252:255]
buffer_load_dwordx4 v11, s[4:7], s83 offen offset:1024 lds
s_waitcnt vmcnt(47) lgkmcnt(0)
buffer_load_dwordx2 v[28:29], v63, s[20:23], s45 offen offset:0
buffer_load_dwordx2 v[30:31], v63, s[20:23], s45 offen offset:32
buffer_load_dwordx2 v[32:33], v63, s[20:23], s45 offen offset:64
buffer_load_dwordx2 v[34:35], v63, s[20:23], s45 offen offset:96
buffer_load_dwordx2 v[36:37], v63, s[20:23], s45 offen offset:128
s_add_u32 s20, s88, 0x6c0000
s_addc_u32 s21, s89, 0
s_mov_b32 s22, 0x240000
s_mov_b32 s23, 0x00020000
v_mfma_f32_16x16x32_bf16 v[184:187], a[36:39], a[112:115], v[184:187]
ds_read_b128 a[0:3], v50 offset:27648
v_mfma_f32_16x16x32_bf16 v[220:223], a[36:39], a[116:119], v[220:223]
buffer_load_dwordx4 a[104:107], v11, s[8:11], s76 offen offset:1024
ds_read_b128 a[4:7], v50 offset:28672
v_mfma_f32_16x16x32_bf16 v[188:191], a[40:43], a[112:115], v[188:191]
ds_read_b128 a[8:11], v50 offset:29696
v_mfma_f32_16x16x32_bf16 v[224:227], a[40:43], a[116:119], v[224:227]
ds_read_b128 a[12:15], v50 offset:30720
v_mfma_f32_16x16x32_bf16 v[192:195], a[44:47], a[112:115], v[192:195]
ds_read_b128 a[16:19], v50 offset:31744
v_mfma_f32_16x16x32_bf16 v[228:231], a[44:47], a[116:119], v[228:231]
buffer_load_dwordx4 a[108:111], v48, s[8:11], s76 offen offset:1024
v_mfma_f32_16x16x32_bf16 v[196:199], a[48:51], a[112:115], v[196:199]
ds_read_b128 a[20:23], v50 offset:32768
v_mfma_f32_16x16x32_bf16 v[232:235], a[48:51], a[116:119], v[232:235]
v_mfma_f32_16x16x32_bf16 v[200:203], a[52:55], a[112:115], v[200:203]
ds_read_b128 a[24:27], v50 offset:33792
v_mfma_f32_16x16x32_bf16 v[236:239], a[52:55], a[116:119], v[236:239]
buffer_load_dwordx4 v11, s[4:7], s83 offen offset:2048 lds
v_mfma_f32_16x16x32_bf16 v[204:207], a[56:59], a[112:115], v[204:207]
ds_read_b128 a[28:31], v50 offset:34816
v_mfma_f32_16x16x32_bf16 v[240:243], a[56:59], a[116:119], v[240:243]
v_mfma_f32_16x16x32_bf16 v[208:211], a[60:63], a[112:115], v[208:211]
ds_read_b128 a[32:35], v50 offset:35840
v_mfma_f32_16x16x32_bf16 v[244:247], a[60:63], a[116:119], v[244:247]
buffer_load_dwordx4 v11, s[4:7], s83 offen offset:3072 lds
v_mfma_f32_16x16x32_bf16 v[212:215], a[64:67], a[112:115], v[212:215]
v_mfma_f32_16x16x32_bf16 v[248:251], a[64:67], a[116:119], v[248:251]
v_mfma_f32_16x16x32_bf16 v[216:219], a[68:71], a[112:115], v[216:219]
v_mfma_f32_16x16x32_bf16 v[252:255], a[68:71], a[116:119], v[252:255]
s_add_u32 m0, s30, 45056
s_add_u32 s83, s66, 8192
buffer_load_dwordx4 v11, s[4:7], s83 offen offset:0 lds
s_waitcnt vmcnt(55) lgkmcnt(0)
s_add_u32 s33, s60, 0
s_lshr_b32 s35, s33, 1
s_lshl_b32 s35, s35, 10
s_and_b32 s33, s33, 1
s_lshl_b32 s33, s33, 3
s_add_u32 s35, s35, s33
buffer_load_dwordx2 v[38:39], v22, s[20:23], s35 offen
s_add_u32 s33, s60, 1
s_lshr_b32 s35, s33, 1
s_lshl_b32 s35, s35, 10
s_and_b32 s33, s33, 1
s_lshl_b32 s33, s33, 3
s_add_u32 s35, s35, s33
buffer_load_dwordx2 v[40:41], v22, s[20:23], s35 offen
s_add_u32 s33, s60, 2
s_lshr_b32 s35, s33, 1
s_lshl_b32 s35, s35, 10
s_and_b32 s33, s33, 1
s_lshl_b32 s33, s33, 3
s_add_u32 s35, s35, s33
buffer_load_dwordx2 v[42:43], v22, s[20:23], s35 offen
s_add_u32 s33, s60, 3
s_lshr_b32 s35, s33, 1
s_lshl_b32 s35, s35, 10
s_and_b32 s33, s33, 1
s_lshl_b32 s33, s33, 3
s_add_u32 s35, s35, s33
buffer_load_dwordx2 v[44:45], v22, s[20:23], s35 offen
s_add_u32 s33, s60, 4
s_lshr_b32 s35, s33, 1
s_lshl_b32 s35, s35, 10
s_and_b32 s33, s33, 1
s_lshl_b32 s33, s33, 3
s_add_u32 s35, s35, s33
s_cmp_ge_u32 s24, 2
s_cselect_b32 s35, 0x7fff0000, s35
buffer_load_dwordx2 v[46:47], v22, s[20:23], s35 offen
v_mfma_f32_16x16x32_bf16 v[184:187], a[0:3], a[120:123], v[184:187]
ds_read_b128 a[36:39], v50 offset:36864
v_mfma_f32_16x16x32_bf16 v[220:223], a[0:3], a[124:127], v[220:223]
ds_read_b128 a[40:43], v50 offset:37888
v_mfma_f32_16x16x32_bf16 v[188:191], a[4:7], a[120:123], v[188:191]
ds_read_b128 a[44:47], v50 offset:38912
v_mfma_f32_16x16x32_bf16 v[224:227], a[4:7], a[124:127], v[224:227]
buffer_load_dwordx4 a[112:115], v11, s[8:11], s76 offen offset:2048
ds_read_b128 a[48:51], v50 offset:39936
v_mfma_f32_16x16x32_bf16 v[192:195], a[8:11], a[120:123], v[192:195]
ds_read_b128 a[52:55], v50 offset:40960
v_mfma_f32_16x16x32_bf16 v[228:231], a[8:11], a[124:127], v[228:231]
v_mfma_f32_16x16x32_bf16 v[196:199], a[12:15], a[120:123], v[196:199]
ds_read_b128 a[56:59], v50 offset:41984
v_mfma_f32_16x16x32_bf16 v[232:235], a[12:15], a[124:127], v[232:235]
buffer_load_dwordx4 a[116:119], v48, s[8:11], s76 offen offset:2048
v_mfma_f32_16x16x32_bf16 v[200:203], a[16:19], a[120:123], v[200:203]
ds_read_b128 a[60:63], v50 offset:43008
v_mfma_f32_16x16x32_bf16 v[236:239], a[16:19], a[124:127], v[236:239]
v_mfma_f32_16x16x32_bf16 v[204:207], a[20:23], a[120:123], v[204:207]
ds_read_b128 a[64:67], v50 offset:44032
v_mfma_f32_16x16x32_bf16 v[240:243], a[20:23], a[124:127], v[240:243]
v_mfma_f32_16x16x32_bf16 v[208:211], a[24:27], a[120:123], v[208:211]
ds_read_b128 a[68:71], v50 offset:45056
v_mfma_f32_16x16x32_bf16 v[244:247], a[24:27], a[124:127], v[244:247]
v_mfma_f32_16x16x32_bf16 v[212:215], a[28:31], a[120:123], v[212:215]
v_mfma_f32_16x16x32_bf16 v[248:251], a[28:31], a[124:127], v[248:251]
v_mfma_f32_16x16x32_bf16 v[216:219], a[32:35], a[120:123], v[216:219]
v_mfma_f32_16x16x32_bf16 v[252:255], a[32:35], a[124:127], v[252:255]
s_waitcnt vmcnt(31) lgkmcnt(0)
s_barrier
s_lshl_b32 s33, s50, 5
s_cmp_lg_u32 s24, 0
s_cbranch_scc1 L_sig9
v_mov_b32 v12, 0
v_mov_b32 v13, 0x10000
s_mov_b64 exec, 1
buffer_atomic_add v13, v12, s[56:59], s33 offen
s_mov_b64 exec, -1
L_sig9:
s_add_u32 s67, s77, 5
s_and_b32 s67, s67, 7
s_mul_i32 s67, s67, 36864
s_add_u32 s67, s67, s79
v_mfma_f32_16x16x32_bf16 v[184:187], a[36:39], a[192:195], v[184:187]
ds_read_b128 a[0:3], v50 offset:46080
v_mfma_f32_16x16x32_bf16 v[220:223], a[36:39], a[196:199], v[220:223]
buffer_load_dwordx4 a[120:123], v11, s[8:11], s76 offen offset:3072
ds_read_b128 a[4:7], v50 offset:47104
v_mfma_f32_16x16x32_bf16 v[188:191], a[40:43], a[192:195], v[188:191]
ds_read_b128 a[8:11], v50 offset:48128
v_mfma_f32_16x16x32_bf16 v[224:227], a[40:43], a[196:199], v[224:227]
ds_read_b128 a[12:15], v50 offset:49152
v_mfma_f32_16x16x32_bf16 v[192:195], a[44:47], a[192:195], v[192:195]
ds_read_b128 a[16:19], v50 offset:50176
v_mfma_f32_16x16x32_bf16 v[228:231], a[44:47], a[196:199], v[228:231]
buffer_load_dwordx4 a[124:127], v48, s[8:11], s76 offen offset:3072
v_mfma_f32_16x16x32_bf16 v[196:199], a[48:51], a[192:195], v[196:199]
ds_read_b128 a[20:23], v50 offset:51200
v_mfma_f32_16x16x32_bf16 v[232:235], a[48:51], a[196:199], v[232:235]
v_mfma_f32_16x16x32_bf16 v[200:203], a[52:55], a[192:195], v[200:203]
ds_read_b128 a[24:27], v50 offset:52224
v_mfma_f32_16x16x32_bf16 v[236:239], a[52:55], a[196:199], v[236:239]
s_add_u32 m0, s30, 73728
s_add_u32 s83, s67, 0
buffer_load_dwordx4 v11, s[4:7], s83 offen offset:0 lds
v_mfma_f32_16x16x32_bf16 v[204:207], a[56:59], a[192:195], v[204:207]
ds_read_b128 a[28:31], v50 offset:53248
v_mfma_f32_16x16x32_bf16 v[240:243], a[56:59], a[196:199], v[240:243]
v_mfma_f32_16x16x32_bf16 v[208:211], a[60:63], a[192:195], v[208:211]
ds_read_b128 a[32:35], v50 offset:54272
v_mfma_f32_16x16x32_bf16 v[244:247], a[60:63], a[196:199], v[244:247]
buffer_load_dwordx4 v11, s[4:7], s83 offen offset:1024 lds
v_mfma_f32_16x16x32_bf16 v[212:215], a[64:67], a[192:195], v[212:215]
v_mfma_f32_16x16x32_bf16 v[248:251], a[64:67], a[196:199], v[248:251]
v_mfma_f32_16x16x32_bf16 v[216:219], a[68:71], a[192:195], v[216:219]
v_mfma_f32_16x16x32_bf16 v[252:255], a[68:71], a[196:199], v[252:255]
buffer_load_dwordx4 v11, s[4:7], s83 offen offset:2048 lds
s_add_u32 s70, s77, 5
s_and_b32 s70, s70, 7
s_lshl_b32 s70, s70, 12
s_add_u32 s70, s70, s27
s_waitcnt vmcnt(36) lgkmcnt(0)
s_lshr_b32 s33, s0, 5
s_mul_i32 s33, s33, 144
s_mul_i32 s34, s54, 36
s_add_u32 s33, s33, s34
s_mul_i32 s33, s33, 9216
s_and_b32 s35, s0, 31
s_mul_i32 s35, s35, 10368
s_add_u32 s35, s35, s33
v_lshlrev_b32 v21, 7, v0
buffer_load_dword v10, v21, s[4:7], s35 offen
s_add_u32 s35, s35, 8192
buffer_load_dword v10, v21, s[4:7], s35 offen
v_mfma_f32_16x16x32_bf16 v[184:187], a[0:3], a[200:203], v[184:187]
ds_read_b128 a[36:39], v50 offset:55296
v_mfma_f32_16x16x32_bf16 v[220:223], a[0:3], a[204:207], v[220:223]
ds_read_b128 a[40:43], v50 offset:56320
v_mfma_f32_16x16x32_bf16 v[188:191], a[4:7], a[200:203], v[188:191]
ds_read_b128 a[44:47], v50 offset:57344
v_mfma_f32_16x16x32_bf16 v[224:227], a[4:7], a[204:207], v[224:227]
buffer_load_dwordx4 a[192:195], v11, s[8:11], s70 offen offset:0
ds_read_b128 a[48:51], v50 offset:58368
v_mfma_f32_16x16x32_bf16 v[192:195], a[8:11], a[200:203], v[192:195]
ds_read_b128 a[52:55], v50 offset:59392
v_mfma_f32_16x16x32_bf16 v[228:231], a[8:11], a[204:207], v[228:231]
v_mfma_f32_16x16x32_bf16 v[196:199], a[12:15], a[200:203], v[196:199]
ds_read_b128 a[56:59], v50 offset:60416
v_mfma_f32_16x16x32_bf16 v[232:235], a[12:15], a[204:207], v[232:235]
buffer_load_dwordx4 a[196:199], v48, s[8:11], s70 offen offset:0
v_mfma_f32_16x16x32_bf16 v[200:203], a[16:19], a[200:203], v[200:203]
ds_read_b128 a[60:63], v50 offset:61440
v_mfma_f32_16x16x32_bf16 v[236:239], a[16:19], a[204:207], v[236:239]
v_mfma_f32_16x16x32_bf16 v[204:207], a[20:23], a[200:203], v[204:207]
ds_read_b128 a[64:67], v50 offset:62464
v_mfma_f32_16x16x32_bf16 v[240:243], a[20:23], a[204:207], v[240:243]
buffer_load_dwordx4 v11, s[4:7], s83 offen offset:3072 lds
v_mfma_f32_16x16x32_bf16 v[208:211], a[24:27], a[200:203], v[208:211]
ds_read_b128 a[68:71], v50 offset:63488
v_mfma_f32_16x16x32_bf16 v[244:247], a[24:27], a[204:207], v[244:247]
v_mfma_f32_16x16x32_bf16 v[212:215], a[28:31], a[200:203], v[212:215]
s_add_u32 m0, s30, 77824
s_add_u32 s83, s67, 4096
buffer_load_dwordx4 v11, s[4:7], s83 offen offset:0 lds
v_mfma_f32_16x16x32_bf16 v[248:251], a[28:31], a[204:207], v[248:251]
v_mfma_f32_16x16x32_bf16 v[216:219], a[32:35], a[200:203], v[216:219]
v_mfma_f32_16x16x32_bf16 v[252:255], a[32:35], a[204:207], v[252:255]
s_waitcnt vmcnt(42) lgkmcnt(0)
v_mfma_f32_16x16x32_bf16 v[184:187], a[36:39], a[208:211], v[184:187]
ds_read_b128 a[0:3], v51 offset:0
v_mfma_f32_16x16x32_bf16 v[220:223], a[36:39], a[212:215], v[220:223]
buffer_load_dwordx4 a[200:203], v11, s[8:11], s70 offen offset:1024
ds_read_b128 a[4:7], v51 offset:1024
v_mfma_f32_16x16x32_bf16 v[188:191], a[40:43], a[208:211], v[188:191]
ds_read_b128 a[8:11], v51 offset:2048
v_mfma_f32_16x16x32_bf16 v[224:227], a[40:43], a[212:215], v[224:227]
ds_read_b128 a[12:15], v51 offset:3072
v_mfma_f32_16x16x32_bf16 v[192:195], a[44:47], a[208:211], v[192:195]
ds_read_b128 a[16:19], v51 offset:4096
v_mfma_f32_16x16x32_bf16 v[228:231], a[44:47], a[212:215], v[228:231]
buffer_load_dwordx4 a[204:207], v48, s[8:11], s70 offen offset:1024
v_mfma_f32_16x16x32_bf16 v[196:199], a[48:51], a[208:211], v[196:199]
ds_read_b128 a[20:23], v51 offset:5120
v_mfma_f32_16x16x32_bf16 v[232:235], a[48:51], a[212:215], v[232:235]
v_mfma_f32_16x16x32_bf16 v[200:203], a[52:55], a[208:211], v[200:203]
ds_read_b128 a[24:27], v51 offset:6144
v_mfma_f32_16x16x32_bf16 v[236:239], a[52:55], a[212:215], v[236:239]
buffer_load_dwordx4 v11, s[4:7], s83 offen offset:1024 lds
v_mfma_f32_16x16x32_bf16 v[204:207], a[56:59], a[208:211], v[204:207]
ds_read_b128 a[28:31], v51 offset:7168
v_mfma_f32_16x16x32_bf16 v[240:243], a[56:59], a[212:215], v[240:243]
v_mfma_f32_16x16x32_bf16 v[208:211], a[60:63], a[208:211], v[208:211]
ds_read_b128 a[32:35], v51 offset:8192
v_mfma_f32_16x16x32_bf16 v[244:247], a[60:63], a[212:215], v[244:247]
buffer_load_dwordx4 v11, s[4:7], s83 offen offset:2048 lds
v_mfma_f32_16x16x32_bf16 v[212:215], a[64:67], a[208:211], v[212:215]
v_mfma_f32_16x16x32_bf16 v[248:251], a[64:67], a[212:215], v[248:251]
v_mfma_f32_16x16x32_bf16 v[216:219], a[68:71], a[208:211], v[216:219]
v_mfma_f32_16x16x32_bf16 v[252:255], a[68:71], a[212:215], v[252:255]
buffer_load_dwordx4 v11, s[4:7], s83 offen offset:3072 lds
s_waitcnt vmcnt(47) lgkmcnt(0)
v_mfma_f32_16x16x32_bf16 v[184:187], a[0:3], a[216:219], v[184:187]
ds_read_b128 a[36:39], v51 offset:9216
v_mfma_f32_16x16x32_bf16 v[220:223], a[0:3], a[220:223], v[220:223]
ds_read_b128 a[40:43], v51 offset:10240
v_mfma_f32_16x16x32_bf16 v[188:191], a[4:7], a[216:219], v[188:191]
ds_read_b128 a[44:47], v51 offset:11264
v_mfma_f32_16x16x32_bf16 v[224:227], a[4:7], a[220:223], v[224:227]
buffer_load_dwordx4 a[208:211], v11, s[8:11], s70 offen offset:2048
ds_read_b128 a[48:51], v51 offset:12288
v_mfma_f32_16x16x32_bf16 v[192:195], a[8:11], a[216:219], v[192:195]
ds_read_b128 a[52:55], v51 offset:13312
v_mfma_f32_16x16x32_bf16 v[228:231], a[8:11], a[220:223], v[228:231]
v_mfma_f32_16x16x32_bf16 v[196:199], a[12:15], a[216:219], v[196:199]
ds_read_b128 a[56:59], v51 offset:14336
v_mfma_f32_16x16x32_bf16 v[232:235], a[12:15], a[220:223], v[232:235]
buffer_load_dwordx4 a[212:215], v48, s[8:11], s70 offen offset:2048
v_mfma_f32_16x16x32_bf16 v[200:203], a[16:19], a[216:219], v[200:203]
ds_read_b128 a[60:63], v51 offset:15360
v_mfma_f32_16x16x32_bf16 v[236:239], a[16:19], a[220:223], v[236:239]
v_mfma_f32_16x16x32_bf16 v[204:207], a[20:23], a[216:219], v[204:207]
ds_read_b128 a[64:67], v51 offset:16384
v_mfma_f32_16x16x32_bf16 v[240:243], a[20:23], a[220:223], v[240:243]
s_add_u32 m0, s30, 81920
s_add_u32 s83, s67, 8192
buffer_load_dwordx4 v11, s[4:7], s83 offen offset:0 lds
v_mfma_f32_16x16x32_bf16 v[208:211], a[24:27], a[216:219], v[208:211]
ds_read_b128 a[68:71], v51 offset:17408
v_mfma_f32_16x16x32_bf16 v[244:247], a[24:27], a[220:223], v[244:247]
v_mfma_f32_16x16x32_bf16 v[212:215], a[28:31], a[216:219], v[212:215]
v_mfma_f32_16x16x32_bf16 v[248:251], a[28:31], a[220:223], v[248:251]
v_mfma_f32_16x16x32_bf16 v[216:219], a[32:35], a[216:219], v[216:219]
v_mfma_f32_16x16x32_bf16 v[252:255], a[32:35], a[220:223], v[252:255]
s_waitcnt vmcnt(50) lgkmcnt(0)
s_barrier
s_add_u32 s68, s77, 6
s_and_b32 s68, s68, 7
s_mul_i32 s68, s68, 36864
s_add_u32 s68, s68, s79
v_mfma_f32_16x16x32_bf16 v[184:187], a[36:39], a[128:131], v[184:187]
ds_read_b128 a[0:3], v49 offset:0
v_mfma_f32_16x16x32_bf16 v[220:223], a[36:39], a[132:135], v[220:223]
buffer_load_dwordx4 a[216:219], v11, s[8:11], s70 offen offset:3072
ds_read_b128 a[4:7], v49 offset:1024
v_mfma_f32_16x16x32_bf16 v[188:191], a[40:43], a[128:131], v[188:191]
ds_read_b128 a[8:11], v49 offset:2048
v_mfma_f32_16x16x32_bf16 v[224:227], a[40:43], a[132:135], v[224:227]
ds_read_b128 a[12:15], v49 offset:3072
v_mfma_f32_16x16x32_bf16 v[192:195], a[44:47], a[128:131], v[192:195]
ds_read_b128 a[16:19], v49 offset:4096
v_mfma_f32_16x16x32_bf16 v[228:231], a[44:47], a[132:135], v[228:231]
buffer_load_dwordx4 a[220:223], v48, s[8:11], s70 offen offset:3072
v_mfma_f32_16x16x32_bf16 v[196:199], a[48:51], a[128:131], v[196:199]
ds_read_b128 a[20:23], v49 offset:5120
v_mfma_f32_16x16x32_bf16 v[232:235], a[48:51], a[132:135], v[232:235]
v_mfma_f32_16x16x32_bf16 v[200:203], a[52:55], a[128:131], v[200:203]
ds_read_b128 a[24:27], v49 offset:6144
v_mfma_f32_16x16x32_bf16 v[236:239], a[52:55], a[132:135], v[236:239]
s_add_u32 m0, s30, 110592
s_add_u32 s83, s68, 0
buffer_load_dwordx4 v11, s[4:7], s83 offen offset:0 lds
v_mfma_f32_16x16x32_bf16 v[204:207], a[56:59], a[128:131], v[204:207]
ds_read_b128 a[28:31], v49 offset:7168
v_mfma_f32_16x16x32_bf16 v[240:243], a[56:59], a[132:135], v[240:243]
v_mfma_f32_16x16x32_bf16 v[208:211], a[60:63], a[128:131], v[208:211]
ds_read_b128 a[32:35], v49 offset:8192
v_mfma_f32_16x16x32_bf16 v[244:247], a[60:63], a[132:135], v[244:247]
buffer_load_dwordx4 v11, s[4:7], s83 offen offset:1024 lds
v_mfma_f32_16x16x32_bf16 v[212:215], a[64:67], a[128:131], v[212:215]
v_mfma_f32_16x16x32_bf16 v[248:251], a[64:67], a[132:135], v[248:251]
v_mfma_f32_16x16x32_bf16 v[216:219], a[68:71], a[128:131], v[216:219]
v_mfma_f32_16x16x32_bf16 v[252:255], a[68:71], a[132:135], v[252:255]
buffer_load_dwordx4 v11, s[4:7], s83 offen offset:2048 lds
s_add_u32 s71, s77, 6
s_and_b32 s71, s71, 7
s_lshl_b32 s71, s71, 12
s_add_u32 s71, s71, s27
s_waitcnt vmcnt(55) lgkmcnt(0)
v_mfma_f32_16x16x32_bf16 v[184:187], a[0:3], a[136:139], v[184:187]
ds_read_b128 a[36:39], v49 offset:9216
v_mfma_f32_16x16x32_bf16 v[220:223], a[0:3], a[140:143], v[220:223]
buffer_load_dwordx4 a[128:131], v11, s[8:11], s71 offen offset:0
ds_read_b128 a[40:43], v49 offset:10240
v_mfma_f32_16x16x32_bf16 v[188:191], a[4:7], a[136:139], v[188:191]
ds_read_b128 a[44:47], v49 offset:11264
v_mfma_f32_16x16x32_bf16 v[224:227], a[4:7], a[140:143], v[224:227]
ds_read_b128 a[48:51], v49 offset:12288
v_mfma_f32_16x16x32_bf16 v[192:195], a[8:11], a[136:139], v[192:195]
ds_read_b128 a[52:55], v49 offset:13312
v_mfma_f32_16x16x32_bf16 v[228:231], a[8:11], a[140:143], v[228:231]
buffer_load_dwordx4 a[132:135], v48, s[8:11], s71 offen offset:0
v_mfma_f32_16x16x32_bf16 v[196:199], a[12:15], a[136:139], v[196:199]
ds_read_b128 a[56:59], v49 offset:14336
v_mfma_f32_16x16x32_bf16 v[232:235], a[12:15], a[140:143], v[232:235]
v_mfma_f32_16x16x32_bf16 v[200:203], a[16:19], a[136:139], v[200:203]
ds_read_b128 a[60:63], v49 offset:15360
v_mfma_f32_16x16x32_bf16 v[236:239], a[16:19], a[140:143], v[236:239]
buffer_load_dwordx4 v11, s[4:7], s83 offen offset:3072 lds
v_mfma_f32_16x16x32_bf16 v[204:207], a[20:23], a[136:139], v[204:207]
ds_read_b128 a[64:67], v49 offset:16384
v_mfma_f32_16x16x32_bf16 v[240:243], a[20:23], a[140:143], v[240:243]
v_mfma_f32_16x16x32_bf16 v[208:211], a[24:27], a[136:139], v[208:211]
ds_read_b128 a[68:71], v49 offset:17408
v_mfma_f32_16x16x32_bf16 v[244:247], a[24:27], a[140:143], v[244:247]
s_add_u32 m0, s30, 114688
s_add_u32 s83, s68, 4096
buffer_load_dwordx4 v11, s[4:7], s83 offen offset:0 lds
v_mfma_f32_16x16x32_bf16 v[212:215], a[28:31], a[136:139], v[212:215]
v_mfma_f32_16x16x32_bf16 v[248:251], a[28:31], a[140:143], v[248:251]
v_mfma_f32_16x16x32_bf16 v[216:219], a[32:35], a[136:139], v[216:219]
v_mfma_f32_16x16x32_bf16 v[252:255], a[32:35], a[140:143], v[252:255]
buffer_load_dwordx4 v11, s[4:7], s83 offen offset:1024 lds
s_waitcnt vmcnt(58) lgkmcnt(0)
v_mfma_f32_16x16x32_bf16 v[184:187], a[36:39], a[72:75], v[184:187]
ds_read_b128 a[0:3], v49 offset:18432
v_mfma_f32_16x16x32_bf16 v[220:223], a[36:39], a[76:79], v[220:223]
ds_read_b128 a[4:7], v49 offset:19456
v_mfma_f32_16x16x32_bf16 v[188:191], a[40:43], a[72:75], v[188:191]
ds_read_b128 a[8:11], v49 offset:20480
v_mfma_f32_16x16x32_bf16 v[224:227], a[40:43], a[76:79], v[224:227]
buffer_load_dwordx4 a[136:139], v11, s[8:11], s71 offen offset:1024
ds_read_b128 a[12:15], v49 offset:21504
v_mfma_f32_16x16x32_bf16 v[192:195], a[44:47], a[72:75], v[192:195]
ds_read_b128 a[16:19], v49 offset:22528
v_mfma_f32_16x16x32_bf16 v[228:231], a[44:47], a[76:79], v[228:231]
v_mfma_f32_16x16x32_bf16 v[196:199], a[48:51], a[72:75], v[196:199]
ds_read_b128 a[20:23], v49 offset:23552
v_mfma_f32_16x16x32_bf16 v[232:235], a[48:51], a[76:79], v[232:235]
buffer_load_dwordx4 a[140:143], v48, s[8:11], s71 offen offset:1024
v_mfma_f32_16x16x32_bf16 v[200:203], a[52:55], a[72:75], v[200:203]
ds_read_b128 a[24:27], v49 offset:24576
v_mfma_f32_16x16x32_bf16 v[236:239], a[52:55], a[76:79], v[236:239]
v_mfma_f32_16x16x32_bf16 v[204:207], a[56:59], a[72:75], v[204:207]
ds_read_b128 a[28:31], v49 offset:25600
v_mfma_f32_16x16x32_bf16 v[240:243], a[56:59], a[76:79], v[240:243]
buffer_load_dwordx4 v11, s[4:7], s83 offen offset:2048 lds
v_mfma_f32_16x16x32_bf16 v[208:211], a[60:63], a[72:75], v[208:211]
ds_read_b128 a[32:35], v49 offset:26624
v_mfma_f32_16x16x32_bf16 v[244:247], a[60:63], a[76:79], v[244:247]
v_mfma_f32_16x16x32_bf16 v[212:215], a[64:67], a[72:75], v[212:215]
buffer_load_dwordx4 v11, s[4:7], s83 offen offset:3072 lds
v_mfma_f32_16x16x32_bf16 v[248:251], a[64:67], a[76:79], v[248:251]
v_mfma_f32_16x16x32_bf16 v[216:219], a[68:71], a[72:75], v[216:219]
v_mfma_f32_16x16x32_bf16 v[252:255], a[68:71], a[76:79], v[252:255]
s_waitcnt vmcnt(60) lgkmcnt(0)
v_mfma_f32_16x16x32_bf16 v[184:187], a[0:3], a[80:83], v[184:187]
ds_read_b128 a[36:39], v49 offset:27648
v_mfma_f32_16x16x32_bf16 v[220:223], a[0:3], a[84:87], v[220:223]
buffer_load_dwordx4 a[72:75], v11, s[8:11], s71 offen offset:2048
ds_read_b128 a[40:43], v49 offset:28672
v_mfma_f32_16x16x32_bf16 v[188:191], a[4:7], a[80:83], v[188:191]
ds_read_b128 a[44:47], v49 offset:29696
v_mfma_f32_16x16x32_bf16 v[224:227], a[4:7], a[84:87], v[224:227]
ds_read_b128 a[48:51], v49 offset:30720
v_mfma_f32_16x16x32_bf16 v[192:195], a[8:11], a[80:83], v[192:195]
ds_read_b128 a[52:55], v49 offset:31744
v_mfma_f32_16x16x32_bf16 v[228:231], a[8:11], a[84:87], v[228:231]
buffer_load_dwordx4 a[76:79], v48, s[8:11], s71 offen offset:2048
v_mfma_f32_16x16x32_bf16 v[196:199], a[12:15], a[80:83], v[196:199]
ds_read_b128 a[56:59], v49 offset:32768
v_mfma_f32_16x16x32_bf16 v[232:235], a[12:15], a[84:87], v[232:235]
v_mfma_f32_16x16x32_bf16 v[200:203], a[16:19], a[80:83], v[200:203]
ds_read_b128 a[60:63], v49 offset:33792
v_mfma_f32_16x16x32_bf16 v[236:239], a[16:19], a[84:87], v[236:239]
s_add_u32 m0, s30, 118784
s_add_u32 s83, s68, 8192
buffer_load_dwordx4 v11, s[4:7], s83 offen offset:0 lds
v_mfma_f32_16x16x32_bf16 v[204:207], a[20:23], a[80:83], v[204:207]
ds_read_b128 a[64:67], v49 offset:34816
v_mfma_f32_16x16x32_bf16 v[240:243], a[20:23], a[84:87], v[240:243]
v_mfma_f32_16x16x32_bf16 v[208:211], a[24:27], a[80:83], v[208:211]
ds_read_b128 a[68:71], v49 offset:35840
v_mfma_f32_16x16x32_bf16 v[244:247], a[24:27], a[84:87], v[244:247]
v_mfma_f32_16x16x32_bf16 v[212:215], a[28:31], a[80:83], v[212:215]
v_mfma_f32_16x16x32_bf16 v[248:251], a[28:31], a[84:87], v[248:251]
v_mfma_f32_16x16x32_bf16 v[216:219], a[32:35], a[80:83], v[216:219]
v_mfma_f32_16x16x32_bf16 v[252:255], a[32:35], a[84:87], v[252:255]
s_waitcnt vmcnt(43) lgkmcnt(0)
s_barrier
s_add_u32 s69, s77, 7
s_and_b32 s69, s69, 7
s_mul_i32 s69, s69, 36864
s_add_u32 s69, s69, s79
s_lshr_b32 s33, s52, 1
s_lshl_b32 s33, s33, 3
v_cmp_eq_u32 vcc, s33, v0
s_nop 1
s_mov_b64 s[42:43], vcc
s_cmp_eq_u32 s24, 0
s_cselect_b64 vcc, s[42:43], 0
v_mov_b32 v12, 0x7fff0000
v_lshlrev_b32 v13, 2, v0
v_cndmask_b32 v62, v12, v13, vcc
v_mfma_f32_16x16x32_bf16 v[184:187], a[36:39], a[88:91], v[184:187]
ds_read_b128 a[0:3], v49 offset:36864
v_mfma_f32_16x16x32_bf16 v[220:223], a[36:39], a[92:95], v[220:223]
buffer_load_dword v61, v62, s[56:59], 0 offen sc1
ds_read_b128 a[4:7], v49 offset:37888
v_mfma_f32_16x16x32_bf16 v[188:191], a[40:43], a[88:91], v[188:191]
ds_read_b128 a[8:11], v49 offset:38912
v_mfma_f32_16x16x32_bf16 v[224:227], a[40:43], a[92:95], v[224:227]
ds_read_b128 a[12:15], v49 offset:39936
v_mfma_f32_16x16x32_bf16 v[192:195], a[44:47], a[88:91], v[192:195]
ds_read_b128 a[16:19], v49 offset:40960
v_mfma_f32_16x16x32_bf16 v[228:231], a[44:47], a[92:95], v[228:231]
buffer_load_dwordx4 a[80:83], v11, s[8:11], s71 offen offset:3072
v_mfma_f32_16x16x32_bf16 v[196:199], a[48:51], a[88:91], v[196:199]
ds_read_b128 a[20:23], v49 offset:41984
v_mfma_f32_16x16x32_bf16 v[232:235], a[48:51], a[92:95], v[232:235]
v_mfma_f32_16x16x32_bf16 v[200:203], a[52:55], a[88:91], v[200:203]
ds_read_b128 a[24:27], v49 offset:43008
v_mfma_f32_16x16x32_bf16 v[236:239], a[52:55], a[92:95], v[236:239]
buffer_load_dwordx4 a[84:87], v48, s[8:11], s71 offen offset:3072
v_mfma_f32_16x16x32_bf16 v[204:207], a[56:59], a[88:91], v[204:207]
ds_read_b128 a[28:31], v49 offset:44032
v_mfma_f32_16x16x32_bf16 v[240:243], a[56:59], a[92:95], v[240:243]
v_mfma_f32_16x16x32_bf16 v[208:211], a[60:63], a[88:91], v[208:211]
ds_read_b128 a[32:35], v49 offset:45056
v_mfma_f32_16x16x32_bf16 v[244:247], a[60:63], a[92:95], v[244:247]
s_add_u32 m0, s30, 0
s_add_u32 s83, s69, 0
buffer_load_dwordx4 v11, s[4:7], s83 offen offset:0 lds
v_mfma_f32_16x16x32_bf16 v[212:215], a[64:67], a[88:91], v[212:215]
v_mfma_f32_16x16x32_bf16 v[248:251], a[64:67], a[92:95], v[248:251]
v_mfma_f32_16x16x32_bf16 v[216:219], a[68:71], a[88:91], v[216:219]
v_mfma_f32_16x16x32_bf16 v[252:255], a[68:71], a[92:95], v[252:255]
buffer_load_dwordx4 v11, s[4:7], s83 offen offset:1024 lds
s_add_u32 s72, s77, 7
s_and_b32 s72, s72, 7
s_lshl_b32 s72, s72, 12
s_add_u32 s72, s72, s27
s_waitcnt vmcnt(48) lgkmcnt(0)
v_mfma_f32_16x16x32_bf16 v[184:187], a[0:3], a[96:99], v[184:187]
ds_read_b128 a[36:39], v49 offset:46080
v_mfma_f32_16x16x32_bf16 v[220:223], a[0:3], a[100:103], v[220:223]
buffer_load_dwordx4 a[88:91], v11, s[8:11], s72 offen offset:0
ds_read_b128 a[40:43], v49 offset:47104
v_mfma_f32_16x16x32_bf16 v[188:191], a[4:7], a[96:99], v[188:191]
ds_read_b128 a[44:47], v49 offset:48128
v_mfma_f32_16x16x32_bf16 v[224:227], a[4:7], a[100:103], v[224:227]
ds_read_b128 a[48:51], v49 offset:49152
v_mfma_f32_16x16x32_bf16 v[192:195], a[8:11], a[96:99], v[192:195]
ds_read_b128 a[52:55], v49 offset:50176
v_mfma_f32_16x16x32_bf16 v[228:231], a[8:11], a[100:103], v[228:231]
buffer_load_dwordx4 a[92:95], v48, s[8:11], s72 offen offset:0
v_mfma_f32_16x16x32_bf16 v[196:199], a[12:15], a[96:99], v[196:199]
ds_read_b128 a[56:59], v49 offset:51200
v_mfma_f32_16x16x32_bf16 v[232:235], a[12:15], a[100:103], v[232:235]
v_mfma_f32_16x16x32_bf16 v[200:203], a[16:19], a[96:99], v[200:203]
ds_read_b128 a[60:63], v49 offset:52224
v_mfma_f32_16x16x32_bf16 v[236:239], a[16:19], a[100:103], v[236:239]
buffer_load_dwordx4 v11, s[4:7], s83 offen offset:2048 lds
v_mfma_f32_16x16x32_bf16 v[204:207], a[20:23], a[96:99], v[204:207]
ds_read_b128 a[64:67], v49 offset:53248
v_mfma_f32_16x16x32_bf16 v[240:243], a[20:23], a[100:103], v[240:243]
v_mfma_f32_16x16x32_bf16 v[208:211], a[24:27], a[96:99], v[208:211]
ds_read_b128 a[68:71], v49 offset:54272
v_mfma_f32_16x16x32_bf16 v[244:247], a[24:27], a[100:103], v[244:247]
buffer_load_dwordx4 v11, s[4:7], s83 offen offset:3072 lds
v_mfma_f32_16x16x32_bf16 v[212:215], a[28:31], a[96:99], v[212:215]
v_mfma_f32_16x16x32_bf16 v[248:251], a[28:31], a[100:103], v[248:251]
v_mfma_f32_16x16x32_bf16 v[216:219], a[32:35], a[96:99], v[216:219]
v_mfma_f32_16x16x32_bf16 v[252:255], a[32:35], a[100:103], v[252:255]
s_add_u32 m0, s30, 4096
s_add_u32 s83, s69, 4096
buffer_load_dwordx4 v11, s[4:7], s83 offen offset:0 lds
s_waitcnt vmcnt(53) lgkmcnt(0)
v_mfma_f32_16x16x32_bf16 v[184:187], a[36:39], a[104:107], v[184:187]
ds_read_b128 a[0:3], v49 offset:55296
v_mfma_f32_16x16x32_bf16 v[220:223], a[36:39], a[108:111], v[220:223]
ds_read_b128 a[4:7], v49 offset:56320
v_mfma_f32_16x16x32_bf16 v[188:191], a[40:43], a[104:107], v[188:191]
ds_read_b128 a[8:11], v49 offset:57344
v_mfma_f32_16x16x32_bf16 v[224:227], a[40:43], a[108:111], v[224:227]
buffer_load_dwordx4 a[96:99], v11, s[8:11], s72 offen offset:1024
ds_read_b128 a[12:15], v49 offset:58368
v_mfma_f32_16x16x32_bf16 v[192:195], a[44:47], a[104:107], v[192:195]
ds_read_b128 a[16:19], v49 offset:59392
v_mfma_f32_16x16x32_bf16 v[228:231], a[44:47], a[108:111], v[228:231]
v_mfma_f32_16x16x32_bf16 v[196:199], a[48:51], a[104:107], v[196:199]
ds_read_b128 a[20:23], v49 offset:60416
v_mfma_f32_16x16x32_bf16 v[232:235], a[48:51], a[108:111], v[232:235]
buffer_load_dwordx4 a[100:103], v48, s[8:11], s72 offen offset:1024
v_mfma_f32_16x16x32_bf16 v[200:203], a[52:55], a[104:107], v[200:203]
ds_read_b128 a[24:27], v49 offset:61440
v_mfma_f32_16x16x32_bf16 v[236:239], a[52:55], a[108:111], v[236:239]
v_mfma_f32_16x16x32_bf16 v[204:207], a[56:59], a[104:107], v[204:207]
ds_read_b128 a[28:31], v49 offset:62464
v_mfma_f32_16x16x32_bf16 v[240:243], a[56:59], a[108:111], v[240:243]
buffer_load_dwordx4 v11, s[4:7], s83 offen offset:1024 lds
v_mfma_f32_16x16x32_bf16 v[208:211], a[60:63], a[104:107], v[208:211]
ds_read_b128 a[32:35], v49 offset:63488
v_mfma_f32_16x16x32_bf16 v[244:247], a[60:63], a[108:111], v[244:247]
v_mfma_f32_16x16x32_bf16 v[212:215], a[64:67], a[104:107], v[212:215]
buffer_load_dwordx4 v11, s[4:7], s83 offen offset:2048 lds
v_mfma_f32_16x16x32_bf16 v[248:251], a[64:67], a[108:111], v[248:251]
v_mfma_f32_16x16x32_bf16 v[216:219], a[68:71], a[104:107], v[216:219]
v_mfma_f32_16x16x32_bf16 v[252:255], a[68:71], a[108:111], v[252:255]
s_waitcnt vmcnt(50) lgkmcnt(0)
s_cmp_lg_u32 s24, 0
s_cbranch_scc1 L_poll10_ok
s_waitcnt vmcnt(13)
s_mov_b32 s35, 400000
L_poll10:
v_bfe_u32 v12, v61, 16, 8
v_cmp_gt_u32 vcc, 32, v12
s_nop 1
s_and_b64 vcc, vcc, s[42:43]
s_cmp_eq_u64 vcc, 0
s_cbranch_scc1 L_poll10_ok
s_sleep 2
buffer_load_dword v61, v62, s[56:59], 0 offen sc1
s_waitcnt vmcnt(0)
s_sub_u32 s35, s35, 1
s_cmp_lg_u32 s35, 0
s_cbranch_scc1 L_poll10
L_poll10_ok:
v_mfma_f32_16x16x32_bf16 v[184:187], a[0:3], a[112:115], v[184:187]
ds_read_b128 a[36:39], v50 offset:0
v_mfma_f32_16x16x32_bf16 v[220:223], a[0:3], a[116:119], v[220:223]
buffer_load_dwordx4 a[104:107], v11, s[8:11], s72 offen offset:2048
ds_read_b128 a[40:43], v50 offset:1024
v_mfma_f32_16x16x32_bf16 v[188:191], a[4:7], a[112:115], v[188:191]
ds_read_b128 a[44:47], v50 offset:2048
v_mfma_f32_16x16x32_bf16 v[224:227], a[4:7], a[116:119], v[224:227]
ds_read_b128 a[48:51], v50 offset:3072
v_mfma_f32_16x16x32_bf16 v[192:195], a[8:11], a[112:115], v[192:195]
ds_read_b128 a[52:55], v50 offset:4096
v_mfma_f32_16x16x32_bf16 v[228:231], a[8:11], a[116:119], v[228:231]
buffer_load_dwordx4 a[108:111], v48, s[8:11], s72 offen offset:2048
v_mfma_f32_16x16x32_bf16 v[196:199], a[12:15], a[112:115], v[196:199]
ds_read_b128 a[56:59], v50 offset:5120
v_mfma_f32_16x16x32_bf16 v[232:235], a[12:15], a[116:119], v[232:235]
v_mfma_f32_16x16x32_bf16 v[200:203], a[16:19], a[112:115], v[200:203]
ds_read_b128 a[60:63], v50 offset:6144
v_mfma_f32_16x16x32_bf16 v[236:239], a[16:19], a[116:119], v[236:239]
buffer_load_dwordx4 v11, s[4:7], s83 offen offset:3072 lds
v_mfma_f32_16x16x32_bf16 v[204:207], a[20:23], a[112:115], v[204:207]
ds_read_b128 a[64:67], v50 offset:7168
v_mfma_f32_16x16x32_bf16 v[240:243], a[20:23], a[116:119], v[240:243]
v_mfma_f32_16x16x32_bf16 v[208:211], a[24:27], a[112:115], v[208:211]
ds_read_b128 a[68:71], v50 offset:8192
v_mfma_f32_16x16x32_bf16 v[244:247], a[24:27], a[116:119], v[244:247]
s_add_u32 m0, s30, 8192
s_add_u32 s83, s69, 8192
buffer_load_dwordx4 v11, s[4:7], s83 offen offset:0 lds
v_mfma_f32_16x16x32_bf16 v[212:215], a[28:31], a[112:115], v[212:215]
v_mfma_f32_16x16x32_bf16 v[248:251], a[28:31], a[116:119], v[248:251]
v_mfma_f32_16x16x32_bf16 v[216:219], a[32:35], a[112:115], v[216:219]
v_mfma_f32_16x16x32_bf16 v[252:255], a[32:35], a[116:119], v[252:255]
s_waitcnt vmcnt(17) lgkmcnt(0)
s_barrier
s_add_u32 s66, s77, 0
s_sub_u32 s33, s66, 9
s_cmp_ge_u32 s66, 9
s_cselect_b32 s66, s33, s66
s_sub_u32 s33, s66, 9
s_cmp_ge_u32 s66, 9
s_cselect_b32 s66, s33, s66
s_mul_i32 s66, s66, 36864
s_add_u32 s66, s66, s78
v_mfma_f32_16x16x32_bf16 v[184:187], a[36:39], a[120:123], v[184:187]
ds_read_b128 a[0:3], v50 offset:9216
v_mfma_f32_16x16x32_bf16 v[220:223], a[36:39], a[124:127], v[220:223]
buffer_load_dwordx4 a[112:115], v11, s[8:11], s72 offen offset:3072
ds_read_b128 a[4:7], v50 offset:10240
v_mfma_f32_16x16x32_bf16 v[188:191], a[40:43], a[120:123], v[188:191]
ds_read_b128 a[8:11], v50 offset:11264
v_mfma_f32_16x16x32_bf16 v[224:227], a[40:43], a[124:127], v[224:227]
ds_read_b128 a[12:15], v50 offset:12288
v_mfma_f32_16x16x32_bf16 v[192:195], a[44:47], a[120:123], v[192:195]
ds_read_b128 a[16:19], v50 offset:13312
v_mfma_f32_16x16x32_bf16 v[228:231], a[44:47], a[124:127], v[228:231]
buffer_load_dwordx4 a[116:119], v48, s[8:11], s72 offen offset:3072
v_mfma_f32_16x16x32_bf16 v[196:199], a[48:51], a[120:123], v[196:199]
ds_read_b128 a[20:23], v50 offset:14336
v_mfma_f32_16x16x32_bf16 v[232:235], a[48:51], a[124:127], v[232:235]
v_mfma_f32_16x16x32_bf16 v[200:203], a[52:55], a[120:123], v[200:203]
ds_read_b128 a[24:27], v50 offset:15360
v_mfma_f32_16x16x32_bf16 v[236:239], a[52:55], a[124:127], v[236:239]
s_add_u32 m0, s30, 36864
s_add_u32 s83, s66, 0
buffer_load_dwordx4 v11, s[4:7], s83 offen offset:0 lds
v_mfma_f32_16x16x32_bf16 v[204:207], a[56:59], a[120:123], v[204:207]
ds_read_b128 a[28:31], v50 offset:16384
v_mfma_f32_16x16x32_bf16 v[240:243], a[56:59], a[124:127], v[240:243]
v_mfma_f32_16x16x32_bf16 v[208:211], a[60:63], a[120:123], v[208:211]
ds_read_b128 a[32:35], v50 offset:17408
v_mfma_f32_16x16x32_bf16 v[244:247], a[60:63], a[124:127], v[244:247]
buffer_load_dwordx4 v11, s[4:7], s83 offen offset:1024 lds
v_mfma_f32_16x16x32_bf16 v[212:215], a[64:67], a[120:123], v[212:215]
v_mfma_f32_16x16x32_bf16 v[248:251], a[64:67], a[124:127], v[248:251]
v_mfma_f32_16x16x32_bf16 v[216:219], a[68:71], a[120:123], v[216:219]
v_mfma_f32_16x16x32_bf16 v[252:255], a[68:71], a[124:127], v[252:255]
buffer_load_dwordx4 v11, s[4:7], s83 offen offset:2048 lds
s_add_u32 s73, s77, 0
s_sub_u32 s33, s73, 9
s_cmp_ge_u32 s73, 9
s_cselect_b32 s73, s33, s73
s_sub_u32 s33, s73, 9
s_cmp_ge_u32 s73, 9
s_cselect_b32 s73, s33, s73
s_lshl_b32 s73, s73, 12
s_add_u32 s73, s73, s28
s_waitcnt vmcnt(22) lgkmcnt(0)
v_mfma_f32_16x16x32_bf16 v[184:187], a[0:3], a[192:195], v[184:187]
ds_read_b128 a[36:39], v50 offset:18432
v_mfma_f32_16x16x32_bf16 v[220:223], a[0:3], a[196:199], v[220:223]
buffer_load_dwordx4 a[120:123], v11, s[12:15], s73 offen offset:0
ds_read_b128 a[40:43], v50 offset:19456
v_mfma_f32_16x16x32_bf16 v[188:191], a[4:7], a[192:195], v[188:191]
ds_read_b128 a[44:47], v50 offset:20480
v_mfma_f32_16x16x32_bf16 v[224:227], a[4:7], a[196:199], v[224:227]
ds_read_b128 a[48:51], v50 offset:21504
v_mfma_f32_16x16x32_bf16 v[192:195], a[8:11], a[192:195], v[192:195]
ds_read_b128 a[52:55], v50 offset:22528
v_mfma_f32_16x16x32_bf16 v[228:231], a[8:11], a[196:199], v[228:231]
buffer_load_dwordx4 a[124:127], v26, s[12:15], s73 offen offset:0
v_mfma_f32_16x16x32_bf16 v[196:199], a[12:15], a[192:195], v[196:199]
ds_read_b128 a[56:59], v50 offset:23552
v_mfma_f32_16x16x32_bf16 v[232:235], a[12:15], a[196:199], v[232:235]
v_mfma_f32_16x16x32_bf16 v[200:203], a[16:19], a[192:195], v[200:203]
ds_read_b128 a[60:63], v50 offset:24576
v_mfma_f32_16x16x32_bf16 v[236:239], a[16:19], a[196:199], v[236:239]
buffer_load_dwordx4 v11, s[4:7], s83 offen offset:3072 lds
v_mfma_f32_16x16x32_bf16 v[204:207], a[20:23], a[192:195], v[204:207]
ds_read_b128 a[64:67], v50 offset:25600
v_mfma_f32_16x16x32_bf16 v[240:243], a[20:23], a[196:199], v[240:243]
v_mfma_f32_16x16x32_bf16 v[208:211], a[24:27], a[192:195], v[208:211]
ds_read_b128 a[68:71], v50 offset:26624
v_mfma_f32_16x16x32_bf16 v[244:247], a[24:27], a[196:199], v[244:247]
s_add_u32 m0, s30, 40960
s_add_u32 s83, s66, 4096
buffer_load_dwordx4 v11, s[4:7], s83 offen offset:0 lds
v_mfma_f32_16x16x32_bf16 v[212:215], a[28:31], a[192:195], v[212:215]
v_mfma_f32_16x16x32_bf16 v[248:251], a[28:31], a[196:199], v[248:251]
v_mfma_f32_16x16x32_bf16 v[216:219], a[32:35], a[192:195], v[216:219]
v_mfma_f32_16x16x32_bf16 v[252:255], a[32:35], a[196:199], v[252:255]
buffer_load_dwordx4 v11, s[4:7], s83 offen offset:1024 lds
s_waitcnt vmcnt(27) lgkmcnt(0)
v_mfma_f32_16x16x32_bf16 v[184:187], a[36:39], a[200:203], v[184:187]
ds_read_b128 a[0:3], v50 offset:27648
v_mfma_f32_16x16x32_bf16 v[220:223], a[36:39], a[204:207], v[220:223]
ds_read_b128 a[4:7], v50 offset:28672
v_mfma_f32_16x16x32_bf16 v[188:191], a[40:43], a[200:203], v[188:191]
ds_read_b128 a[8:11], v50 offset:29696
v_mfma_f32_16x16x32_bf16 v[224:227], a[40:43], a[204:207], v[224:227]
buffer_load_dwordx4 a[192:195], v11, s[12:15], s73 offen offset:1024
ds_read_b128 a[12:15], v50 offset:30720
v_mfma_f32_16x16x32_bf16 v[192:195], a[44:47], a[200:203], v[192:195]
ds_read_b128 a[16:19], v50 offset:31744
v_mfma_f32_16x16x32_bf16 v[228:231], a[44:47], a[204:207], v[228:231]
v_mfma_f32_16x16x32_bf16 v[196:199], a[48:51], a[200:203], v[196:199]
ds_read_b128 a[20:23], v50 offset:32768
v_mfma_f32_16x16x32_bf16 v[232:235], a[48:51], a[204:207], v[232:235]
buffer_load_dwordx4 a[196:199], v26, s[12:15], s73 offen offset:1024
v_mfma_f32_16x16x32_bf16 v[200:203], a[52:55], a[200:203], v[200:203]
ds_read_b128 a[24:27], v50 offset:33792
v_mfma_f32_16x16x32_bf16 v[236:239], a[52:55], a[204:207], v[236:239]
v_mfma_f32_16x16x32_bf16 v[204:207], a[56:59], a[200:203], v[204:207]
ds_read_b128 a[28:31], v50 offset:34816
v_mfma_f32_16x16x32_bf16 v[240:243], a[56:59], a[204:207], v[240:243]
buffer_load_dwordx4 v11, s[4:7], s83 offen offset:2048 lds
v_mfma_f32_16x16x32_bf16 v[208:211], a[60:63], a[200:203], v[208:211]
ds_read_b128 a[32:35], v50 offset:35840
v_mfma_f32_16x16x32_bf16 v[244:247], a[60:63], a[204:207], v[244:247]
v_mfma_f32_16x16x32_bf16 v[212:215], a[64:67], a[200:203], v[212:215]
buffer_load_dwordx4 v11, s[4:7], s83 offen offset:3072 lds
v_mfma_f32_16x16x32_bf16 v[248:251], a[64:67], a[204:207], v[248:251]
v_mfma_f32_16x16x32_bf16 v[216:219], a[68:71], a[200:203], v[216:219]
v_mfma_f32_16x16x32_bf16 v[252:255], a[68:71], a[204:207], v[252:255]
s_waitcnt vmcnt(31) lgkmcnt(0)
v_mfma_f32_16x16x32_bf16 v[184:187], a[0:3], a[208:211], v[184:187]
ds_read_b128 a[36:39], v50 offset:36864
v_mfma_f32_16x16x32_bf16 v[220:223], a[0:3], a[212:215], v[220:223]
buffer_load_dwordx4 a[200:203], v11, s[12:15], s73 offen offset:2048
ds_read_b128 a[40:43], v50 offset:37888
v_mfma_f32_16x16x32_bf16 v[188:191], a[4:7], a[208:211], v[188:191]
ds_read_b128 a[44:47], v50 offset:38912
v_mfma_f32_16x16x32_bf16 v[224:227], a[4:7], a[212:215], v[224:227]
ds_read_b128 a[48:51], v50 offset:39936
v_mfma_f32_16x16x32_bf16 v[192:195], a[8:11], a[208:211], v[192:195]
ds_read_b128 a[52:55], v50 offset:40960
v_mfma_f32_16x16x32_bf16 v[228:231], a[8:11], a[212:215], v[228:231]
buffer_load_dwordx4 a[204:207], v26, s[12:15], s73 offen offset:2048
v_mfma_f32_16x16x32_bf16 v[196:199], a[12:15], a[208:211], v[196:199]
ds_read_b128 a[56:59], v50 offset:41984
v_mfma_f32_16x16x32_bf16 v[232:235], a[12:15], a[212:215], v[232:235]
v_mfma_f32_16x16x32_bf16 v[200:203], a[16:19], a[208:211], v[200:203]
ds_read_b128 a[60:63], v50 offset:43008
v_mfma_f32_16x16x32_bf16 v[236:239], a[16:19], a[212:215], v[236:239]
s_add_u32 m0, s30, 45056
s_add_u32 s83, s66, 8192
buffer_load_dwordx4 v11, s[4:7], s83 offen offset:0 lds
v_mfma_f32_16x16x32_bf16 v[204:207], a[20:23], a[208:211], v[204:207]
ds_read_b128 a[64:67], v50 offset:44032
v_mfma_f32_16x16x32_bf16 v[240:243], a[20:23], a[212:215], v[240:243]
v_mfma_f32_16x16x32_bf16 v[208:211], a[24:27], a[208:211], v[208:211]
ds_read_b128 a[68:71], v50 offset:45056
v_mfma_f32_16x16x32_bf16 v[244:247], a[24:27], a[212:215], v[244:247]
v_mfma_f32_16x16x32_bf16 v[212:215], a[28:31], a[208:211], v[212:215]
v_mfma_f32_16x16x32_bf16 v[248:251], a[28:31], a[212:215], v[248:251]
v_mfma_f32_16x16x32_bf16 v[216:219], a[32:35], a[208:211], v[216:219]
v_mfma_f32_16x16x32_bf16 v[252:255], a[32:35], a[212:215], v[252:255]
s_waitcnt vmcnt(34) lgkmcnt(0)
s_barrier
s_add_u32 s67, s77, 1
s_sub_u32 s33, s67, 9
s_cmp_ge_u32 s67, 9
s_cselect_b32 s67, s33, s67
s_sub_u32 s33, s67, 9
s_cmp_ge_u32 s67, 9
s_cselect_b32 s67, s33, s67
s_mul_i32 s67, s67, 36864
s_add_u32 s67, s67, s78
v_mfma_f32_16x16x32_bf16 v[184:187], a[36:39], a[216:219], v[184:187]
ds_read_b128 a[0:3], v50 offset:46080
v_mfma_f32_16x16x32_bf16 v[220:223], a[36:39], a[220:223], v[220:223]
buffer_load_dwordx4 a[208:211], v11, s[12:15], s73 offen offset:3072
ds_read_b128 a[4:7], v50 offset:47104
v_mfma_f32_16x16x32_bf16 v[188:191], a[40:43], a[216:219], v[188:191]
ds_read_b128 a[8:11], v50 offset:48128
v_mfma_f32_16x16x32_bf16 v[224:227], a[40:43], a[220:223], v[224:227]
ds_read_b128 a[12:15], v50 offset:49152
v_mfma_f32_16x16x32_bf16 v[192:195], a[44:47], a[216:219], v[192:195]
ds_read_b128 a[16:19], v50 offset:50176
v_mfma_f32_16x16x32_bf16 v[228:231], a[44:47], a[220:223], v[228:231]
buffer_load_dwordx4 a[212:215], v26, s[12:15], s73 offen offset:3072
v_mfma_f32_16x16x32_bf16 v[196:199], a[48:51], a[216:219], v[196:199]
ds_read_b128 a[20:23], v50 offset:51200
v_mfma_f32_16x16x32_bf16 v[232:235], a[48:51], a[220:223], v[232:235]
v_mfma_f32_16x16x32_bf16 v[200:203], a[52:55], a[216:219], v[200:203]
ds_read_b128 a[24:27], v50 offset:52224
v_mfma_f32_16x16x32_bf16 v[236:239], a[52:55], a[220:223], v[236:239]
s_add_u32 m0, s30, 73728
s_add_u32 s83, s67, 0
buffer_load_dwordx4 v11, s[4:7], s83 offen offset:0 lds
v_mfma_f32_16x16x32_bf16 v[204:207], a[56:59], a[216:219], v[204:207]
ds_read_b128 a[28:31], v50 offset:53248
v_mfma_f32_16x16x32_bf16 v[240:243], a[56:59], a[220:223], v[240:243]
v_mfma_f32_16x16x32_bf16 v[208:211], a[60:63], a[216:219], v[208:211]
ds_read_b128 a[32:35], v50 offset:54272
v_mfma_f32_16x16x32_bf16 v[244:247], a[60:63], a[220:223], v[244:247]
buffer_load_dwordx4 v11, s[4:7], s83 offen offset:1024 lds
v_mfma_f32_16x16x32_bf16 v[212:215], a[64:67], a[216:219], v[212:215]
v_mfma_f32_16x16x32_bf16 v[248:251], a[64:67], a[220:223], v[248:251]
v_mfma_f32_16x16x32_bf16 v[216:219], a[68:71], a[216:219], v[216:219]
v_mfma_f32_16x16x32_bf16 v[252:255], a[68:71], a[220:223], v[252:255]
buffer_load_dwordx4 v11, s[4:7], s83 offen offset:2048 lds
s_add_u32 s76, s77, 1
s_sub_u32 s33, s76, 9
s_cmp_ge_u32 s76, 9
s_cselect_b32 s76, s33, s76
s_sub_u32 s33, s76, 9
s_cmp_ge_u32 s76, 9
s_cselect_b32 s76, s33, s76
s_lshl_b32 s76, s76, 12
s_add_u32 s76, s76, s28
s_waitcnt vmcnt(39) lgkmcnt(0)
v_mfma_f32_16x16x32_bf16 v[184:187], a[0:3], a[128:131], v[184:187]
ds_read_b128 a[36:39], v50 offset:55296
v_mfma_f32_16x16x32_bf16 v[220:223], a[0:3], a[132:135], v[220:223]
buffer_load_dwordx4 a[216:219], v11, s[12:15], s76 offen offset:0
ds_read_b128 a[40:43], v50 offset:56320
v_mfma_f32_16x16x32_bf16 v[188:191], a[4:7], a[128:131], v[188:191]
ds_read_b128 a[44:47], v50 offset:57344
v_mfma_f32_16x16x32_bf16 v[224:227], a[4:7], a[132:135], v[224:227]
ds_read_b128 a[48:51], v50 offset:58368
v_mfma_f32_16x16x32_bf16 v[192:195], a[8:11], a[128:131], v[192:195]
ds_read_b128 a[52:55], v50 offset:59392
v_mfma_f32_16x16x32_bf16 v[228:231], a[8:11], a[132:135], v[228:231]
buffer_load_dwordx4 a[220:223], v26, s[12:15], s76 offen offset:0
v_mfma_f32_16x16x32_bf16 v[196:199], a[12:15], a[128:131], v[196:199]
ds_read_b128 a[56:59], v50 offset:60416
v_mfma_f32_16x16x32_bf16 v[232:235], a[12:15], a[132:135], v[232:235]
v_mfma_f32_16x16x32_bf16 v[200:203], a[16:19], a[128:131], v[200:203]
ds_read_b128 a[60:63], v50 offset:61440
v_mfma_f32_16x16x32_bf16 v[236:239], a[16:19], a[132:135], v[236:239]
buffer_load_dwordx4 v11, s[4:7], s83 offen offset:3072 lds
v_mfma_f32_16x16x32_bf16 v[204:207], a[20:23], a[128:131], v[204:207]
ds_read_b128 a[64:67], v50 offset:62464
v_mfma_f32_16x16x32_bf16 v[240:243], a[20:23], a[132:135], v[240:243]
v_mfma_f32_16x16x32_bf16 v[208:211], a[24:27], a[128:131], v[208:211]
ds_read_b128 a[68:71], v50 offset:63488
v_mfma_f32_16x16x32_bf16 v[244:247], a[24:27], a[132:135], v[244:247]
s_add_u32 m0, s30, 77824
s_add_u32 s83, s67, 4096
buffer_load_dwordx4 v11, s[4:7], s83 offen offset:0 lds
v_mfma_f32_16x16x32_bf16 v[212:215], a[28:31], a[128:131], v[212:215]
v_mfma_f32_16x16x32_bf16 v[248:251], a[28:31], a[132:135], v[248:251]
v_mfma_f32_16x16x32_bf16 v[216:219], a[32:35], a[128:131], v[216:219]
v_mfma_f32_16x16x32_bf16 v[252:255], a[32:35], a[132:135], v[252:255]
buffer_load_dwordx4 v11, s[4:7], s83 offen offset:1024 lds
s_waitcnt vmcnt(44) lgkmcnt(0)
v_mfma_f32_16x16x32_bf16 v[184:187], a[36:39], a[136:139], v[184:187]
ds_read_b128 a[0:3], v51 offset:0
v_mfma_f32_16x16x32_bf16 v[220:223], a[36:39], a[140:143], v[220:223]
ds_read_b128 a[4:7], v51 offset:1024
v_mfma_f32_16x16x32_bf16 v[188:191], a[40:43], a[136:139], v[188:191]
ds_read_b128 a[8:11], v51 offset:2048
v_mfma_f32_16x16x32_bf16 v[224:227], a[40:43], a[140:143], v[224:227]
buffer_load_dwordx4 a[128:131], v11, s[12:15], s76 offen offset:1024
ds_read_b128 a[12:15], v51 offset:3072
v_mfma_f32_16x16x32_bf16 v[192:195], a[44:47], a[136:139], v[192:195]
ds_read_b128 a[16:19], v51 offset:4096
v_mfma_f32_16x16x32_bf16 v[228:231], a[44:47], a[140:143], v[228:231]
v_mfma_f32_16x16x32_bf16 v[196:199], a[48:51], a[136:139], v[196:199]
ds_read_b128 a[20:23], v51 offset:5120
v_mfma_f32_16x16x32_bf16 v[232:235], a[48:51], a[140:143], v[232:235]
buffer_load_dwordx4 a[132:135], v26, s[12:15], s76 offen offset:1024
v_mfma_f32_16x16x32_bf16 v[200:203], a[52:55], a[136:139], v[200:203]
ds_read_b128 a[24:27], v51 offset:6144
v_mfma_f32_16x16x32_bf16 v[236:239], a[52:55], a[140:143], v[236:239]
v_mfma_f32_16x16x32_bf16 v[204:207], a[56:59], a[136:139], v[204:207]
ds_read_b128 a[28:31], v51 offset:7168
v_mfma_f32_16x16x32_bf16 v[240:243], a[56:59], a[140:143], v[240:243]
buffer_load_dwordx4 v11, s[4:7], s83 offen offset:2048 lds
v_mfma_f32_16x16x32_bf16 v[208:211], a[60:63], a[136:139], v[208:211]
ds_read_b128 a[32:35], v51 offset:8192
v_mfma_f32_16x16x32_bf16 v[244:247], a[60:63], a[140:143], v[244:247]
v_mfma_f32_16x16x32_bf16 v[212:215], a[64:67], a[136:139], v[212:215]
buffer_load_dwordx4 v11, s[4:7], s83 offen offset:3072 lds
v_mfma_f32_16x16x32_bf16 v[248:251], a[64:67], a[140:143], v[248:251]
v_mfma_f32_16x16x32_bf16 v[216:219], a[68:71], a[136:139], v[216:219]
v_mfma_f32_16x16x32_bf16 v[252:255], a[68:71], a[140:143], v[252:255]
s_waitcnt vmcnt(48) lgkmcnt(0)
v_mfma_f32_16x16x32_bf16 v[184:187], a[0:3], a[72:75], v[184:187]
ds_read_b128 a[36:39], v51 offset:9216
v_mfma_f32_16x16x32_bf16 v[220:223], a[0:3], a[76:79], v[220:223]
buffer_load_dwordx4 a[136:139], v11, s[12:15], s76 offen offset:2048
ds_read_b128 a[40:43], v51 offset:10240
v_mfma_f32_16x16x32_bf16 v[188:191], a[4:7], a[72:75], v[188:191]
ds_read_b128 a[44:47], v51 offset:11264
v_mfma_f32_16x16x32_bf16 v[224:227], a[4:7], a[76:79], v[224:227]
ds_read_b128 a[48:51], v51 offset:12288
v_mfma_f32_16x16x32_bf16 v[192:195], a[8:11], a[72:75], v[192:195]
ds_read_b128 a[52:55], v51 offset:13312
v_mfma_f32_16x16x32_bf16 v[228:231], a[8:11], a[76:79], v[228:231]
buffer_load_dwordx4 a[140:143], v26, s[12:15], s76 offen offset:2048
v_mfma_f32_16x16x32_bf16 v[196:199], a[12:15], a[72:75], v[196:199]
ds_read_b128 a[56:59], v51 offset:14336
v_mfma_f32_16x16x32_bf16 v[232:235], a[12:15], a[76:79], v[232:235]
v_mfma_f32_16x16x32_bf16 v[200:203], a[16:19], a[72:75], v[200:203]
ds_read_b128 a[60:63], v51 offset:15360
v_mfma_f32_16x16x32_bf16 v[236:239], a[16:19], a[76:79], v[236:239]
s_add_u32 m0, s30, 81920
s_add_u32 s83, s67, 8192
buffer_load_dwordx4 v11, s[4:7], s83 offen offset:0 lds
v_mfma_f32_16x16x32_bf16 v[204:207], a[20:23], a[72:75], v[204:207]
ds_read_b128 a[64:67], v51 offset:16384
v_mfma_f32_16x16x32_bf16 v[240:243], a[20:23], a[76:79], v[240:243]
v_mfma_f32_16x16x32_bf16 v[208:211], a[24:27], a[72:75], v[208:211]
ds_read_b128 a[68:71], v51 offset:17408
v_mfma_f32_16x16x32_bf16 v[244:247], a[24:27], a[76:79], v[244:247]
v_mfma_f32_16x16x32_bf16 v[212:215], a[28:31], a[72:75], v[212:215]
v_mfma_f32_16x16x32_bf16 v[248:251], a[28:31], a[76:79], v[248:251]
v_mfma_f32_16x16x32_bf16 v[216:219], a[32:35], a[72:75], v[216:219]
v_mfma_f32_16x16x32_bf16 v[252:255], a[32:35], a[76:79], v[252:255]
s_waitcnt vmcnt(34) lgkmcnt(0)
s_barrier
s_add_u32 s68, s77, 2
s_sub_u32 s33, s68, 9
s_cmp_ge_u32 s68, 9
s_cselect_b32 s68, s33, s68
s_sub_u32 s33, s68, 9
s_cmp_ge_u32 s68, 9
s_cselect_b32 s68, s33, s68
s_mul_i32 s68, s68, 36864
s_add_u32 s68, s68, s78
v_mfma_f32_16x16x32_bf16 v[184:187], a[36:39], a[80:83], v[184:187]
ds_read_b128 a[0:3], v49 offset:0
v_mfma_f32_16x16x32_bf16 v[220:223], a[36:39], a[84:87], v[220:223]
buffer_load_dwordx4 a[72:75], v11, s[12:15], s76 offen offset:3072
ds_read_b128 a[4:7], v49 offset:1024
v_mfma_f32_16x16x32_bf16 v[188:191], a[40:43], a[80:83], v[188:191]
ds_read_b128 a[8:11], v49 offset:2048
v_mfma_f32_16x16x32_bf16 v[224:227], a[40:43], a[84:87], v[224:227]
ds_read_b128 a[12:15], v49 offset:3072
v_mfma_f32_16x16x32_bf16 v[192:195], a[44:47], a[80:83], v[192:195]
ds_read_b128 a[16:19], v49 offset:4096
v_mfma_f32_16x16x32_bf16 v[228:231], a[44:47], a[84:87], v[228:231]
buffer_load_dwordx4 a[76:79], v26, s[12:15], s76 offen offset:3072
v_mfma_f32_16x16x32_bf16 v[196:199], a[48:51], a[80:83], v[196:199]
ds_read_b128 a[20:23], v49 offset:5120
v_mfma_f32_16x16x32_bf16 v[232:235], a[48:51], a[84:87], v[232:235]
v_mfma_f32_16x16x32_bf16 v[200:203], a[52:55], a[80:83], v[200:203]
ds_read_b128 a[24:27], v49 offset:6144
v_mfma_f32_16x16x32_bf16 v[236:239], a[52:55], a[84:87], v[236:239]
s_add_u32 m0, s30, 110592
s_add_u32 s83, s68, 0
buffer_load_dwordx4 v11, s[4:7], s83 offen offset:0 lds
v_mfma_f32_16x16x32_bf16 v[204:207], a[56:59], a[80:83], v[204:207]
ds_read_b128 a[28:31], v49 offset:7168
v_mfma_f32_16x16x32_bf16 v[240:243], a[56:59], a[84:87], v[240:243]
v_mfma_f32_16x16x32_bf16 v[208:211], a[60:63], a[80:83], v[208:211]
ds_read_b128 a[32:35], v49 offset:8192
v_mfma_f32_16x16x32_bf16 v[244:247], a[60:63], a[84:87], v[244:247]
buffer_load_dwordx4 v11, s[4:7], s83 offen offset:1024 lds
v_mfma_f32_16x16x32_bf16 v[212:215], a[64:67], a[80:83], v[212:215]
v_mfma_f32_16x16x32_bf16 v[248:251], a[64:67], a[84:87], v[248:251]
v_mfma_f32_16x16x32_bf16 v[216:219], a[68:71], a[80:83], v[216:219]
v_mfma_f32_16x16x32_bf16 v[252:255], a[68:71], a[84:87], v[252:255]
buffer_load_dwordx4 v11, s[4:7], s83 offen offset:2048 lds
s_add_u32 s70, s77, 2
s_sub_u32 s33, s70, 9
s_cmp_ge_u32 s70, 9
s_cselect_b32 s70, s33, s70
s_sub_u32 s33, s70, 9
s_cmp_ge_u32 s70, 9
s_cselect_b32 s70, s33, s70
s_lshl_b32 s70, s70, 12
s_add_u32 s70, s70, s28
s_waitcnt vmcnt(39) lgkmcnt(0)
v_mfma_f32_16x16x32_bf16 v[184:187], a[0:3], a[88:91], v[184:187]
ds_read_b128 a[36:39], v49 offset:9216
v_mfma_f32_16x16x32_bf16 v[220:223], a[0:3], a[92:95], v[220:223]
buffer_load_dwordx4 a[80:83], v11, s[12:15], s70 offen offset:0
ds_read_b128 a[40:43], v49 offset:10240
v_mfma_f32_16x16x32_bf16 v[188:191], a[4:7], a[88:91], v[188:191]
ds_read_b128 a[44:47], v49 offset:11264
v_mfma_f32_16x16x32_bf16 v[224:227], a[4:7], a[92:95], v[224:227]
ds_read_b128 a[48:51], v49 offset:12288
v_mfma_f32_16x16x32_bf16 v[192:195], a[8:11], a[88:91], v[192:195]
ds_read_b128 a[52:55], v49 offset:13312
v_mfma_f32_16x16x32_bf16 v[228:231], a[8:11], a[92:95], v[228:231]
buffer_load_dwordx4 a[84:87], v26, s[12:15], s70 offen offset:0
v_mfma_f32_16x16x32_bf16 v[196:199], a[12:15], a[88:91], v[196:199]
ds_read_b128 a[56:59], v49 offset:14336
v_mfma_f32_16x16x32_bf16 v[232:235], a[12:15], a[92:95], v[232:235]
v_mfma_f32_16x16x32_bf16 v[200:203], a[16:19], a[88:91], v[200:203]
ds_read_b128 a[60:63], v49 offset:15360
v_mfma_f32_16x16x32_bf16 v[236:239], a[16:19], a[92:95], v[236:239]
buffer_load_dwordx4 v11, s[4:7], s83 offen offset:3072 lds
v_mfma_f32_16x16x32_bf16 v[204:207], a[20:23], a[88:91], v[204:207]
ds_read_b128 a[64:67], v49 offset:16384
v_mfma_f32_16x16x32_bf16 v[240:243], a[20:23], a[92:95], v[240:243]
v_mfma_f32_16x16x32_bf16 v[208:211], a[24:27], a[88:91], v[208:211]
ds_read_b128 a[68:71], v49 offset:17408
v_mfma_f32_16x16x32_bf16 v[244:247], a[24:27], a[92:95], v[244:247]
s_add_u32 m0, s30, 114688
s_add_u32 s83, s68, 4096
buffer_load_dwordx4 v11, s[4:7], s83 offen offset:0 lds
v_mfma_f32_16x16x32_bf16 v[212:215], a[28:31], a[88:91], v[212:215]
v_mfma_f32_16x16x32_bf16 v[248:251], a[28:31], a[92:95], v[248:251]
v_mfma_f32_16x16x32_bf16 v[216:219], a[32:35], a[88:91], v[216:219]
v_mfma_f32_16x16x32_bf16 v[252:255], a[32:35], a[92:95], v[252:255]
buffer_load_dwordx4 v11, s[4:7], s83 offen offset:1024 lds
s_waitcnt vmcnt(44) lgkmcnt(0)
v_mfma_f32_16x16x32_bf16 v[184:187], a[36:39], a[96:99], v[184:187]
ds_read_b128 a[0:3], v49 offset:18432
v_mfma_f32_16x16x32_bf16 v[220:223], a[36:39], a[100:103], v[220:223]
ds_read_b128 a[4:7], v49 offset:19456
v_mfma_f32_16x16x32_bf16 v[188:191], a[40:43], a[96:99], v[188:191]
ds_read_b128 a[8:11], v49 offset:20480
v_mfma_f32_16x16x32_bf16 v[224:227], a[40:43], a[100:103], v[224:227]
buffer_load_dwordx4 a[88:91], v11, s[12:15], s70 offen offset:1024
ds_read_b128 a[12:15], v49 offset:21504
v_mfma_f32_16x16x32_bf16 v[192:195], a[44:47], a[96:99], v[192:195]
ds_read_b128 a[16:19], v49 offset:22528
v_mfma_f32_16x16x32_bf16 v[228:231], a[44:47], a[100:103], v[228:231]
v_mfma_f32_16x16x32_bf16 v[196:199], a[48:51], a[96:99], v[196:199]
ds_read_b128 a[20:23], v49 offset:23552
v_mfma_f32_16x16x32_bf16 v[232:235], a[48:51], a[100:103], v[232:235]
buffer_load_dwordx4 a[92:95], v26, s[12:15], s70 offen offset:1024
v_mfma_f32_16x16x32_bf16 v[200:203], a[52:55], a[96:99], v[200:203]
ds_read_b128 a[24:27], v49 offset:24576
v_mfma_f32_16x16x32_bf16 v[236:239], a[52:55], a[100:103], v[236:239]
v_mfma_f32_16x16x32_bf16 v[204:207], a[56:59], a[96:99], v[204:207]
ds_read_b128 a[28:31], v49 offset:25600
v_mfma_f32_16x16x32_bf16 v[240:243], a[56:59], a[100:103], v[240:243]
buffer_load_dwordx4 v11, s[4:7], s83 offen offset:2048 lds
v_mfma_f32_16x16x32_bf16 v[208:211], a[60:63], a[96:99], v[208:211]
ds_read_b128 a[32:35], v49 offset:26624
v_mfma_f32_16x16x32_bf16 v[244:247], a[60:63], a[100:103], v[244:247]
v_mfma_f32_16x16x32_bf16 v[212:215], a[64:67], a[96:99], v[212:215]
buffer_load_dwordx4 v11, s[4:7], s83 offen offset:3072 lds
v_mfma_f32_16x16x32_bf16 v[248:251], a[64:67], a[100:103], v[248:251]
v_mfma_f32_16x16x32_bf16 v[216:219], a[68:71], a[96:99], v[216:219]
v_mfma_f32_16x16x32_bf16 v[252:255], a[68:71], a[100:103], v[252:255]
s_waitcnt vmcnt(48) lgkmcnt(0)
v_mfma_f32_16x16x32_bf16 v[184:187], a[0:3], a[104:107], v[184:187]
ds_read_b128 a[36:39], v49 offset:27648
v_mfma_f32_16x16x32_bf16 v[220:223], a[0:3], a[108:111], v[220:223]
buffer_load_dwordx4 a[96:99], v11, s[12:15], s70 offen offset:2048
ds_read_b128 a[40:43], v49 offset:28672
v_mfma_f32_16x16x32_bf16 v[188:191], a[4:7], a[104:107], v[188:191]
ds_read_b128 a[44:47], v49 offset:29696
v_mfma_f32_16x16x32_bf16 v[224:227], a[4:7], a[108:111], v[224:227]
ds_read_b128 a[48:51], v49 offset:30720
v_mfma_f32_16x16x32_bf16 v[192:195], a[8:11], a[104:107], v[192:195]
ds_read_b128 a[52:55], v49 offset:31744
v_mfma_f32_16x16x32_bf16 v[228:231], a[8:11], a[108:111], v[228:231]
buffer_load_dwordx4 a[100:103], v26, s[12:15], s70 offen offset:2048
v_mfma_f32_16x16x32_bf16 v[196:199], a[12:15], a[104:107], v[196:199]
ds_read_b128 a[56:59], v49 offset:32768
v_mfma_f32_16x16x32_bf16 v[232:235], a[12:15], a[108:111], v[232:235]
v_mfma_f32_16x16x32_bf16 v[200:203], a[16:19], a[104:107], v[200:203]
ds_read_b128 a[60:63], v49 offset:33792
v_mfma_f32_16x16x32_bf16 v[236:239], a[16:19], a[108:111], v[236:239]
s_add_u32 m0, s30, 118784
s_add_u32 s83, s68, 8192
buffer_load_dwordx4 v11, s[4:7], s83 offen offset:0 lds
v_mfma_f32_16x16x32_bf16 v[204:207], a[20:23], a[104:107], v[204:207]
ds_read_b128 a[64:67], v49 offset:34816
v_mfma_f32_16x16x32_bf16 v[240:243], a[20:23], a[108:111], v[240:243]
v_mfma_f32_16x16x32_bf16 v[208:211], a[24:27], a[104:107], v[208:211]
ds_read_b128 a[68:71], v49 offset:35840
v_mfma_f32_16x16x32_bf16 v[244:247], a[24:27], a[108:111], v[244:247]
v_mfma_f32_16x16x32_bf16 v[212:215], a[28:31], a[104:107], v[212:215]
v_mfma_f32_16x16x32_bf16 v[248:251], a[28:31], a[108:111], v[248:251]
v_mfma_f32_16x16x32_bf16 v[216:219], a[32:35], a[104:107], v[216:219]
v_mfma_f32_16x16x32_bf16 v[252:255], a[32:35], a[108:111], v[252:255]
s_waitcnt vmcnt(34) lgkmcnt(0)
s_barrier
s_add_u32 s69, s77, 3
s_sub_u32 s33, s69, 9
s_cmp_ge_u32 s69, 9
s_cselect_b32 s69, s33, s69
s_sub_u32 s33, s69, 9
s_cmp_ge_u32 s69, 9
s_cselect_b32 s69, s33, s69
s_mul_i32 s69, s69, 36864
s_add_u32 s69, s69, s78
v_mfma_f32_16x16x32_bf16 v[184:187], a[36:39], a[112:115], v[184:187]
ds_read_b128 a[0:3], v49 offset:36864
v_mfma_f32_16x16x32_bf16 v[220:223], a[36:39], a[116:119], v[220:223]
buffer_load_dwordx4 a[104:107], v11, s[12:15], s70 offen offset:3072
ds_read_b128 a[4:7], v49 offset:37888
v_mfma_f32_16x16x32_bf16 v[188:191], a[40:43], a[112:115], v[188:191]
ds_read_b128 a[8:11], v49 offset:38912
v_mfma_f32_16x16x32_bf16 v[224:227], a[40:43], a[116:119], v[224:227]
ds_read_b128 a[12:15], v49 offset:39936
v_mfma_f32_16x16x32_bf16 v[192:195], a[44:47], a[112:115], v[192:195]
ds_read_b128 a[16:19], v49 offset:40960
v_mfma_f32_16x16x32_bf16 v[228:231], a[44:47], a[116:119], v[228:231]
buffer_load_dwordx4 a[108:111], v26, s[12:15], s70 offen offset:3072
v_mfma_f32_16x16x32_bf16 v[196:199], a[48:51], a[112:115], v[196:199]
ds_read_b128 a[20:23], v49 offset:41984
v_mfma_f32_16x16x32_bf16 v[232:235], a[48:51], a[116:119], v[232:235]
v_mfma_f32_16x16x32_bf16 v[200:203], a[52:55], a[112:115], v[200:203]
ds_read_b128 a[24:27], v49 offset:43008
v_mfma_f32_16x16x32_bf16 v[236:239], a[52:55], a[116:119], v[236:239]
s_add_u32 m0, s30, 0
s_add_u32 s83, s69, 0
buffer_load_dwordx4 v11, s[4:7], s83 offen offset:0 lds
v_mfma_f32_16x16x32_bf16 v[204:207], a[56:59], a[112:115], v[204:207]
ds_read_b128 a[28:31], v49 offset:44032
v_mfma_f32_16x16x32_bf16 v[240:243], a[56:59], a[116:119], v[240:243]
v_mfma_f32_16x16x32_bf16 v[208:211], a[60:63], a[112:115], v[208:211]
ds_read_b128 a[32:35], v49 offset:45056
v_mfma_f32_16x16x32_bf16 v[244:247], a[60:63], a[116:119], v[244:247]
buffer_load_dwordx4 v11, s[4:7], s83 offen offset:1024 lds
v_mfma_f32_16x16x32_bf16 v[212:215], a[64:67], a[112:115], v[212:215]
v_mfma_f32_16x16x32_bf16 v[248:251], a[64:67], a[116:119], v[248:251]
v_mfma_f32_16x16x32_bf16 v[216:219], a[68:71], a[112:115], v[216:219]
v_mfma_f32_16x16x32_bf16 v[252:255], a[68:71], a[116:119], v[252:255]
buffer_load_dwordx4 v11, s[4:7], s83 offen offset:2048 lds
s_add_u32 s71, s77, 3
s_sub_u32 s33, s71, 9
s_cmp_ge_u32 s71, 9
s_cselect_b32 s71, s33, s71
s_sub_u32 s33, s71, 9
s_cmp_ge_u32 s71, 9
s_cselect_b32 s71, s33, s71
s_lshl_b32 s71, s71, 12
s_add_u32 s71, s71, s28
s_nop 7
v_cvt_pk_bf16_f32 v184, v184, v185
v_cvt_pk_bf16_f32 v185, v186, v187
v_cvt_pk_bf16_f32 v186, v188, v189
v_cvt_pk_bf16_f32 v187, v190, v191
buffer_store_dwordx4 v[184:187], v11, s[16:19], s93 offen offset:0 sc1
v_cvt_pk_bf16_f32 v192, v192, v193
v_cvt_pk_bf16_f32 v193, v194, v195
v_cvt_pk_bf16_f32 v194, v196, v197
v_cvt_pk_bf16_f32 v195, v198, v199
buffer_store_dwordx4 v[192:195], v11, s[16:19], s93 offen offset:1024 sc1
v_cvt_pk_bf16_f32 v200, v200, v201
v_cvt_pk_bf16_f32 v201, v202, v203
buffer_store_dwordx4 v[200:203], v11, s[16:19], s93 offen offset:2048 sc1
v_cvt_pk_bf16_f32 v204, v204, v205
v_cvt_pk_bf16_f32 v205, v206, v207
v_cvt_pk_bf16_f32 v206, v208, v209
v_cvt_pk_bf16_f32 v207, v210, v211
buffer_store_dwordx4 v[204:207], v11, s[16:19], s93 offen offset:3072 sc1
s_add_u32 s93, s93, 4096
v_cvt_pk_bf16_f32 v212, v212, v213
v_cvt_pk_bf16_f32 v213, v214, v215
v_cvt_pk_bf16_f32 v214, v216, v217
v_cvt_pk_bf16_f32 v215, v218, v219
buffer_store_dwordx4 v[212:215], v11, s[16:19], s93 offen offset:0 sc1
v_cvt_pk_bf16_f32 v220, v220, v221
v_cvt_pk_bf16_f32 v221, v222, v223
v_cvt_pk_bf16_f32 v222, v224, v225
v_cvt_pk_bf16_f32 v223, v226, v227
buffer_store_dwordx4 v[220:223], v11, s[16:19], s93 offen offset:1024 sc1
v_cvt_pk_bf16_f32 v228, v228, v229
v_cvt_pk_bf16_f32 v229, v230, v231
v_cvt_pk_bf16_f32 v230, v232, v233
v_cvt_pk_bf16_f32 v231, v234, v235
buffer_store_dwordx4 v[228:231], v11, s[16:19], s93 offen offset:2048 sc1
v_cvt_pk_bf16_f32 v236, v236, v237
v_cvt_pk_bf16_f32 v237, v238, v239
buffer_store_dwordx4 v[236:239], v11, s[16:19], s93 offen offset:3072 sc1
s_add_u32 s93, s93, 4096
v_cvt_pk_bf16_f32 v240, v240, v241
v_cvt_pk_bf16_f32 v241, v242, v243
v_cvt_pk_bf16_f32 v242, v244, v245
v_cvt_pk_bf16_f32 v243, v246, v247
buffer_store_dwordx4 v[240:243], v11, s[16:19], s93 offen offset:0 sc1
v_cvt_pk_bf16_f32 v248, v248, v249
v_cvt_pk_bf16_f32 v249, v250, v251
v_cvt_pk_bf16_f32 v250, v252, v253
v_cvt_pk_bf16_f32 v251, v254, v255
buffer_store_dwordx4 v[248:251], v11, s[16:19], s93 offen offset:1024 sc1
s_add_u32 s93, s93, 10477568
s_nop 0
s_waitcnt vmcnt(49) lgkmcnt(0)
v_mfma_f32_16x16x32_bf16 v[184:187], a[0:3], a[120:123], 0
ds_read_b128 a[36:39], v49 offset:46080
v_mfma_f32_16x16x32_bf16 v[220:223], a[0:3], a[124:127], 0
ds_read_b128 a[40:43], v49 offset:47104
v_mfma_f32_16x16x32_bf16 v[188:191], a[4:7], a[120:123], 0
ds_read_b128 a[44:47], v49 offset:48128
v_mfma_f32_16x16x32_bf16 v[224:227], a[4:7], a[124:127], 0
buffer_load_dwordx4 a[112:115], v11, s[12:15], s71 offen offset:0
ds_read_b128 a[48:51], v49 offset:49152
v_mfma_f32_16x16x32_bf16 v[192:195], a[8:11], a[120:123], 0
ds_read_b128 a[52:55], v49 offset:50176
v_mfma_f32_16x16x32_bf16 v[228:231], a[8:11], a[124:127], 0
v_mfma_f32_16x16x32_bf16 v[196:199], a[12:15], a[120:123], 0
ds_read_b128 a[56:59], v49 offset:51200
v_mfma_f32_16x16x32_bf16 v[232:235], a[12:15], a[124:127], 0
buffer_load_dwordx4 a[116:119], v26, s[12:15], s71 offen offset:0
v_mfma_f32_16x16x32_bf16 v[200:203], a[16:19], a[120:123], 0
ds_read_b128 a[60:63], v49 offset:52224
v_mfma_f32_16x16x32_bf16 v[236:239], a[16:19], a[124:127], 0
v_mfma_f32_16x16x32_bf16 v[204:207], a[20:23], a[120:123], 0
ds_read_b128 a[64:67], v49 offset:53248
v_mfma_f32_16x16x32_bf16 v[240:243], a[20:23], a[124:127], 0
buffer_load_dwordx4 v11, s[4:7], s83 offen offset:3072 lds
v_mfma_f32_16x16x32_bf16 v[208:211], a[24:27], a[120:123], 0
ds_read_b128 a[68:71], v49 offset:54272
v_mfma_f32_16x16x32_bf16 v[244:247], a[24:27], a[124:127], 0
v_mfma_f32_16x16x32_bf16 v[212:215], a[28:31], a[120:123], 0
s_add_u32 m0, s30, 4096
s_add_u32 s83, s69, 4096
buffer_load_dwordx4 v11, s[4:7], s83 offen offset:0 lds
v_mfma_f32_16x16x32_bf16 v[248:251], a[28:31], a[124:127], 0
v_mfma_f32_16x16x32_bf16 v[216:219], a[32:35], a[120:123], 0
v_mfma_f32_16x16x32_bf16 v[252:255], a[32:35], a[124:127], 0
s_waitcnt vmcnt(53) lgkmcnt(0)
v_mfma_f32_16x16x32_bf16 v[184:187], a[36:39], a[192:195], v[184:187]
ds_read_b128 a[0:3], v49 offset:55296
v_mfma_f32_16x16x32_bf16 v[220:223], a[36:39], a[196:199], v[220:223]
buffer_load_dwordx4 a[120:123], v11, s[12:15], s71 offen offset:1024
ds_read_b128 a[4:7], v49 offset:56320
v_mfma_f32_16x16x32_bf16 v[188:191], a[40:43], a[192:195], v[188:191]
ds_read_b128 a[8:11], v49 offset:57344
v_mfma_f32_16x16x32_bf16 v[224:227], a[40:43], a[196:199], v[224:227]
ds_read_b128 a[12:15], v49 offset:58368
v_mfma_f32_16x16x32_bf16 v[192:195], a[44:47], a[192:195], v[192:195]
ds_read_b128 a[16:19], v49 offset:59392
v_mfma_f32_16x16x32_bf16 v[228:231], a[44:47], a[196:199], v[228:231]
buffer_load_dwordx4 a[124:127], v26, s[12:15], s71 offen offset:1024
v_mfma_f32_16x16x32_bf16 v[196:199], a[48:51], a[192:195], v[196:199]
ds_read_b128 a[20:23], v49 offset:60416
v_mfma_f32_16x16x32_bf16 v[232:235], a[48:51], a[196:199], v[232:235]
v_mfma_f32_16x16x32_bf16 v[200:203], a[52:55], a[192:195], v[200:203]
ds_read_b128 a[24:27], v49 offset:61440
v_mfma_f32_16x16x32_bf16 v[236:239], a[52:55], a[196:199], v[236:239]
buffer_load_dwordx4 v11, s[4:7], s83 offen offset:1024 lds
v_mfma_f32_16x16x32_bf16 v[204:207], a[56:59], a[192:195], v[204:207]
ds_read_b128 a[28:31], v49 offset:62464
v_mfma_f32_16x16x32_bf16 v[240:243], a[56:59], a[196:199], v[240:243]
v_mfma_f32_16x16x32_bf16 v[208:211], a[60:63], a[192:195], v[208:211]
ds_read_b128 a[32:35], v49 offset:63488
v_mfma_f32_16x16x32_bf16 v[244:247], a[60:63], a[196:199], v[244:247]
buffer_load_dwordx4 v11, s[4:7], s83 offen offset:2048 lds
v_mfma_f32_16x16x32_bf16 v[212:215], a[64:67], a[192:195], v[212:215]
v_mfma_f32_16x16x32_bf16 v[248:251], a[64:67], a[196:199], v[248:251]
v_mfma_f32_16x16x32_bf16 v[216:219], a[68:71], a[192:195], v[216:219]
v_mfma_f32_16x16x32_bf16 v[252:255], a[68:71], a[196:199], v[252:255]
buffer_load_dwordx4 v11, s[4:7], s83 offen offset:3072 lds
s_waitcnt vmcnt(58) lgkmcnt(0)
v_mfma_f32_16x16x32_bf16 v[184:187], a[0:3], a[200:203], v[184:187]
ds_read_b128 a[36:39], v50 offset:0
v_mfma_f32_16x16x32_bf16 v[220:223], a[0:3], a[204:207], v[220:223]
ds_read_b128 a[40:43], v50 offset:1024
v_mfma_f32_16x16x32_bf16 v[188:191], a[4:7], a[200:203], v[188:191]
ds_read_b128 a[44:47], v50 offset:2048
v_mfma_f32_16x16x32_bf16 v[224:227], a[4:7], a[204:207], v[224:227]
buffer_load_dwordx4 a[192:195], v11, s[12:15], s71 offen offset:2048
ds_read_b128 a[48:51], v50 offset:3072
v_mfma_f32_16x16x32_bf16 v[192:195], a[8:11], a[200:203], v[192:195]
ds_read_b128 a[52:55], v50 offset:4096
v_mfma_f32_16x16x32_bf16 v[228:231], a[8:11], a[204:207], v[228:231]
v_mfma_f32_16x16x32_bf16 v[196:199], a[12:15], a[200:203], v[196:199]
ds_read_b128 a[56:59], v50 offset:5120
v_mfma_f32_16x16x32_bf16 v[232:235], a[12:15], a[204:207], v[232:235]
buffer_load_dwordx4 a[196:199], v26, s[12:15], s71 offen offset:2048
v_mfma_f32_16x16x32_bf16 v[200:203], a[16:19], a[200:203], v[200:203]
ds_read_b128 a[60:63], v50 offset:6144
v_mfma_f32_16x16x32_bf16 v[236:239], a[16:19], a[204:207], v[236:239]
v_mfma_f32_16x16x32_bf16 v[204:207], a[20:23], a[200:203], v[204:207]
ds_read_b128 a[64:67], v50 offset:7168
v_mfma_f32_16x16x32_bf16 v[240:243], a[20:23], a[204:207], v[240:243]
s_add_u32 m0, s30, 8192
s_add_u32 s83, s69, 8192
buffer_load_dwordx4 v11, s[4:7], s83 offen offset:0 lds
v_mfma_f32_16x16x32_bf16 v[208:211], a[24:27], a[200:203], v[208:211]
ds_read_b128 a[68:71], v50 offset:8192
v_mfma_f32_16x16x32_bf16 v[244:247], a[24:27], a[204:207], v[244:247]
v_mfma_f32_16x16x32_bf16 v[212:215], a[28:31], a[200:203], v[212:215]
v_mfma_f32_16x16x32_bf16 v[248:251], a[28:31], a[204:207], v[248:251]
v_mfma_f32_16x16x32_bf16 v[216:219], a[32:35], a[200:203], v[216:219]
v_mfma_f32_16x16x32_bf16 v[252:255], a[32:35], a[204:207], v[252:255]
s_waitcnt vmcnt(44) lgkmcnt(0)
s_barrier
s_add_u32 s66, s77, 4
s_sub_u32 s33, s66, 9
s_cmp_ge_u32 s66, 9
s_cselect_b32 s66, s33, s66
s_sub_u32 s33, s66, 9
s_cmp_ge_u32 s66, 9
s_cselect_b32 s66, s33, s66
s_mul_i32 s66, s66, 36864
s_add_u32 s66, s66, s78
v_mfma_f32_16x16x32_bf16 v[184:187], a[36:39], a[208:211], v[184:187]
ds_read_b128 a[0:3], v50 offset:9216
v_mfma_f32_16x16x32_bf16 v[220:223], a[36:39], a[212:215], v[220:223]
buffer_load_dwordx4 a[200:203], v11, s[12:15], s71 offen offset:3072
ds_read_b128 a[4:7], v50 offset:10240
v_mfma_f32_16x16x32_bf16 v[188:191], a[40:43], a[208:211], v[188:191]
ds_read_b128 a[8:11], v50 offset:11264
v_mfma_f32_16x16x32_bf16 v[224:227], a[40:43], a[212:215], v[224:227]
ds_read_b128 a[12:15], v50 offset:12288
v_mfma_f32_16x16x32_bf16 v[192:195], a[44:47], a[208:211], v[192:195]
ds_read_b128 a[16:19], v50 offset:13312
v_mfma_f32_16x16x32_bf16 v[228:231], a[44:47], a[212:215], v[228:231]
buffer_load_dwordx4 a[204:207], v26, s[12:15], s71 offen offset:3072
v_mfma_f32_16x16x32_bf16 v[196:199], a[48:51], a[208:211], v[196:199]
ds_read_b128 a[20:23], v50 offset:14336
v_mfma_f32_16x16x32_bf16 v[232:235], a[48:51], a[212:215], v[232:235]
v_mfma_f32_16x16x32_bf16 v[200:203], a[52:55], a[208:211], v[200:203]
ds_read_b128 a[24:27], v50 offset:15360
v_mfma_f32_16x16x32_bf16 v[236:239], a[52:55], a[212:215], v[236:239]
s_add_u32 m0, s30, 36864
s_add_u32 s83, s66, 0
buffer_load_dwordx4 v11, s[4:7], s83 offen offset:0 lds
v_mfma_f32_16x16x32_bf16 v[204:207], a[56:59], a[208:211], v[204:207]
ds_read_b128 a[28:31], v50 offset:16384
v_mfma_f32_16x16x32_bf16 v[240:243], a[56:59], a[212:215], v[240:243]
v_mfma_f32_16x16x32_bf16 v[208:211], a[60:63], a[208:211], v[208:211]
ds_read_b128 a[32:35], v50 offset:17408
v_mfma_f32_16x16x32_bf16 v[244:247], a[60:63], a[212:215], v[244:247]
buffer_load_dwordx4 v11, s[4:7], s83 offen offset:1024 lds
v_mfma_f32_16x16x32_bf16 v[212:215], a[64:67], a[208:211], v[212:215]
v_mfma_f32_16x16x32_bf16 v[248:251], a[64:67], a[212:215], v[248:251]
v_mfma_f32_16x16x32_bf16 v[216:219], a[68:71], a[208:211], v[216:219]
v_mfma_f32_16x16x32_bf16 v[252:255], a[68:71], a[212:215], v[252:255]
buffer_load_dwordx4 v11, s[4:7], s83 offen offset:2048 lds
s_add_u32 s72, s77, 4
s_sub_u32 s33, s72, 9
s_cmp_ge_u32 s72, 9
s_cselect_b32 s72, s33, s72
s_sub_u32 s33, s72, 9
s_cmp_ge_u32 s72, 9
s_cselect_b32 s72, s33, s72
s_lshl_b32 s72, s72, 12
s_add_u32 s72, s72, s28
s_waitcnt vmcnt(49) lgkmcnt(0)
v_mfma_f32_16x16x32_bf16 v[184:187], a[0:3], a[216:219], v[184:187]
ds_read_b128 a[36:39], v50 offset:18432
v_mfma_f32_16x16x32_bf16 v[220:223], a[0:3], a[220:223], v[220:223]
buffer_load_dwordx4 a[208:211], v11, s[12:15], s72 offen offset:0
ds_read_b128 a[40:43], v50 offset:19456
v_mfma_f32_16x16x32_bf16 v[188:191], a[4:7], a[216:219], v[188:191]
ds_read_b128 a[44:47], v50 offset:20480
v_mfma_f32_16x16x32_bf16 v[224:227], a[4:7], a[220:223], v[224:227]
ds_read_b128 a[48:51], v50 offset:21504
v_mfma_f32_16x16x32_bf16 v[192:195], a[8:11], a[216:219], v[192:195]
ds_read_b128 a[52:55], v50 offset:22528
v_mfma_f32_16x16x32_bf16 v[228:231], a[8:11], a[220:223], v[228:231]
buffer_load_dwordx4 a[212:215], v26, s[12:15], s72 offen offset:0
v_mfma_f32_16x16x32_bf16 v[196:199], a[12:15], a[216:219], v[196:199]
ds_read_b128 a[56:59], v50 offset:23552
v_mfma_f32_16x16x32_bf16 v[232:235], a[12:15], a[220:223], v[232:235]
v_mfma_f32_16x16x32_bf16 v[200:203], a[16:19], a[216:219], v[200:203]
ds_read_b128 a[60:63], v50 offset:24576
v_mfma_f32_16x16x32_bf16 v[236:239], a[16:19], a[220:223], v[236:239]
buffer_load_dwordx4 v11, s[4:7], s83 offen offset:3072 lds
v_mfma_f32_16x16x32_bf16 v[204:207], a[20:23], a[216:219], v[204:207]
ds_read_b128 a[64:67], v50 offset:25600
v_mfma_f32_16x16x32_bf16 v[240:243], a[20:23], a[220:223], v[240:243]
v_mfma_f32_16x16x32_bf16 v[208:211], a[24:27], a[216:219], v[208:211]
ds_read_b128 a[68:71], v50 offset:26624
v_mfma_f32_16x16x32_bf16 v[244:247], a[24:27], a[220:223], v[244:247]
s_add_u32 m0, s30, 40960
s_add_u32 s83, s66, 4096
buffer_load_dwordx4 v11, s[4:7], s83 offen offset:0 lds
v_mfma_f32_16x16x32_bf16 v[212:215], a[28:31], a[216:219], v[212:215]
v_mfma_f32_16x16x32_bf16 v[248:251], a[28:31], a[220:223], v[248:251]
v_mfma_f32_16x16x32_bf16 v[216:219], a[32:35], a[216:219], v[216:219]
v_mfma_f32_16x16x32_bf16 v[252:255], a[32:35], a[220:223], v[252:255]
buffer_load_dwordx4 v11, s[4:7], s83 offen offset:1024 lds
s_waitcnt vmcnt(54) lgkmcnt(0)
v_mfma_f32_16x16x32_bf16 v[184:187], a[36:39], a[128:131], v[184:187]
ds_read_b128 a[0:3], v50 offset:27648
v_mfma_f32_16x16x32_bf16 v[220:223], a[36:39], a[132:135], v[220:223]
ds_read_b128 a[4:7], v50 offset:28672
v_mfma_f32_16x16x32_bf16 v[188:191], a[40:43], a[128:131], v[188:191]
ds_read_b128 a[8:11], v50 offset:29696
v_mfma_f32_16x16x32_bf16 v[224:227], a[40:43], a[132:135], v[224:227]
buffer_load_dwordx4 a[216:219], v11, s[12:15], s72 offen offset:1024
ds_read_b128 a[12:15], v50 offset:30720
v_mfma_f32_16x16x32_bf16 v[192:195], a[44:47], a[128:131], v[192:195]
ds_read_b128 a[16:19], v50 offset:31744
v_mfma_f32_16x16x32_bf16 v[228:231], a[44:47], a[132:135], v[228:231]
v_mfma_f32_16x16x32_bf16 v[196:199], a[48:51], a[128:131], v[196:199]
ds_read_b128 a[20:23], v50 offset:32768
v_mfma_f32_16x16x32_bf16 v[232:235], a[48:51], a[132:135], v[232:235]
buffer_load_dwordx4 a[220:223], v26, s[12:15], s72 offen offset:1024
v_mfma_f32_16x16x32_bf16 v[200:203], a[52:55], a[128:131], v[200:203]
ds_read_b128 a[24:27], v50 offset:33792
v_mfma_f32_16x16x32_bf16 v[236:239], a[52:55], a[132:135], v[236:239]
v_mfma_f32_16x16x32_bf16 v[204:207], a[56:59], a[128:131], v[204:207]
ds_read_b128 a[28:31], v50 offset:34816
v_mfma_f32_16x16x32_bf16 v[240:243], a[56:59], a[132:135], v[240:243]
buffer_load_dwordx4 v11, s[4:7], s83 offen offset:2048 lds
v_mfma_f32_16x16x32_bf16 v[208:211], a[60:63], a[128:131], v[208:211]
ds_read_b128 a[32:35], v50 offset:35840
v_mfma_f32_16x16x32_bf16 v[244:247], a[60:63], a[132:135], v[244:247]
v_mfma_f32_16x16x32_bf16 v[212:215], a[64:67], a[128:131], v[212:215]
buffer_load_dwordx4 v11, s[4:7], s83 offen offset:3072 lds
v_mfma_f32_16x16x32_bf16 v[248:251], a[64:67], a[132:135], v[248:251]
v_mfma_f32_16x16x32_bf16 v[216:219], a[68:71], a[128:131], v[216:219]
v_mfma_f32_16x16x32_bf16 v[252:255], a[68:71], a[132:135], v[252:255]
s_waitcnt vmcnt(58) lgkmcnt(0)
v_mfma_f32_16x16x32_bf16 v[184:187], a[0:3], a[136:139], v[184:187]
ds_read_b128 a[36:39], v50 offset:36864
v_mfma_f32_16x16x32_bf16 v[220:223], a[0:3], a[140:143], v[220:223]
buffer_load_dwordx4 a[128:131], v11, s[12:15], s72 offen offset:2048
ds_read_b128 a[40:43], v50 offset:37888
v_mfma_f32_16x16x32_bf16 v[188:191], a[4:7], a[136:139], v[188:191]
ds_read_b128 a[44:47], v50 offset:38912
v_mfma_f32_16x16x32_bf16 v[224:227], a[4:7], a[140:143], v[224:227]
ds_read_b128 a[48:51], v50 offset:39936
v_mfma_f32_16x16x32_bf16 v[192:195], a[8:11], a[136:139], v[192:195]
ds_read_b128 a[52:55], v50 offset:40960
v_mfma_f32_16x16x32_bf16 v[228:231], a[8:11], a[140:143], v[228:231]
buffer_load_dwordx4 a[132:135], v26, s[12:15], s72 offen offset:2048
v_mfma_f32_16x16x32_bf16 v[196:199], a[12:15], a[136:139], v[196:199]
ds_read_b128 a[56:59], v50 offset:41984
v_mfma_f32_16x16x32_bf16 v[232:235], a[12:15], a[140:143], v[232:235]
v_mfma_f32_16x16x32_bf16 v[200:203], a[16:19], a[136:139], v[200:203]
ds_read_b128 a[60:63], v50 offset:43008
v_mfma_f32_16x16x32_bf16 v[236:239], a[16:19], a[140:143], v[236:239]
s_add_u32 m0, s30, 45056
s_add_u32 s83, s66, 8192
buffer_load_dwordx4 v11, s[4:7], s83 offen offset:0 lds
v_mfma_f32_16x16x32_bf16 v[204:207], a[20:23], a[136:139], v[204:207]
ds_read_b128 a[64:67], v50 offset:44032
v_mfma_f32_16x16x32_bf16 v[240:243], a[20:23], a[140:143], v[240:243]
v_mfma_f32_16x16x32_bf16 v[208:211], a[24:27], a[136:139], v[208:211]
ds_read_b128 a[68:71], v50 offset:45056
v_mfma_f32_16x16x32_bf16 v[244:247], a[24:27], a[140:143], v[244:247]
v_mfma_f32_16x16x32_bf16 v[212:215], a[28:31], a[136:139], v[212:215]
v_mfma_f32_16x16x32_bf16 v[248:251], a[28:31], a[140:143], v[248:251]
v_mfma_f32_16x16x32_bf16 v[216:219], a[32:35], a[136:139], v[216:219]
v_mfma_f32_16x16x32_bf16 v[252:255], a[32:35], a[140:143], v[252:255]
s_waitcnt vmcnt(29) lgkmcnt(0)
s_barrier
s_add_u32 s56, s88, 0x7800000
s_addc_u32 s57, s89, 0
s_mov_b32 s58, 0x10000
s_mov_b32 s59, 0x00020000
s_mov_b32 s33, s92
s_cmp_lg_u32 s24, 0
s_cbranch_scc1 L_sig11
v_mov_b32 v12, 0
v_mov_b32 v13, 0x1
s_mov_b64 exec, 1
buffer_atomic_add v13, v12, s[56:59], s33 offen
s_mov_b64 exec, -1
L_sig11:
s_add_u32 s67, s77, 5
s_sub_u32 s33, s67, 9
s_cmp_ge_u32 s67, 9
s_cselect_b32 s67, s33, s67
s_sub_u32 s33, s67, 9
s_cmp_ge_u32 s67, 9
s_cselect_b32 s67, s33, s67
s_mul_i32 s67, s67, 36864
s_add_u32 s67, s67, s78
v_mfma_f32_16x16x32_bf16 v[184:187], a[36:39], a[72:75], v[184:187]
ds_read_b128 a[0:3], v50 offset:46080
v_mfma_f32_16x16x32_bf16 v[220:223], a[36:39], a[76:79], v[220:223]
buffer_load_dwordx4 a[136:139], v11, s[12:15], s72 offen offset:3072
ds_read_b128 a[4:7], v50 offset:47104
v_mfma_f32_16x16x32_bf16 v[188:191], a[40:43], a[72:75], v[188:191]
ds_read_b128 a[8:11], v50 offset:48128
v_mfma_f32_16x16x32_bf16 v[224:227], a[40:43], a[76:79], v[224:227]
ds_read_b128 a[12:15], v50 offset:49152
v_mfma_f32_16x16x32_bf16 v[192:195], a[44:47], a[72:75], v[192:195]
ds_read_b128 a[16:19], v50 offset:50176
v_mfma_f32_16x16x32_bf16 v[228:231], a[44:47], a[76:79], v[228:231]
buffer_load_dwordx4 a[140:143], v26, s[12:15], s72 offen offset:3072
v_mfma_f32_16x16x32_bf16 v[196:199], a[48:51], a[72:75], v[196:199]
ds_read_b128 a[20:23], v50 offset:51200
v_mfma_f32_16x16x32_bf16 v[232:235], a[48:51], a[76:79], v[232:235]
v_mfma_f32_16x16x32_bf16 v[200:203], a[52:55], a[72:75], v[200:203]
ds_read_b128 a[24:27], v50 offset:52224
v_mfma_f32_16x16x32_bf16 v[236:239], a[52:55], a[76:79], v[236:239]
s_add_u32 m0, s30, 73728
s_add_u32 s83, s67, 0
buffer_load_dwordx4 v11, s[4:7], s83 offen offset:0 lds
v_mfma_f32_16x16x32_bf16 v[204:207], a[56:59], a[72:75], v[204:207]
ds_read_b128 a[28:31], v50 offset:53248
v_mfma_f32_16x16x32_bf16 v[240:243], a[56:59], a[76:79], v[240:243]
v_mfma_f32_16x16x32_bf16 v[208:211], a[60:63], a[72:75], v[208:211]
ds_read_b128 a[32:35], v50 offset:54272
v_mfma_f32_16x16x32_bf16 v[244:247], a[60:63], a[76:79], v[244:247]
buffer_load_dwordx4 v11, s[4:7], s83 offen offset:1024 lds
v_mfma_f32_16x16x32_bf16 v[212:215], a[64:67], a[72:75], v[212:215]
v_mfma_f32_16x16x32_bf16 v[248:251], a[64:67], a[76:79], v[248:251]
v_mfma_f32_16x16x32_bf16 v[216:219], a[68:71], a[72:75], v[216:219]
v_mfma_f32_16x16x32_bf16 v[252:255], a[68:71], a[76:79], v[252:255]
buffer_load_dwordx4 v11, s[4:7], s83 offen offset:2048 lds
s_add_u32 s73, s77, 5
s_sub_u32 s33, s73, 9
s_cmp_ge_u32 s73, 9
s_cselect_b32 s73, s33, s73
s_sub_u32 s33, s73, 9
s_cmp_ge_u32 s73, 9
s_cselect_b32 s73, s33, s73
s_lshl_b32 s73, s73, 12
s_add_u32 s73, s73, s28
s_waitcnt vmcnt(34) lgkmcnt(0)
v_mfma_f32_16x16x32_bf16 v[184:187], a[0:3], a[80:83], v[184:187]
ds_read_b128 a[36:39], v50 offset:55296
v_mfma_f32_16x16x32_bf16 v[220:223], a[0:3], a[84:87], v[220:223]
buffer_load_dwordx4 a[72:75], v11, s[12:15], s73 offen offset:0
ds_read_b128 a[40:43], v50 offset:56320
v_mfma_f32_16x16x32_bf16 v[188:191], a[4:7], a[80:83], v[188:191]
ds_read_b128 a[44:47], v50 offset:57344
v_mfma_f32_16x16x32_bf16 v[224:227], a[4:7], a[84:87], v[224:227]
ds_read_b128 a[48:51], v50 offset:58368
v_mfma_f32_16x16x32_bf16 v[192:195], a[8:11], a[80:83], v[192:195]
ds_read_b128 a[52:55], v50 offset:59392
v_mfma_f32_16x16x32_bf16 v[228:231], a[8:11], a[84:87], v[228:231]
buffer_load_dwordx4 a[76:79], v26, s[12:15], s73 offen offset:0
v_mfma_f32_16x16x32_bf16 v[196:199], a[12:15], a[80:83], v[196:199]
ds_read_b128 a[56:59], v50 offset:60416
v_mfma_f32_16x16x32_bf16 v[232:235], a[12:15], a[84:87], v[232:235]
v_mfma_f32_16x16x32_bf16 v[200:203], a[16:19], a[80:83], v[200:203]
ds_read_b128 a[60:63], v50 offset:61440
v_mfma_f32_16x16x32_bf16 v[236:239], a[16:19], a[84:87], v[236:239]
buffer_load_dwordx4 v11, s[4:7], s83 offen offset:3072 lds
v_mfma_f32_16x16x32_bf16 v[204:207], a[20:23], a[80:83], v[204:207]
ds_read_b128 a[64:67], v50 offset:62464
v_mfma_f32_16x16x32_bf16 v[240:243], a[20:23], a[84:87], v[240:243]
v_mfma_f32_16x16x32_bf16 v[208:211], a[24:27], a[80:83], v[208:211]
ds_read_b128 a[68:71], v50 offset:63488
v_mfma_f32_16x16x32_bf16 v[244:247], a[24:27], a[84:87], v[244:247]
s_add_u32 m0, s30, 77824
s_add_u32 s83, s67, 4096
buffer_load_dwordx4 v11, s[4:7], s83 offen offset:0 lds
v_mfma_f32_16x16x32_bf16 v[212:215], a[28:31], a[80:83], v[212:215]
v_mfma_f32_16x16x32_bf16 v[248:251], a[28:31], a[84:87], v[248:251]
v_mfma_f32_16x16x32_bf16 v[216:219], a[32:35], a[80:83], v[216:219]
v_mfma_f32_16x16x32_bf16 v[252:255], a[32:35], a[84:87], v[252:255]
buffer_load_dwordx4 v11, s[4:7], s83 offen offset:1024 lds
s_waitcnt vmcnt(39) lgkmcnt(0)
v_mfma_f32_16x16x32_bf16 v[184:187], a[36:39], a[88:91], v[184:187]
ds_read_b128 a[0:3], v51 offset:0
v_mfma_f32_16x16x32_bf16 v[220:223], a[36:39], a[92:95], v[220:223]
ds_read_b128 a[4:7], v51 offset:1024
v_mfma_f32_16x16x32_bf16 v[188:191], a[40:43], a[88:91], v[188:191]
ds_read_b128 a[8:11], v51 offset:2048
v_mfma_f32_16x16x32_bf16 v[224:227], a[40:43], a[92:95], v[224:227]
buffer_load_dwordx4 a[80:83], v11, s[12:15], s73 offen offset:1024
ds_read_b128 a[12:15], v51 offset:3072
v_mfma_f32_16x16x32_bf16 v[192:195], a[44:47], a[88:91], v[192:195]
ds_read_b128 a[16:19], v51 offset:4096
v_mfma_f32_16x16x32_bf16 v[228:231], a[44:47], a[92:95], v[228:231]
v_mfma_f32_16x16x32_bf16 v[196:199], a[48:51], a[88:91], v[196:199]
ds_read_b128 a[20:23], v51 offset:5120
v_mfma_f32_16x16x32_bf16 v[232:235], a[48:51], a[92:95], v[232:235]
buffer_load_dwordx4 a[84:87], v26, s[12:15], s73 offen offset:1024
v_mfma_f32_16x16x32_bf16 v[200:203], a[52:55], a[88:91], v[200:203]
ds_read_b128 a[24:27], v51 offset:6144
v_mfma_f32_16x16x32_bf16 v[236:239], a[52:55], a[92:95], v[236:239]
v_mfma_f32_16x16x32_bf16 v[204:207], a[56:59], a[88:91], v[204:207]
ds_read_b128 a[28:31], v51 offset:7168
v_mfma_f32_16x16x32_bf16 v[240:243], a[56:59], a[92:95], v[240:243]
buffer_load_dwordx4 v11, s[4:7], s83 offen offset:2048 lds
v_mfma_f32_16x16x32_bf16 v[208:211], a[60:63], a[88:91], v[208:211]
ds_read_b128 a[32:35], v51 offset:8192
v_mfma_f32_16x16x32_bf16 v[244:247], a[60:63], a[92:95], v[244:247]
v_mfma_f32_16x16x32_bf16 v[212:215], a[64:67], a[88:91], v[212:215]
buffer_load_dwordx4 v11, s[4:7], s83 offen offset:3072 lds
v_mfma_f32_16x16x32_bf16 v[248:251], a[64:67], a[92:95], v[248:251]
v_mfma_f32_16x16x32_bf16 v[216:219], a[68:71], a[88:91], v[216:219]
v_mfma_f32_16x16x32_bf16 v[252:255], a[68:71], a[92:95], v[252:255]
s_waitcnt vmcnt(43) lgkmcnt(0)
v_mfma_f32_16x16x32_bf16 v[184:187], a[0:3], a[96:99], v[184:187]
ds_read_b128 a[36:39], v51 offset:9216
v_mfma_f32_16x16x32_bf16 v[220:223], a[0:3], a[100:103], v[220:223]
buffer_load_dwordx4 a[88:91], v11, s[12:15], s73 offen offset:2048
ds_read_b128 a[40:43], v51 offset:10240
v_mfma_f32_16x16x32_bf16 v[188:191], a[4:7], a[96:99], v[188:191]
ds_read_b128 a[44:47], v51 offset:11264
v_mfma_f32_16x16x32_bf16 v[224:227], a[4:7], a[100:103], v[224:227]
ds_read_b128 a[48:51], v51 offset:12288
v_mfma_f32_16x16x32_bf16 v[192:195], a[8:11], a[96:99], v[192:195]
ds_read_b128 a[52:55], v51 offset:13312
v_mfma_f32_16x16x32_bf16 v[228:231], a[8:11], a[100:103], v[228:231]
buffer_load_dwordx4 a[92:95], v26, s[12:15], s73 offen offset:2048
v_mfma_f32_16x16x32_bf16 v[196:199], a[12:15], a[96:99], v[196:199]
ds_read_b128 a[56:59], v51 offset:14336
v_mfma_f32_16x16x32_bf16 v[232:235], a[12:15], a[100:103], v[232:235]
v_mfma_f32_16x16x32_bf16 v[200:203], a[16:19], a[96:99], v[200:203]
ds_read_b128 a[60:63], v51 offset:15360
v_mfma_f32_16x16x32_bf16 v[236:239], a[16:19], a[100:103], v[236:239]
s_add_u32 m0, s30, 81920
s_add_u32 s83, s67, 8192
buffer_load_dwordx4 v11, s[4:7], s83 offen offset:0 lds
v_mfma_f32_16x16x32_bf16 v[204:207], a[20:23], a[96:99], v[204:207]
ds_read_b128 a[64:67], v51 offset:16384
v_mfma_f32_16x16x32_bf16 v[240:243], a[20:23], a[100:103], v[240:243]
v_mfma_f32_16x16x32_bf16 v[208:211], a[24:27], a[96:99], v[208:211]
ds_read_b128 a[68:71], v51 offset:17408
v_mfma_f32_16x16x32_bf16 v[244:247], a[24:27], a[100:103], v[244:247]
v_mfma_f32_16x16x32_bf16 v[212:215], a[28:31], a[96:99], v[212:215]
v_mfma_f32_16x16x32_bf16 v[248:251], a[28:31], a[100:103], v[248:251]
v_mfma_f32_16x16x32_bf16 v[216:219], a[32:35], a[96:99], v[216:219]
v_mfma_f32_16x16x32_bf16 v[252:255], a[32:35], a[100:103], v[252:255]
s_waitcnt vmcnt(34) lgkmcnt(0)
s_barrier
s_add_u32 s68, s77, 6
s_sub_u32 s33, s68, 9
s_cmp_ge_u32 s68, 9
s_cselect_b32 s68, s33, s68
s_sub_u32 s33, s68, 9
s_cmp_ge_u32 s68, 9
s_cselect_b32 s68, s33, s68
s_mul_i32 s68, s68, 36864
s_add_u32 s68, s68, s78
v_mfma_f32_16x16x32_bf16 v[184:187], a[36:39], a[104:107], v[184:187]
ds_read_b128 a[0:3], v49 offset:0
v_mfma_f32_16x16x32_bf16 v[220:223], a[36:39], a[108:111], v[220:223]
buffer_load_dwordx4 a[96:99], v11, s[12:15], s73 offen offset:3072
ds_read_b128 a[4:7], v49 offset:1024
v_mfma_f32_16x16x32_bf16 v[188:191], a[40:43], a[104:107], v[188:191]
ds_read_b128 a[8:11], v49 offset:2048
v_mfma_f32_16x16x32_bf16 v[224:227], a[40:43], a[108:111], v[224:227]
ds_read_b128 a[12:15], v49 offset:3072
v_mfma_f32_16x16x32_bf16 v[192:195], a[44:47], a[104:107], v[192:195]
ds_read_b128 a[16:19], v49 offset:4096
v_mfma_f32_16x16x32_bf16 v[228:231], a[44:47], a[108:111], v[228:231]
buffer_load_dwordx4 a[100:103], v26, s[12:15], s73 offen offset:3072
v_mfma_f32_16x16x32_bf16 v[196:199], a[48:51], a[104:107], v[196:199]
ds_read_b128 a[20:23], v49 offset:5120
v_mfma_f32_16x16x32_bf16 v[232:235], a[48:51], a[108:111], v[232:235]
v_mfma_f32_16x16x32_bf16 v[200:203], a[52:55], a[104:107], v[200:203]
ds_read_b128 a[24:27], v49 offset:6144
v_mfma_f32_16x16x32_bf16 v[236:239], a[52:55], a[108:111], v[236:239]
s_add_u32 m0, s30, 110592
s_add_u32 s83, s68, 0
buffer_load_dwordx4 v11, s[4:7], s83 offen offset:0 lds
v_mfma_f32_16x16x32_bf16 v[204:207], a[56:59], a[104:107], v[204:207]
ds_read_b128 a[28:31], v49 offset:7168
v_mfma_f32_16x16x32_bf16 v[240:243], a[56:59], a[108:111], v[240:243]
v_mfma_f32_16x16x32_bf16 v[208:211], a[60:63], a[104:107], v[208:211]
ds_read_b128 a[32:35], v49 offset:8192
v_mfma_f32_16x16x32_bf16 v[244:247], a[60:63], a[108:111], v[244:247]
buffer_load_dwordx4 v11, s[4:7], s83 offen offset:1024 lds
v_mfma_f32_16x16x32_bf16 v[212:215], a[64:67], a[104:107], v[212:215]
v_mfma_f32_16x16x32_bf16 v[248:251], a[64:67], a[108:111], v[248:251]
v_mfma_f32_16x16x32_bf16 v[216:219], a[68:71], a[104:107], v[216:219]
v_mfma_f32_16x16x32_bf16 v[252:255], a[68:71], a[108:111], v[252:255]
buffer_load_dwordx4 v11, s[4:7], s83 offen offset:2048 lds
s_add_u32 s76, s77, 6
s_sub_u32 s33, s76, 9
s_cmp_ge_u32 s76, 9
s_cselect_b32 s76, s33, s76
s_sub_u32 s33, s76, 9
s_cmp_ge_u32 s76, 9
s_cselect_b32 s76, s33, s76
s_lshl_b32 s76, s76, 12
s_add_u32 s76, s76, s28
s_waitcnt vmcnt(39) lgkmcnt(0)
v_mfma_f32_16x16x32_bf16 v[184:187], a[0:3], a[112:115], v[184:187]
ds_read_b128 a[36:39], v49 offset:9216
v_mfma_f32_16x16x32_bf16 v[220:223], a[0:3], a[116:119], v[220:223]
buffer_load_dwordx4 a[104:107], v11, s[12:15], s76 offen offset:0
ds_read_b128 a[40:43], v49 offset:10240
v_mfma_f32_16x16x32_bf16 v[188:191], a[4:7], a[112:115], v[188:191]
ds_read_b128 a[44:47], v49 offset:11264
v_mfma_f32_16x16x32_bf16 v[224:227], a[4:7], a[116:119], v[224:227]
ds_read_b128 a[48:51], v49 offset:12288
v_mfma_f32_16x16x32_bf16 v[192:195], a[8:11], a[112:115], v[192:195]
ds_read_b128 a[52:55], v49 offset:13312
v_mfma_f32_16x16x32_bf16 v[228:231], a[8:11], a[116:119], v[228:231]
buffer_load_dwordx4 a[108:111], v26, s[12:15], s76 offen offset:0
v_mfma_f32_16x16x32_bf16 v[196:199], a[12:15], a[112:115], v[196:199]
ds_read_b128 a[56:59], v49 offset:14336
v_mfma_f32_16x16x32_bf16 v[232:235], a[12:15], a[116:119], v[232:235]
v_mfma_f32_16x16x32_bf16 v[200:203], a[16:19], a[112:115], v[200:203]
ds_read_b128 a[60:63], v49 offset:15360
v_mfma_f32_16x16x32_bf16 v[236:239], a[16:19], a[116:119], v[236:239]
buffer_load_dwordx4 v11, s[4:7], s83 offen offset:3072 lds
v_mfma_f32_16x16x32_bf16 v[204:207], a[20:23], a[112:115], v[204:207]
ds_read_b128 a[64:67], v49 offset:16384
v_mfma_f32_16x16x32_bf16 v[240:243], a[20:23], a[116:119], v[240:243]
v_mfma_f32_16x16x32_bf16 v[208:211], a[24:27], a[112:115], v[208:211]
ds_read_b128 a[68:71], v49 offset:17408
v_mfma_f32_16x16x32_bf16 v[244:247], a[24:27], a[116:119], v[244:247]
s_add_u32 m0, s30, 114688
s_add_u32 s83, s68, 4096
buffer_load_dwordx4 v11, s[4:7], s83 offen offset:0 lds
v_mfma_f32_16x16x32_bf16 v[212:215], a[28:31], a[112:115], v[212:215]
v_mfma_f32_16x16x32_bf16 v[248:251], a[28:31], a[116:119], v[248:251]
v_mfma_f32_16x16x32_bf16 v[216:219], a[32:35], a[112:115], v[216:219]
v_mfma_f32_16x16x32_bf16 v[252:255], a[32:35], a[116:119], v[252:255]
buffer_load_dwordx4 v11, s[4:7], s83 offen offset:1024 lds
s_waitcnt vmcnt(44) lgkmcnt(0)
v_mfma_f32_16x16x32_bf16 v[184:187], a[36:39], a[120:123], v[184:187]
ds_read_b128 a[0:3], v49 offset:18432
v_mfma_f32_16x16x32_bf16 v[220:223], a[36:39], a[124:127], v[220:223]
ds_read_b128 a[4:7], v49 offset:19456
v_mfma_f32_16x16x32_bf16 v[188:191], a[40:43], a[120:123], v[188:191]
ds_read_b128 a[8:11], v49 offset:20480
v_mfma_f32_16x16x32_bf16 v[224:227], a[40:43], a[124:127], v[224:227]
buffer_load_dwordx4 a[112:115], v11, s[12:15], s76 offen offset:1024
ds_read_b128 a[12:15], v49 offset:21504
v_mfma_f32_16x16x32_bf16 v[192:195], a[44:47], a[120:123], v[192:195]
ds_read_b128 a[16:19], v49 offset:22528
v_mfma_f32_16x16x32_bf16 v[228:231], a[44:47], a[124:127], v[228:231]
v_mfma_f32_16x16x32_bf16 v[196:199], a[48:51], a[120:123], v[196:199]
ds_read_b128 a[20:23], v49 offset:23552
v_mfma_f32_16x16x32_bf16 v[232:235], a[48:51], a[124:127], v[232:235]
buffer_load_dwordx4 a[116:119], v26, s[12:15], s76 offen offset:1024
v_mfma_f32_16x16x32_bf16 v[200:203], a[52:55], a[120:123], v[200:203]
ds_read_b128 a[24:27], v49 offset:24576
v_mfma_f32_16x16x32_bf16 v[236:239], a[52:55], a[124:127], v[236:239]
v_mfma_f32_16x16x32_bf16 v[204:207], a[56:59], a[120:123], v[204:207]
ds_read_b128 a[28:31], v49 offset:25600
v_mfma_f32_16x16x32_bf16 v[240:243], a[56:59], a[124:127], v[240:243]
buffer_load_dwordx4 v11, s[4:7], s83 offen offset:2048 lds
v_mfma_f32_16x16x32_bf16 v[208:211], a[60:63], a[120:123], v[208:211]
ds_read_b128 a[32:35], v49 offset:26624
v_mfma_f32_16x16x32_bf16 v[244:247], a[60:63], a[124:127], v[244:247]
v_mfma_f32_16x16x32_bf16 v[212:215], a[64:67], a[120:123], v[212:215]
buffer_load_dwordx4 v11, s[4:7], s83 offen offset:3072 lds
v_mfma_f32_16x16x32_bf16 v[248:251], a[64:67], a[124:127], v[248:251]
v_mfma_f32_16x16x32_bf16 v[216:219], a[68:71], a[120:123], v[216:219]
v_mfma_f32_16x16x32_bf16 v[252:255], a[68:71], a[124:127], v[252:255]
s_waitcnt vmcnt(48) lgkmcnt(0)
v_mfma_f32_16x16x32_bf16 v[184:187], a[0:3], a[192:195], v[184:187]
ds_read_b128 a[36:39], v49 offset:27648
v_mfma_f32_16x16x32_bf16 v[220:223], a[0:3], a[196:199], v[220:223]
buffer_load_dwordx4 a[120:123], v11, s[12:15], s76 offen offset:2048
ds_read_b128 a[40:43], v49 offset:28672
v_mfma_f32_16x16x32_bf16 v[188:191], a[4:7], a[192:195], v[188:191]
ds_read_b128 a[44:47], v49 offset:29696
v_mfma_f32_16x16x32_bf16 v[224:227], a[4:7], a[196:199], v[224:227]
ds_read_b128 a[48:51], v49 offset:30720
v_mfma_f32_16x16x32_bf16 v[192:195], a[8:11], a[192:195], v[192:195]
ds_read_b128 a[52:55], v49 offset:31744
v_mfma_f32_16x16x32_bf16 v[228:231], a[8:11], a[196:199], v[228:231]
buffer_load_dwordx4 a[124:127], v26, s[12:15], s76 offen offset:2048
v_mfma_f32_16x16x32_bf16 v[196:199], a[12:15], a[192:195], v[196:199]
ds_read_b128 a[56:59], v49 offset:32768
v_mfma_f32_16x16x32_bf16 v[232:235], a[12:15], a[196:199], v[232:235]
v_mfma_f32_16x16x32_bf16 v[200:203], a[16:19], a[192:195], v[200:203]
ds_read_b128 a[60:63], v49 offset:33792
v_mfma_f32_16x16x32_bf16 v[236:239], a[16:19], a[196:199], v[236:239]
s_add_u32 m0, s30, 118784
s_add_u32 s83, s68, 8192
buffer_load_dwordx4 v11, s[4:7], s83 offen offset:0 lds
v_mfma_f32_16x16x32_bf16 v[204:207], a[20:23], a[192:195], v[204:207]
ds_read_b128 a[64:67], v49 offset:34816
v_mfma_f32_16x16x32_bf16 v[240:243], a[20:23], a[196:199], v[240:243]
v_mfma_f32_16x16x32_bf16 v[208:211], a[24:27], a[192:195], v[208:211]
ds_read_b128 a[68:71], v49 offset:35840
v_mfma_f32_16x16x32_bf16 v[244:247], a[24:27], a[196:199], v[244:247]
v_mfma_f32_16x16x32_bf16 v[212:215], a[28:31], a[192:195], v[212:215]
v_mfma_f32_16x16x32_bf16 v[248:251], a[28:31], a[196:199], v[248:251]
v_mfma_f32_16x16x32_bf16 v[216:219], a[32:35], a[192:195], v[216:219]
v_mfma_f32_16x16x32_bf16 v[252:255], a[32:35], a[196:199], v[252:255]
s_waitcnt vmcnt(34) lgkmcnt(0)
s_barrier
s_add_u32 s69, s77, 7
s_sub_u32 s33, s69, 9
s_cmp_ge_u32 s69, 9
s_cselect_b32 s69, s33, s69
s_sub_u32 s33, s69, 9
s_cmp_ge_u32 s69, 9
s_cselect_b32 s69, s33, s69
s_mul_i32 s69, s69, 36864
s_add_u32 s69, s69, s78
v_mfma_f32_16x16x32_bf16 v[184:187], a[36:39], a[200:203], v[184:187]
ds_read_b128 a[0:3], v49 offset:36864
v_mfma_f32_16x16x32_bf16 v[220:223], a[36:39], a[204:207], v[220:223]
buffer_load_dwordx4 a[192:195], v11, s[12:15], s76 offen offset:3072
ds_read_b128 a[4:7], v49 offset:37888
v_mfma_f32_16x16x32_bf16 v[188:191], a[40:43], a[200:203], v[188:191]
ds_read_b128 a[8:11], v49 offset:38912
v_mfma_f32_16x16x32_bf16 v[224:227], a[40:43], a[204:207], v[224:227]
ds_read_b128 a[12:15], v49 offset:39936
v_mfma_f32_16x16x32_bf16 v[192:195], a[44:47], a[200:203], v[192:195]
ds_read_b128 a[16:19], v49 offset:40960
v_mfma_f32_16x16x32_bf16 v[228:231], a[44:47], a[204:207], v[228:231]
buffer_load_dwordx4 a[196:199], v26, s[12:15], s76 offen offset:3072
v_mfma_f32_16x16x32_bf16 v[196:199], a[48:51], a[200:203], v[196:199]
ds_read_b128 a[20:23], v49 offset:41984
v_mfma_f32_16x16x32_bf16 v[232:235], a[48:51], a[204:207], v[232:235]
v_mfma_f32_16x16x32_bf16 v[200:203], a[52:55], a[200:203], v[200:203]
ds_read_b128 a[24:27], v49 offset:43008
v_mfma_f32_16x16x32_bf16 v[236:239], a[52:55], a[204:207], v[236:239]
s_add_u32 m0, s30, 0
s_add_u32 s83, s69, 0
buffer_load_dwordx4 v11, s[4:7], s83 offen offset:0 lds
v_mfma_f32_16x16x32_bf16 v[204:207], a[56:59], a[200:203], v[204:207]
ds_read_b128 a[28:31], v49 offset:44032
v_mfma_f32_16x16x32_bf16 v[240:243], a[56:59], a[204:207], v[240:243]
v_mfma_f32_16x16x32_bf16 v[208:211], a[60:63], a[200:203], v[208:211]
ds_read_b128 a[32:35], v49 offset:45056
v_mfma_f32_16x16x32_bf16 v[244:247], a[60:63], a[204:207], v[244:247]
buffer_load_dwordx4 v11, s[4:7], s83 offen offset:1024 lds
v_mfma_f32_16x16x32_bf16 v[212:215], a[64:67], a[200:203], v[212:215]
v_mfma_f32_16x16x32_bf16 v[248:251], a[64:67], a[204:207], v[248:251]
v_mfma_f32_16x16x32_bf16 v[216:219], a[68:71], a[200:203], v[216:219]
v_mfma_f32_16x16x32_bf16 v[252:255], a[68:71], a[204:207], v[252:255]
buffer_load_dwordx4 v11, s[4:7], s83 offen offset:2048 lds
s_add_u32 s70, s77, 7
s_sub_u32 s33, s70, 9
s_cmp_ge_u32 s70, 9
s_cselect_b32 s70, s33, s70
s_sub_u32 s33, s70, 9
s_cmp_ge_u32 s70, 9
s_cselect_b32 s70, s33, s70
s_lshl_b32 s70, s70, 12
s_add_u32 s70, s70, s28
s_waitcnt vmcnt(39) lgkmcnt(0)
v_mfma_f32_16x16x32_bf16 v[184:187], a[0:3], a[208:211], v[184:187]
ds_read_b128 a[36:39], v49 offset:46080
v_mfma_f32_16x16x32_bf16 v[220:223], a[0:3], a[212:215], v[220:223]
buffer_load_dwordx4 a[200:203], v11, s[12:15], s70 offen offset:0
ds_read_b128 a[40:43], v49 offset:47104
v_mfma_f32_16x16x32_bf16 v[188:191], a[4:7], a[208:211], v[188:191]
ds_read_b128 a[44:47], v49 offset:48128
v_mfma_f32_16x16x32_bf16 v[224:227], a[4:7], a[212:215], v[224:227]
ds_read_b128 a[48:51], v49 offset:49152
v_mfma_f32_16x16x32_bf16 v[192:195], a[8:11], a[208:211], v[192:195]
ds_read_b128 a[52:55], v49 offset:50176
v_mfma_f32_16x16x32_bf16 v[228:231], a[8:11], a[212:215], v[228:231]
buffer_load_dwordx4 a[204:207], v26, s[12:15], s70 offen offset:0
v_mfma_f32_16x16x32_bf16 v[196:199], a[12:15], a[208:211], v[196:199]
ds_read_b128 a[56:59], v49 offset:51200
v_mfma_f32_16x16x32_bf16 v[232:235], a[12:15], a[212:215], v[232:235]
v_mfma_f32_16x16x32_bf16 v[200:203], a[16:19], a[208:211], v[200:203]
ds_read_b128 a[60:63], v49 offset:52224
v_mfma_f32_16x16x32_bf16 v[236:239], a[16:19], a[212:215], v[236:239]
buffer_load_dwordx4 v11, s[4:7], s83 offen offset:3072 lds
v_mfma_f32_16x16x32_bf16 v[204:207], a[20:23], a[208:211], v[204:207]
ds_read_b128 a[64:67], v49 offset:53248
v_mfma_f32_16x16x32_bf16 v[240:243], a[20:23], a[212:215], v[240:243]
v_mfma_f32_16x16x32_bf16 v[208:211], a[24:27], a[208:211], v[208:211]
ds_read_b128 a[68:71], v49 offset:54272
v_mfma_f32_16x16x32_bf16 v[244:247], a[24:27], a[212:215], v[244:247]
s_add_u32 m0, s30, 4096
s_add_u32 s83, s69, 4096
buffer_load_dwordx4 v11, s[4:7], s83 offen offset:0 lds
v_mfma_f32_16x16x32_bf16 v[212:215], a[28:31], a[208:211], v[212:215]
v_mfma_f32_16x16x32_bf16 v[248:251], a[28:31], a[212:215], v[248:251]
v_mfma_f32_16x16x32_bf16 v[216:219], a[32:35], a[208:211], v[216:219]
v_mfma_f32_16x16x32_bf16 v[252:255], a[32:35], a[212:215], v[252:255]
buffer_load_dwordx4 v11, s[4:7], s83 offen offset:1024 lds
s_waitcnt vmcnt(44) lgkmcnt(0)
v_mfma_f32_16x16x32_bf16 v[184:187], a[36:39], a[216:219], v[184:187]
ds_read_b128 a[0:3], v49 offset:55296
v_mfma_f32_16x16x32_bf16 v[220:223], a[36:39], a[220:223], v[220:223]
ds_read_b128 a[4:7], v49 offset:56320
v_mfma_f32_16x16x32_bf16 v[188:191], a[40:43], a[216:219], v[188:191]
ds_read_b128 a[8:11], v49 offset:57344
v_mfma_f32_16x16x32_bf16 v[224:227], a[40:43], a[220:223], v[224:227]
buffer_load_dwordx4 a[208:211], v11, s[12:15], s70 offen offset:1024
ds_read_b128 a[12:15], v49 offset:58368
v_mfma_f32_16x16x32_bf16 v[192:195], a[44:47], a[216:219], v[192:195]
ds_read_b128 a[16:19], v49 offset:59392
v_mfma_f32_16x16x32_bf16 v[228:231], a[44:47], a[220:223], v[228:231]
v_mfma_f32_16x16x32_bf16 v[196:199], a[48:51], a[216:219], v[196:199]
ds_read_b128 a[20:23], v49 offset:60416
v_mfma_f32_16x16x32_bf16 v[232:235], a[48:51], a[220:223], v[232:235]
buffer_load_dwordx4 a[212:215], v26, s[12:15], s70 offen offset:1024
v_mfma_f32_16x16x32_bf16 v[200:203], a[52:55], a[216:219], v[200:203]
ds_read_b128 a[24:27], v49 offset:61440
v_mfma_f32_16x16x32_bf16 v[236:239], a[52:55], a[220:223], v[236:239]
v_mfma_f32_16x16x32_bf16 v[204:207], a[56:59], a[216:219], v[204:207]
ds_read_b128 a[28:31], v49 offset:62464
v_mfma_f32_16x16x32_bf16 v[240:243], a[56:59], a[220:223], v[240:243]
buffer_load_dwordx4 v11, s[4:7], s83 offen offset:2048 lds
v_mfma_f32_16x16x32_bf16 v[208:211], a[60:63], a[216:219], v[208:211]
ds_read_b128 a[32:35], v49 offset:63488
v_mfma_f32_16x16x32_bf16 v[244:247], a[60:63], a[220:223], v[244:247]
v_mfma_f32_16x16x32_bf16 v[212:215], a[64:67], a[216:219], v[212:215]
buffer_load_dwordx4 v11, s[4:7], s83 offen offset:3072 lds
v_mfma_f32_16x16x32_bf16 v[248:251], a[64:67], a[220:223], v[248:251]
v_mfma_f32_16x16x32_bf16 v[216:219], a[68:71], a[216:219], v[216:219]
v_mfma_f32_16x16x32_bf16 v[252:255], a[68:71], a[220:223], v[252:255]
s_waitcnt vmcnt(48) lgkmcnt(0)
v_mfma_f32_16x16x32_bf16 v[184:187], a[0:3], a[128:131], v[184:187]
ds_read_b128 a[36:39], v50 offset:0
v_mfma_f32_16x16x32_bf16 v[220:223], a[0:3], a[132:135], v[220:223]
buffer_load_dwordx4 a[216:219], v11, s[12:15], s70 offen offset:2048
ds_read_b128 a[40:43], v50 offset:1024
v_mfma_f32_16x16x32_bf16 v[188:191], a[4:7], a[128:131], v[188:191]
ds_read_b128 a[44:47], v50 offset:2048
v_mfma_f32_16x16x32_bf16 v[224:227], a[4:7], a[132:135], v[224:227]
ds_read_b128 a[48:51], v50 offset:3072
v_mfma_f32_16x16x32_bf16 v[192:195], a[8:11], a[128:131], v[192:195]
ds_read_b128 a[52:55], v50 offset:4096
v_mfma_f32_16x16x32_bf16 v[228:231], a[8:11], a[132:135], v[228:231]
buffer_load_dwordx4 a[220:223], v26, s[12:15], s70 offen offset:2048
v_mfma_f32_16x16x32_bf16 v[196:199], a[12:15], a[128:131], v[196:199]
ds_read_b128 a[56:59], v50 offset:5120
v_mfma_f32_16x16x32_bf16 v[232:235], a[12:15], a[132:135], v[232:235]
v_mfma_f32_16x16x32_bf16 v[200:203], a[16:19], a[128:131], v[200:203]
ds_read_b128 a[60:63], v50 offset:6144
v_mfma_f32_16x16x32_bf16 v[236:239], a[16:19], a[132:135], v[236:239]
s_add_u32 m0, s30, 8192
s_add_u32 s83, s69, 8192
buffer_load_dwordx4 v11, s[4:7], s83 offen offset:0 lds
v_mfma_f32_16x16x32_bf16 v[204:207], a[20:23], a[128:131], v[204:207]
ds_read_b128 a[64:67], v50 offset:7168
v_mfma_f32_16x16x32_bf16 v[240:243], a[20:23], a[132:135], v[240:243]
v_mfma_f32_16x16x32_bf16 v[208:211], a[24:27], a[128:131], v[208:211]
ds_read_b128 a[68:71], v50 offset:8192
v_mfma_f32_16x16x32_bf16 v[244:247], a[24:27], a[132:135], v[244:247]
v_mfma_f32_16x16x32_bf16 v[212:215], a[28:31], a[128:131], v[212:215]
v_mfma_f32_16x16x32_bf16 v[248:251], a[28:31], a[132:135], v[248:251]
v_mfma_f32_16x16x32_bf16 v[216:219], a[32:35], a[128:131], v[216:219]
v_mfma_f32_16x16x32_bf16 v[252:255], a[32:35], a[132:135], v[252:255]
s_waitcnt vmcnt(34) lgkmcnt(0)
s_barrier
s_add_u32 s66, s77, 8
s_sub_u32 s33, s66, 9
s_cmp_ge_u32 s66, 9
s_cselect_b32 s66, s33, s66
s_sub_u32 s33, s66, 9
s_cmp_ge_u32 s66, 9
s_cselect_b32 s66, s33, s66
s_mul_i32 s66, s66, 36864
s_add_u32 s66, s66, s78
v_cmp_eq_u32 vcc, 0, v0
s_nop 1
s_mov_b64 s[42:43], vcc
s_cmp_eq_u32 s24, 0
s_cselect_b64 vcc, s[42:43], 0
v_mov_b32 v12, 0x7fff0000
v_lshlrev_b32 v13, 2, v0
v_cndmask_b32 v62, v12, v13, vcc
v_mfma_f32_16x16x32_bf16 v[184:187], a[36:39], a[136:139], v[184:187]
ds_read_b128 a[0:3], v50 offset:9216
v_mfma_f32_16x16x32_bf16 v[220:223], a[36:39], a[140:143], v[220:223]
buffer_load_dword v61, v62, s[56:59], s92 offen sc1
ds_read_b128 a[4:7], v50 offset:10240
v_mfma_f32_16x16x32_bf16 v[188:191], a[40:43], a[136:139], v[188:191]
ds_read_b128 a[8:11], v50 offset:11264
v_mfma_f32_16x16x32_bf16 v[224:227], a[40:43], a[140:143], v[224:227]
ds_read_b128 a[12:15], v50 offset:12288
v_mfma_f32_16x16x32_bf16 v[192:195], a[44:47], a[136:139], v[192:195]
ds_read_b128 a[16:19], v50 offset:13312
v_mfma_f32_16x16x32_bf16 v[228:231], a[44:47], a[140:143], v[228:231]
buffer_load_dwordx4 a[128:131], v11, s[12:15], s70 offen offset:3072
v_mfma_f32_16x16x32_bf16 v[196:199], a[48:51], a[136:139], v[196:199]
ds_read_b128 a[20:23], v50 offset:14336
v_mfma_f32_16x16x32_bf16 v[232:235], a[48:51], a[140:143], v[232:235]
v_mfma_f32_16x16x32_bf16 v[200:203], a[52:55], a[136:139], v[200:203]
ds_read_b128 a[24:27], v50 offset:15360
v_mfma_f32_16x16x32_bf16 v[236:239], a[52:55], a[140:143], v[236:239]
buffer_load_dwordx4 a[132:135], v26, s[12:15], s70 offen offset:3072
v_mfma_f32_16x16x32_bf16 v[204:207], a[56:59], a[136:139], v[204:207]
ds_read_b128 a[28:31], v50 offset:16384
v_mfma_f32_16x16x32_bf16 v[240:243], a[56:59], a[140:143], v[240:243]
v_mfma_f32_16x16x32_bf16 v[208:211], a[60:63], a[136:139], v[208:211]
ds_read_b128 a[32:35], v50 offset:17408
v_mfma_f32_16x16x32_bf16 v[244:247], a[60:63], a[140:143], v[244:247]
s_add_u32 m0, s30, 36864
s_add_u32 s83, s66, 0
buffer_load_dwordx4 v11, s[4:7], s83 offen offset:0 lds
v_mfma_f32_16x16x32_bf16 v[212:215], a[64:67], a[136:139], v[212:215]
v_mfma_f32_16x16x32_bf16 v[248:251], a[64:67], a[140:143], v[248:251]
v_mfma_f32_16x16x32_bf16 v[216:219], a[68:71], a[136:139], v[216:219]
v_mfma_f32_16x16x32_bf16 v[252:255], a[68:71], a[140:143], v[252:255]
buffer_load_dwordx4 v11, s[4:7], s83 offen offset:1024 lds
s_add_u32 s71, s77, 8
s_sub_u32 s33, s71, 9
s_cmp_ge_u32 s71, 9
s_cselect_b32 s71, s33, s71
s_sub_u32 s33, s71, 9
s_cmp_ge_u32 s71, 9
s_cselect_b32 s71, s33, s71
s_lshl_b32 s71, s71, 12
s_add_u32 s71, s71, s28
s_waitcnt vmcnt(39) lgkmcnt(0)
v_mfma_f32_16x16x32_bf16 v[184:187], a[0:3], a[72:75], v[184:187]
ds_read_b128 a[36:39], v50 offset:18432
v_mfma_f32_16x16x32_bf16 v[220:223], a[0:3], a[76:79], v[220:223]
buffer_load_dwordx4 a[136:139], v11, s[12:15], s71 offen offset:0
ds_read_b128 a[40:43], v50 offset:19456
v_mfma_f32_16x16x32_bf16 v[188:191], a[4:7], a[72:75], v[188:191]
ds_read_b128 a[44:47], v50 offset:20480
v_mfma_f32_16x16x32_bf16 v[224:227], a[4:7], a[76:79], v[224:227]
ds_read_b128 a[48:51], v50 offset:21504
v_mfma_f32_16x16x32_bf16 v[192:195], a[8:11], a[72:75], v[192:195]
ds_read_b128 a[52:55], v50 offset:22528
v_mfma_f32_16x16x32_bf16 v[228:231], a[8:11], a[76:79], v[228:231]
buffer_load_dwordx4 a[140:143], v26, s[12:15], s71 offen offset:0
v_mfma_f32_16x16x32_bf16 v[196:199], a[12:15], a[72:75], v[196:199]
ds_read_b128 a[56:59], v50 offset:23552
v_mfma_f32_16x16x32_bf16 v[232:235], a[12:15], a[76:79], v[232:235]
v_mfma_f32_16x16x32_bf16 v[200:203], a[16:19], a[72:75], v[200:203]
ds_read_b128 a[60:63], v50 offset:24576
v_mfma_f32_16x16x32_bf16 v[236:239], a[16:19], a[76:79], v[236:239]
buffer_load_dwordx4 v11, s[4:7], s83 offen offset:2048 lds
v_mfma_f32_16x16x32_bf16 v[204:207], a[20:23], a[72:75], v[204:207]
ds_read_b128 a[64:67], v50 offset:25600
v_mfma_f32_16x16x32_bf16 v[240:243], a[20:23], a[76:79], v[240:243]
v_mfma_f32_16x16x32_bf16 v[208:211], a[24:27], a[72:75], v[208:211]
ds_read_b128 a[68:71], v50 offset:26624
v_mfma_f32_16x16x32_bf16 v[244:247], a[24:27], a[76:79], v[244:247]
buffer_load_dwordx4 v11, s[4:7], s83 offen offset:3072 lds
v_mfma_f32_16x16x32_bf16 v[212:215], a[28:31], a[72:75], v[212:215]
v_mfma_f32_16x16x32_bf16 v[248:251], a[28:31], a[76:79], v[248:251]
v_mfma_f32_16x16x32_bf16 v[216:219], a[32:35], a[72:75], v[216:219]
v_mfma_f32_16x16x32_bf16 v[252:255], a[32:35], a[76:79], v[252:255]
s_add_u32 m0, s30, 40960
s_add_u32 s83, s66, 4096
buffer_load_dwordx4 v11, s[4:7], s83 offen offset:0 lds
s_waitcnt vmcnt(44) lgkmcnt(0)
v_mfma_f32_16x16x32_bf16 v[184:187], a[36:39], a[80:83], v[184:187]
ds_read_b128 a[0:3], v50 offset:27648
v_mfma_f32_16x16x32_bf16 v[220:223], a[36:39], a[84:87], v[220:223]
ds_read_b128 a[4:7], v50 offset:28672
v_mfma_f32_16x16x32_bf16 v[188:191], a[40:43], a[80:83], v[188:191]
ds_read_b128 a[8:11], v50 offset:29696
v_mfma_f32_16x16x32_bf16 v[224:227], a[40:43], a[84:87], v[224:227]
buffer_load_dwordx4 a[72:75], v11, s[12:15], s71 offen offset:1024
ds_read_b128 a[12:15], v50 offset:30720
v_mfma_f32_16x16x32_bf16 v[192:195], a[44:47], a[80:83], v[192:195]
ds_read_b128 a[16:19], v50 offset:31744
v_mfma_f32_16x16x32_bf16 v[228:231], a[44:47], a[84:87], v[228:231]
v_mfma_f32_16x16x32_bf16 v[196:199], a[48:51], a[80:83], v[196:199]
ds_read_b128 a[20:23], v50 offset:32768
v_mfma_f32_16x16x32_bf16 v[232:235], a[48:51], a[84:87], v[232:235]
buffer_load_dwordx4 a[76:79], v26, s[12:15], s71 offen offset:1024
v_mfma_f32_16x16x32_bf16 v[200:203], a[52:55], a[80:83], v[200:203]
ds_read_b128 a[24:27], v50 offset:33792
v_mfma_f32_16x16x32_bf16 v[236:239], a[52:55], a[84:87], v[236:239]
v_mfma_f32_16x16x32_bf16 v[204:207], a[56:59], a[80:83], v[204:207]
ds_read_b128 a[28:31], v50 offset:34816
v_mfma_f32_16x16x32_bf16 v[240:243], a[56:59], a[84:87], v[240:243]
buffer_load_dwordx4 v11, s[4:7], s83 offen offset:1024 lds
v_mfma_f32_16x16x32_bf16 v[208:211], a[60:63], a[80:83], v[208:211]
ds_read_b128 a[32:35], v50 offset:35840
v_mfma_f32_16x16x32_bf16 v[244:247], a[60:63], a[84:87], v[244:247]
v_mfma_f32_16x16x32_bf16 v[212:215], a[64:67], a[80:83], v[212:215]
buffer_load_dwordx4 v11, s[4:7], s83 offen offset:2048 lds
v_mfma_f32_16x16x32_bf16 v[248:251], a[64:67], a[84:87], v[248:251]
v_mfma_f32_16x16x32_bf16 v[216:219], a[68:71], a[80:83], v[216:219]
v_mfma_f32_16x16x32_bf16 v[252:255], a[68:71], a[84:87], v[252:255]
s_waitcnt vmcnt(48) lgkmcnt(0)
s_cmp_lg_u32 s24, 0
s_cbranch_scc1 L_poll12_ok
s_waitcnt vmcnt(13)
s_mov_b32 s35, 400000
L_poll12:
v_bfe_u32 v12, v61, 0, 8
v_cmp_gt_u32 vcc, 4, v12
s_nop 1
s_and_b64 vcc, vcc, s[42:43]
s_cmp_eq_u64 vcc, 0
s_cbranch_scc1 L_poll12_ok
s_sleep 2
buffer_load_dword v61, v62, s[56:59], s92 offen sc1
s_waitcnt vmcnt(0)
s_sub_u32 s35, s35, 1
s_cmp_lg_u32 s35, 0
s_cbranch_scc1 L_poll12
L_poll12_ok:
v_mfma_f32_16x16x32_bf16 v[184:187], a[0:3], a[88:91], v[184:187]
ds_read_b128 a[36:39], v50 offset:36864
v_mfma_f32_16x16x32_bf16 v[220:223], a[0:3], a[92:95], v[220:223]
buffer_load_dwordx4 a[80:83], v11, s[12:15], s71 offen offset:2048
ds_read_b128 a[40:43], v50 offset:37888
v_mfma_f32_16x16x32_bf16 v[188:191], a[4:7], a[88:91], v[188:191]
ds_read_b128 a[44:47], v50 offset:38912
v_mfma_f32_16x16x32_bf16 v[224:227], a[4:7], a[92:95], v[224:227]
ds_read_b128 a[48:51], v50 offset:39936
v_mfma_f32_16x16x32_bf16 v[192:195], a[8:11], a[88:91], v[192:195]
ds_read_b128 a[52:55], v50 offset:40960
v_mfma_f32_16x16x32_bf16 v[228:231], a[8:11], a[92:95], v[228:231]
buffer_load_dwordx4 a[84:87], v26, s[12:15], s71 offen offset:2048
v_mfma_f32_16x16x32_bf16 v[196:199], a[12:15], a[88:91], v[196:199]
ds_read_b128 a[56:59], v50 offset:41984
v_mfma_f32_16x16x32_bf16 v[232:235], a[12:15], a[92:95], v[232:235]
v_mfma_f32_16x16x32_bf16 v[200:203], a[16:19], a[88:91], v[200:203]
ds_read_b128 a[60:63], v50 offset:43008
v_mfma_f32_16x16x32_bf16 v[236:239], a[16:19], a[92:95], v[236:239]
buffer_load_dwordx4 v11, s[4:7], s83 offen offset:3072 lds
v_mfma_f32_16x16x32_bf16 v[204:207], a[20:23], a[88:91], v[204:207]
ds_read_b128 a[64:67], v50 offset:44032
v_mfma_f32_16x16x32_bf16 v[240:243], a[20:23], a[92:95], v[240:243]
v_mfma_f32_16x16x32_bf16 v[208:211], a[24:27], a[88:91], v[208:211]
ds_read_b128 a[68:71], v50 offset:45056
v_mfma_f32_16x16x32_bf16 v[244:247], a[24:27], a[92:95], v[244:247]
s_add_u32 m0, s30, 45056
s_add_u32 s83, s66, 8192
buffer_load_dwordx4 v11, s[4:7], s83 offen offset:0 lds
v_mfma_f32_16x16x32_bf16 v[212:215], a[28:31], a[88:91], v[212:215]
v_mfma_f32_16x16x32_bf16 v[248:251], a[28:31], a[92:95], v[248:251]
v_mfma_f32_16x16x32_bf16 v[216:219], a[32:35], a[88:91], v[216:219]
v_mfma_f32_16x16x32_bf16 v[252:255], a[32:35], a[92:95], v[252:255]
s_waitcnt vmcnt(17) lgkmcnt(0)
s_barrier
v_mfma_f32_16x16x32_bf16 v[184:187], a[36:39], a[96:99], v[184:187]
ds_read_b128 a[0:3], v50 offset:46080
v_mfma_f32_16x16x32_bf16 v[220:223], a[36:39], a[100:103], v[220:223]
buffer_load_dwordx4 a[88:91], v11, s[12:15], s71 offen offset:3072
ds_read_b128 a[4:7], v50 offset:47104
v_mfma_f32_16x16x32_bf16 v[188:191], a[40:43], a[96:99], v[188:191]
ds_read_b128 a[8:11], v50 offset:48128
v_mfma_f32_16x16x32_bf16 v[224:227], a[40:43], a[100:103], v[224:227]
ds_read_b128 a[12:15], v50 offset:49152
v_mfma_f32_16x16x32_bf16 v[192:195], a[44:47], a[96:99], v[192:195]
ds_read_b128 a[16:19], v50 offset:50176
v_mfma_f32_16x16x32_bf16 v[228:231], a[44:47], a[100:103], v[228:231]
buffer_load_dwordx4 a[92:95], v26, s[12:15], s71 offen offset:3072
v_mfma_f32_16x16x32_bf16 v[196:199], a[48:51], a[96:99], v[196:199]
ds_read_b128 a[20:23], v50 offset:51200
v_mfma_f32_16x16x32_bf16 v[232:235], a[48:51], a[100:103], v[232:235]
v_mfma_f32_16x16x32_bf16 v[200:203], a[52:55], a[96:99], v[200:203]
ds_read_b128 a[24:27], v50 offset:52224
v_mfma_f32_16x16x32_bf16 v[236:239], a[52:55], a[100:103], v[236:239]
s_add_u32 s82, s94, 0
buffer_load_dwordx4 v[128:131], v11, s[16:19], s82 offen offset:0
v_mfma_f32_16x16x32_bf16 v[204:207], a[56:59], a[96:99], v[204:207]
ds_read_b128 a[28:31], v50 offset:53248
v_mfma_f32_16x16x32_bf16 v[240:243], a[56:59], a[100:103], v[240:243]
v_mfma_f32_16x16x32_bf16 v[208:211], a[60:63], a[96:99], v[208:211]
ds_read_b128 a[32:35], v50 offset:54272
v_mfma_f32_16x16x32_bf16 v[244:247], a[60:63], a[100:103], v[244:247]
s_add_u32 s82, s94, 0
buffer_load_dwordx4 v[132:135], v11, s[16:19], s82 offen offset:1024
v_mfma_f32_16x16x32_bf16 v[212:215], a[64:67], a[96:99], v[212:215]
v_mfma_f32_16x16x32_bf16 v[248:251], a[64:67], a[100:103], v[248:251]
v_mfma_f32_16x16x32_bf16 v[216:219], a[68:71], a[96:99], v[216:219]
v_mfma_f32_16x16x32_bf16 v[252:255], a[68:71], a[100:103], v[252:255]
s_add_u32 s82, s91, 0
buffer_load_dwordx4 v[136:139], v11, s[16:19], s82 offen offset:0
s_waitcnt vmcnt(22) lgkmcnt(0)
v_mfma_f32_16x16x32_bf16 v[184:187], a[0:3], a[104:107], v[184:187]
ds_read_b128 a[36:39], v50 offset:55296
v_mfma_f32_16x16x32_bf16 v[220:223], a[0:3], a[108:111], v[220:223]
ds_read_b128 a[40:43], v50 offset:56320
v_mfma_f32_16x16x32_bf16 v[188:191], a[4:7], a[104:107], v[188:191]
ds_read_b128 a[44:47], v50 offset:57344
v_mfma_f32_16x16x32_bf16 v[224:227], a[4:7], a[108:111], v[224:227]
s_add_u32 s82, s94, 10240
buffer_load_dwordx4 v[140:143], v11, s[16:19], s82 offen offset:0
ds_read_b128 a[48:51], v50 offset:58368
v_mfma_f32_16x16x32_bf16 v[192:195], a[8:11], a[104:107], v[192:195]
ds_read_b128 a[52:55], v50 offset:59392
v_mfma_f32_16x16x32_bf16 v[228:231], a[8:11], a[108:111], v[228:231]
v_mfma_f32_16x16x32_bf16 v[196:199], a[12:15], a[104:107], v[196:199]
ds_read_b128 a[56:59], v50 offset:60416
v_mfma_f32_16x16x32_bf16 v[232:235], a[12:15], a[108:111], v[232:235]
s_add_u32 s82, s94, 10240
buffer_load_dwordx4 v[144:147], v11, s[16:19], s82 offen offset:1024
v_mfma_f32_16x16x32_bf16 v[200:203], a[16:19], a[104:107], v[200:203]
ds_read_b128 a[60:63], v50 offset:61440
v_mfma_f32_16x16x32_bf16 v[236:239], a[16:19], a[108:111], v[236:239]
v_mfma_f32_16x16x32_bf16 v[204:207], a[20:23], a[104:107], v[204:207]
ds_read_b128 a[64:67], v50 offset:62464
v_mfma_f32_16x16x32_bf16 v[240:243], a[20:23], a[108:111], v[240:243]
s_add_u32 s82, s91, 10240
buffer_load_dwordx4 v[148:151], v11, s[16:19], s82 offen offset:0
v_mfma_f32_16x16x32_bf16 v[208:211], a[24:27], a[104:107], v[208:211]
ds_read_b128 a[68:71], v50 offset:63488
v_mfma_f32_16x16x32_bf16 v[244:247], a[24:27], a[108:111], v[244:247]
v_mfma_f32_16x16x32_bf16 v[212:215], a[28:31], a[104:107], v[212:215]
s_add_u32 s82, s94, 20480
buffer_load_dwordx4 v[152:155], v11, s[16:19], s82 offen offset:0
v_mfma_f32_16x16x32_bf16 v[248:251], a[28:31], a[108:111], v[248:251]
v_mfma_f32_16x16x32_bf16 v[216:219], a[32:35], a[104:107], v[216:219]
v_mfma_f32_16x16x32_bf16 v[252:255], a[32:35], a[108:111], v[252:255]
s_waitcnt vmcnt(26) lgkmcnt(0)
v_mfma_f32_16x16x32_bf16 v[184:187], a[36:39], a[112:115], v[184:187]
ds_read_b128 a[0:3], v51 offset:0
v_mfma_f32_16x16x32_bf16 v[220:223], a[36:39], a[116:119], v[220:223]
s_add_u32 s82, s94, 20480
buffer_load_dwordx4 v[156:159], v11, s[16:19], s82 offen offset:1024
ds_read_b128 a[4:7], v51 offset:1024
v_mfma_f32_16x16x32_bf16 v[188:191], a[40:43], a[112:115], v[188:191]
ds_read_b128 a[8:11], v51 offset:2048
v_mfma_f32_16x16x32_bf16 v[224:227], a[40:43], a[116:119], v[224:227]
ds_read_b128 a[12:15], v51 offset:3072
v_mfma_f32_16x16x32_bf16 v[192:195], a[44:47], a[112:115], v[192:195]
ds_read_b128 a[16:19], v51 offset:4096
v_mfma_f32_16x16x32_bf16 v[228:231], a[44:47], a[116:119], v[228:231]
s_add_u32 s82, s91, 20480
buffer_load_dwordx4 v[160:163], v11, s[16:19], s82 offen offset:0
v_mfma_f32_16x16x32_bf16 v[196:199], a[48:51], a[112:115], v[196:199]
ds_read_b128 a[20:23], v51 offset:5120
v_mfma_f32_16x16x32_bf16 v[232:235], a[48:51], a[116:119], v[232:235]
v_mfma_f32_16x16x32_bf16 v[200:203], a[52:55], a[112:115], v[200:203]
ds_read_b128 a[24:27], v51 offset:6144
v_mfma_f32_16x16x32_bf16 v[236:239], a[52:55], a[116:119], v[236:239]
s_add_u32 s82, s94, 30720
buffer_load_dwordx4 v[164:167], v11, s[16:19], s82 offen offset:0
v_mfma_f32_16x16x32_bf16 v[204:207], a[56:59], a[112:115], v[204:207]
ds_read_b128 a[28:31], v51 offset:7168
v_mfma_f32_16x16x32_bf16 v[240:243], a[56:59], a[116:119], v[240:243]
v_mfma_f32_16x16x32_bf16 v[208:211], a[60:63], a[112:115], v[208:211]
ds_read_b128 a[32:35], v51 offset:8192
v_mfma_f32_16x16x32_bf16 v[244:247], a[60:63], a[116:119], v[244:247]
s_add_u32 s82, s94, 30720
buffer_load_dwordx4 v[168:171], v11, s[16:19], s82 offen offset:1024
v_mfma_f32_16x16x32_bf16 v[212:215], a[64:67], a[112:115], v[212:215]
v_mfma_f32_16x16x32_bf16 v[248:251], a[64:67], a[116:119], v[248:251]
v_mfma_f32_16x16x32_bf16 v[216:219], a[68:71], a[112:115], v[216:219]
v_mfma_f32_16x16x32_bf16 v[252:255], a[68:71], a[116:119], v[252:255]
s_add_u32 s82, s91, 30720
buffer_load_dwordx4 v[172:175], v11, s[16:19], s82 offen offset:0
s_waitcnt vmcnt(31) lgkmcnt(0)
v_mfma_f32_16x16x32_bf16 v[184:187], a[0:3], a[120:123], v[184:187]
ds_read_b128 a[36:39], v51 offset:9216
v_mfma_f32_16x16x32_bf16 v[220:223], a[0:3], a[124:127], v[220:223]
ds_read_b128 a[40:43], v51 offset:10240
v_mfma_f32_16x16x32_bf16 v[188:191], a[4:7], a[120:123], v[188:191]
ds_read_b128 a[44:47], v51 offset:11264
v_mfma_f32_16x16x32_bf16 v[224:227], a[4:7], a[124:127], v[224:227]
ds_read_b128 a[48:51], v51 offset:12288
v_mfma_f32_16x16x32_bf16 v[192:195], a[8:11], a[120:123], v[192:195]
ds_read_b128 a[52:55], v51 offset:13312
v_mfma_f32_16x16x32_bf16 v[228:231], a[8:11], a[124:127], v[228:231]
v_mfma_f32_16x16x32_bf16 v[196:199], a[12:15], a[120:123], v[196:199]
ds_read_b128 a[56:59], v51 offset:14336
v_mfma_f32_16x16x32_bf16 v[232:235], a[12:15], a[124:127], v[232:235]
v_mfma_f32_16x16x32_bf16 v[200:203], a[16:19], a[120:123], v[200:203]
ds_read_b128 a[60:63], v51 offset:15360
v_mfma_f32_16x16x32_bf16 v[236:239], a[16:19], a[124:127], v[236:239]
v_mfma_f32_16x16x32_bf16 v[204:207], a[20:23], a[120:123], v[204:207]
ds_read_b128 a[64:67], v51 offset:16384
v_mfma_f32_16x16x32_bf16 v[240:243], a[20:23], a[124:127], v[240:243]
v_mfma_f32_16x16x32_bf16 v[208:211], a[24:27], a[120:123], v[208:211]
ds_read_b128 a[68:71], v51 offset:17408
v_mfma_f32_16x16x32_bf16 v[244:247], a[24:27], a[124:127], v[244:247]
v_mfma_f32_16x16x32_bf16 v[212:215], a[28:31], a[120:123], v[212:215]
v_mfma_f32_16x16x32_bf16 v[248:251], a[28:31], a[124:127], v[248:251]
v_mfma_f32_16x16x32_bf16 v[216:219], a[32:35], a[120:123], v[216:219]
v_mfma_f32_16x16x32_bf16 v[252:255], a[32:35], a[124:127], v[252:255]
s_waitcnt vmcnt(31) lgkmcnt(0)
s_barrier
v_mfma_f32_16x16x32_bf16 v[184:187], a[36:39], a[192:195], v[184:187]
ds_read_b128 a[0:3], v49 offset:0
v_mfma_f32_16x16x32_bf16 v[220:223], a[36:39], a[196:199], v[220:223]
ds_read_b128 a[4:7], v49 offset:1024
v_mfma_f32_16x16x32_bf16 v[188:191], a[40:43], a[192:195], v[188:191]
ds_read_b128 a[8:11], v49 offset:2048
v_mfma_f32_16x16x32_bf16 v[224:227], a[40:43], a[196:199], v[224:227]
ds_read_b128 a[12:15], v49 offset:3072
v_mfma_f32_16x16x32_bf16 v[192:195], a[44:47], a[192:195], v[192:195]
ds_read_b128 a[16:19], v49 offset:4096
v_mfma_f32_16x16x32_bf16 v[228:231], a[44:47], a[196:199], v[228:231]
v_mfma_f32_16x16x32_bf16 v[196:199], a[48:51], a[192:195], v[196:199]
ds_read_b128 a[20:23], v49 offset:5120
v_mfma_f32_16x16x32_bf16 v[232:235], a[48:51], a[196:199], v[232:235]
v_mfma_f32_16x16x32_bf16 v[200:203], a[52:55], a[192:195], v[200:203]
ds_read_b128 a[24:27], v49 offset:6144
v_mfma_f32_16x16x32_bf16 v[236:239], a[52:55], a[196:199], v[236:239]
v_mfma_f32_16x16x32_bf16 v[204:207], a[56:59], a[192:195], v[204:207]
ds_read_b128 a[28:31], v49 offset:7168
v_mfma_f32_16x16x32_bf16 v[240:243], a[56:59], a[196:199], v[240:243]
v_mfma_f32_16x16x32_bf16 v[208:211], a[60:63], a[192:195], v[208:211]
ds_read_b128 a[32:35], v49 offset:8192
v_mfma_f32_16x16x32_bf16 v[244:247], a[60:63], a[196:199], v[244:247]
v_mfma_f32_16x16x32_bf16 v[212:215], a[64:67], a[192:195], v[212:215]
v_mfma_f32_16x16x32_bf16 v[248:251], a[64:67], a[196:199], v[248:251]
v_mfma_f32_16x16x32_bf16 v[216:219], a[68:71], a[192:195], v[216:219]
v_mfma_f32_16x16x32_bf16 v[252:255], a[68:71], a[196:199], v[252:255]
s_waitcnt vmcnt(31) lgkmcnt(0)
v_mfma_f32_16x16x32_bf16 v[184:187], a[0:3], a[200:203], v[184:187]
ds_read_b128 a[36:39], v49 offset:9216
v_mfma_f32_16x16x32_bf16 v[220:223], a[0:3], a[204:207], v[220:223]
ds_read_b128 a[40:43], v49 offset:10240
v_mfma_f32_16x16x32_bf16 v[188:191], a[4:7], a[200:203], v[188:191]
ds_read_b128 a[44:47], v49 offset:11264
v_mfma_f32_16x16x32_bf16 v[224:227], a[4:7], a[204:207], v[224:227]
ds_read_b128 a[48:51], v49 offset:12288
v_mfma_f32_16x16x32_bf16 v[192:195], a[8:11], a[200:203], v[192:195]
ds_read_b128 a[52:55], v49 offset:13312
v_mfma_f32_16x16x32_bf16 v[228:231], a[8:11], a[204:207], v[228:231]
v_mfma_f32_16x16x32_bf16 v[196:199], a[12:15], a[200:203], v[196:199]
ds_read_b128 a[56:59], v49 offset:14336
v_mfma_f32_16x16x32_bf16 v[232:235], a[12:15], a[204:207], v[232:235]
v_mfma_f32_16x16x32_bf16 v[200:203], a[16:19], a[200:203], v[200:203]
ds_read_b128 a[60:63], v49 offset:15360
v_mfma_f32_16x16x32_bf16 v[236:239], a[16:19], a[204:207], v[236:239]
v_mfma_f32_16x16x32_bf16 v[204:207], a[20:23], a[200:203], v[204:207]
ds_read_b128 a[64:67], v49 offset:16384
v_mfma_f32_16x16x32_bf16 v[240:243], a[20:23], a[204:207], v[240:243]
v_mfma_f32_16x16x32_bf16 v[208:211], a[24:27], a[200:203], v[208:211]
ds_read_b128 a[68:71], v49 offset:17408
v_mfma_f32_16x16x32_bf16 v[244:247], a[24:27], a[204:207], v[244:247]
v_mfma_f32_16x16x32_bf16 v[212:215], a[28:31], a[200:203], v[212:215]
v_mfma_f32_16x16x32_bf16 v[248:251], a[28:31], a[204:207], v[248:251]
v_mfma_f32_16x16x32_bf16 v[216:219], a[32:35], a[200:203], v[216:219]
v_mfma_f32_16x16x32_bf16 v[252:255], a[32:35], a[204:207], v[252:255]
s_waitcnt vmcnt(31) lgkmcnt(0)
v_mfma_f32_16x16x32_bf16 v[184:187], a[36:39], a[208:211], v[184:187]
ds_read_b128 a[0:3], v49 offset:18432
v_mfma_f32_16x16x32_bf16 v[220:223], a[36:39], a[212:215], v[220:223]
ds_read_b128 a[4:7], v49 offset:19456
v_mfma_f32_16x16x32_bf16 v[188:191], a[40:43], a[208:211], v[188:191]
ds_read_b128 a[8:11], v49 offset:20480
v_mfma_f32_16x16x32_bf16 v[224:227], a[40:43], a[212:215], v[224:227]
ds_read_b128 a[12:15], v49 offset:21504
v_mfma_f32_16x16x32_bf16 v[192:195], a[44:47], a[208:211], v[192:195]
ds_read_b128 a[16:19], v49 offset:22528
v_mfma_f32_16x16x32_bf16 v[228:231], a[44:47], a[212:215], v[228:231]
v_mfma_f32_16x16x32_bf16 v[196:199], a[48:51], a[208:211], v[196:199]
ds_read_b128 a[20:23], v49 offset:23552
v_mfma_f32_16x16x32_bf16 v[232:235], a[48:51], a[212:215], v[232:235]
v_mfma_f32_16x16x32_bf16 v[200:203], a[52:55], a[208:211], v[200:203]
ds_read_b128 a[24:27], v49 offset:24576
v_mfma_f32_16x16x32_bf16 v[236:239], a[52:55], a[212:215], v[236:239]
v_mfma_f32_16x16x32_bf16 v[204:207], a[56:59], a[208:211], v[204:207]
ds_read_b128 a[28:31], v49 offset:25600
v_mfma_f32_16x16x32_bf16 v[240:243], a[56:59], a[212:215], v[240:243]
v_mfma_f32_16x16x32_bf16 v[208:211], a[60:63], a[208:211], v[208:211]
ds_read_b128 a[32:35], v49 offset:26624
v_mfma_f32_16x16x32_bf16 v[244:247], a[60:63], a[212:215], v[244:247]
v_mfma_f32_16x16x32_bf16 v[212:215], a[64:67], a[208:211], v[212:215]
v_mfma_f32_16x16x32_bf16 v[248:251], a[64:67], a[212:215], v[248:251]
v_mfma_f32_16x16x32_bf16 v[216:219], a[68:71], a[208:211], v[216:219]
v_mfma_f32_16x16x32_bf16 v[252:255], a[68:71], a[212:215], v[252:255]
s_waitcnt vmcnt(31) lgkmcnt(0)
v_mfma_f32_16x16x32_bf16 v[184:187], a[0:3], a[216:219], v[184:187]
ds_read_b128 a[36:39], v49 offset:27648
v_mfma_f32_16x16x32_bf16 v[220:223], a[0:3], a[220:223], v[220:223]
ds_read_b128 a[40:43], v49 offset:28672
v_mfma_f32_16x16x32_bf16 v[188:191], a[4:7], a[216:219], v[188:191]
ds_read_b128 a[44:47], v49 offset:29696
v_mfma_f32_16x16x32_bf16 v[224:227], a[4:7], a[220:223], v[224:227]
ds_read_b128 a[48:51], v49 offset:30720
v_mfma_f32_16x16x32_bf16 v[192:195], a[8:11], a[216:219], v[192:195]
ds_read_b128 a[52:55], v49 offset:31744
v_mfma_f32_16x16x32_bf16 v[228:231], a[8:11], a[220:223], v[228:231]
v_mfma_f32_16x16x32_bf16 v[196:199], a[12:15], a[216:219], v[196:199]
ds_read_b128 a[56:59], v49 offset:32768
v_mfma_f32_16x16x32_bf16 v[232:235], a[12:15], a[220:223], v[232:235]
v_mfma_f32_16x16x32_bf16 v[200:203], a[16:19], a[216:219], v[200:203]
ds_read_b128 a[60:63], v49 offset:33792
v_mfma_f32_16x16x32_bf16 v[236:239], a[16:19], a[220:223], v[236:239]
v_mfma_f32_16x16x32_bf16 v[204:207], a[20:23], a[216:219], v[204:207]
ds_read_b128 a[64:67], v49 offset:34816
v_mfma_f32_16x16x32_bf16 v[240:243], a[20:23], a[220:223], v[240:243]
v_mfma_f32_16x16x32_bf16 v[208:211], a[24:27], a[216:219], v[208:211]
ds_read_b128 a[68:71], v49 offset:35840
v_mfma_f32_16x16x32_bf16 v[244:247], a[24:27], a[220:223], v[244:247]
v_mfma_f32_16x16x32_bf16 v[212:215], a[28:31], a[216:219], v[212:215]
v_mfma_f32_16x16x32_bf16 v[248:251], a[28:31], a[220:223], v[248:251]
v_mfma_f32_16x16x32_bf16 v[216:219], a[32:35], a[216:219], v[216:219]
v_mfma_f32_16x16x32_bf16 v[252:255], a[32:35], a[220:223], v[252:255]
s_waitcnt vmcnt(14) lgkmcnt(0)
s_barrier
v_mfma_f32_16x16x32_bf16 v[184:187], a[36:39], a[128:131], v[184:187]
ds_read_b128 a[0:3], v49 offset:36864
v_mfma_f32_16x16x32_bf16 v[220:223], a[36:39], a[132:135], v[220:223]
ds_read_b128 a[4:7], v49 offset:37888
v_mfma_f32_16x16x32_bf16 v[188:191], a[40:43], a[128:131], v[188:191]
ds_read_b128 a[8:11], v49 offset:38912
v_mfma_f32_16x16x32_bf16 v[224:227], a[40:43], a[132:135], v[224:227]
ds_read_b128 a[12:15], v49 offset:39936
v_mfma_f32_16x16x32_bf16 v[192:195], a[44:47], a[128:131], v[192:195]
ds_read_b128 a[16:19], v49 offset:40960
v_mfma_f32_16x16x32_bf16 v[228:231], a[44:47], a[132:135], v[228:231]
v_mfma_f32_16x16x32_bf16 v[196:199], a[48:51], a[128:131], v[196:199]
ds_read_b128 a[20:23], v49 offset:41984
v_mfma_f32_16x16x32_bf16 v[232:235], a[48:51], a[132:135], v[232:235]
v_mfma_f32_16x16x32_bf16 v[200:203], a[52:55], a[128:131], v[200:203]
ds_read_b128 a[24:27], v49 offset:43008
v_mfma_f32_16x16x32_bf16 v[236:239], a[52:55], a[132:135], v[236:239]
v_mfma_f32_16x16x32_bf16 v[204:207], a[56:59], a[128:131], v[204:207]
ds_read_b128 a[28:31], v49 offset:44032
v_mfma_f32_16x16x32_bf16 v[240:243], a[56:59], a[132:135], v[240:243]
v_mfma_f32_16x16x32_bf16 v[208:211], a[60:63], a[128:131], v[208:211]
ds_read_b128 a[32:35], v49 offset:45056
v_mfma_f32_16x16x32_bf16 v[244:247], a[60:63], a[132:135], v[244:247]
v_mfma_f32_16x16x32_bf16 v[212:215], a[64:67], a[128:131], v[212:215]
v_mfma_f32_16x16x32_bf16 v[248:251], a[64:67], a[132:135], v[248:251]
v_mfma_f32_16x16x32_bf16 v[216:219], a[68:71], a[128:131], v[216:219]
v_mfma_f32_16x16x32_bf16 v[252:255], a[68:71], a[132:135], v[252:255]
s_waitcnt vmcnt(14) lgkmcnt(0)
v_mfma_f32_16x16x32_bf16 v[184:187], a[0:3], a[136:139], v[184:187]
ds_read_b128 a[36:39], v49 offset:46080
v_mfma_f32_16x16x32_bf16 v[220:223], a[0:3], a[140:143], v[220:223]
ds_read_b128 a[40:43], v49 offset:47104
v_mfma_f32_16x16x32_bf16 v[188:191], a[4:7], a[136:139], v[188:191]
ds_read_b128 a[44:47], v49 offset:48128
v_mfma_f32_16x16x32_bf16 v[224:227], a[4:7], a[140:143], v[224:227]
ds_read_b128 a[48:51], v49 offset:49152
v_mfma_f32_16x16x32_bf16 v[192:195], a[8:11], a[136:139], v[192:195]
ds_read_b128 a[52:55], v49 offset:50176
v_mfma_f32_16x16x32_bf16 v[228:231], a[8:11], a[140:143], v[228:231]
v_mfma_f32_16x16x32_bf16 v[196:199], a[12:15], a[136:139], v[196:199]
ds_read_b128 a[56:59], v49 offset:51200
v_mfma_f32_16x16x32_bf16 v[232:235], a[12:15], a[140:143], v[232:235]
v_mfma_f32_16x16x32_bf16 v[200:203], a[16:19], a[136:139], v[200:203]
ds_read_b128 a[60:63], v49 offset:52224
v_mfma_f32_16x16x32_bf16 v[236:239], a[16:19], a[140:143], v[236:239]
v_mfma_f32_16x16x32_bf16 v[204:207], a[20:23], a[136:139], v[204:207]
ds_read_b128 a[64:67], v49 offset:53248
v_mfma_f32_16x16x32_bf16 v[240:243], a[20:23], a[140:143], v[240:243]
v_mfma_f32_16x16x32_bf16 v[208:211], a[24:27], a[136:139], v[208:211]
ds_read_b128 a[68:71], v49 offset:54272
v_mfma_f32_16x16x32_bf16 v[244:247], a[24:27], a[140:143], v[244:247]
v_mfma_f32_16x16x32_bf16 v[212:215], a[28:31], a[136:139], v[212:215]
v_mfma_f32_16x16x32_bf16 v[248:251], a[28:31], a[140:143], v[248:251]
v_mfma_f32_16x16x32_bf16 v[216:219], a[32:35], a[136:139], v[216:219]
v_mfma_f32_16x16x32_bf16 v[252:255], a[32:35], a[140:143], v[252:255]
s_waitcnt vmcnt(14) lgkmcnt(0)
v_mfma_f32_16x16x32_bf16 v[184:187], a[36:39], a[72:75], v[184:187]
ds_read_b128 a[0:3], v49 offset:55296
v_mfma_f32_16x16x32_bf16 v[220:223], a[36:39], a[76:79], v[220:223]
ds_read_b128 a[4:7], v49 offset:56320
v_mfma_f32_16x16x32_bf16 v[188:191], a[40:43], a[72:75], v[188:191]
ds_read_b128 a[8:11], v49 offset:57344
v_mfma_f32_16x16x32_bf16 v[224:227], a[40:43], a[76:79], v[224:227]
ds_read_b128 a[12:15], v49 offset:58368
v_mfma_f32_16x16x32_bf16 v[192:195], a[44:47], a[72:75], v[192:195]
ds_read_b128 a[16:19], v49 offset:59392
v_mfma_f32_16x16x32_bf16 v[228:231], a[44:47], a[76:79], v[228:231]
v_mfma_f32_16x16x32_bf16 v[196:199], a[48:51], a[72:75], v[196:199]
ds_read_b128 a[20:23], v49 offset:60416
v_mfma_f32_16x16x32_bf16 v[232:235], a[48:51], a[76:79], v[232:235]
v_mfma_f32_16x16x32_bf16 v[200:203], a[52:55], a[72:75], v[200:203]
ds_read_b128 a[24:27], v49 offset:61440
v_mfma_f32_16x16x32_bf16 v[236:239], a[52:55], a[76:79], v[236:239]
v_mfma_f32_16x16x32_bf16 v[204:207], a[56:59], a[72:75], v[204:207]
ds_read_b128 a[28:31], v49 offset:62464
v_mfma_f32_16x16x32_bf16 v[240:243], a[56:59], a[76:79], v[240:243]
v_mfma_f32_16x16x32_bf16 v[208:211], a[60:63], a[72:75], v[208:211]
ds_read_b128 a[32:35], v49 offset:63488
v_mfma_f32_16x16x32_bf16 v[244:247], a[60:63], a[76:79], v[244:247]
v_mfma_f32_16x16x32_bf16 v[212:215], a[64:67], a[72:75], v[212:215]
v_mfma_f32_16x16x32_bf16 v[248:251], a[64:67], a[76:79], v[248:251]
v_mfma_f32_16x16x32_bf16 v[216:219], a[68:71], a[72:75], v[216:219]
v_mfma_f32_16x16x32_bf16 v[252:255], a[68:71], a[76:79], v[252:255]
s_waitcnt vmcnt(14) lgkmcnt(0)
v_mfma_f32_16x16x32_bf16 v[184:187], a[0:3], a[80:83], v[184:187]
ds_read_b128 a[36:39], v50 offset:0
v_mfma_f32_16x16x32_bf16 v[220:223], a[0:3], a[84:87], v[220:223]
ds_read_b128 a[40:43], v50 offset:1024
v_mfma_f32_16x16x32_bf16 v[188:191], a[4:7], a[80:83], v[188:191]
ds_read_b128 a[44:47], v50 offset:2048
v_mfma_f32_16x16x32_bf16 v[224:227], a[4:7], a[84:87], v[224:227]
ds_read_b128 a[48:51], v50 offset:3072
v_mfma_f32_16x16x32_bf16 v[192:195], a[8:11], a[80:83], v[192:195]
ds_read_b128 a[52:55], v50 offset:4096
v_mfma_f32_16x16x32_bf16 v[228:231], a[8:11], a[84:87], v[228:231]
v_mfma_f32_16x16x32_bf16 v[196:199], a[12:15], a[80:83], v[196:199]
ds_read_b128 a[56:59], v50 offset:5120
v_mfma_f32_16x16x32_bf16 v[232:235], a[12:15], a[84:87], v[232:235]
v_mfma_f32_16x16x32_bf16 v[200:203], a[16:19], a[80:83], v[200:203]
ds_read_b128 a[60:63], v50 offset:6144
v_mfma_f32_16x16x32_bf16 v[236:239], a[16:19], a[84:87], v[236:239]
v_mfma_f32_16x16x32_bf16 v[204:207], a[20:23], a[80:83], v[204:207]
ds_read_b128 a[64:67], v50 offset:7168
v_mfma_f32_16x16x32_bf16 v[240:243], a[20:23], a[84:87], v[240:243]
v_mfma_f32_16x16x32_bf16 v[208:211], a[24:27], a[80:83], v[208:211]
ds_read_b128 a[68:71], v50 offset:8192
v_mfma_f32_16x16x32_bf16 v[244:247], a[24:27], a[84:87], v[244:247]
v_mfma_f32_16x16x32_bf16 v[212:215], a[28:31], a[80:83], v[212:215]
v_mfma_f32_16x16x32_bf16 v[248:251], a[28:31], a[84:87], v[248:251]
v_mfma_f32_16x16x32_bf16 v[216:219], a[32:35], a[80:83], v[216:219]
v_mfma_f32_16x16x32_bf16 v[252:255], a[32:35], a[84:87], v[252:255]
s_waitcnt vmcnt(12) lgkmcnt(0)
v_mfma_f32_16x16x32_bf16 v[184:187], a[36:39], a[88:91], v[184:187]
v_mfma_f32_16x16x32_bf16 v[220:223], a[36:39], a[92:95], v[220:223]
v_mfma_f32_16x16x32_bf16 v[188:191], a[40:43], a[88:91], v[188:191]
v_mfma_f32_16x16x32_bf16 v[224:227], a[40:43], a[92:95], v[224:227]
v_mfma_f32_16x16x32_bf16 v[192:195], a[44:47], a[88:91], v[192:195]
v_mfma_f32_16x16x32_bf16 v[228:231], a[44:47], a[92:95], v[228:231]
v_mfma_f32_16x16x32_bf16 v[196:199], a[48:51], a[88:91], v[196:199]
v_mfma_f32_16x16x32_bf16 v[232:235], a[48:51], a[92:95], v[232:235]
v_mfma_f32_16x16x32_bf16 v[200:203], a[52:55], a[88:91], v[200:203]
v_mfma_f32_16x16x32_bf16 v[236:239], a[52:55], a[92:95], v[236:239]
v_mfma_f32_16x16x32_bf16 v[204:207], a[56:59], a[88:91], v[204:207]
v_mfma_f32_16x16x32_bf16 v[240:243], a[56:59], a[92:95], v[240:243]
v_mfma_f32_16x16x32_bf16 v[208:211], a[60:63], a[88:91], v[208:211]
v_mfma_f32_16x16x32_bf16 v[244:247], a[60:63], a[92:95], v[244:247]
v_mfma_f32_16x16x32_bf16 v[212:215], a[64:67], a[88:91], v[212:215]
v_mfma_f32_16x16x32_bf16 v[248:251], a[64:67], a[92:95], v[248:251]
v_mfma_f32_16x16x32_bf16 v[216:219], a[68:71], a[88:91], v[216:219]
v_mfma_f32_16x16x32_bf16 v[252:255], a[68:71], a[92:95], v[252:255]
s_nop 7
s_barrier
s_cmp_eq_u32 s24, s54
s_cbranch_scc1 L_own
v_cvt_pk_bf16_f32 v184, v184, v185
v_cvt_pk_bf16_f32 v185, v186, v187
v_cvt_pk_bf16_f32 v186, v188, v189
v_cvt_pk_bf16_f32 v187, v190, v191
buffer_store_dwordx4 v[184:187], v11, s[16:19], s93 offen offset:0 sc1
v_cvt_pk_bf16_f32 v192, v192, v193
v_cvt_pk_bf16_f32 v193, v194, v195
v_cvt_pk_bf16_f32 v194, v196, v197
v_cvt_pk_bf16_f32 v195, v198, v199
buffer_store_dwordx4 v[192:195], v11, s[16:19], s93 offen offset:1024 sc1
v_cvt_pk_bf16_f32 v200, v200, v201
v_cvt_pk_bf16_f32 v201, v202, v203
buffer_store_dwordx4 v[200:203], v11, s[16:19], s93 offen offset:2048 sc1
v_cvt_pk_bf16_f32 v204, v204, v205
v_cvt_pk_bf16_f32 v205, v206, v207
v_cvt_pk_bf16_f32 v206, v208, v209
v_cvt_pk_bf16_f32 v207, v210, v211
buffer_store_dwordx4 v[204:207], v11, s[16:19], s93 offen offset:3072 sc1
s_add_u32 s93, s93, 4096
v_cvt_pk_bf16_f32 v212, v212, v213
v_cvt_pk_bf16_f32 v213, v214, v215
v_cvt_pk_bf16_f32 v214, v216, v217
v_cvt_pk_bf16_f32 v215, v218, v219
buffer_store_dwordx4 v[212:215], v11, s[16:19], s93 offen offset:0 sc1
v_cvt_pk_bf16_f32 v220, v220, v221
v_cvt_pk_bf16_f32 v221, v222, v223
v_cvt_pk_bf16_f32 v222, v224, v225
v_cvt_pk_bf16_f32 v223, v226, v227
buffer_store_dwordx4 v[220:223], v11, s[16:19], s93 offen offset:1024 sc1
v_cvt_pk_bf16_f32 v228, v228, v229
v_cvt_pk_bf16_f32 v229, v230, v231
v_cvt_pk_bf16_f32 v230, v232, v233
v_cvt_pk_bf16_f32 v231, v234, v235
buffer_store_dwordx4 v[228:231], v11, s[16:19], s93 offen offset:2048 sc1
v_cvt_pk_bf16_f32 v236, v236, v237
v_cvt_pk_bf16_f32 v237, v238, v239
buffer_store_dwordx4 v[236:239], v11, s[16:19], s93 offen offset:3072 sc1
s_add_u32 s93, s93, 4096
v_cvt_pk_bf16_f32 v240, v240, v241
v_cvt_pk_bf16_f32 v241, v242, v243
v_cvt_pk_bf16_f32 v242, v244, v245
v_cvt_pk_bf16_f32 v243, v246, v247
buffer_store_dwordx4 v[240:243], v11, s[16:19], s93 offen offset:0 sc1
v_cvt_pk_bf16_f32 v248, v248, v249
v_cvt_pk_bf16_f32 v249, v250, v251
v_cvt_pk_bf16_f32 v250, v252, v253
v_cvt_pk_bf16_f32 v251, v254, v255
buffer_store_dwordx4 v[248:251], v11, s[16:19], s93 offen offset:1024 sc1
s_waitcnt vmcnt(10)
s_branch L_own_done
L_own:
ds_write_b128 v11, v[184:187] offset:0
ds_write_b128 v11, v[188:191] offset:1024
ds_write_b128 v11, v[192:195] offset:2048
ds_write_b128 v11, v[196:199] offset:3072
ds_write_b128 v11, v[200:203] offset:4096
ds_write_b128 v11, v[204:207] offset:5120
ds_write_b128 v11, v[208:211] offset:6144
ds_write_b128 v11, v[212:215] offset:7168
ds_write_b128 v11, v[216:219] offset:8192
ds_write_b128 v11, v[220:223] offset:9216
ds_write_b128 v11, v[224:227] offset:10240
ds_write_b128 v11, v[228:231] offset:11264
ds_write_b128 v11, v[232:235] offset:12288
ds_write_b128 v11, v[236:239] offset:13312
ds_write_b128 v11, v[240:243] offset:14336
ds_write_b128 v11, v[244:247] offset:15360
ds_write_b128 v11, v[248:251] offset:16384
ds_write_b128 v11, v[252:255] offset:17408
s_waitcnt vmcnt(0)
L_own_done:
v_lshlrev_b32 v64, 16, v128
v_and_b32 v65, 0xffff0000, v128
v_lshlrev_b32 v66, 16, v129
v_and_b32 v67, 0xffff0000, v129
v_lshlrev_b32 v16, 16, v140
v_and_b32 v17, 0xffff0000, v140
v_lshlrev_b32 v18, 16, v141
v_and_b32 v19, 0xffff0000, v141
v_pk_add_f32 v[64:65], v[64:65], v[16:17]
v_pk_add_f32 v[66:67], v[66:67], v[18:19]
v_lshlrev_b32 v12, 16, v152
v_and_b32 v13, 0xffff0000, v152
v_lshlrev_b32 v14, 16, v153
v_and_b32 v15, 0xffff0000, v153
v_pk_add_f32 v[64:65], v[64:65], v[12:13]
v_pk_add_f32 v[66:67], v[66:67], v[14:15]
v_lshlrev_b32 v16, 16, v164
v_and_b32 v17, 0xffff0000, v164
v_lshlrev_b32 v18, 16, v165
v_and_b32 v19, 0xffff0000, v165
v_pk_add_f32 v[64:65], v[64:65], v[16:17]
v_pk_add_f32 v[66:67], v[66:67], v[18:19]
v_lshlrev_b32 v68, 16, v130
v_and_b32 v69, 0xffff0000, v130
v_lshlrev_b32 v70, 16, v131
v_and_b32 v71, 0xffff0000, v131
v_lshlrev_b32 v16, 16, v142
v_and_b32 v17, 0xffff0000, v142
v_lshlrev_b32 v18, 16, v143
v_and_b32 v19, 0xffff0000, v143
v_pk_add_f32 v[68:69], v[68:69], v[16:17]
v_pk_add_f32 v[70:71], v[70:71], v[18:19]
v_lshlrev_b32 v12, 16, v154
v_and_b32 v13, 0xffff0000, v154
v_lshlrev_b32 v14, 16, v155
v_and_b32 v15, 0xffff0000, v155
v_pk_add_f32 v[68:69], v[68:69], v[12:13]
v_pk_add_f32 v[70:71], v[70:71], v[14:15]
v_lshlrev_b32 v16, 16, v166
v_and_b32 v17, 0xffff0000, v166
v_lshlrev_b32 v18, 16, v167
v_and_b32 v19, 0xffff0000, v167
v_pk_add_f32 v[68:69], v[68:69], v[16:17]
v_pk_add_f32 v[70:71], v[70:71], v[18:19]
v_lshlrev_b32 v72, 16, v132
v_and_b32 v73, 0xffff0000, v132
v_lshlrev_b32 v74, 16, v133
v_and_b32 v75, 0xffff0000, v133
v_lshlrev_b32 v16, 16, v144
v_and_b32 v17, 0xffff0000, v144
v_lshlrev_b32 v18, 16, v145
v_and_b32 v19, 0xffff0000, v145
v_pk_add_f32 v[72:73], v[72:73], v[16:17]
v_pk_add_f32 v[74:75], v[74:75], v[18:19]
v_lshlrev_b32 v12, 16, v156
v_and_b32 v13, 0xffff0000, v156
v_lshlrev_b32 v14, 16, v157
v_and_b32 v15, 0xffff0000, v157
v_pk_add_f32 v[72:73], v[72:73], v[12:13]
v_pk_add_f32 v[74:75], v[74:75], v[14:15]
v_lshlrev_b32 v16, 16, v168
v_and_b32 v17, 0xffff0000, v168
v_lshlrev_b32 v18, 16, v169
v_and_b32 v19, 0xffff0000, v169
v_pk_add_f32 v[72:73], v[72:73], v[16:17]
v_pk_add_f32 v[74:75], v[74:75], v[18:19]
v_lshlrev_b32 v76, 16, v134
v_and_b32 v77, 0xffff0000, v134
v_lshlrev_b32 v78, 16, v135
v_and_b32 v79, 0xffff0000, v135
v_lshlrev_b32 v16, 16, v146
v_and_b32 v17, 0xffff0000, v146
v_lshlrev_b32 v18, 16, v147
v_and_b32 v19, 0xffff0000, v147
v_pk_add_f32 v[76:77], v[76:77], v[16:17]
v_pk_add_f32 v[78:79], v[78:79], v[18:19]
v_lshlrev_b32 v12, 16, v158
v_and_b32 v13, 0xffff0000, v158
v_lshlrev_b32 v14, 16, v159
v_and_b32 v15, 0xffff0000, v159
v_pk_add_f32 v[76:77], v[76:77], v[12:13]
v_pk_add_f32 v[78:79], v[78:79], v[14:15]
v_lshlrev_b32 v16, 16, v170
v_and_b32 v17, 0xffff0000, v170
v_lshlrev_b32 v18, 16, v171
v_and_b32 v19, 0xffff0000, v171
v_pk_add_f32 v[76:77], v[76:77], v[16:17]
v_pk_add_f32 v[78:79], v[78:79], v[18:19]
v_lshlrev_b32 v80, 16, v136
v_and_b32 v81, 0xffff0000, v136
v_lshlrev_b32 v82, 16, v137
v_and_b32 v83, 0xffff0000, v137
v_lshlrev_b32 v16, 16, v148
v_and_b32 v17, 0xffff0000, v148
v_lshlrev_b32 v18, 16, v149
v_and_b32 v19, 0xffff0000, v149
v_pk_add_f32 v[80:81], v[80:81], v[16:17]
v_pk_add_f32 v[82:83], v[82:83], v[18:19]
v_lshlrev_b32 v12, 16, v160
v_and_b32 v13, 0xffff0000, v160
v_lshlrev_b32 v14, 16, v161
v_and_b32 v15, 0xffff0000, v161
v_pk_add_f32 v[80:81], v[80:81], v[12:13]
v_pk_add_f32 v[82:83], v[82:83], v[14:15]
v_lshlrev_b32 v16, 16, v172
v_and_b32 v17, 0xffff0000, v172
v_lshlrev_b32 v18, 16, v173
v_and_b32 v19, 0xffff0000, v173
v_pk_add_f32 v[80:81], v[80:81], v[16:17]
v_pk_add_f32 v[82:83], v[82:83], v[18:19]
v_lshlrev_b32 v84, 16, v28
v_and_b32 v85, 0xffff0000, v28
v_lshlrev_b32 v86, 16, v29
v_and_b32 v87, 0xffff0000, v29
v_lshlrev_b32 v104, 16, v38
v_and_b32 v105, 0xffff0000, v38
v_lshlrev_b32 v106, 16, v39
v_and_b32 v107, 0xffff0000, v39
v_lshlrev_b32 v88, 16, v30
v_and_b32 v89, 0xffff0000, v30
v_lshlrev_b32 v90, 16, v31
v_and_b32 v91, 0xffff0000, v31
v_lshlrev_b32 v108, 16, v40
v_and_b32 v109, 0xffff0000, v40
v_lshlrev_b32 v110, 16, v41
v_and_b32 v111, 0xffff0000, v41
v_lshlrev_b32 v92, 16, v32
v_and_b32 v93, 0xffff0000, v32
v_lshlrev_b32 v94, 16, v33
v_and_b32 v95, 0xffff0000, v33
v_lshlrev_b32 v112, 16, v42
v_and_b32 v113, 0xffff0000, v42
v_lshlrev_b32 v114, 16, v43
v_and_b32 v115, 0xffff0000, v43
v_lshlrev_b32 v96, 16, v34
v_and_b32 v97, 0xffff0000, v34
v_lshlrev_b32 v98, 16, v35
v_and_b32 v99, 0xffff0000, v35
v_lshlrev_b32 v116, 16, v44
v_and_b32 v117, 0xffff0000, v44
v_lshlrev_b32 v118, 16, v45
v_and_b32 v119, 0xffff0000, v45
v_lshlrev_b32 v100, 16, v36
v_and_b32 v101, 0xffff0000, v36
v_lshlrev_b32 v102, 16, v37
v_and_b32 v103, 0xffff0000, v37
v_lshlrev_b32 v120, 16, v46
v_and_b32 v121, 0xffff0000, v46
v_lshlrev_b32 v122, 16, v47
v_and_b32 v123, 0xffff0000, v47
s_mov_b32 s20, s84
s_mov_b32 s21, s85
s_mov_b32 s22, 0x240000
s_mov_b32 s23, 0x00020000
s_mov_b32 s63, 0xbfb8aa3b
v_add_u32 v20, s53, v11
s_waitcnt vmcnt(0) lgkmcnt(0)
s_barrier
s_mov_b32 s27, 20000
v_mov_b32 v12, 0
s_cmp_lg_u32 s24, 0
s_cbranch_scc1 L_cx_wait
v_mov_b32 v13, 0x100
s_mov_b64 exec, 1
buffer_atomic_add v13, v12, s[56:59], s92 offen
s_mov_b64 exec, -1
s_mov_b32 s35, 400000
L_cx_poll:
buffer_load_dword v13, v12, s[56:59], s92 offen sc1
s_waitcnt vmcnt(0)
v_readfirstlane_b32 s34, v13
s_cmp_ge_u32 s34, 0x400
s_cbranch_scc1 L_cx_wait
s_sleep 1
s_sub_u32 s35, s35, 1
s_cmp_lg_u32 s35, 0
s_cbranch_scc1 L_cx_poll
L_cx_wait:
s_barrier
s_mov_b32 s27, 1
ds_read_b128 v[192:195], v20 offset:0
ds_read_b128 v[196:199], v20 offset:1024
ds_read_b128 v[200:203], v20 offset:2048
ds_read_b128 v[204:207], v20 offset:3072
ds_read_b128 v[208:211], v20 offset:4096
s_add_u32 s33, s54, 1
s_and_b32 s33, s33, 3
s_mul_i32 s33, s33, 10240
s_add_u32 s33, s33, 10485760
s_add_u32 s66, s33, s94
s_add_u32 s67, s33, s91
s_add_u32 s33, s54, 2
s_and_b32 s33, s33, 3
s_mul_i32 s33, s33, 10240
s_add_u32 s33, s33, 10485760
s_add_u32 s68, s33, s94
s_add_u32 s69, s33, s91
s_add_u32 s33, s54, 3
s_and_b32 s33, s33, 3
s_mul_i32 s33, s33, 10240
s_add_u32 s33, s33, 10485760
s_add_u32 s70, s33, s94
s_add_u32 s71, s33, s91
s_waitcnt lgkmcnt(0)
v_pk_add_f32 v[104:105], v[104:105], v[192:193]
v_pk_add_f32 v[106:107], v[106:107], v[194:195]
v_pk_add_f32 v[108:109], v[108:109], v[196:197]
v_pk_add_f32 v[110:111], v[110:111], v[198:199]
v_pk_add_f32 v[112:113], v[112:113], v[200:201]
v_pk_add_f32 v[114:115], v[114:115], v[202:203]
v_pk_add_f32 v[116:117], v[116:117], v[204:205]
v_pk_add_f32 v[118:119], v[118:119], v[206:207]
v_pk_add_f32 v[120:121], v[120:121], v[208:209]
v_pk_add_f32 v[122:123], v[122:123], v[210:211]
L_fin_poll:
buffer_load_dwordx4 v[128:131], v11, s[16:19], s66 offen offset:0 sc1
buffer_load_dwordx4 v[132:135], v11, s[16:19], s66 offen offset:1024 sc1
buffer_load_dwordx4 v[136:139], v11, s[16:19], s67 offen offset:0 sc1
buffer_load_dwordx4 v[140:143], v11, s[16:19], s68 offen offset:0 sc1
buffer_load_dwordx4 v[144:147], v11, s[16:19], s68 offen offset:1024 sc1
buffer_load_dwordx4 v[148:151], v11, s[16:19], s69 offen offset:0 sc1
buffer_load_dwordx4 v[152:155], v11, s[16:19], s70 offen offset:0 sc1
buffer_load_dwordx4 v[156:159], v11, s[16:19], s70 offen offset:1024 sc1
buffer_load_dwordx4 v[160:163], v11, s[16:19], s71 offen offset:0 sc1
s_waitcnt vmcnt(0)
v_max3_u32 v12, v128, v129, v130
v_max3_u32 v12, v12, v131, v132
v_max3_u32 v12, v12, v133, v134
v_max3_u32 v12, v12, v135, v136
v_max3_u32 v12, v12, v137, v140
v_max3_u32 v12, v12, v141, v142
v_max3_u32 v12, v12, v143, v144
v_max3_u32 v12, v12, v145, v146
v_max3_u32 v12, v12, v147, v148
v_max3_u32 v12, v12, v149, v152
v_max3_u32 v12, v12, v153, v154
v_max3_u32 v12, v12, v155, v156
v_max3_u32 v12, v12, v157, v158
v_max3_u32 v12, v12, v159, v160
v_max_u32 v12, v12, v161
v_cmp_eq_u32 vcc, -1, v12
s_sub_u32 s27, s27, 1
s_cbranch_vccz L_fin_ok
s_cmp_lg_u32 s27, 0
s_cbranch_scc1 L_fin_poll
L_fin_ok:
v_lshlrev_b32 v12, 16, v128
v_and_b32 v13, 0xffff0000, v128
v_lshlrev_b32 v14, 16, v129
v_and_b32 v15, 0xffff0000, v129
v_pk_add_f32 v[104:105], v[104:105], v[12:13]
v_pk_add_f32 v[106:107], v[106:107], v[14:15]
v_lshlrev_b32 v16, 16, v140
v_and_b32 v17, 0xffff0000, v140
v_lshlrev_b32 v18, 16, v141
v_and_b32 v19, 0xffff0000, v141
v_pk_add_f32 v[104:105], v[104:105], v[16:17]
v_pk_add_f32 v[106:107], v[106:107], v[18:19]
v_lshlrev_b32 v12, 16, v152
v_and_b32 v13, 0xffff0000, v152
v_lshlrev_b32 v14, 16, v153
v_and_b32 v15, 0xffff0000, v153
v_pk_add_f32 v[104:105], v[104:105], v[12:13]
v_pk_add_f32 v[106:107], v[106:107], v[14:15]
v_lshlrev_b32 v16, 16, v130
v_and_b32 v17, 0xffff0000, v130
v_lshlrev_b32 v18, 16, v131
v_and_b32 v19, 0xffff0000, v131
v_pk_add_f32 v[108:109], v[108:109], v[16:17]
v_pk_add_f32 v[110:111], v[110:111], v[18:19]
v_lshlrev_b32 v12, 16, v142
v_and_b32 v13, 0xffff0000, v142
v_lshlrev_b32 v14, 16, v143
v_and_b32 v15, 0xffff0000, v143
v_pk_add_f32 v[108:109], v[108:109], v[12:13]
v_pk_add_f32 v[110:111], v[110:111], v[14:15]
v_lshlrev_b32 v16, 16, v154
v_and_b32 v17, 0xffff0000, v154
v_lshlrev_b32 v18, 16, v155
v_and_b32 v19, 0xffff0000, v155
v_pk_add_f32 v[108:109], v[108:109], v[16:17]
v_pk_add_f32 v[110:111], v[110:111], v[18:19]
v_lshlrev_b32 v12, 16, v132
v_and_b32 v13, 0xffff0000, v132
v_lshlrev_b32 v14, 16, v133
v_and_b32 v15, 0xffff0000, v133
v_pk_add_f32 v[112:113], v[112:113], v[12:13]
v_pk_add_f32 v[114:115], v[114:115], v[14:15]
v_lshlrev_b32 v16, 16, v144
v_and_b32 v17, 0xffff0000, v144
v_lshlrev_b32 v18, 16, v145
v_and_b32 v19, 0xffff0000, v145
v_pk_add_f32 v[112:113], v[112:113], v[16:17]
v_pk_add_f32 v[114:115], v[114:115], v[18:19]
v_lshlrev_b32 v12, 16, v156
v_and_b32 v13, 0xffff0000, v156
v_lshlrev_b32 v14, 16, v157
v_and_b32 v15, 0xffff0000, v157
v_pk_add_f32 v[112:113], v[112:113], v[12:13]
v_pk_add_f32 v[114:115], v[114:115], v[14:15]
v_lshlrev_b32 v16, 16, v134
v_and_b32 v17, 0xffff0000, v134
v_lshlrev_b32 v18, 16, v135
v_and_b32 v19, 0xffff0000, v135
v_pk_add_f32 v[116:117], v[116:117], v[16:17]
v_pk_add_f32 v[118:119], v[118:119], v[18:19]
v_lshlrev_b32 v12, 16, v146
v_and_b32 v13, 0xffff0000, v146
v_lshlrev_b32 v14, 16, v147
v_and_b32 v15, 0xffff0000, v147
v_pk_add_f32 v[116:117], v[116:117], v[12:13]
v_pk_add_f32 v[118:119], v[118:119], v[14:15]
v_lshlrev_b32 v16, 16, v158
v_and_b32 v17, 0xffff0000, v158
v_lshlrev_b32 v18, 16, v159
v_and_b32 v19, 0xffff0000, v159
v_pk_add_f32 v[116:117], v[116:117], v[16:17]
v_pk_add_f32 v[118:119], v[118:119], v[18:19]
v_lshlrev_b32 v12, 16, v136
v_and_b32 v13, 0xffff0000, v136
v_lshlrev_b32 v14, 16, v137
v_and_b32 v15, 0xffff0000, v137
v_pk_add_f32 v[120:121], v[120:121], v[12:13]
v_pk_add_f32 v[122:123], v[122:123], v[14:15]
v_lshlrev_b32 v16, 16, v148
v_and_b32 v17, 0xffff0000, v148
v_lshlrev_b32 v18, 16, v149
v_and_b32 v19, 0xffff0000, v149
v_pk_add_f32 v[120:121], v[120:121], v[16:17]
v_pk_add_f32 v[122:123], v[122:123], v[18:19]
v_lshlrev_b32 v12, 16, v160
v_and_b32 v13, 0xffff0000, v160
v_lshlrev_b32 v14, 16, v161
v_and_b32 v15, 0xffff0000, v161
v_pk_add_f32 v[120:121], v[120:121], v[12:13]
v_pk_add_f32 v[122:123], v[122:123], v[14:15]
v_mul_f32 v192, s63, v104
v_mul_f32 v193, s63, v105
v_mul_f32 v194, s63, v106
v_mul_f32 v195, s63, v107
v_exp_f32 v192, v192
v_exp_f32 v193, v193
v_exp_f32 v194, v194
v_exp_f32 v195, v195
v_pk_mul_f32 v[104:105], v[104:105], v[64:65]
v_pk_mul_f32 v[106:107], v[106:107], v[66:67]
v_add_f32 v192, 1.0, v192
v_add_f32 v193, 1.0, v193
v_add_f32 v194, 1.0, v194
v_add_f32 v195, 1.0, v195
v_rcp_f32 v192, v192
v_rcp_f32 v193, v193
v_rcp_f32 v194, v194
v_rcp_f32 v195, v195
s_nop 0
v_pk_fma_f32 v[84:85], v[104:105], v[192:193], v[84:85]
v_pk_fma_f32 v[86:87], v[106:107], v[194:195], v[86:87]
v_cvt_pk_bf16_f32 v192, v84, v85
v_cvt_pk_bf16_f32 v193, v86, v87
buffer_store_dwordx2 v[192:193], v63, s[20:23], s45 offen offset:0
v_mul_f32 v196, s63, v108
v_mul_f32 v197, s63, v109
v_mul_f32 v198, s63, v110
v_mul_f32 v199, s63, v111
v_exp_f32 v196, v196
v_exp_f32 v197, v197
v_exp_f32 v198, v198
v_exp_f32 v199, v199
v_pk_mul_f32 v[108:109], v[108:109], v[68:69]
v_pk_mul_f32 v[110:111], v[110:111], v[70:71]
v_add_f32 v196, 1.0, v196
v_add_f32 v197, 1.0, v197
v_add_f32 v198, 1.0, v198
v_add_f32 v199, 1.0, v199
v_rcp_f32 v196, v196
v_rcp_f32 v197, v197
v_rcp_f32 v198, v198
v_rcp_f32 v199, v199
s_nop 0
v_pk_fma_f32 v[88:89], v[108:109], v[196:197], v[88:89]
v_pk_fma_f32 v[90:91], v[110:111], v[198:199], v[90:91]
v_cvt_pk_bf16_f32 v196, v88, v89
v_cvt_pk_bf16_f32 v197, v90, v91
buffer_store_dwordx2 v[196:197], v63, s[20:23], s45 offen offset:32
v_mul_f32 v200, s63, v112
v_mul_f32 v201, s63, v113
v_mul_f32 v202, s63, v114
v_mul_f32 v203, s63, v115
v_exp_f32 v200, v200
v_exp_f32 v201, v201
v_exp_f32 v202, v202
v_exp_f32 v203, v203
v_pk_mul_f32 v[112:113], v[112:113], v[72:73]
v_pk_mul_f32 v[114:115], v[114:115], v[74:75]
v_add_f32 v200, 1.0, v200
v_add_f32 v201, 1.0, v201
v_add_f32 v202, 1.0, v202
v_add_f32 v203, 1.0, v203
v_rcp_f32 v200, v200
v_rcp_f32 v201, v201
v_rcp_f32 v202, v202
v_rcp_f32 v203, v203
s_nop 0
v_pk_fma_f32 v[92:93], v[112:113], v[200:201], v[92:93]
v_pk_fma_f32 v[94:95], v[114:115], v[202:203], v[94:95]
v_cvt_pk_bf16_f32 v200, v92, v93
v_cvt_pk_bf16_f32 v201, v94, v95
buffer_store_dwordx2 v[200:201], v63, s[20:23], s45 offen offset:64
v_mul_f32 v204, s63, v116
v_mul_f32 v205, s63, v117
v_mul_f32 v206, s63, v118
v_mul_f32 v207, s63, v119
v_exp_f32 v204, v204
v_exp_f32 v205, v205
v_exp_f32 v206, v206
v_exp_f32 v207, v207
v_pk_mul_f32 v[116:117], v[116:117], v[76:77]
v_pk_mul_f32 v[118:119], v[118:119], v[78:79]
v_add_f32 v204, 1.0, v204
v_add_f32 v205, 1.0, v205
v_add_f32 v206, 1.0, v206
v_add_f32 v207, 1.0, v207
v_rcp_f32 v204, v204
v_rcp_f32 v205, v205
v_rcp_f32 v206, v206
v_rcp_f32 v207, v207
s_nop 0
v_pk_fma_f32 v[96:97], v[116:117], v[204:205], v[96:97]
v_pk_fma_f32 v[98:99], v[118:119], v[206:207], v[98:99]
v_cvt_pk_bf16_f32 v204, v96, v97
v_cvt_pk_bf16_f32 v205, v98, v99
buffer_store_dwordx2 v[204:205], v63, s[20:23], s45 offen offset:96
v_mul_f32 v208, s63, v120
v_mul_f32 v209, s63, v121
v_mul_f32 v210, s63, v122
v_mul_f32 v211, s63, v123
v_exp_f32 v208, v208
v_exp_f32 v209, v209
v_exp_f32 v210, v210
v_exp_f32 v211, v211
v_pk_mul_f32 v[120:121], v[120:121], v[80:81]
v_pk_mul_f32 v[122:123], v[122:123], v[82:83]
v_add_f32 v208, 1.0, v208
v_add_f32 v209, 1.0, v209
v_add_f32 v210, 1.0, v210
v_add_f32 v211, 1.0, v211
v_rcp_f32 v208, v208
v_rcp_f32 v209, v209
v_rcp_f32 v210, v210
v_rcp_f32 v211, v211
s_nop 0
v_pk_fma_f32 v[100:101], v[120:121], v[208:209], v[100:101]
v_pk_fma_f32 v[102:103], v[122:123], v[210:211], v[102:103]
v_cvt_pk_bf16_f32 v208, v100, v101
v_cvt_pk_bf16_f32 v209, v102, v103
s_cmp_ge_u32 s24, 2
s_cselect_b32 s45, 0x7fff0000, s45
buffer_store_dwordx2 v[208:209], v63, s[20:23], s45 offen offset:128
L_exit:
s_endpgm
L_fallback:
s_waitcnt vmcnt(0)
v_accvgpr_write_b32 a0, 0
v_accvgpr_write_b32 a1, 0
v_accvgpr_write_b32 a2, 0
v_accvgpr_write_b32 a3, 0
v_accvgpr_write_b32 a4, 0
v_accvgpr_write_b32 a5, 0
v_accvgpr_write_b32 a6, 0
v_accvgpr_write_b32 a7, 0
v_accvgpr_write_b32 a8, 0
v_accvgpr_write_b32 a9, 0
v_accvgpr_write_b32 a10, 0
v_accvgpr_write_b32 a11, 0
v_accvgpr_write_b32 a12, 0
v_accvgpr_write_b32 a13, 0
v_accvgpr_write_b32 a14, 0
v_accvgpr_write_b32 a15, 0
v_accvgpr_write_b32 a16, 0
v_accvgpr_write_b32 a17, 0
v_accvgpr_write_b32 a18, 0
v_accvgpr_write_b32 a19, 0
v_accvgpr_write_b32 a20, 0
v_accvgpr_write_b32 a21, 0
v_accvgpr_write_b32 a22, 0
v_accvgpr_write_b32 a23, 0
v_accvgpr_write_b32 a24, 0
v_accvgpr_write_b32 a25, 0
v_accvgpr_write_b32 a26, 0
v_accvgpr_write_b32 a27, 0
v_accvgpr_write_b32 a28, 0
v_accvgpr_write_b32 a29, 0
v_accvgpr_write_b32 a30, 0
v_accvgpr_write_b32 a31, 0
v_accvgpr_write_b32 a32, 0
v_accvgpr_write_b32 a33, 0
v_accvgpr_write_b32 a34, 0
v_accvgpr_write_b32 a35, 0
v_accvgpr_write_b32 a36, 0
v_accvgpr_write_b32 a37, 0
v_accvgpr_write_b32 a38, 0
v_accvgpr_write_b32 a39, 0
v_accvgpr_write_b32 a40, 0
v_accvgpr_write_b32 a41, 0
v_accvgpr_write_b32 a42, 0
v_accvgpr_write_b32 a43, 0
v_accvgpr_write_b32 a44, 0
v_accvgpr_write_b32 a45, 0
v_accvgpr_write_b32 a46, 0
v_accvgpr_write_b32 a47, 0
v_accvgpr_write_b32 a48, 0
v_accvgpr_write_b32 a49, 0
v_accvgpr_write_b32 a50, 0
v_accvgpr_write_b32 a51, 0
v_accvgpr_write_b32 a52, 0
v_accvgpr_write_b32 a53, 0
v_accvgpr_write_b32 a54, 0
v_accvgpr_write_b32 a55, 0
v_accvgpr_write_b32 a56, 0
v_accvgpr_write_b32 a57, 0
v_accvgpr_write_b32 a58, 0
v_accvgpr_write_b32 a59, 0
v_accvgpr_write_b32 a60, 0
v_accvgpr_write_b32 a61, 0
v_accvgpr_write_b32 a62, 0
v_accvgpr_write_b32 a63, 0
v_accvgpr_write_b32 a64, 0
v_accvgpr_write_b32 a65, 0
v_accvgpr_write_b32 a66, 0
v_accvgpr_write_b32 a67, 0
v_accvgpr_write_b32 a68, 0
v_accvgpr_write_b32 a69, 0
v_accvgpr_write_b32 a70, 0
v_accvgpr_write_b32 a71, 0
v_accvgpr_write_b32 a72, 0
v_accvgpr_write_b32 a73, 0
v_accvgpr_write_b32 a74, 0
v_accvgpr_write_b32 a75, 0
v_accvgpr_write_b32 a76, 0
v_accvgpr_write_b32 a77, 0
v_accvgpr_write_b32 a78, 0
v_accvgpr_write_b32 a79, 0
v_accvgpr_write_b32 a80, 0
v_accvgpr_write_b32 a81, 0
v_accvgpr_write_b32 a82, 0
v_accvgpr_write_b32 a83, 0
v_accvgpr_write_b32 a84, 0
v_accvgpr_write_b32 a85, 0
v_accvgpr_write_b32 a86, 0
v_accvgpr_write_b32 a87, 0
v_accvgpr_write_b32 a88, 0
v_accvgpr_write_b32 a89, 0
v_accvgpr_write_b32 a90, 0
v_accvgpr_write_b32 a91, 0
v_accvgpr_write_b32 a92, 0
v_accvgpr_write_b32 a93, 0
v_accvgpr_write_b32 a94, 0
v_accvgpr_write_b32 a95, 0
v_accvgpr_write_b32 a96, 0
v_accvgpr_write_b32 a97, 0
v_accvgpr_write_b32 a98, 0
v_accvgpr_write_b32 a99, 0
v_accvgpr_write_b32 a100, 0
v_accvgpr_write_b32 a101, 0
v_accvgpr_write_b32 a102, 0
v_accvgpr_write_b32 a103, 0
v_accvgpr_write_b32 a104, 0
v_accvgpr_write_b32 a105, 0
v_accvgpr_write_b32 a106, 0
v_accvgpr_write_b32 a107, 0
v_accvgpr_write_b32 a108, 0
v_accvgpr_write_b32 a109, 0
v_accvgpr_write_b32 a110, 0
v_accvgpr_write_b32 a111, 0
v_accvgpr_write_b32 a112, 0
v_accvgpr_write_b32 a113, 0
v_accvgpr_write_b32 a114, 0
v_accvgpr_write_b32 a115, 0
v_accvgpr_write_b32 a116, 0
v_accvgpr_write_b32 a117, 0
v_accvgpr_write_b32 a118, 0
v_accvgpr_write_b32 a119, 0
v_accvgpr_write_b32 a120, 0
v_accvgpr_write_b32 a121, 0
v_accvgpr_write_b32 a122, 0
v_accvgpr_write_b32 a123, 0
v_accvgpr_write_b32 a124, 0
v_accvgpr_write_b32 a125, 0
v_accvgpr_write_b32 a126, 0
v_accvgpr_write_b32 a127, 0
v_mov_b32 v112, 0
v_mov_b32 v113, 0
v_mov_b32 v114, 0
v_mov_b32 v115, 0
v_mov_b32 v116, 0
v_mov_b32 v117, 0
v_mov_b32 v118, 0
v_mov_b32 v119, 0
v_mov_b32 v120, 0
v_mov_b32 v121, 0
v_mov_b32 v122, 0
v_mov_b32 v123, 0
v_mov_b32 v124, 0
v_mov_b32 v125, 0
v_mov_b32 v126, 0
v_mov_b32 v127, 0
v_mov_b32 v80, 0xff800000
v_mov_b32 v84, 0
v_mov_b32 v81, 0xff800000
v_mov_b32 v85, 0
v_mov_b32 v82, 0xff800000
v_mov_b32 v86, 0
v_mov_b32 v83, 0xff800000
v_mov_b32 v87, 0
s_mov_b32 s30, s55
s_mov_b32 s25, s30
s_mov_b32 s26, s30
s_mov_b32 s27, 64
L_fb_loop:
s_bitcmp1_b32 s27, 0
s_cbranch_scc1 L_fb_odd
s_barrier
s_add_u32 m0, s30, 0
s_nop 0
buffer_load_dwordx4 v32, s[4:7], s25 offen offset:0 lds
buffer_load_dwordx4 v33, s[4:7], s25 offen offset:1024 lds
buffer_load_dwordx4 v34, s[4:7], s25 offen offset:2048 lds
buffer_load_dwordx4 v35, s[4:7], s25 offen offset:3072 lds
s_add_u32 s25, s25, 16384
s_nop 0
s_add_u32 m0, s30, 65536
s_nop 0
buffer_load_dwordx4 v36, s[8:11], s26 offen offset:0 lds
buffer_load_dwordx4 v37, s[8:11], s26 offen offset:1024 lds
buffer_load_dwordx4 v36, s[8:11], s26 offen offset:2048 lds
buffer_load_dwordx4 v37, s[8:11], s26 offen offset:3072 lds
s_add_u32 s26, s26, 16384
s_nop 0
s_waitcnt vmcnt(0)
s_barrier
L_fb_odd:
ds_read_b128 a[192:195], v64 offset:0
ds_read_b128 a[196:199], v65 offset:0
ds_read_b128 a[200:203], v66 offset:0
ds_read_b128 a[204:207], v67 offset:0
ds_read_b128 a[208:211], v64 offset:4096
ds_read_b128 a[212:215], v65 offset:4096
ds_read_b128 a[216:219], v66 offset:4096
ds_read_b128 a[220:223], v67 offset:4096
s_waitcnt lgkmcnt(0)
ds_read_b64_tr_b16 a[224:225], v68 offset:0
ds_read_b64_tr_b16 a[226:227], v68 offset:4096
ds_read_b64_tr_b16 a[228:229], v69 offset:0
ds_read_b64_tr_b16 a[230:231], v69 offset:4096
ds_read_b64_tr_b16 a[232:233], v70 offset:0
ds_read_b64_tr_b16 a[234:235], v70 offset:4096
ds_read_b64_tr_b16 a[236:237], v71 offset:0
ds_read_b64_tr_b16 a[238:239], v71 offset:4096
ds_read_b64_tr_b16 a[240:241], v72 offset:0
ds_read_b64_tr_b16 a[242:243], v72 offset:4096
ds_read_b64_tr_b16 a[244:245], v73 offset:0
ds_read_b64_tr_b16 a[246:247], v73 offset:4096
ds_read_b64_tr_b16 a[248:249], v74 offset:0
ds_read_b64_tr_b16 a[250:251], v74 offset:4096
ds_read_b64_tr_b16 a[252:253], v75 offset:0
ds_read_b64_tr_b16 a[254:255], v75 offset:4096
s_waitcnt lgkmcnt(0)
v_xor_b32 v64, 0x2000, v64
v_xor_b32 v65, 0x2000, v65
v_xor_b32 v66, 0x2000, v66
v_xor_b32 v67, 0x2000, v67
v_xor_b32 v68, 0x2000, v68
v_xor_b32 v69, 0x2000, v69
v_xor_b32 v70, 0x2000, v70
v_xor_b32 v71, 0x2000, v71
v_xor_b32 v72, 0x2000, v72
v_xor_b32 v73, 0x2000, v73
v_xor_b32 v74, 0x2000, v74
v_xor_b32 v75, 0x2000, v75
v_mfma_f32_16x16x32_bf16 v[128:131], a[192:195], a[128:131], 0
v_mfma_f32_16x16x32_bf16 v[128:131], a[196:199], a[132:135], v[128:131]
v_mfma_f32_16x16x32_bf16 v[128:131], a[200:203], a[136:139], v[128:131]
v_mfma_f32_16x16x32_bf16 v[128:131], a[204:207], a[140:143], v[128:131]
v_mfma_f32_16x16x32_bf16 v[132:135], a[208:211], a[128:131], 0
v_mfma_f32_16x16x32_bf16 v[132:135], a[212:215], a[132:135], v[132:135]
v_mfma_f32_16x16x32_bf16 v[132:135], a[216:219], a[136:139], v[132:135]
v_mfma_f32_16x16x32_bf16 v[132:135], a[220:223], a[140:143], v[132:135]
v_mfma_f32_16x16x32_bf16 v[136:139], a[192:195], a[144:147], 0
v_mfma_f32_16x16x32_bf16 v[136:139], a[196:199], a[148:151], v[136:139]
v_mfma_f32_16x16x32_bf16 v[136:139], a[200:203], a[152:155], v[136:139]
v_mfma_f32_16x16x32_bf16 v[136:139], a[204:207], a[156:159], v[136:139]
v_mfma_f32_16x16x32_bf16 v[140:143], a[208:211], a[144:147], 0
v_mfma_f32_16x16x32_bf16 v[140:143], a[212:215], a[148:151], v[140:143]
v_mfma_f32_16x16x32_bf16 v[140:143], a[216:219], a[152:155], v[140:143]
v_mfma_f32_16x16x32_bf16 v[140:143], a[220:223], a[156:159], v[140:143]
v_mfma_f32_16x16x32_bf16 v[144:147], a[192:195], a[160:163], 0
v_mfma_f32_16x16x32_bf16 v[144:147], a[196:199], a[164:167], v[144:147]
v_mfma_f32_16x16x32_bf16 v[144:147], a[200:203], a[168:171], v[144:147]
v_mfma_f32_16x16x32_bf16 v[144:147], a[204:207], a[172:175], v[144:147]
v_mfma_f32_16x16x32_bf16 v[148:151], a[208:211], a[160:163], 0
v_mfma_f32_16x16x32_bf16 v[148:151], a[212:215], a[164:167], v[148:151]
v_mfma_f32_16x16x32_bf16 v[148:151], a[216:219], a[168:171], v[148:151]
v_mfma_f32_16x16x32_bf16 v[148:151], a[220:223], a[172:175], v[148:151]
v_mfma_f32_16x16x32_bf16 v[152:155], a[192:195], a[176:179], 0
v_mfma_f32_16x16x32_bf16 v[152:155], a[196:199], a[180:183], v[152:155]
v_mfma_f32_16x16x32_bf16 v[152:155], a[200:203], a[184:187], v[152:155]
v_mfma_f32_16x16x32_bf16 v[152:155], a[204:207], a[188:191], v[152:155]
v_mfma_f32_16x16x32_bf16 v[156:159], a[208:211], a[176:179], 0
v_mfma_f32_16x16x32_bf16 v[156:159], a[212:215], a[180:183], v[156:159]
v_mfma_f32_16x16x32_bf16 v[156:159], a[216:219], a[184:187], v[156:159]
v_mfma_f32_16x16x32_bf16 v[156:159], a[220:223], a[188:191], v[156:159]
s_nop 7
s_nop 7
v_max3_f32 v12, v128, v129, v130
v_max3_f32 v12, v12, v131, v132
v_max3_f32 v12, v12, v133, v134
v_max_f32 v12, v12, v135
v_mov_b32 v13, v12
s_nop 1
v_permlane16_swap_b32 v12, v13
s_nop 1
v_max_f32 v12, v12, v13
v_mov_b32 v13, v12
s_nop 1
v_permlane32_swap_b32 v12, v13
s_nop 1
v_max_f32 v12, v12, v13
v_max_f32 v12, v12, v80
v_sub_f32 v14, v80, v12
v_exp_f32 v14, v14
v_mov_b32 v80, v12
v_mul_f32 v84, v84, v14
v_accvgpr_read_b32 v16, a0
v_accvgpr_read_b32 v17, a1
v_accvgpr_read_b32 v18, a2
v_accvgpr_read_b32 v19, a3
v_mul_f32 v16, v16, v14
v_mul_f32 v17, v17, v14
v_mul_f32 v18, v18, v14
v_mul_f32 v19, v19, v14
v_accvgpr_write_b32 a0, v16
v_accvgpr_write_b32 a1, v17
v_accvgpr_write_b32 a2, v18
v_accvgpr_write_b32 a3, v19
v_accvgpr_read_b32 v16, a4
v_accvgpr_read_b32 v17, a5
v_accvgpr_read_b32 v18, a6
v_accvgpr_read_b32 v19, a7
v_mul_f32 v16, v16, v14
v_mul_f32 v17, v17, v14
v_mul_f32 v18, v18, v14
v_mul_f32 v19, v19, v14
v_accvgpr_write_b32 a4, v16
v_accvgpr_write_b32 a5, v17
v_accvgpr_write_b32 a6, v18
v_accvgpr_write_b32 a7, v19
v_accvgpr_read_b32 v16, a8
v_accvgpr_read_b32 v17, a9
v_accvgpr_read_b32 v18, a10
v_accvgpr_read_b32 v19, a11
v_mul_f32 v16, v16, v14
v_mul_f32 v17, v17, v14
v_mul_f32 v18, v18, v14
v_mul_f32 v19, v19, v14
v_accvgpr_write_b32 a8, v16
v_accvgpr_write_b32 a9, v17
v_accvgpr_write_b32 a10, v18
v_accvgpr_write_b32 a11, v19
v_accvgpr_read_b32 v16, a12
v_accvgpr_read_b32 v17, a13
v_accvgpr_read_b32 v18, a14
v_accvgpr_read_b32 v19, a15
v_mul_f32 v16, v16, v14
v_mul_f32 v17, v17, v14
v_mul_f32 v18, v18, v14
v_mul_f32 v19, v19, v14
v_accvgpr_write_b32 a12, v16
v_accvgpr_write_b32 a13, v17
v_accvgpr_write_b32 a14, v18
v_accvgpr_write_b32 a15, v19
v_accvgpr_read_b32 v16, a16
v_accvgpr_read_b32 v17, a17
v_accvgpr_read_b32 v18, a18
v_accvgpr_read_b32 v19, a19
v_mul_f32 v16, v16, v14
v_mul_f32 v17, v17, v14
v_mul_f32 v18, v18, v14
v_mul_f32 v19, v19, v14
v_accvgpr_write_b32 a16, v16
v_accvgpr_write_b32 a17, v17
v_accvgpr_write_b32 a18, v18
v_accvgpr_write_b32 a19, v19
v_accvgpr_read_b32 v16, a20
v_accvgpr_read_b32 v17, a21
v_accvgpr_read_b32 v18, a22
v_accvgpr_read_b32 v19, a23
v_mul_f32 v16, v16, v14
v_mul_f32 v17, v17, v14
v_mul_f32 v18, v18, v14
v_mul_f32 v19, v19, v14
v_accvgpr_write_b32 a20, v16
v_accvgpr_write_b32 a21, v17
v_accvgpr_write_b32 a22, v18
v_accvgpr_write_b32 a23, v19
v_accvgpr_read_b32 v16, a24
v_accvgpr_read_b32 v17, a25
v_accvgpr_read_b32 v18, a26
v_accvgpr_read_b32 v19, a27
v_mul_f32 v16, v16, v14
v_mul_f32 v17, v17, v14
v_mul_f32 v18, v18, v14
v_mul_f32 v19, v19, v14
v_accvgpr_write_b32 a24, v16
v_accvgpr_write_b32 a25, v17
v_accvgpr_write_b32 a26, v18
v_accvgpr_write_b32 a27, v19
v_accvgpr_read_b32 v16, a28
v_accvgpr_read_b32 v17, a29
v_accvgpr_read_b32 v18, a30
v_accvgpr_read_b32 v19, a31
v_mul_f32 v16, v16, v14
v_mul_f32 v17, v17, v14
v_mul_f32 v18, v18, v14
v_mul_f32 v19, v19, v14
v_accvgpr_write_b32 a28, v16
v_accvgpr_write_b32 a29, v17
v_accvgpr_write_b32 a30, v18
v_accvgpr_write_b32 a31, v19
v_sub_f32 v128, v128, v12
v_exp_f32_e64 v128, v128
v_sub_f32 v129, v129, v12
v_exp_f32_e64 v129, v129
v_sub_f32 v130, v130, v12
v_exp_f32_e64 v130, v130
v_sub_f32 v131, v131, v12
v_exp_f32_e64 v131, v131
v_sub_f32 v132, v132, v12
v_exp_f32_e64 v132, v132
v_sub_f32 v133, v133, v12
v_exp_f32_e64 v133, v133
v_sub_f32 v134, v134, v12
v_exp_f32_e64 v134, v134
v_sub_f32 v135, v135, v12
v_exp_f32_e64 v135, v135
s_nop 0
v_add_f32 v84, v84, v128
v_add_f32 v84, v84, v129
v_add_f32 v84, v84, v130
v_add_f32 v84, v84, v131
v_add_f32 v84, v84, v132
v_add_f32 v84, v84, v133
v_add_f32 v84, v84, v134
v_add_f32 v84, v84, v135
v_cvt_pk_bf16_f32 v128, v128, v129
v_cvt_pk_bf16_f32 v129, v130, v131
v_cvt_pk_bf16_f32 v130, v132, v133
v_cvt_pk_bf16_f32 v131, v134, v135
v_max3_f32 v12, v136, v137, v138
v_max3_f32 v12, v12, v139, v140
v_max3_f32 v12, v12, v141, v142
v_max_f32 v12, v12, v143
v_mov_b32 v13, v12
s_nop 1
v_permlane16_swap_b32 v12, v13
s_nop 1
v_max_f32 v12, v12, v13
v_mov_b32 v13, v12
s_nop 1
v_permlane32_swap_b32 v12, v13
s_nop 1
v_max_f32 v12, v12, v13
v_max_f32 v12, v12, v81
v_sub_f32 v14, v81, v12
v_exp_f32 v14, v14
v_mov_b32 v81, v12
v_mul_f32 v85, v85, v14
v_accvgpr_read_b32 v16, a32
v_accvgpr_read_b32 v17, a33
v_accvgpr_read_b32 v18, a34
v_accvgpr_read_b32 v19, a35
v_mul_f32 v16, v16, v14
v_mul_f32 v17, v17, v14
v_mul_f32 v18, v18, v14
v_mul_f32 v19, v19, v14
v_accvgpr_write_b32 a32, v16
v_accvgpr_write_b32 a33, v17
v_accvgpr_write_b32 a34, v18
v_accvgpr_write_b32 a35, v19
v_accvgpr_read_b32 v16, a36
v_accvgpr_read_b32 v17, a37
v_accvgpr_read_b32 v18, a38
v_accvgpr_read_b32 v19, a39
v_mul_f32 v16, v16, v14
v_mul_f32 v17, v17, v14
v_mul_f32 v18, v18, v14
v_mul_f32 v19, v19, v14
v_accvgpr_write_b32 a36, v16
v_accvgpr_write_b32 a37, v17
v_accvgpr_write_b32 a38, v18
v_accvgpr_write_b32 a39, v19
v_accvgpr_read_b32 v16, a40
v_accvgpr_read_b32 v17, a41
v_accvgpr_read_b32 v18, a42
v_accvgpr_read_b32 v19, a43
v_mul_f32 v16, v16, v14
v_mul_f32 v17, v17, v14
v_mul_f32 v18, v18, v14
v_mul_f32 v19, v19, v14
v_accvgpr_write_b32 a40, v16
v_accvgpr_write_b32 a41, v17
v_accvgpr_write_b32 a42, v18
v_accvgpr_write_b32 a43, v19
v_accvgpr_read_b32 v16, a44
v_accvgpr_read_b32 v17, a45
v_accvgpr_read_b32 v18, a46
v_accvgpr_read_b32 v19, a47
v_mul_f32 v16, v16, v14
v_mul_f32 v17, v17, v14
v_mul_f32 v18, v18, v14
v_mul_f32 v19, v19, v14
v_accvgpr_write_b32 a44, v16
v_accvgpr_write_b32 a45, v17
v_accvgpr_write_b32 a46, v18
v_accvgpr_write_b32 a47, v19
v_accvgpr_read_b32 v16, a48
v_accvgpr_read_b32 v17, a49
v_accvgpr_read_b32 v18, a50
v_accvgpr_read_b32 v19, a51
v_mul_f32 v16, v16, v14
v_mul_f32 v17, v17, v14
v_mul_f32 v18, v18, v14
v_mul_f32 v19, v19, v14
v_accvgpr_write_b32 a48, v16
v_accvgpr_write_b32 a49, v17
v_accvgpr_write_b32 a50, v18
v_accvgpr_write_b32 a51, v19
v_accvgpr_read_b32 v16, a52
v_accvgpr_read_b32 v17, a53
v_accvgpr_read_b32 v18, a54
v_accvgpr_read_b32 v19, a55
v_mul_f32 v16, v16, v14
v_mul_f32 v17, v17, v14
v_mul_f32 v18, v18, v14
v_mul_f32 v19, v19, v14
v_accvgpr_write_b32 a52, v16
v_accvgpr_write_b32 a53, v17
v_accvgpr_write_b32 a54, v18
v_accvgpr_write_b32 a55, v19
v_accvgpr_read_b32 v16, a56
v_accvgpr_read_b32 v17, a57
v_accvgpr_read_b32 v18, a58
v_accvgpr_read_b32 v19, a59
v_mul_f32 v16, v16, v14
v_mul_f32 v17, v17, v14
v_mul_f32 v18, v18, v14
v_mul_f32 v19, v19, v14
v_accvgpr_write_b32 a56, v16
v_accvgpr_write_b32 a57, v17
v_accvgpr_write_b32 a58, v18
v_accvgpr_write_b32 a59, v19
v_accvgpr_read_b32 v16, a60
v_accvgpr_read_b32 v17, a61
v_accvgpr_read_b32 v18, a62
v_accvgpr_read_b32 v19, a63
v_mul_f32 v16, v16, v14
v_mul_f32 v17, v17, v14
v_mul_f32 v18, v18, v14
v_mul_f32 v19, v19, v14
v_accvgpr_write_b32 a60, v16
v_accvgpr_write_b32 a61, v17
v_accvgpr_write_b32 a62, v18
v_accvgpr_write_b32 a63, v19
v_sub_f32 v136, v136, v12
v_exp_f32_e64 v136, v136
v_sub_f32 v137, v137, v12
v_exp_f32_e64 v137, v137
v_sub_f32 v138, v138, v12
v_exp_f32_e64 v138, v138
v_sub_f32 v139, v139, v12
v_exp_f32_e64 v139, v139
v_sub_f32 v140, v140, v12
v_exp_f32_e64 v140, v140
v_sub_f32 v141, v141, v12
v_exp_f32_e64 v141, v141
v_sub_f32 v142, v142, v12
v_exp_f32_e64 v142, v142
v_sub_f32 v143, v143, v12
v_exp_f32_e64 v143, v143
s_nop 0
v_add_f32 v85, v85, v136
v_add_f32 v85, v85, v137
v_add_f32 v85, v85, v138
v_add_f32 v85, v85, v139
v_add_f32 v85, v85, v140
v_add_f32 v85, v85, v141
v_add_f32 v85, v85, v142
v_add_f32 v85, v85, v143
v_cvt_pk_bf16_f32 v136, v136, v137
v_cvt_pk_bf16_f32 v137, v138, v139
v_cvt_pk_bf16_f32 v138, v140, v141
v_cvt_pk_bf16_f32 v139, v142, v143
v_max3_f32 v12, v144, v145, v146
v_max3_f32 v12, v12, v147, v148
v_max3_f32 v12, v12, v149, v150
v_max_f32 v12, v12, v151
v_mov_b32 v13, v12
s_nop 1
v_permlane16_swap_b32 v12, v13
s_nop 1
v_max_f32 v12, v12, v13
v_mov_b32 v13, v12
s_nop 1
v_permlane32_swap_b32 v12, v13
s_nop 1
v_max_f32 v12, v12, v13
v_max_f32 v12, v12, v82
v_sub_f32 v14, v82, v12
v_exp_f32 v14, v14
v_mov_b32 v82, v12
v_mul_f32 v86, v86, v14
v_accvgpr_read_b32 v16, a64
v_accvgpr_read_b32 v17, a65
v_accvgpr_read_b32 v18, a66
v_accvgpr_read_b32 v19, a67
v_mul_f32 v16, v16, v14
v_mul_f32 v17, v17, v14
v_mul_f32 v18, v18, v14
v_mul_f32 v19, v19, v14
v_accvgpr_write_b32 a64, v16
v_accvgpr_write_b32 a65, v17
v_accvgpr_write_b32 a66, v18
v_accvgpr_write_b32 a67, v19
v_accvgpr_read_b32 v16, a68
v_accvgpr_read_b32 v17, a69
v_accvgpr_read_b32 v18, a70
v_accvgpr_read_b32 v19, a71
v_mul_f32 v16, v16, v14
v_mul_f32 v17, v17, v14
v_mul_f32 v18, v18, v14
v_mul_f32 v19, v19, v14
v_accvgpr_write_b32 a68, v16
v_accvgpr_write_b32 a69, v17
v_accvgpr_write_b32 a70, v18
v_accvgpr_write_b32 a71, v19
v_accvgpr_read_b32 v16, a72
v_accvgpr_read_b32 v17, a73
v_accvgpr_read_b32 v18, a74
v_accvgpr_read_b32 v19, a75
v_mul_f32 v16, v16, v14
v_mul_f32 v17, v17, v14
v_mul_f32 v18, v18, v14
v_mul_f32 v19, v19, v14
v_accvgpr_write_b32 a72, v16
v_accvgpr_write_b32 a73, v17
v_accvgpr_write_b32 a74, v18
v_accvgpr_write_b32 a75, v19
v_accvgpr_read_b32 v16, a76
v_accvgpr_read_b32 v17, a77
v_accvgpr_read_b32 v18, a78
v_accvgpr_read_b32 v19, a79
v_mul_f32 v16, v16, v14
v_mul_f32 v17, v17, v14
v_mul_f32 v18, v18, v14
v_mul_f32 v19, v19, v14
v_accvgpr_write_b32 a76, v16
v_accvgpr_write_b32 a77, v17
v_accvgpr_write_b32 a78, v18
v_accvgpr_write_b32 a79, v19
v_accvgpr_read_b32 v16, a80
v_accvgpr_read_b32 v17, a81
v_accvgpr_read_b32 v18, a82
v_accvgpr_read_b32 v19, a83
v_mul_f32 v16, v16, v14
v_mul_f32 v17, v17, v14
v_mul_f32 v18, v18, v14
v_mul_f32 v19, v19, v14
v_accvgpr_write_b32 a80, v16
v_accvgpr_write_b32 a81, v17
v_accvgpr_write_b32 a82, v18
v_accvgpr_write_b32 a83, v19
v_accvgpr_read_b32 v16, a84
v_accvgpr_read_b32 v17, a85
v_accvgpr_read_b32 v18, a86
v_accvgpr_read_b32 v19, a87
v_mul_f32 v16, v16, v14
v_mul_f32 v17, v17, v14
v_mul_f32 v18, v18, v14
v_mul_f32 v19, v19, v14
v_accvgpr_write_b32 a84, v16
v_accvgpr_write_b32 a85, v17
v_accvgpr_write_b32 a86, v18
v_accvgpr_write_b32 a87, v19
v_accvgpr_read_b32 v16, a88
v_accvgpr_read_b32 v17, a89
v_accvgpr_read_b32 v18, a90
v_accvgpr_read_b32 v19, a91
v_mul_f32 v16, v16, v14
v_mul_f32 v17, v17, v14
v_mul_f32 v18, v18, v14
v_mul_f32 v19, v19, v14
v_accvgpr_write_b32 a88, v16
v_accvgpr_write_b32 a89, v17
v_accvgpr_write_b32 a90, v18
v_accvgpr_write_b32 a91, v19
v_accvgpr_read_b32 v16, a92
v_accvgpr_read_b32 v17, a93
v_accvgpr_read_b32 v18, a94
v_accvgpr_read_b32 v19, a95
v_mul_f32 v16, v16, v14
v_mul_f32 v17, v17, v14
v_mul_f32 v18, v18, v14
v_mul_f32 v19, v19, v14
v_accvgpr_write_b32 a92, v16
v_accvgpr_write_b32 a93, v17
v_accvgpr_write_b32 a94, v18
v_accvgpr_write_b32 a95, v19
v_sub_f32 v144, v144, v12
v_exp_f32_e64 v144, v144
v_sub_f32 v145, v145, v12
v_exp_f32_e64 v145, v145
v_sub_f32 v146, v146, v12
v_exp_f32_e64 v146, v146
v_sub_f32 v147, v147, v12
v_exp_f32_e64 v147, v147
v_sub_f32 v148, v148, v12
v_exp_f32_e64 v148, v148
v_sub_f32 v149, v149, v12
v_exp_f32_e64 v149, v149
v_sub_f32 v150, v150, v12
v_exp_f32_e64 v150, v150
v_sub_f32 v151, v151, v12
v_exp_f32_e64 v151, v151
s_nop 0
v_add_f32 v86, v86, v144
v_add_f32 v86, v86, v145
v_add_f32 v86, v86, v146
v_add_f32 v86, v86, v147
v_add_f32 v86, v86, v148
v_add_f32 v86, v86, v149
v_add_f32 v86, v86, v150
v_add_f32 v86, v86, v151
v_cvt_pk_bf16_f32 v144, v144, v145
v_cvt_pk_bf16_f32 v145, v146, v147
v_cvt_pk_bf16_f32 v146, v148, v149
v_cvt_pk_bf16_f32 v147, v150, v151
v_max3_f32 v12, v152, v153, v154
v_max3_f32 v12, v12, v155, v156
v_max3_f32 v12, v12, v157, v158
v_max_f32 v12, v12, v159
v_mov_b32 v13, v12
s_nop 1
v_permlane16_swap_b32 v12, v13
s_nop 1
v_max_f32 v12, v12, v13
v_mov_b32 v13, v12
s_nop 1
v_permlane32_swap_b32 v12, v13
s_nop 1
v_max_f32 v12, v12, v13
v_max_f32 v12, v12, v83
v_sub_f32 v14, v83, v12
v_exp_f32 v14, v14
v_mov_b32 v83, v12
v_mul_f32 v87, v87, v14
v_accvgpr_read_b32 v16, a96
v_accvgpr_read_b32 v17, a97
v_accvgpr_read_b32 v18, a98
v_accvgpr_read_b32 v19, a99
v_mul_f32 v16, v16, v14
v_mul_f32 v17, v17, v14
v_mul_f32 v18, v18, v14
v_mul_f32 v19, v19, v14
v_accvgpr_write_b32 a96, v16
v_accvgpr_write_b32 a97, v17
v_accvgpr_write_b32 a98, v18
v_accvgpr_write_b32 a99, v19
v_accvgpr_read_b32 v16, a100
v_accvgpr_read_b32 v17, a101
v_accvgpr_read_b32 v18, a102
v_accvgpr_read_b32 v19, a103
v_mul_f32 v16, v16, v14
v_mul_f32 v17, v17, v14
v_mul_f32 v18, v18, v14
v_mul_f32 v19, v19, v14
v_accvgpr_write_b32 a100, v16
v_accvgpr_write_b32 a101, v17
v_accvgpr_write_b32 a102, v18
v_accvgpr_write_b32 a103, v19
v_accvgpr_read_b32 v16, a104
v_accvgpr_read_b32 v17, a105
v_accvgpr_read_b32 v18, a106
v_accvgpr_read_b32 v19, a107
v_mul_f32 v16, v16, v14
v_mul_f32 v17, v17, v14
v_mul_f32 v18, v18, v14
v_mul_f32 v19, v19, v14
v_accvgpr_write_b32 a104, v16
v_accvgpr_write_b32 a105, v17
v_accvgpr_write_b32 a106, v18
v_accvgpr_write_b32 a107, v19
v_accvgpr_read_b32 v16, a108
v_accvgpr_read_b32 v17, a109
v_accvgpr_read_b32 v18, a110
v_accvgpr_read_b32 v19, a111
v_mul_f32 v16, v16, v14
v_mul_f32 v17, v17, v14
v_mul_f32 v18, v18, v14
v_mul_f32 v19, v19, v14
v_accvgpr_write_b32 a108, v16
v_accvgpr_write_b32 a109, v17
v_accvgpr_write_b32 a110, v18
v_accvgpr_write_b32 a111, v19
v_accvgpr_read_b32 v16, a112
v_accvgpr_read_b32 v17, a113
v_accvgpr_read_b32 v18, a114
v_accvgpr_read_b32 v19, a115
v_mul_f32 v16, v16, v14
v_mul_f32 v17, v17, v14
v_mul_f32 v18, v18, v14
v_mul_f32 v19, v19, v14
v_accvgpr_write_b32 a112, v16
v_accvgpr_write_b32 a113, v17
v_accvgpr_write_b32 a114, v18
v_accvgpr_write_b32 a115, v19
v_accvgpr_read_b32 v16, a116
v_accvgpr_read_b32 v17, a117
v_accvgpr_read_b32 v18, a118
v_accvgpr_read_b32 v19, a119
v_mul_f32 v16, v16, v14
v_mul_f32 v17, v17, v14
v_mul_f32 v18, v18, v14
v_mul_f32 v19, v19, v14
v_accvgpr_write_b32 a116, v16
v_accvgpr_write_b32 a117, v17
v_accvgpr_write_b32 a118, v18
v_accvgpr_write_b32 a119, v19
v_accvgpr_read_b32 v16, a120
v_accvgpr_read_b32 v17, a121
v_accvgpr_read_b32 v18, a122
v_accvgpr_read_b32 v19, a123
v_mul_f32 v16, v16, v14
v_mul_f32 v17, v17, v14
v_mul_f32 v18, v18, v14
v_mul_f32 v19, v19, v14
v_accvgpr_write_b32 a120, v16
v_accvgpr_write_b32 a121, v17
v_accvgpr_write_b32 a122, v18
v_accvgpr_write_b32 a123, v19
v_accvgpr_read_b32 v16, a124
v_accvgpr_read_b32 v17, a125
v_accvgpr_read_b32 v18, a126
v_accvgpr_read_b32 v19, a127
v_mul_f32 v16, v16, v14
v_mul_f32 v17, v17, v14
v_mul_f32 v18, v18, v14
v_mul_f32 v19, v19, v14
v_accvgpr_write_b32 a124, v16
v_accvgpr_write_b32 a125, v17
v_accvgpr_write_b32 a126, v18
v_accvgpr_write_b32 a127, v19
v_sub_f32 v152, v152, v12
v_exp_f32_e64 v152, v152
v_sub_f32 v153, v153, v12
v_exp_f32_e64 v153, v153
v_sub_f32 v154, v154, v12
v_exp_f32_e64 v154, v154
v_sub_f32 v155, v155, v12
v_exp_f32_e64 v155, v155
v_sub_f32 v156, v156, v12
v_exp_f32_e64 v156, v156
v_sub_f32 v157, v157, v12
v_exp_f32_e64 v157, v157
v_sub_f32 v158, v158, v12
v_exp_f32_e64 v158, v158
v_sub_f32 v159, v159, v12
v_exp_f32_e64 v159, v159
s_nop 0
v_add_f32 v87, v87, v152
v_add_f32 v87, v87, v153
v_add_f32 v87, v87, v154
v_add_f32 v87, v87, v155
v_add_f32 v87, v87, v156
v_add_f32 v87, v87, v157
v_add_f32 v87, v87, v158
v_add_f32 v87, v87, v159
v_cvt_pk_bf16_f32 v152, v152, v153
v_cvt_pk_bf16_f32 v153, v154, v155
v_cvt_pk_bf16_f32 v154, v156, v157
v_cvt_pk_bf16_f32 v155, v158, v159
s_nop 1
v_mfma_f32_16x16x32_bf16 a[0:3], a[224:227], v[128:131], a[0:3]
v_mfma_f32_16x16x32_bf16 a[32:35], a[224:227], v[136:139], a[32:35]
v_mfma_f32_16x16x32_bf16 a[64:67], a[224:227], v[144:147], a[64:67]
v_mfma_f32_16x16x32_bf16 a[96:99], a[224:227], v[152:155], a[96:99]
v_mfma_f32_16x16x32_bf16 a[4:7], a[228:231], v[128:131], a[4:7]
v_mfma_f32_16x16x32_bf16 a[36:39], a[228:231], v[136:139], a[36:39]
v_mfma_f32_16x16x32_bf16 a[68:71], a[228:231], v[144:147], a[68:71]
v_mfma_f32_16x16x32_bf16 a[100:103], a[228:231], v[152:155], a[100:103]
v_mfma_f32_16x16x32_bf16 a[8:11], a[232:235], v[128:131], a[8:11]
v_mfma_f32_16x16x32_bf16 a[40:43], a[232:235], v[136:139], a[40:43]
v_mfma_f32_16x16x32_bf16 a[72:75], a[232:235], v[144:147], a[72:75]
v_mfma_f32_16x16x32_bf16 a[104:107], a[232:235], v[152:155], a[104:107]
v_mfma_f32_16x16x32_bf16 a[12:15], a[236:239], v[128:131], a[12:15]
v_mfma_f32_16x16x32_bf16 a[44:47], a[236:239], v[136:139], a[44:47]
v_mfma_f32_16x16x32_bf16 a[76:79], a[236:239], v[144:147], a[76:79]
v_mfma_f32_16x16x32_bf16 a[108:111], a[236:239], v[152:155], a[108:111]
v_mfma_f32_16x16x32_bf16 a[16:19], a[240:243], v[128:131], a[16:19]
v_mfma_f32_16x16x32_bf16 a[48:51], a[240:243], v[136:139], a[48:51]
v_mfma_f32_16x16x32_bf16 a[80:83], a[240:243], v[144:147], a[80:83]
v_mfma_f32_16x16x32_bf16 a[112:115], a[240:243], v[152:155], a[112:115]
v_mfma_f32_16x16x32_bf16 a[20:23], a[244:247], v[128:131], a[20:23]
v_mfma_f32_16x16x32_bf16 a[52:55], a[244:247], v[136:139], a[52:55]
v_mfma_f32_16x16x32_bf16 a[84:87], a[244:247], v[144:147], a[84:87]
v_mfma_f32_16x16x32_bf16 a[116:119], a[244:247], v[152:155], a[116:119]
v_mfma_f32_16x16x32_bf16 a[24:27], a[248:251], v[128:131], a[24:27]
v_mfma_f32_16x16x32_bf16 a[56:59], a[248:251], v[136:139], a[56:59]
v_mfma_f32_16x16x32_bf16 a[88:91], a[248:251], v[144:147], a[88:91]
v_mfma_f32_16x16x32_bf16 a[120:123], a[248:251], v[152:155], a[120:123]
v_mfma_f32_16x16x32_bf16 a[28:31], a[252:255], v[128:131], a[28:31]
v_mfma_f32_16x16x32_bf16 a[60:63], a[252:255], v[136:139], a[60:63]
v_mfma_f32_16x16x32_bf16 a[92:95], a[252:255], v[144:147], a[92:95]
v_mfma_f32_16x16x32_bf16 a[124:127], a[252:255], v[152:155], a[124:127]
s_nop 7
s_nop 7
s_sub_u32 s27, s27, 1
s_cmp_lg_u32 s27, 0
s_cbranch_scc1 L_fb_loop
v_mov_b32 v12, v84
v_mov_b32 v13, v12
s_nop 1
v_permlane16_swap_b32 v12, v13
s_nop 1
v_add_f32 v12, v12, v13
v_mov_b32 v13, v12
s_nop 1
v_permlane32_swap_b32 v12, v13
s_nop 1
v_add_f32 v12, v12, v13
v_mov_b32 v112, v12
v_mov_b32 v12, v85
v_mov_b32 v13, v12
s_nop 1
v_permlane16_swap_b32 v12, v13
s_nop 1
v_add_f32 v12, v12, v13
v_mov_b32 v13, v12
s_nop 1
v_permlane32_swap_b32 v12, v13
s_nop 1
v_add_f32 v12, v12, v13
v_mov_b32 v116, v12
v_mov_b32 v12, v86
v_mov_b32 v13, v12
s_nop 1
v_permlane16_swap_b32 v12, v13
s_nop 1
v_add_f32 v12, v12, v13
v_mov_b32 v13, v12
s_nop 1
v_permlane32_swap_b32 v12, v13
s_nop 1
v_add_f32 v12, v12, v13
v_mov_b32 v120, v12
v_mov_b32 v12, v87
v_mov_b32 v13, v12
s_nop 1
v_permlane16_swap_b32 v12, v13
s_nop 1
v_add_f32 v12, v12, v13
v_mov_b32 v13, v12
s_nop 1
v_permlane32_swap_b32 v12, v13
s_nop 1
v_add_f32 v12, v12, v13
v_mov_b32 v124, v12
s_mul_i32 s30, s24, 9216
s_barrier
s_add_u32 m0, s93, 0
s_add_u32 s3, s92, 0
buffer_load_dwordx4 v52, s[16:19], s3 offen offset:0 lds
s_add_u32 m0, s93, 0
s_add_u32 s3, s92, 0
buffer_load_dwordx4 v53, s[16:19], s3 offen offset:1024 lds
s_add_u32 m0, s93, 0
s_add_u32 s3, s92, 0
buffer_load_dwordx4 v54, s[16:19], s3 offen offset:2048 lds
s_add_u32 m0, s93, 0
s_add_u32 s3, s92, 0
buffer_load_dwordx4 v55, s[16:19], s3 offen offset:3072 lds
s_add_u32 m0, s93, 4096
s_add_u32 s3, s92, 0
buffer_load_dwordx4 v56, s[16:19], s3 offen offset:0 lds
s_add_u32 m0, s93, 4096
s_add_u32 s3, s92, 0
buffer_load_dwordx4 v57, s[16:19], s3 offen offset:1024 lds
s_add_u32 m0, s93, 4096
s_add_u32 s3, s92, 0
buffer_load_dwordx4 v58, s[16:19], s3 offen offset:2048 lds
s_add_u32 m0, s93, 4096
s_add_u32 s3, s92, 0
buffer_load_dwordx4 v59, s[16:19], s3 offen offset:3072 lds
s_add_u32 m0, s93, 8192
s_add_u32 s3, s92, 0
buffer_load_dwordx4 v60, s[16:19], s3 offen offset:0 lds
s_add_u32 s3, s94, 0
buffer_load_dwordx4 a[192:195], v11, s[12:15], s3 offen
s_add_u32 s3, s94, 18432
buffer_load_dwordx4 a[196:199], v11, s[12:15], s3 offen
s_add_u32 s3, s94, 36864
buffer_load_dwordx4 a[200:203], v11, s[12:15], s3 offen
s_add_u32 s3, s94, 55296
buffer_load_dwordx4 a[204:207], v11, s[12:15], s3 offen
s_add_u32 s3, s94, 1024
buffer_load_dwordx4 a[208:211], v11, s[12:15], s3 offen
s_add_u32 s3, s94, 19456
buffer_load_dwordx4 a[212:215], v11, s[12:15], s3 offen
s_add_u32 s3, s94, 37888
buffer_load_dwordx4 a[216:219], v11, s[12:15], s3 offen
s_add_u32 s3, s94, 56320
buffer_load_dwordx4 a[220:223], v11, s[12:15], s3 offen
s_waitcnt vmcnt(0)
s_branch L_att_epi
L_code_end:
.section .rodata,"a"
.p2align 6
.amdhsa_kernel recurrent_scan__mha_block_cached__mixer_s_mlp__prompt_kernel
  .amdhsa_next_free_vgpr 512
  .amdhsa_next_free_sgpr 102
  .amdhsa_accum_offset 256
  .amdhsa_group_segment_fixed_size 0
  .amdhsa_kernarg_size 104
  .amdhsa_user_sgpr_count 2
  .amdhsa_user_sgpr_kernarg_segment_ptr 1
  .amdhsa_system_sgpr_workgroup_id_x 1
  .amdhsa_float_denorm_mode_32 3
.end_amdhsa_kernel
```
